```python
import torch

def _softmax(x, axis=-1):
    return torch.softmax(x, dim=axis)
def _gelu(x):
    return torch.nn.functional.gelu(x, approximate="tanh")
def _silu(x):
    return torch.nn.functional.silu(x)
def _sigmoid(x):
    return torch.sigmoid(x)
def _layernorm(x, axis=-1, eps=1e-5):
    m = x.mean(dim=axis, keepdim=True)
    v = x.var(dim=axis, keepdim=True, unbiased=False)
    return (x - m) / torch.sqrt(v + eps)
def _scatter_add(tgt, idx, src, axis=0):
    return tgt.clone().index_add_(axis, idx, src)
def _segment_sum(src, seg, n):
    out = torch.zeros((n,) + src.shape[1:], dtype=src.dtype)
    return out.index_add_(0, seg, src)
def _pad(x, pw):
    flat = tuple(v for pair in reversed(pw) for v in pair)
    return torch.nn.functional.pad(x, flat)

kernel_name = 'concat_heads__gqa_block_cached__gqa_block_cached__near_ridge'

def setup_inputs():

    _w = (lambda a: (lambda t: t.to(torch.bfloat16) if t.is_floating_point() else t)(torch.as_tensor(a)))
    def _A_setup():
        B, Sq, D = 8, 144, 640
        Hq, Hkv, Sk, Dh = 32, 32, 512, 192
        assert Hq % Hkv == 0, (Hq, Hkv)
        return {
            "x": _w((lambda *s: torch.randn(*s, dtype=torch.bfloat16) * 0.8)(B, Sq, D)),
            "k_cache": _w((lambda *s: torch.randn(*s, dtype=torch.bfloat16) * 0.8)(B, Hkv, Sk, Dh)),
            "v_cache": _w((lambda *s: torch.randn(*s, dtype=torch.bfloat16) * 0.05)(B, Hkv, Sk, Dh)),
            "wq": _w((lambda *s: torch.randn(*s, dtype=torch.bfloat16) * 0.8)(D, Hq * Dh) * (D ** -0.5)),
            "wo": _w((lambda *s: torch.randn(*s, dtype=torch.bfloat16) * 0.05)(Hq * Dh, D) * ((Hq * Dh) ** -0.5)),
        }
    _A_in = _A_setup()

    def _B_setup():
        B, Sq, D = 8, 144, 640
        Hq, Hkv, Sk, Dh = 32, 32, 512, 192
        assert Hq % Hkv == 0, (Hq, Hkv)
        return {
            "x": _w((lambda *s: torch.randn(*s, dtype=torch.bfloat16) * 0.8)(B, Sq, D)),
            "k_cache": _w((lambda *s: torch.randn(*s, dtype=torch.bfloat16) * 0.8)(B, Hkv, Sk, Dh)),
            "v_cache": _w((lambda *s: torch.randn(*s, dtype=torch.bfloat16) * 0.05)(B, Hkv, Sk, Dh)),
            "wq": _w((lambda *s: torch.randn(*s, dtype=torch.bfloat16) * 0.8)(D, Hq * Dh) * (D ** -0.5)),
            "wo": _w((lambda *s: torch.randn(*s, dtype=torch.bfloat16) * 0.05)(Hq * Dh, D) * ((Hq * Dh) ** -0.5)),
        }
    _B_in = _B_setup()

    return {
        "A_x": _A_in["x"],
        "A_k_cache": _A_in["k_cache"],
        "A_v_cache": _A_in["v_cache"],
        "A_wq": _A_in["wq"],
        "A_wo": _A_in["wo"],
        "B_x": _B_in["x"],
        "B_k_cache": _B_in["k_cache"],
        "B_v_cache": _B_in["v_cache"],
        "B_wq": _B_in["wq"],
        "B_wo": _B_in["wo"],
    }

def reference(A_x, A_k_cache, A_v_cache, A_wq, A_wo, B_x, B_k_cache, B_v_cache, B_wq, B_wo):
    def _A_ref(x, k_cache, v_cache, wq, wo):
        B, Sq, D = x.shape
        Hq, Dh = 32, 192
        Hkv = k_cache.shape[1]
        rep = Hq // Hkv
        q = (lambda x, *d: x.permute(*d))((x @ wq).reshape(B, Sq, Hq, Dh), 0, 2, 1, 3)
        k = (lambda x, n, axis: torch.repeat_interleave(x, n, dim=axis))(k_cache, rep, axis=1)
        v = (lambda x, n, axis: torch.repeat_interleave(x, n, dim=axis))(v_cache, rep, axis=1)
        scores = torch.einsum("bhqd,bhkd->bhqk", q, k) * (Dh ** -0.5)
        p = _softmax(scores, axis=-1)
        o = torch.einsum("bhqk,bhkd->bhqd", p, v)
        return (lambda x, *d: x.permute(*d))(o, 0, 2, 1, 3).reshape(B, Sq, Hq * Dh) @ wo

    def _B_ref(x, k_cache, v_cache, wq, wo):
        B, Sq, D = x.shape
        Hq, Dh = 32, 192
        Hkv = k_cache.shape[1]
        rep = Hq // Hkv
        q = (lambda x, *d: x.permute(*d))((x @ wq).reshape(B, Sq, Hq, Dh), 0, 2, 1, 3)
        k = (lambda x, n, axis: torch.repeat_interleave(x, n, dim=axis))(k_cache, rep, axis=1)
        v = (lambda x, n, axis: torch.repeat_interleave(x, n, dim=axis))(v_cache, rep, axis=1)
        scores = torch.einsum("bhqd,bhkd->bhqk", q, k) * (Dh ** -0.5)
        p = _softmax(scores, axis=-1)
        o = torch.einsum("bhqk,bhkd->bhqd", p, v)
        return (lambda x, *d: x.permute(*d))(o, 0, 2, 1, 3).reshape(B, Sq, Hq * Dh) @ wo

    a = _A_ref(A_x, A_k_cache, A_v_cache, A_wq, A_wo)
    b = _B_ref(B_x, B_k_cache, B_v_cache, B_wq, B_wo)
    return torch.concatenate([a, b], axis=-1)
```

```asm
; @launch kernel=concat_heads__gqa_block_cached__gqa_block_cached__near_ridge_kernel grid=(256,1,1) block=(256,1,1) lds=163840
; @launch kernel=reduce_kernel grid=(256,1,1) block=(320,1,1) lds=0
.amdgcn_target "amdgcn-amd-amdhsa--gfx950"
.text
.globl concat_heads__gqa_block_cached__gqa_block_cached__near_ridge_kernel
.p2align 8
.type concat_heads__gqa_block_cached__gqa_block_cached__near_ridge_kernel,@function
concat_heads__gqa_block_cached__gqa_block_cached__near_ridge_kernel:
s_cmp_ge_u32 s2, 0x100
s_cbranch_scc1 L_end
s_getpc_b64 s[4:5]
L_pc:
s_lshr_b32 s3, s2, 3
s_lshl_b32 s3, s3, 12
v_lshl_add_u32 v104, v0, 4, s3
v_min_u32 v104, L_end2-L_pc-16, v104
global_load_dwordx4 v[104:107], v104, s[4:5]
s_load_dwordx8 s[40:47], s[0:1], 0
s_load_dwordx2 s[48:49], s[0:1], 32
s_load_dwordx2 s[50:51], s[0:1], 40
s_load_dwordx4 s[52:55], s[0:1], 48
s_load_dwordx4 s[56:59], s[0:1], 64
s_load_dwordx2 s[60:61], s[0:1], 88
s_load_dwordx2 s[62:63], s[0:1], 96
v_lshrrev_b32 v1, 6, v0
s_and_b32 s97, s2, 3
s_bfe_u32 s96, s2, 0x10002
s_bfe_u32 s98, s2, 0x30003
s_lshr_b32 s99, s2, 6
v_readfirstlane_b32 s32, v1
s_lshl_b32 s100, s97, 2
s_add_u32 s100, s100, s99
s_mul_i32 s37, s98, 5
s_lshr_b32 s37, s37, 1
s_mul_i32 s101, s99, 5
s_add_u32 s37, s37, s101
s_cmp_ge_u32 s37, 20
s_cselect_b32 s101, 20, 0
s_sub_u32 s37, s37, s101
s_lshl_b32 s37, s37, 6
s_mul_i32 s33, s32, 6144
s_mul_i32 s34, s32, 3072
s_lshl_b32 s35, s32, 11
s_mul_i32 s36, s32, 5120
v_and_b32 v0, 63, v0
v_or_b32 v1, 0, v1
v_or_b32 v2, 0, v0
v_mul_u32_u24 v3, 0xaab, v2
v_lshrrev_b32 v3, 16, v3
v_mul_u32_u24 v4, 24, v3
v_subrev_u32 v4, v4, v2
v_and_b32 v5, 2, v3
v_lshlrev_b32 v5, 1, v5
v_and_b32 v6, 1, v1
v_lshlrev_b32 v6, 1, v6
v_or_b32 v5, v5, v6
v_lshlrev_b32 v7, 3, v1
v_add_u32 v7, v7, v3
v_mul_u32_u24 v7, 0x3000, v7
v_xor_b32 v4, v4, v5
v_lshlrev_b32 v4, 4, v4
v_add_u32 v7, v7, v4
v_subrev_u32 v229, 0, v7
v_add_u32 v8, 64, v0
v_or_b32 v8, 0, v8
v_mul_u32_u24 v9, 0xaab, v8
v_lshrrev_b32 v9, 16, v9
v_mul_u32_u24 v10, 24, v9
v_subrev_u32 v10, v10, v8
v_and_b32 v11, 2, v9
v_lshlrev_b32 v11, 1, v11
v_and_b32 v12, 1, v1
v_lshlrev_b32 v12, 1, v12
v_or_b32 v11, v11, v12
v_lshlrev_b32 v13, 3, v1
v_add_u32 v13, v13, v9
v_mul_u32_u24 v13, 0x3000, v13
v_xor_b32 v10, v10, v11
v_lshlrev_b32 v10, 4, v10
v_add_u32 v13, v13, v10
v_subrev_u32 v230, 0x400, v13
v_add_u32 v14, 0x80, v0
v_or_b32 v14, 0, v14
v_mul_u32_u24 v15, 0xaab, v14
v_lshrrev_b32 v15, 16, v15
v_mul_u32_u24 v16, 24, v15
v_subrev_u32 v16, v16, v14
v_and_b32 v17, 2, v15
v_lshlrev_b32 v17, 1, v17
v_and_b32 v18, 1, v1
v_lshlrev_b32 v18, 1, v18
v_or_b32 v17, v17, v18
v_lshlrev_b32 v19, 3, v1
v_add_u32 v19, v19, v15
v_mul_u32_u24 v19, 0x3000, v19
v_xor_b32 v16, v16, v17
v_lshlrev_b32 v16, 4, v16
v_add_u32 v19, v19, v16
v_subrev_u32 v231, 0x800, v19
v_and_b32 v20, 3, v0
v_lshrrev_b32 v21, 4, v0
v_and_b32 v21, 3, v21
v_xor_b32 v20, v20, v21
v_lshlrev_b32 v20, 4, v20
v_lshlrev_b32 v22, 5, v1
v_lshrrev_b32 v23, 2, v0
v_add_u32 v22, v22, v23
v_mul_u32_u24 v22, 0x500, v22
v_add_u32 v232, v22, v20
v_add_u32 v233, 0x4c00, v232
v_lshrrev_b32 v25, 2, v0
v_mul_u32_u24 v25, 0x500, v25
v_add_u32 v25, v25, v20
v_add_u32 v234, 0x28000, v25
s_waitcnt lgkmcnt(0)
s_cmp_eq_u32 s96, 0
s_cselect_b64 s[40:41], s[40:41], s[50:51]
s_cselect_b64 s[42:43], s[42:43], s[52:53]
s_cselect_b64 s[44:45], s[44:45], s[54:55]
s_cselect_b64 s[46:47], s[46:47], s[56:57]
s_cselect_b64 s[48:49], s[48:49], s[58:59]
s_mul_i32 s101, s100, 384
s_add_u32 s12, s46, s101
s_addc_u32 s13, s47, 0
s_sub_u32 s14, 0x780000, s101
s_mov_b32 s15, 0x20000
s_mul_i32 s101, s98, 184320
s_add_u32 s16, s40, s101
s_addc_u32 s17, s41, 0
s_sub_u32 s18, 0x168000, s101
s_mov_b32 s19, 0x20000
s_lshl_b32 s101, s98, 5
s_add_u32 s101, s101, s100
s_mul_i32 s101, s101, 196608
s_add_u32 s4, s42, s101
s_addc_u32 s5, s43, 0
s_sub_u32 s6, 0x3000000, s101
s_mov_b32 s7, 0x20000
s_add_u32 s8, s44, s101
s_addc_u32 s9, s45, 0
s_sub_u32 s10, 0x3000000, s101
s_mov_b32 s11, 0x20000
s_mul_i32 s101, s99, 320
s_add_u32 s20, s48, s101
s_addc_u32 s21, s49, 0
s_sub_u32 s22, 0x780000, s101
s_mov_b32 s23, 0x20000
s_mov_b32 s24, s62
s_mov_b32 s25, s63
s_mov_b32 s26, 0x10000000
s_mov_b32 s27, 0x20000
s_mov_b32 s28, s60
s_mov_b32 s29, s61
s_mov_b32 s30, 0x100
s_mov_b32 s31, 0x20000
s_mov_b32 s63, s2
s_lshl_b32 s101, s32, 4
s_mov_b64 s[42:43], 0xffff
s_lshl_b64 s[42:43], s[42:43], s101
s_add_u32 m0, s34, 0x18000
s_mul_i32 s38, s37, 6144
buffer_load_dwordx4 v229, s[12:15], s38 offen offset:0 lds
buffer_load_dwordx4 v230, s[12:15], s38 offen offset:1024 lds
buffer_load_dwordx4 v231, s[12:15], s38 offen offset:2048 lds
s_add_u32 m0, s35, 0x1b000
s_nop 0
buffer_load_dwordx4 v232, s[16:19], s37 offen lds
buffer_load_dwordx4 v233, s[16:19], s37 offen offset:1024 lds
s_mov_b32 m0, 0x1d000
s_mov_b64 exec, s[42:43]
buffer_load_dwordx4 v234, s[16:19], s37 offen lds
s_mov_b64 exec, -1
s_add_u32 m0, s34, 0x1d400
s_add_u32 s37, s37, 64
s_cmp_eq_u32 s37, 0x500
s_cselect_b32 s37, 0, s37
s_mul_i32 s38, s37, 6144
buffer_load_dwordx4 v229, s[12:15], s38 offen offset:0 lds
buffer_load_dwordx4 v230, s[12:15], s38 offen offset:1024 lds
buffer_load_dwordx4 v231, s[12:15], s38 offen offset:2048 lds
s_add_u32 m0, s35, 0x20400
s_nop 0
buffer_load_dwordx4 v232, s[16:19], s37 offen lds
buffer_load_dwordx4 v233, s[16:19], s37 offen offset:1024 lds
s_mov_b32 m0, 0x22400
s_mov_b64 exec, s[42:43]
buffer_load_dwordx4 v234, s[16:19], s37 offen lds
s_mov_b64 exec, -1
v_lshrrev_b32 v26, 2, v0
v_and_b32 v26, 3, v26
v_and_b32 v27, 3, v0
v_lshrrev_b32 v28, 5, v0
v_lshrrev_b32 v29, 4, v0
v_and_b32 v30, 1, v29
v_and_b32 v31, 15, v0
v_and_b32 v32, 31, v0
v_lshlrev_b32 v33, 3, v28
v_add_u32 v33, v33, v26
v_mul_u32_u24 v33, 0x180, v33
v_lshlrev_b32 v34, 1, v30
v_and_b32 v35, 1, v27
v_add_u32 v34, v34, v35
v_and_b32 v36, 2, v26
v_lshlrev_b32 v36, 1, v36
v_lshlrev_b32 v37, 1, v28
v_or_b32 v36, v36, v37
v_xor_b32 v34, v34, v36
v_lshlrev_b32 v34, 4, v34
v_add_u32 v33, v33, v34
v_lshrrev_b32 v38, 1, v27
v_lshlrev_b32 v38, 3, v38
v_add_u32 v33, v33, v38
v_add_u32 v235, 0x18000, v33
v_lshlrev_b32 v39, 3, v28
v_add_u32 v39, v39, v26
v_mul_u32_u24 v39, 0x180, v39
v_lshlrev_b32 v6, 1, v30
v_and_b32 v5, 1, v27
v_add_u32 v6, v6, v5
v_add_u32 v6, 4, v6
v_and_b32 v4, 2, v26
v_lshlrev_b32 v4, 1, v4
v_lshlrev_b32 v7, 1, v28
v_or_b32 v4, v4, v7
v_xor_b32 v6, v6, v4
v_lshlrev_b32 v6, 4, v6
v_add_u32 v39, v39, v6
v_lshrrev_b32 v2, 1, v27
v_lshlrev_b32 v2, 3, v2
v_add_u32 v39, v39, v2
v_add_u32 v236, 0x18000, v39
v_lshlrev_b32 v3, 3, v29
v_add_u32 v3, v3, v26
v_mul_u32_u24 v3, 0x180, v3
v_mul_u32_u24 v12, 3, v1
v_lshlrev_b32 v12, 1, v12
v_lshrrev_b32 v11, 1, v27
v_add_u32 v12, v12, v11
v_and_b32 v10, 2, v26
v_lshlrev_b32 v10, 1, v10
v_lshlrev_b32 v13, 1, v30
v_or_b32 v10, v10, v13
v_xor_b32 v12, v12, v10
v_lshlrev_b32 v12, 4, v12
v_add_u32 v3, v3, v12
v_and_b32 v8, 1, v27
v_lshlrev_b32 v8, 3, v8
v_add_u32 v3, v3, v8
v_add_u32 v237, 0x18000, v3
v_lshlrev_b32 v9, 3, v29
v_add_u32 v9, v9, v26
v_mul_u32_u24 v9, 0x180, v9
v_mul_u32_u24 v18, 3, v1
v_add_u32 v18, 1, v18
v_lshlrev_b32 v18, 1, v18
v_lshrrev_b32 v17, 1, v27
v_add_u32 v18, v18, v17
v_and_b32 v16, 2, v26
v_lshlrev_b32 v16, 1, v16
v_lshlrev_b32 v19, 1, v30
v_or_b32 v16, v16, v19
v_xor_b32 v18, v18, v16
v_lshlrev_b32 v18, 4, v18
v_add_u32 v9, v9, v18
v_and_b32 v14, 1, v27
v_lshlrev_b32 v14, 3, v14
v_add_u32 v9, v9, v14
v_add_u32 v238, 0x18000, v9
v_lshlrev_b32 v15, 3, v29
v_add_u32 v15, v15, v26
v_mul_u32_u24 v15, 0x180, v15
v_mul_u32_u24 v21, 3, v1
v_add_u32 v21, 2, v21
v_lshlrev_b32 v21, 1, v21
v_lshrrev_b32 v23, 1, v27
v_add_u32 v21, v21, v23
v_and_b32 v22, 2, v26
v_lshlrev_b32 v22, 1, v22
v_lshlrev_b32 v24, 1, v30
v_or_b32 v22, v22, v24
v_xor_b32 v21, v21, v22
v_lshlrev_b32 v21, 4, v21
v_add_u32 v15, v15, v21
v_and_b32 v25, 1, v27
v_lshlrev_b32 v25, 3, v25
v_add_u32 v15, v15, v25
v_add_u32 v239, 0x18000, v15
v_lshlrev_b32 v20, 6, v32
v_or_b32 v35, 0, v28
v_lshrrev_b32 v37, 2, v32
v_and_b32 v37, 3, v37
v_xor_b32 v35, v35, v37
v_lshlrev_b32 v35, 4, v35
v_add_u32 v20, v20, v35
v_add_u32 v20, s35, v20
v_add_u32 v240, 0x1b000, v20
v_lshlrev_b32 v36, 6, v32
v_add_u32 v34, 2, v28
v_or_b32 v34, 0, v34
v_lshrrev_b32 v38, 2, v32
v_and_b32 v38, 3, v38
v_xor_b32 v34, v34, v38
v_lshlrev_b32 v34, 4, v34
v_add_u32 v36, v36, v34
v_add_u32 v36, s35, v36
v_add_u32 v241, 0x1b000, v36
v_lshlrev_b32 v33, 6, v31
v_lshrrev_b32 v5, 2, v31
v_xor_b32 v5, v29, v5
v_lshlrev_b32 v5, 4, v5
v_add_u32 v33, v33, v5
v_add_u32 v242, 0x1d000, v33
v_subrev_u32 v72, 0x18000, v235
v_subrev_u32 v73, 0x18000, v236
v_subrev_u32 v74, 0x18000, v237
v_subrev_u32 v75, 0x18000, v238
v_subrev_u32 v76, 0x18000, v239
v_subrev_u32 v77, 0x18000, v240
v_subrev_u32 v78, 0x18000, v241
v_subrev_u32 v79, 0x18000, v242
v_subrev_u32 v192, 0xc000, v235
v_subrev_u32 v193, 0xc000, v236
v_subrev_u32 v194, 0xc000, v237
v_subrev_u32 v195, 0xc000, v238
v_subrev_u32 v196, 0xc000, v239
v_subrev_u32 v197, 0xc000, v240
v_subrev_u32 v198, 0xc000, v241
v_subrev_u32 v199, 0xc000, v242
s_add_u32 m0, s34, 0x22800
s_add_u32 s37, s37, 64
s_cmp_eq_u32 s37, 0x500
s_cselect_b32 s37, 0, s37
s_mul_i32 s38, s37, 6144
buffer_load_dwordx4 v229, s[12:15], s38 offen offset:0 lds
buffer_load_dwordx4 v230, s[12:15], s38 offen offset:1024 lds
buffer_load_dwordx4 v231, s[12:15], s38 offen offset:2048 lds
s_add_u32 m0, s35, 0x25800
s_nop 0
buffer_load_dwordx4 v232, s[16:19], s37 offen lds
buffer_load_dwordx4 v233, s[16:19], s37 offen offset:1024 lds
s_mov_b32 m0, 0x27800
s_mov_b64 exec, s[42:43]
buffer_load_dwordx4 v234, s[16:19], s37 offen lds
s_mov_b64 exec, -1
s_waitcnt vmcnt(12)
s_barrier
ds_read_b64_tr_b16 v[128:129], v235 offset:0
ds_read_b64_tr_b16 v[130:131], v235 offset:1536
ds_read_b128 v[156:159], v240 offset:0
ds_read_b64_tr_b16 v[132:133], v236 offset:0
ds_read_b64_tr_b16 v[134:135], v236 offset:1536
ds_read_b64_tr_b16 v[136:137], v235 offset:128
ds_read_b64_tr_b16 v[138:139], v235 offset:1664
ds_read_b64_tr_b16 v[140:141], v236 offset:128
ds_read_b64_tr_b16 v[142:143], v236 offset:1664
s_waitcnt lgkmcnt(6)
v_mfma_f32_32x32x16_bf16 a[144:159], v[128:131], v[156:159], 0
ds_read_b64_tr_b16 v[144:145], v237 offset:0
ds_read_b64_tr_b16 v[146:147], v237 offset:1536
ds_read_b128 v[160:163], v242 offset:0
s_waitcnt lgkmcnt(7)
v_mfma_f32_32x32x16_bf16 a[160:175], v[132:135], v[156:159], 0
ds_read_b64_tr_b16 v[148:149], v235 offset:256
ds_read_b64_tr_b16 v[150:151], v235 offset:1792
ds_read_b64_tr_b16 v[152:153], v236 offset:256
ds_read_b64_tr_b16 v[154:155], v236 offset:1792
s_waitcnt lgkmcnt(9)
v_mfma_f32_32x32x16_bf16 a[176:191], v[136:139], v[156:159], 0
ds_read_b64_tr_b16 v[128:129], v235 offset:6144
ds_read_b64_tr_b16 v[130:131], v235 offset:7680
ds_read_b128 v[164:167], v241 offset:0
ds_read_b64_tr_b16 v[132:133], v236 offset:6144
ds_read_b64_tr_b16 v[134:135], v236 offset:7680
s_waitcnt lgkmcnt(12)
v_mfma_f32_32x32x16_bf16 a[192:207], v[140:143], v[156:159], 0
ds_read_b64_tr_b16 v[136:137], v238 offset:0
ds_read_b64_tr_b16 v[138:139], v238 offset:1536
ds_read_b64_tr_b16 v[140:141], v235 offset:6272
ds_read_b64_tr_b16 v[142:143], v235 offset:7808
s_add_u32 m0, s34, 0x0
s_add_u32 s37, s37, 64
s_cmp_eq_u32 s37, 0x500
s_cselect_b32 s37, 0, s37
s_mul_i32 s38, s37, 6144
buffer_load_dwordx4 v229, s[12:15], s38 offen offset:0 lds
buffer_load_dwordx4 v230, s[12:15], s38 offen offset:1024 lds
s_waitcnt lgkmcnt(9)
v_mfma_f32_16x16x32_bf16 a[240:243], v[144:147], v[160:163], 0
buffer_load_dwordx4 v231, s[12:15], s38 offen offset:2048 lds
v_mfma_f32_32x32x16_bf16 a[208:223], v[148:151], v[156:159], 0
s_add_u32 m0, s35, 0x3000
s_nop 0
buffer_load_dwordx4 v232, s[16:19], s37 offen lds
buffer_load_dwordx4 v233, s[16:19], s37 offen offset:1024 lds
v_mfma_f32_32x32x16_bf16 a[224:239], v[152:155], v[156:159], 0
ds_read_b64_tr_b16 v[144:145], v236 offset:6272
ds_read_b64_tr_b16 v[146:147], v236 offset:7808
s_mov_b32 m0, 0x5000
s_mov_b64 exec, s[42:43]
buffer_load_dwordx4 v234, s[16:19], s37 offen lds
s_mov_b64 exec, -1
s_waitcnt lgkmcnt(2)
v_mfma_f32_32x32x16_bf16 a[144:159], v[128:131], v[164:167], a[144:159]
v_or_b32 v7, 0, v0
v_mul_u32_u24 v7, 0xaab, v7
v_lshrrev_b32 v7, 16, v7
v_lshrrev_b32 v7, 1, v7
s_add_u32 m0, s34, 0x6000
s_add_u32 s37, s37, 64
s_cmp_eq_u32 s37, 0x500
s_cselect_b32 s37, 0, s37
s_mul_i32 s38, s37, 6144
buffer_load_dwordx4 v229, s[12:15], s38 offen offset:0 lds
buffer_load_dwordx4 v230, s[12:15], s38 offen offset:1024 lds
v_mfma_f32_32x32x16_bf16 a[160:175], v[132:135], v[164:167], a[160:175]
ds_read_b64_tr_b16 v[148:149], v235 offset:6400
ds_read_b64_tr_b16 v[150:151], v235 offset:7936
v_and_b32 v7, 7, v7
v_xor_b32 v7, v0, v7
v_lshlrev_b32 v7, 4, v7
v_add_u32 v208, s33, v7
v_add_u32 v4, 64, v0
buffer_load_dwordx4 v231, s[12:15], s38 offen offset:2048 lds
v_mfma_f32_16x16x32_bf16 a[244:247], v[136:139], v[160:163], 0
ds_read_b64_tr_b16 v[152:153], v236 offset:6400
ds_read_b64_tr_b16 v[154:155], v236 offset:7936
v_or_b32 v4, 0, v4
v_mul_u32_u24 v4, 0xaab, v4
v_lshrrev_b32 v4, 16, v4
v_lshrrev_b32 v4, 1, v4
v_and_b32 v4, 7, v4
s_add_u32 m0, s35, 0x9000
s_nop 0
buffer_load_dwordx4 v232, s[16:19], s37 offen lds
buffer_load_dwordx4 v233, s[16:19], s37 offen offset:1024 lds
v_mfma_f32_32x32x16_bf16 a[176:191], v[140:143], v[164:167], a[176:191]
ds_read_b64_tr_b16 v[128:129], v239 offset:0
ds_read_b64_tr_b16 v[130:131], v239 offset:1536
v_xor_b32 v4, v0, v4
v_lshlrev_b32 v4, 4, v4
v_add_u32 v209, s33, v4
v_add_u32 v6, 0x80, v0
v_or_b32 v6, 0, v6
s_mov_b32 m0, 0xb000
s_mov_b64 exec, s[42:43]
buffer_load_dwordx4 v234, s[16:19], s37 offen lds
s_mov_b64 exec, -1
s_waitcnt lgkmcnt(2)
v_mfma_f32_32x32x16_bf16 a[192:207], v[144:147], v[164:167], a[192:207]
s_waitcnt vmcnt(18)
s_barrier
ds_read_b64_tr_b16 v[132:133], v235 offset:21504
ds_read_b64_tr_b16 v[134:135], v235 offset:23040
ds_read_b128 v[168:171], v240 offset:21504
v_mul_u32_u24 v6, 0xaab, v6
v_lshrrev_b32 v6, 16, v6
v_lshrrev_b32 v6, 1, v6
v_and_b32 v6, 7, v6
v_xor_b32 v6, v0, v6
v_mfma_f32_32x32x16_bf16 a[208:223], v[148:151], v[164:167], a[208:223]
ds_read_b64_tr_b16 v[136:137], v236 offset:21504
ds_read_b64_tr_b16 v[138:139], v236 offset:23040
v_lshlrev_b32 v6, 4, v6
v_add_u32 v210, s33, v6
v_add_u32 v2, 0xc0, v0
v_or_b32 v2, 0, v2
v_mul_u32_u24 v2, 0xaab, v2
v_mfma_f32_32x32x16_bf16 a[224:239], v[152:155], v[164:167], a[224:239]
ds_read_b64_tr_b16 v[140:141], v235 offset:21632
ds_read_b64_tr_b16 v[142:143], v235 offset:23168
v_lshrrev_b32 v2, 16, v2
v_lshrrev_b32 v2, 1, v2
v_and_b32 v2, 7, v2
v_xor_b32 v2, v0, v2
v_lshlrev_b32 v2, 4, v2
s_waitcnt lgkmcnt(4)
v_mfma_f32_16x16x32_bf16 a[248:251], v[128:131], v[160:163], 0
ds_read_b64_tr_b16 v[144:145], v236 offset:21632
ds_read_b64_tr_b16 v[146:147], v236 offset:23168
v_add_u32 v211, s33, v2
v_add_u32 v39, 0x100, v0
v_or_b32 v39, 0, v39
v_mul_u32_u24 v39, 0xaab, v39
v_lshrrev_b32 v39, 16, v39
v_mfma_f32_32x32x16_bf16 a[144:159], v[132:135], v[168:171], a[144:159]
ds_read_b64_tr_b16 v[148:149], v237 offset:21504
ds_read_b64_tr_b16 v[150:151], v237 offset:23040
ds_read_b128 v[172:175], v242 offset:21504
v_lshrrev_b32 v39, 1, v39
v_and_b32 v39, 7, v39
v_xor_b32 v39, v0, v39
v_lshlrev_b32 v39, 4, v39
v_add_u32 v39, s33, v39
s_waitcnt lgkmcnt(5)
v_mfma_f32_32x32x16_bf16 a[160:175], v[136:139], v[168:171], a[160:175]
ds_read_b64_tr_b16 v[152:153], v235 offset:21760
ds_read_b64_tr_b16 v[154:155], v235 offset:23296
v_add_u32 v212, 0x1000, v39
v_add_u32 v11, 0x140, v0
v_or_b32 v11, 0, v11
v_mul_u32_u24 v11, 0xaab, v11
v_lshrrev_b32 v11, 16, v11
v_mfma_f32_32x32x16_bf16 a[176:191], v[140:143], v[168:171], a[176:191]
ds_read_b64_tr_b16 v[128:129], v236 offset:21760
ds_read_b64_tr_b16 v[130:131], v236 offset:23296
v_lshrrev_b32 v11, 1, v11
v_and_b32 v11, 7, v11
v_xor_b32 v11, v0, v11
v_lshlrev_b32 v11, 4, v11
v_add_u32 v11, s33, v11
s_waitcnt lgkmcnt(4)
v_mfma_f32_32x32x16_bf16 a[192:207], v[144:147], v[168:171], a[192:207]
ds_read_b64_tr_b16 v[132:133], v235 offset:27648
ds_read_b64_tr_b16 v[134:135], v235 offset:29184
ds_read_b128 v[176:179], v241 offset:21504
v_add_u32 v213, 0x1000, v11
v_or_b32 v13, 0, v0
v_mul_u32_u24 v13, 0xaab, v13
v_lshrrev_b32 v13, 16, v13
v_and_b32 v10, 2, v13
s_add_u32 m0, s34, 0xc000
s_add_u32 s37, s37, 64
s_cmp_eq_u32 s37, 0x500
s_cselect_b32 s37, 0, s37
s_mul_i32 s38, s37, 6144
buffer_load_dwordx4 v229, s[12:15], s38 offen offset:0 lds
buffer_load_dwordx4 v230, s[12:15], s38 offen offset:1024 lds
v_mfma_f32_16x16x32_bf16 a[240:243], v[148:151], v[172:175], a[240:243]
ds_read_b64_tr_b16 v[136:137], v236 offset:27648
ds_read_b64_tr_b16 v[138:139], v236 offset:29184
v_lshlrev_b32 v10, 1, v10
v_and_b32 v12, 4, v13
v_lshrrev_b32 v12, 1, v12
v_or_b32 v10, v10, v12
v_xor_b32 v10, v0, v10
buffer_load_dwordx4 v231, s[12:15], s38 offen offset:2048 lds
s_waitcnt lgkmcnt(2)
v_mfma_f32_32x32x16_bf16 a[208:223], v[152:155], v[168:171], a[208:223]
ds_read_b64_tr_b16 v[140:141], v238 offset:21504
ds_read_b64_tr_b16 v[142:143], v238 offset:23040
v_lshlrev_b32 v10, 4, v10
v_add_u32 v214, s33, v10
v_add_u32 v8, 64, v0
v_or_b32 v8, 0, v8
v_mul_u32_u24 v8, 0xaab, v8
s_add_u32 m0, s35, 0xf000
s_nop 0
buffer_load_dwordx4 v232, s[16:19], s37 offen lds
buffer_load_dwordx4 v233, s[16:19], s37 offen offset:1024 lds
v_mfma_f32_32x32x16_bf16 a[224:239], v[128:131], v[168:171], a[224:239]
ds_read_b64_tr_b16 v[144:145], v235 offset:27776
ds_read_b64_tr_b16 v[146:147], v235 offset:29312
v_lshrrev_b32 v8, 16, v8
v_and_b32 v3, 2, v8
v_lshlrev_b32 v3, 1, v3
v_and_b32 v17, 4, v8
v_lshrrev_b32 v17, 1, v17
s_mov_b32 m0, 0x11000
s_mov_b64 exec, s[42:43]
buffer_load_dwordx4 v234, s[16:19], s37 offen lds
s_mov_b64 exec, -1
v_mfma_f32_32x32x16_bf16 a[144:159], v[132:135], v[176:179], a[144:159]
ds_read_b64_tr_b16 v[148:149], v236 offset:27776
ds_read_b64_tr_b16 v[150:151], v236 offset:29312
v_or_b32 v3, v3, v17
v_xor_b32 v3, v0, v3
v_lshlrev_b32 v3, 4, v3
v_add_u32 v215, s33, v3
v_add_u32 v19, 0x80, v0
s_add_u32 m0, s34, 0x12000
s_add_u32 s37, s37, 64
s_cmp_eq_u32 s37, 0x500
s_cselect_b32 s37, 0, s37
s_mul_i32 s38, s37, 6144
buffer_load_dwordx4 v229, s[12:15], s38 offen offset:0 lds
buffer_load_dwordx4 v230, s[12:15], s38 offen offset:1024 lds
s_waitcnt lgkmcnt(2)
v_mfma_f32_32x32x16_bf16 a[160:175], v[136:139], v[176:179], a[160:175]
ds_read_b64_tr_b16 v[152:153], v235 offset:27904
ds_read_b64_tr_b16 v[154:155], v235 offset:29440
v_or_b32 v19, 0, v19
v_mul_u32_u24 v19, 0xaab, v19
v_lshrrev_b32 v19, 16, v19
v_and_b32 v16, 2, v19
v_lshlrev_b32 v16, 1, v16
buffer_load_dwordx4 v231, s[12:15], s38 offen offset:2048 lds
v_mfma_f32_16x16x32_bf16 a[244:247], v[140:143], v[172:175], a[244:247]
ds_read_b64_tr_b16 v[128:129], v236 offset:27904
ds_read_b64_tr_b16 v[130:131], v236 offset:29440
v_and_b32 v18, 4, v19
v_lshrrev_b32 v18, 1, v18
v_or_b32 v16, v16, v18
v_xor_b32 v16, v0, v16
v_lshlrev_b32 v16, 4, v16
s_add_u32 m0, s35, 0x15000
s_nop 0
buffer_load_dwordx4 v232, s[16:19], s37 offen lds
buffer_load_dwordx4 v233, s[16:19], s37 offen offset:1024 lds
v_mfma_f32_32x32x16_bf16 a[176:191], v[144:147], v[176:179], a[176:191]
ds_read_b64_tr_b16 v[132:133], v239 offset:21504
ds_read_b64_tr_b16 v[134:135], v239 offset:23040
v_add_u32 v216, s33, v16
v_mul_u32_u24 v14, 0x180, v32
v_or_b32 v9, 0, v28
v_lshrrev_b32 v23, 1, v32
v_and_b32 v23, 7, v23
s_mov_b32 m0, 0x17000
s_mov_b64 exec, s[42:43]
buffer_load_dwordx4 v234, s[16:19], s37 offen lds
s_mov_b64 exec, -1
s_waitcnt lgkmcnt(2)
v_mfma_f32_32x32x16_bf16 a[192:207], v[148:151], v[176:179], a[192:207]
s_waitcnt vmcnt(24)
s_barrier
ds_read_b64_tr_b16 v[136:137], v235 offset:43008
ds_read_b64_tr_b16 v[138:139], v235 offset:44544
ds_read_b128 v[156:159], v240 offset:43008
v_xor_b32 v9, v9, v23
v_lshlrev_b32 v9, 4, v9
v_add_u32 v217, v14, v9
v_mul_u32_u24 v24, 0x180, v32
v_add_u32 v22, 2, v28
v_mfma_f32_32x32x16_bf16 a[208:223], v[152:155], v[176:179], a[208:223]
ds_read_b64_tr_b16 v[140:141], v236 offset:43008
ds_read_b64_tr_b16 v[142:143], v236 offset:44544
v_or_b32 v22, 0, v22
v_lshrrev_b32 v21, 1, v32
v_and_b32 v21, 7, v21
v_xor_b32 v22, v22, v21
v_lshlrev_b32 v22, 4, v22
v_mfma_f32_32x32x16_bf16 a[224:239], v[128:131], v[176:179], a[224:239]
ds_read_b64_tr_b16 v[144:145], v235 offset:43136
ds_read_b64_tr_b16 v[146:147], v235 offset:44672
v_add_u32 v218, v24, v22
v_mul_u32_u24 v25, 0x180, v32
v_add_u32 v15, 4, v28
v_or_b32 v15, 0, v15
v_lshrrev_b32 v37, 1, v32
s_waitcnt lgkmcnt(4)
v_mfma_f32_16x16x32_bf16 a[248:251], v[132:135], v[172:175], a[248:251]
ds_read_b64_tr_b16 v[148:149], v236 offset:43136
ds_read_b64_tr_b16 v[150:151], v236 offset:44672
v_and_b32 v37, 7, v37
v_xor_b32 v15, v15, v37
v_lshlrev_b32 v15, 4, v15
v_add_u32 v219, v25, v15
v_mul_u32_u24 v35, 0x180, v32
v_mfma_f32_32x32x16_bf16 a[144:159], v[136:139], v[156:159], a[144:159]
ds_read_b64_tr_b16 v[152:153], v237 offset:43008
ds_read_b64_tr_b16 v[154:155], v237 offset:44544
ds_read_b128 v[164:167], v242 offset:43008
v_add_u32 v20, 6, v28
v_or_b32 v20, 0, v20
v_lshrrev_b32 v38, 1, v32
v_and_b32 v38, 7, v38
v_xor_b32 v20, v20, v38
s_waitcnt lgkmcnt(5)
v_mfma_f32_32x32x16_bf16 a[160:175], v[140:143], v[156:159], a[160:175]
ds_read_b64_tr_b16 v[128:129], v235 offset:43264
ds_read_b64_tr_b16 v[130:131], v235 offset:44800
v_lshlrev_b32 v20, 4, v20
v_add_u32 v220, v35, v20
v_mul_u32_u24 v34, 0x180, v31
v_or_b32 v36, 0, v29
v_lshrrev_b32 v5, 1, v31
v_mfma_f32_32x32x16_bf16 a[176:191], v[144:147], v[156:159], a[176:191]
ds_read_b64_tr_b16 v[132:133], v236 offset:43264
ds_read_b64_tr_b16 v[134:135], v236 offset:44800
v_xor_b32 v36, v36, v5
v_lshlrev_b32 v36, 4, v36
v_add_u32 v34, v34, v36
v_add_u32 v221, s33, v34
v_mul_u32_u24 v33, 0x180, v31
s_waitcnt lgkmcnt(4)
v_mfma_f32_32x32x16_bf16 a[192:207], v[148:151], v[156:159], a[192:207]
ds_read_b64_tr_b16 v[136:137], v235 offset:49152
ds_read_b64_tr_b16 v[138:139], v235 offset:50688
ds_read_b128 v[160:163], v241 offset:43008
v_add_u32 v7, 4, v29
v_or_b32 v7, 0, v7
v_lshrrev_b32 v4, 1, v31
v_xor_b32 v7, v7, v4
v_lshlrev_b32 v7, 4, v7
s_add_u32 m0, s34, 0x18000
s_add_u32 s37, s37, 64
s_cmp_eq_u32 s37, 0x500
s_cselect_b32 s37, 0, s37
s_mul_i32 s38, s37, 6144
buffer_load_dwordx4 v229, s[12:15], s38 offen offset:0 lds
buffer_load_dwordx4 v230, s[12:15], s38 offen offset:1024 lds
v_mfma_f32_16x16x32_bf16 a[240:243], v[152:155], v[164:167], a[240:243]
ds_read_b64_tr_b16 v[140:141], v236 offset:49152
ds_read_b64_tr_b16 v[142:143], v236 offset:50688
v_add_u32 v33, v33, v7
v_add_u32 v222, s33, v33
v_lshlrev_b32 v6, 2, v28
v_add_u32 v6, v6, v26
v_mul_u32_u24 v6, 0x180, v6
buffer_load_dwordx4 v231, s[12:15], s38 offen offset:2048 lds
s_waitcnt lgkmcnt(2)
v_mfma_f32_32x32x16_bf16 a[208:223], v[128:131], v[156:159], a[208:223]
ds_read_b64_tr_b16 v[144:145], v238 offset:43008
ds_read_b64_tr_b16 v[146:147], v238 offset:44544
v_lshlrev_b32 v2, 1, v30
v_lshrrev_b32 v39, 1, v27
v_add_u32 v2, v2, v39
v_and_b32 v11, 2, v26
v_lshlrev_b32 v11, 1, v11
s_add_u32 m0, s35, 0x1b000
s_nop 0
buffer_load_dwordx4 v232, s[16:19], s37 offen lds
buffer_load_dwordx4 v233, s[16:19], s37 offen offset:1024 lds
v_mfma_f32_32x32x16_bf16 a[224:239], v[132:135], v[156:159], a[224:239]
ds_read_b64_tr_b16 v[148:149], v235 offset:49280
ds_read_b64_tr_b16 v[150:151], v235 offset:50816
v_lshlrev_b32 v12, 1, v28
v_or_b32 v11, v11, v12
v_xor_b32 v2, v2, v11
v_lshlrev_b32 v2, 4, v2
v_add_u32 v6, v6, v2
s_mov_b32 m0, 0x1d000
s_mov_b64 exec, s[42:43]
buffer_load_dwordx4 v234, s[16:19], s37 offen lds
s_mov_b64 exec, -1
v_mfma_f32_32x32x16_bf16 a[144:159], v[136:139], v[160:163], a[144:159]
ds_read_b64_tr_b16 v[152:153], v236 offset:49280
ds_read_b64_tr_b16 v[154:155], v236 offset:50816
v_and_b32 v10, 1, v27
v_lshlrev_b32 v10, 3, v10
v_add_u32 v6, v6, v10
v_add_u32 v223, 0xc000, v6
v_lshlrev_b32 v13, 2, v28
s_add_u32 m0, s34, 0x1d400
s_add_u32 s37, s37, 64
s_cmp_eq_u32 s37, 0x500
s_cselect_b32 s37, 0, s37
s_mul_i32 s38, s37, 6144
buffer_load_dwordx4 v229, s[12:15], s38 offen offset:0 lds
buffer_load_dwordx4 v230, s[12:15], s38 offen offset:1024 lds
s_waitcnt lgkmcnt(2)
v_mfma_f32_32x32x16_bf16 a[160:175], v[140:143], v[160:163], a[160:175]
ds_read_b64_tr_b16 v[128:129], v235 offset:49408
ds_read_b64_tr_b16 v[130:131], v235 offset:50944
v_add_u32 v13, v13, v26
v_mul_u32_u24 v13, 0x180, v13
v_lshlrev_b32 v17, 1, v30
v_lshrrev_b32 v3, 1, v27
v_add_u32 v17, v17, v3
buffer_load_dwordx4 v231, s[12:15], s38 offen offset:2048 lds
v_mfma_f32_16x16x32_bf16 a[244:247], v[144:147], v[164:167], a[244:247]
ds_read_b64_tr_b16 v[132:133], v236 offset:49408
ds_read_b64_tr_b16 v[134:135], v236 offset:50944
v_add_u32 v17, 4, v17
v_and_b32 v8, 2, v26
v_lshlrev_b32 v8, 1, v8
v_lshlrev_b32 v18, 1, v28
v_or_b32 v8, v8, v18
s_add_u32 m0, s35, 0x20400
s_nop 0
buffer_load_dwordx4 v232, s[16:19], s37 offen lds
buffer_load_dwordx4 v233, s[16:19], s37 offen offset:1024 lds
v_mfma_f32_32x32x16_bf16 a[176:191], v[148:151], v[160:163], a[176:191]
ds_read_b64_tr_b16 v[136:137], v239 offset:43008
ds_read_b64_tr_b16 v[138:139], v239 offset:44544
v_xor_b32 v17, v17, v8
v_lshlrev_b32 v17, 4, v17
v_add_u32 v13, v13, v17
v_and_b32 v16, 1, v27
v_lshlrev_b32 v16, 3, v16
s_mov_b32 m0, 0x22400
s_mov_b64 exec, s[42:43]
buffer_load_dwordx4 v234, s[16:19], s37 offen lds
s_mov_b64 exec, -1
s_waitcnt lgkmcnt(2)
v_mfma_f32_32x32x16_bf16 a[192:207], v[152:155], v[160:163], a[192:207]
s_waitcnt vmcnt(30)
s_barrier
ds_read_b64_tr_b16 v[140:141], v72 offset:0
ds_read_b64_tr_b16 v[142:143], v72 offset:1536
ds_read_b128 v[168:171], v77 offset:0
v_add_u32 v13, v13, v16
v_add_u32 v224, 0xc000, v13
v_lshlrev_b32 v19, 2, v29
v_add_u32 v19, v19, v26
v_mul_u32_u24 v19, 0x180, v19
v_mfma_f32_32x32x16_bf16 a[208:223], v[128:131], v[160:163], a[208:223]
ds_read_b64_tr_b16 v[144:145], v73 offset:0
ds_read_b64_tr_b16 v[146:147], v73 offset:1536
v_lshrrev_b32 v23, 1, v27
v_and_b32 v9, 2, v26
v_lshlrev_b32 v9, 1, v9
v_lshlrev_b32 v14, 1, v30
v_or_b32 v9, v9, v14
v_mfma_f32_32x32x16_bf16 a[224:239], v[132:135], v[160:163], a[224:239]
ds_read_b64_tr_b16 v[148:149], v72 offset:128
ds_read_b64_tr_b16 v[150:151], v72 offset:1664
v_xor_b32 v23, v23, v9
v_lshlrev_b32 v23, 4, v23
v_add_u32 v19, v19, v23
v_and_b32 v21, 1, v27
v_lshlrev_b32 v21, 3, v21
s_waitcnt lgkmcnt(4)
v_mfma_f32_16x16x32_bf16 a[248:251], v[136:139], v[164:167], a[248:251]
ds_read_b64_tr_b16 v[152:153], v73 offset:128
ds_read_b64_tr_b16 v[154:155], v73 offset:1664
v_add_u32 v19, v19, v21
v_add_u32 v19, s33, v19
v_add_u32 v225, 0xc000, v19
v_lshlrev_b32 v22, 2, v29
v_add_u32 v22, v22, v26
v_mfma_f32_32x32x16_bf16 a[144:159], v[140:143], v[168:171], a[144:159]
ds_read_b64_tr_b16 v[128:129], v74 offset:0
ds_read_b64_tr_b16 v[130:131], v74 offset:1536
ds_read_b128 v[176:179], v79 offset:0
v_mul_u32_u24 v22, 0x180, v22
v_lshrrev_b32 v24, 1, v27
v_add_u32 v24, 2, v24
v_and_b32 v37, 2, v26
v_lshlrev_b32 v37, 1, v37
s_waitcnt lgkmcnt(5)
v_mfma_f32_32x32x16_bf16 a[160:175], v[144:147], v[168:171], a[160:175]
ds_read_b64_tr_b16 v[132:133], v72 offset:256
ds_read_b64_tr_b16 v[134:135], v72 offset:1792
v_lshlrev_b32 v15, 1, v30
v_or_b32 v37, v37, v15
v_xor_b32 v24, v24, v37
v_lshlrev_b32 v24, 4, v24
v_add_u32 v22, v22, v24
v_mfma_f32_32x32x16_bf16 a[176:191], v[148:151], v[168:171], a[176:191]
ds_read_b64_tr_b16 v[136:137], v73 offset:256
ds_read_b64_tr_b16 v[138:139], v73 offset:1792
v_and_b32 v25, 1, v27
v_lshlrev_b32 v25, 3, v25
v_add_u32 v22, v22, v25
v_add_u32 v22, s33, v22
v_add_u32 v226, 0xc000, v22
s_waitcnt lgkmcnt(4)
v_mfma_f32_32x32x16_bf16 a[192:207], v[152:155], v[168:171], a[192:207]
ds_read_b64_tr_b16 v[140:141], v72 offset:6144
ds_read_b64_tr_b16 v[142:143], v72 offset:7680
ds_read_b128 v[172:175], v78 offset:0
v_lshlrev_b32 v38, 2, v29
v_add_u32 v38, v38, v26
v_mul_u32_u24 v38, 0x180, v38
v_lshrrev_b32 v20, 1, v27
v_add_u32 v20, 4, v20
s_add_u32 m0, s34, 0x22800
s_add_u32 s37, s37, 64
s_cmp_eq_u32 s37, 0x500
s_cselect_b32 s37, 0, s37
s_mul_i32 s38, s37, 6144
buffer_load_dwordx4 v229, s[12:15], s38 offen offset:0 lds
v_mfma_f32_16x16x32_bf16 a[240:243], v[128:131], v[176:179], a[240:243]
ds_read_b64_tr_b16 v[144:145], v73 offset:6144
ds_read_b64_tr_b16 v[146:147], v73 offset:7680
v_and_b32 v35, 2, v26
v_lshlrev_b32 v35, 1, v35
v_lshlrev_b32 v5, 1, v30
v_or_b32 v35, v35, v5
v_xor_b32 v20, v20, v35
buffer_load_dwordx4 v230, s[12:15], s38 offen offset:1024 lds
s_waitcnt lgkmcnt(2)
v_mfma_f32_32x32x16_bf16 a[208:223], v[132:135], v[168:171], a[208:223]
ds_read_b64_tr_b16 v[148:149], v75 offset:0
ds_read_b64_tr_b16 v[150:151], v75 offset:1536
v_lshlrev_b32 v20, 4, v20
v_add_u32 v38, v38, v20
v_and_b32 v36, 1, v27
v_lshlrev_b32 v36, 3, v36
v_add_u32 v38, v38, v36
buffer_load_dwordx4 v231, s[12:15], s38 offen offset:2048 lds
v_mfma_f32_32x32x16_bf16 a[224:239], v[136:139], v[168:171], a[224:239]
ds_read_b64_tr_b16 v[152:153], v72 offset:6272
ds_read_b64_tr_b16 v[154:155], v72 offset:7808
v_add_u32 v38, s33, v38
v_add_u32 v227, 0xc000, v38
v_lshlrev_b32 v34, 2, v29
v_add_u32 v34, v34, v26
v_mul_u32_u24 v34, 0x180, v34
s_add_u32 m0, s35, 0x25800
s_nop 0
buffer_load_dwordx4 v232, s[16:19], s37 offen lds
v_mfma_f32_32x32x16_bf16 a[144:159], v[140:143], v[172:175], a[144:159]
ds_read_b64_tr_b16 v[128:129], v73 offset:6272
ds_read_b64_tr_b16 v[130:131], v73 offset:7808
v_lshrrev_b32 v4, 1, v27
v_add_u32 v4, 6, v4
v_and_b32 v7, 2, v26
v_lshlrev_b32 v7, 1, v7
v_lshlrev_b32 v33, 1, v30
buffer_load_dwordx4 v233, s[16:19], s37 offen offset:1024 lds
s_waitcnt lgkmcnt(3)
v_mfma_f32_32x32x16_bf16 a[160:175], v[144:147], v[172:175], a[160:175]
ds_read_b64_tr_b16 v[132:133], v72 offset:6400
ds_read_b64_tr_b16 v[134:135], v72 offset:7936
v_or_b32 v7, v7, v33
v_xor_b32 v4, v4, v7
v_lshlrev_b32 v4, 4, v4
v_add_u32 v34, v34, v4
v_and_b32 v39, 1, v27
s_mov_b32 m0, 0x27800
s_mov_b64 exec, s[42:43]
buffer_load_dwordx4 v234, s[16:19], s37 offen lds
s_mov_b64 exec, -1
v_mfma_f32_16x16x32_bf16 a[244:247], v[148:151], v[176:179], a[244:247]
ds_read_b64_tr_b16 v[136:137], v73 offset:6400
ds_read_b64_tr_b16 v[138:139], v73 offset:7936
v_lshlrev_b32 v39, 3, v39
v_add_u32 v34, v34, v39
v_add_u32 v34, s33, v34
v_add_u32 v228, 0xc000, v34
v_mul_u32_u24 v12, 0x3000, v1
s_waitcnt lgkmcnt(4)
v_mfma_f32_32x32x16_bf16 a[176:191], v[152:155], v[172:175], a[176:191]
ds_read_b64_tr_b16 v[140:141], v76 offset:0
ds_read_b64_tr_b16 v[142:143], v76 offset:1536
v_lshlrev_b32 v11, 4, v0
v_add_u32 v243, v12, v11
v_lshlrev_b32 v2, 4, v0
v_add_u32 v244, 0xc000, v2
v_mfma_f32_32x32x16_bf16 a[192:207], v[128:131], v[172:175], a[192:207]
s_waitcnt vmcnt(30)
s_barrier
ds_read_b64_tr_b16 v[144:145], v72 offset:24576
ds_read_b64_tr_b16 v[146:147], v72 offset:26112
ds_read_b128 v[156:159], v77 offset:24576
s_waitcnt lgkmcnt(5)
v_mfma_f32_32x32x16_bf16 a[208:223], v[132:135], v[172:175], a[208:223]
ds_read_b64_tr_b16 v[148:149], v73 offset:24576
ds_read_b64_tr_b16 v[150:151], v73 offset:26112
v_mfma_f32_32x32x16_bf16 a[224:239], v[136:139], v[172:175], a[224:239]
ds_read_b64_tr_b16 v[152:153], v72 offset:24704
ds_read_b64_tr_b16 v[154:155], v72 offset:26240
ds_read_b64_tr_b16 v[128:129], v73 offset:24704
ds_read_b64_tr_b16 v[130:131], v73 offset:26240
ds_read_b64_tr_b16 v[132:133], v74 offset:24576
ds_read_b64_tr_b16 v[134:135], v74 offset:26112
s_mov_b32 s56, 0
s_mov_b32 s2, 0x3dd53b95
s_mov_b64 s[44:45], 1
s_lshl_b32 s101, s96, 3
s_add_u32 s101, s101, s98
s_lshl_b32 s57, s101, 2
s_add_u32 s57, s57, s97
s_lshl_b32 s57, s57, 2
s_add_u32 s28, s28, s57
s_addc_u32 s29, s29, 0
s_cmp_eq_u32 s32, 0
s_cselect_b32 s30, 4, 0
s_mov_b32 s57, s30
s_waitcnt lgkmcnt(6)
v_mfma_f32_16x16x32_bf16 a[248:251], v[140:143], v[176:179], a[248:251]
v_mfma_f32_32x32x16_bf16 a[144:159], v[144:147], v[156:159], a[144:159]
ds_read_b128 v[160:163], v79 offset:24576
ds_read_b64_tr_b16 v[136:137], v72 offset:24832
ds_read_b64_tr_b16 v[138:139], v72 offset:26368
s_lshl_b32 s58, s97, 4
s_add_u32 s58, s58, s101
s_lshl_b32 s58, s58, 2
s_add_u32 s58, s58, s99
s_mul_i32 s58, s58, 46080
s_add_u32 s58, s58, 0x2000000
s_lshl_b32 s101, s101, 5
v_mfma_f32_32x32x16_bf16 a[160:175], v[148:151], v[156:159], a[160:175]
s_waitcnt lgkmcnt(3)
v_mfma_f32_32x32x16_bf16 a[176:191], v[152:155], v[156:159], a[176:191]
ds_read_b64_tr_b16 v[140:141], v73 offset:24832
ds_read_b64_tr_b16 v[142:143], v73 offset:26368
ds_read_b64_tr_b16 v[144:145], v72 offset:30720
ds_read_b64_tr_b16 v[146:147], v72 offset:32256
ds_read_b128 v[164:167], v78 offset:24576
ds_read_b64_tr_b16 v[148:149], v73 offset:30720
ds_read_b64_tr_b16 v[150:151], v73 offset:32256
v_mfma_f32_32x32x16_bf16 a[192:207], v[128:131], v[156:159], a[192:207]
ds_read_b64_tr_b16 v[152:153], v75 offset:24576
ds_read_b64_tr_b16 v[154:155], v75 offset:26112
ds_read_b64_tr_b16 v[128:129], v72 offset:30848
ds_read_b64_tr_b16 v[130:131], v72 offset:32384
s_add_u32 m0, s34, 0x0
s_add_u32 s37, s37, 64
s_cmp_eq_u32 s37, 0x500
s_cselect_b32 s37, 0, s37
s_mul_i32 s38, s37, 6144
buffer_load_dwordx4 v229, s[12:15], s38 offen offset:0 lds
s_waitcnt lgkmcnt(11)
v_mfma_f32_16x16x32_bf16 a[240:243], v[132:135], v[160:163], a[240:243]
s_add_u32 s40, s99, 0
s_and_b32 s40, s40, 3
s_lshl_b32 s41, s97, 2
s_add_u32 s40, s40, s41
s_mul_i32 s48, s40, 245760
s_add_u32 s40, s40, s101
s_mul_i32 s52, s40, 55296
buffer_load_dwordx4 v230, s[12:15], s38 offen offset:1024 lds
v_mfma_f32_32x32x16_bf16 a[208:223], v[136:139], v[156:159], a[208:223]
buffer_load_dwordx4 v231, s[12:15], s38 offen offset:2048 lds
s_waitcnt lgkmcnt(0)
v_mfma_f32_32x32x16_bf16 a[224:239], v[140:143], v[156:159], a[224:239]
ds_read_b64_tr_b16 v[132:133], v73 offset:30848
ds_read_b64_tr_b16 v[134:135], v73 offset:32384
ds_read_b64_tr_b16 v[136:137], v72 offset:30976
ds_read_b64_tr_b16 v[138:139], v72 offset:32512
s_add_u32 m0, s35, 0x3000
s_nop 0
buffer_load_dwordx4 v232, s[16:19], s37 offen lds
v_mfma_f32_32x32x16_bf16 a[144:159], v[144:147], v[164:167], a[144:159]
ds_read_b64_tr_b16 v[140:141], v73 offset:30976
ds_read_b64_tr_b16 v[142:143], v73 offset:32512
ds_read_b64_tr_b16 v[144:145], v76 offset:24576
ds_read_b64_tr_b16 v[146:147], v76 offset:26112
buffer_load_dwordx4 v233, s[16:19], s37 offen offset:1024 lds
v_mfma_f32_32x32x16_bf16 a[160:175], v[148:151], v[164:167], a[160:175]
s_waitcnt vmcnt(29)
s_barrier
ds_read_b64_tr_b16 v[148:149], v192 offset:0
ds_read_b64_tr_b16 v[150:151], v192 offset:1536
s_add_u32 s40, s99, 1
s_and_b32 s40, s40, 3
s_lshl_b32 s41, s97, 2
s_add_u32 s40, s40, s41
s_mul_i32 s49, s40, 245760
s_add_u32 s40, s40, s101
s_mul_i32 s53, s40, 55296
s_mov_b32 m0, 0x5000
s_mov_b64 exec, s[42:43]
buffer_load_dwordx4 v234, s[16:19], s37 offen lds
s_mov_b64 exec, -1
v_mfma_f32_16x16x32_bf16 a[244:247], v[152:155], v[160:163], a[244:247]
v_mfma_f32_32x32x16_bf16 a[176:191], v[128:131], v[164:167], a[176:191]
ds_read_b128 v[168:171], v197 offset:0
ds_read_b64_tr_b16 v[152:153], v193 offset:0
ds_read_b64_tr_b16 v[154:155], v193 offset:1536
s_waitcnt lgkmcnt(5)
v_mfma_f32_32x32x16_bf16 a[192:207], v[132:135], v[164:167], a[192:207]
ds_read_b64_tr_b16 v[128:129], v192 offset:128
ds_read_b64_tr_b16 v[130:131], v192 offset:1664
ds_read_b64_tr_b16 v[132:133], v193 offset:128
ds_read_b64_tr_b16 v[134:135], v193 offset:1664
v_mfma_f32_32x32x16_bf16 a[208:223], v[136:139], v[164:167], a[208:223]
ds_read_b64_tr_b16 v[136:137], v194 offset:0
ds_read_b64_tr_b16 v[138:139], v194 offset:1536
ds_read_b128 v[172:175], v199 offset:0
s_add_u32 s40, s99, 2
s_and_b32 s40, s40, 3
s_lshl_b32 s41, s97, 2
s_add_u32 s40, s40, s41
s_mul_i32 s50, s40, 245760
s_add_u32 s40, s40, s101
s_mul_i32 s54, s40, 55296
v_mfma_f32_32x32x16_bf16 a[224:239], v[140:143], v[164:167], a[224:239]
ds_read_b64_tr_b16 v[140:141], v192 offset:256
ds_read_b64_tr_b16 v[142:143], v192 offset:1792
v_mfma_f32_16x16x32_bf16 a[248:251], v[144:147], v[160:163], a[248:251]
ds_read_b64_tr_b16 v[144:145], v193 offset:256
ds_read_b64_tr_b16 v[146:147], v193 offset:1792
s_waitcnt lgkmcnt(7)
v_mfma_f32_32x32x16_bf16 a[144:159], v[148:151], v[168:171], a[144:159]
ds_read_b64_tr_b16 v[148:149], v192 offset:6144
ds_read_b64_tr_b16 v[150:151], v192 offset:7680
ds_read_b128 v[176:179], v198 offset:0
s_add_u32 s40, s99, 3
s_and_b32 s40, s40, 3
s_lshl_b32 s41, s97, 2
s_add_u32 s40, s40, s41
s_mul_i32 s51, s40, 245760
s_add_u32 s40, s40, s101
s_mul_i32 s55, s40, 55296
v_mfma_f32_32x32x16_bf16 a[160:175], v[152:155], v[168:171], a[160:175]
ds_read_b64_tr_b16 v[152:153], v193 offset:6144
ds_read_b64_tr_b16 v[154:155], v193 offset:7680
v_mfma_f32_32x32x16_bf16 a[176:191], v[128:131], v[168:171], a[176:191]
ds_read_b64_tr_b16 v[128:129], v195 offset:0
ds_read_b64_tr_b16 v[130:131], v195 offset:1536
s_add_u32 m0, s34, 0x6000
s_add_u32 s37, s37, 64
s_cmp_eq_u32 s37, 0x500
s_cselect_b32 s37, 0, s37
s_mul_i32 s38, s37, 6144
buffer_load_dwordx4 v229, s[12:15], s38 offen offset:0 lds
v_mfma_f32_32x32x16_bf16 a[192:207], v[132:135], v[168:171], a[192:207]
ds_read_b64_tr_b16 v[132:133], v192 offset:6272
ds_read_b64_tr_b16 v[134:135], v192 offset:7808
s_waitcnt lgkmcnt(6)
v_mfma_f32_16x16x32_bf16 a[240:243], v[136:139], v[172:175], a[240:243]
ds_read_b64_tr_b16 v[136:137], v193 offset:6272
ds_read_b64_tr_b16 v[138:139], v193 offset:7808
buffer_load_dwordx4 v230, s[12:15], s38 offen offset:1024 lds
v_mfma_f32_32x32x16_bf16 a[208:223], v[140:143], v[168:171], a[208:223]
ds_read_b64_tr_b16 v[140:141], v192 offset:6400
ds_read_b64_tr_b16 v[142:143], v192 offset:7936
buffer_load_dwordx4 v231, s[12:15], s38 offen offset:2048 lds
v_mfma_f32_32x32x16_bf16 a[224:239], v[144:147], v[168:171], a[224:239]
ds_read_b64_tr_b16 v[144:145], v193 offset:6400
ds_read_b64_tr_b16 v[146:147], v193 offset:7936
s_add_u32 s40, s98, 0
s_cmp_ge_u32 s40, 9
s_cselect_b32 s41, 9, 0
s_sub_u32 s40, s40, s41
s_mul_i32 s41, s40, 43
s_lshr_b32 s41, s41, 7
s_mul_i32 s74, s41, 3
s_sub_u32 s40, s40, s74
s_add_u32 m0, s35, 0x9000
s_nop 0
buffer_load_dwordx4 v232, s[16:19], s37 offen lds
v_mfma_f32_32x32x16_bf16 a[144:159], v[148:151], v[176:179], a[144:159]
buffer_load_dwordx4 v233, s[16:19], s37 offen offset:1024 lds
s_waitcnt lgkmcnt(2)
v_mfma_f32_32x32x16_bf16 a[160:175], v[152:155], v[176:179], a[160:175]
ds_read_b64_tr_b16 v[148:149], v196 offset:0
ds_read_b64_tr_b16 v[150:151], v196 offset:1536
s_waitcnt vmcnt(29)
s_barrier
s_mov_b32 m0, 0xb000
s_mov_b64 exec, s[42:43]
buffer_load_dwordx4 v234, s[16:19], s37 offen lds
s_mov_b64 exec, -1
v_mfma_f32_16x16x32_bf16 a[244:247], v[128:131], v[172:175], a[244:247]
v_mfma_f32_32x32x16_bf16 a[176:191], v[132:135], v[176:179], a[176:191]
ds_read_b64_tr_b16 v[152:153], v192 offset:24576
ds_read_b64_tr_b16 v[154:155], v192 offset:26112
ds_read_b128 v[156:159], v197 offset:24576
s_add_u32 s41, s41, s99
s_add_u32 s41, s41, 1
s_and_b32 s41, s41, 3
s_lshl2_add_u32 s41, s97, s41
s_mul_i32 s78, s41, 245760
s_mul_i32 s74, s40, 81920
s_add_u32 s78, s78, s74
v_mfma_f32_32x32x16_bf16 a[192:207], v[136:139], v[176:179], a[192:207]
v_mfma_f32_32x32x16_bf16 a[208:223], v[140:143], v[176:179], a[208:223]
ds_read_b64_tr_b16 v[128:129], v193 offset:24576
ds_read_b64_tr_b16 v[130:131], v193 offset:26112
ds_read_b64_tr_b16 v[132:133], v192 offset:24704
ds_read_b64_tr_b16 v[134:135], v192 offset:26240
ds_read_b64_tr_b16 v[136:137], v193 offset:24704
ds_read_b64_tr_b16 v[138:139], v193 offset:26240
s_waitcnt lgkmcnt(8)
v_mfma_f32_32x32x16_bf16 a[224:239], v[144:147], v[176:179], a[224:239]
ds_read_b64_tr_b16 v[140:141], v194 offset:24576
ds_read_b64_tr_b16 v[142:143], v194 offset:26112
ds_read_b128 v[164:167], v199 offset:24576
ds_read_b64_tr_b16 v[144:145], v192 offset:24832
ds_read_b64_tr_b16 v[146:147], v192 offset:26368
s_add_u32 s41, s41, s101
s_mul_i32 s87, s41, 55296
s_lshl_b32 s74, s40, 12
s_add_u32 s87, s87, s74
s_lshl_b32 s75, s40, 11
v_mfma_f32_16x16x32_bf16 a[248:251], v[148:151], v[172:175], a[248:251]
s_waitcnt lgkmcnt(11)
v_mfma_f32_32x32x16_bf16 a[144:159], v[152:155], v[156:159], a[144:159]
ds_read_b64_tr_b16 v[148:149], v193 offset:24832
ds_read_b64_tr_b16 v[150:151], v193 offset:26368
ds_read_b64_tr_b16 v[152:153], v192 offset:30720
ds_read_b64_tr_b16 v[154:155], v192 offset:32256
s_waitcnt lgkmcnt(9)
v_mfma_f32_32x32x16_bf16 a[160:175], v[128:131], v[156:159], a[160:175]
ds_read_b128 v[160:163], v198 offset:24576
ds_read_b64_tr_b16 v[128:129], v193 offset:30720
ds_read_b64_tr_b16 v[130:131], v193 offset:32256
s_add_u32 s40, s98, 1
s_cmp_ge_u32 s40, 9
s_cselect_b32 s41, 9, 0
s_sub_u32 s40, s40, s41
s_mul_i32 s41, s40, 43
s_lshr_b32 s41, s41, 7
s_mul_i32 s74, s41, 3
s_sub_u32 s40, s40, s74
v_mfma_f32_32x32x16_bf16 a[176:191], v[132:135], v[156:159], a[176:191]
ds_read_b64_tr_b16 v[132:133], v195 offset:24576
ds_read_b64_tr_b16 v[134:135], v195 offset:26112
v_mfma_f32_32x32x16_bf16 a[192:207], v[136:139], v[156:159], a[192:207]
ds_read_b64_tr_b16 v[136:137], v192 offset:30848
ds_read_b64_tr_b16 v[138:139], v192 offset:32384
s_add_u32 m0, s34, 0xc000
s_add_u32 s37, s37, 64
s_cmp_eq_u32 s37, 0x500
s_cselect_b32 s37, 0, s37
s_mul_i32 s38, s37, 6144
buffer_load_dwordx4 v229, s[12:15], s38 offen offset:0 lds
s_waitcnt lgkmcnt(4)
v_mfma_f32_16x16x32_bf16 a[240:243], v[140:143], v[164:167], a[240:243]
buffer_load_dwordx4 v230, s[12:15], s38 offen offset:1024 lds
v_mfma_f32_32x32x16_bf16 a[208:223], v[144:147], v[156:159], a[208:223]
ds_read_b64_tr_b16 v[140:141], v193 offset:30848
ds_read_b64_tr_b16 v[142:143], v193 offset:32384
buffer_load_dwordx4 v231, s[12:15], s38 offen offset:2048 lds
v_mfma_f32_32x32x16_bf16 a[224:239], v[148:151], v[156:159], a[224:239]
ds_read_b64_tr_b16 v[144:145], v192 offset:30976
ds_read_b64_tr_b16 v[146:147], v192 offset:32512
ds_read_b64_tr_b16 v[148:149], v193 offset:30976
ds_read_b64_tr_b16 v[150:151], v193 offset:32512
s_add_u32 s41, s41, s99
s_add_u32 s41, s41, 1
s_and_b32 s41, s41, 3
s_lshl2_add_u32 s41, s97, s41
s_mul_i32 s79, s41, 245760
s_mul_i32 s74, s40, 81920
s_add_u32 s79, s79, s74
s_add_u32 m0, s35, 0xf000
s_nop 0
buffer_load_dwordx4 v232, s[16:19], s37 offen lds
v_mfma_f32_32x32x16_bf16 a[144:159], v[152:155], v[160:163], a[144:159]
buffer_load_dwordx4 v233, s[16:19], s37 offen offset:1024 lds
v_mfma_f32_32x32x16_bf16 a[160:175], v[128:131], v[160:163], a[160:175]
ds_read_b64_tr_b16 v[152:153], v196 offset:24576
ds_read_b64_tr_b16 v[154:155], v196 offset:26112
s_waitcnt vmcnt(29)
s_barrier
s_mov_b32 m0, 0x11000
s_mov_b64 exec, s[42:43]
buffer_load_dwordx4 v234, s[16:19], s37 offen lds
s_mov_b64 exec, -1
s_waitcnt lgkmcnt(2)
v_mfma_f32_16x16x32_bf16 a[244:247], v[132:135], v[164:167], a[244:247]
s_add_u32 s41, s41, s101
s_mul_i32 s88, s41, 55296
s_lshl_b32 s74, s40, 12
s_add_u32 s88, s88, s74
s_lshl_b32 s76, s40, 11
v_mfma_f32_32x32x16_bf16 a[176:191], v[136:139], v[160:163], a[176:191]
v_mfma_f32_32x32x16_bf16 a[192:207], v[140:143], v[160:163], a[192:207]
ds_read_b64_tr_b16 v[128:129], v235 offset:0
ds_read_b64_tr_b16 v[130:131], v235 offset:1536
ds_read_b128 v[168:171], v240 offset:0
ds_read_b64_tr_b16 v[132:133], v236 offset:0
ds_read_b64_tr_b16 v[134:135], v236 offset:1536
ds_read_b64_tr_b16 v[136:137], v235 offset:128
ds_read_b64_tr_b16 v[138:139], v235 offset:1664
v_mfma_f32_32x32x16_bf16 a[208:223], v[144:147], v[160:163], a[208:223]
ds_read_b64_tr_b16 v[140:141], v236 offset:128
ds_read_b64_tr_b16 v[142:143], v236 offset:1664
ds_read_b64_tr_b16 v[144:145], v237 offset:0
ds_read_b64_tr_b16 v[146:147], v237 offset:1536
ds_read_b128 v[176:179], v242 offset:0
v_mfma_f32_32x32x16_bf16 a[224:239], v[148:151], v[160:163], a[224:239]
ds_read_b64_tr_b16 v[148:149], v235 offset:256
ds_read_b64_tr_b16 v[150:151], v235 offset:1792
s_add_u32 s40, s98, 2
s_cmp_ge_u32 s40, 9
s_cselect_b32 s41, 9, 0
s_sub_u32 s40, s40, s41
s_mul_i32 s41, s40, 43
s_lshr_b32 s41, s41, 7
s_mul_i32 s74, s41, 3
s_sub_u32 s40, s40, s74
s_waitcnt lgkmcnt(7)
v_mfma_f32_16x16x32_bf16 a[248:251], v[152:155], v[164:167], a[248:251]
v_mfma_f32_32x32x16_bf16 a[144:159], v[128:131], v[168:171], a[144:159]
ds_read_b64_tr_b16 v[152:153], v236 offset:256
ds_read_b64_tr_b16 v[154:155], v236 offset:1792
ds_read_b64_tr_b16 v[128:129], v235 offset:6144
ds_read_b64_tr_b16 v[130:131], v235 offset:7680
v_mfma_f32_32x32x16_bf16 a[160:175], v[132:135], v[168:171], a[160:175]
ds_read_b128 v[172:175], v241 offset:0
ds_read_b64_tr_b16 v[132:133], v236 offset:6144
ds_read_b64_tr_b16 v[134:135], v236 offset:7680
s_add_u32 s41, s41, s99
s_add_u32 s41, s41, 1
s_and_b32 s41, s41, 3
s_lshl2_add_u32 s41, s97, s41
s_mul_i32 s80, s41, 245760
s_mul_i32 s74, s40, 81920
s_add_u32 s80, s80, s74
v_mfma_f32_32x32x16_bf16 a[176:191], v[136:139], v[168:171], a[176:191]
ds_read_b64_tr_b16 v[136:137], v238 offset:0
ds_read_b64_tr_b16 v[138:139], v238 offset:1536
s_waitcnt lgkmcnt(8)
v_mfma_f32_32x32x16_bf16 a[192:207], v[140:143], v[168:171], a[192:207]
ds_read_b64_tr_b16 v[140:141], v235 offset:6272
ds_read_b64_tr_b16 v[142:143], v235 offset:7808
s_add_u32 m0, s34, 0x12000
s_add_u32 s37, s37, 64
s_cmp_eq_u32 s37, 0x500
s_cselect_b32 s37, 0, s37
s_mul_i32 s38, s37, 6144
buffer_load_dwordx4 v229, s[12:15], s38 offen offset:0 lds
v_mfma_f32_16x16x32_bf16 a[240:243], v[144:147], v[176:179], a[240:243]
buffer_load_dwordx4 v230, s[12:15], s38 offen offset:1024 lds
v_mfma_f32_32x32x16_bf16 a[208:223], v[148:151], v[168:171], a[208:223]
ds_read_b64_tr_b16 v[144:145], v236 offset:6272
ds_read_b64_tr_b16 v[146:147], v236 offset:7808
ds_read_b64_tr_b16 v[148:149], v235 offset:6400
ds_read_b64_tr_b16 v[150:151], v235 offset:7936
buffer_load_dwordx4 v231, s[12:15], s38 offen offset:2048 lds
s_waitcnt lgkmcnt(6)
v_mfma_f32_32x32x16_bf16 a[224:239], v[152:155], v[168:171], a[224:239]
ds_read_b64_tr_b16 v[152:153], v236 offset:6400
ds_read_b64_tr_b16 v[154:155], v236 offset:7936
s_add_u32 s41, s41, s101
s_mul_i32 s89, s41, 55296
s_lshl_b32 s74, s40, 12
s_add_u32 s89, s89, s74
s_lshl_b32 s77, s40, 11
s_add_u32 m0, s35, 0x15000
s_nop 0
buffer_load_dwordx4 v232, s[16:19], s37 offen lds
v_mfma_f32_32x32x16_bf16 a[144:159], v[128:131], v[172:175], a[144:159]
buffer_load_dwordx4 v233, s[16:19], s37 offen offset:1024 lds
v_mfma_f32_32x32x16_bf16 a[160:175], v[132:135], v[172:175], a[160:175]
ds_read_b64_tr_b16 v[128:129], v239 offset:0
ds_read_b64_tr_b16 v[130:131], v239 offset:1536
s_waitcnt vmcnt(29)
s_barrier
s_mov_b32 m0, 0x17000
s_mov_b64 exec, s[42:43]
buffer_load_dwordx4 v234, s[16:19], s37 offen lds
s_mov_b64 exec, -1
v_mfma_f32_16x16x32_bf16 a[244:247], v[136:139], v[176:179], a[244:247]
s_waitcnt lgkmcnt(2)
v_mfma_f32_32x32x16_bf16 a[176:191], v[140:143], v[172:175], a[176:191]
ds_read_b64_tr_b16 v[132:133], v235 offset:21504
ds_read_b64_tr_b16 v[134:135], v235 offset:23040
ds_read_b128 v[156:159], v240 offset:21504
s_add_u32 s40, s98, 3
s_cmp_ge_u32 s40, 9
s_cselect_b32 s41, 9, 0
s_sub_u32 s40, s40, s41
s_mul_i32 s41, s40, 43
s_lshr_b32 s41, s41, 7
s_mul_i32 s74, s41, 3
s_sub_u32 s40, s40, s74
v_mfma_f32_32x32x16_bf16 a[192:207], v[144:147], v[172:175], a[192:207]
v_mfma_f32_32x32x16_bf16 a[208:223], v[148:151], v[172:175], a[208:223]
ds_read_b64_tr_b16 v[136:137], v236 offset:21504
ds_read_b64_tr_b16 v[138:139], v236 offset:23040
ds_read_b64_tr_b16 v[140:141], v235 offset:21632
ds_read_b64_tr_b16 v[142:143], v235 offset:23168
ds_read_b64_tr_b16 v[144:145], v236 offset:21632
ds_read_b64_tr_b16 v[146:147], v236 offset:23168
v_mfma_f32_32x32x16_bf16 a[224:239], v[152:155], v[172:175], a[224:239]
ds_read_b64_tr_b16 v[148:149], v237 offset:21504
ds_read_b64_tr_b16 v[150:151], v237 offset:23040
ds_read_b128 v[160:163], v242 offset:21504
ds_read_b64_tr_b16 v[152:153], v235 offset:21760
ds_read_b64_tr_b16 v[154:155], v235 offset:23296
s_waitcnt lgkmcnt(11)
v_mfma_f32_16x16x32_bf16 a[248:251], v[128:131], v[176:179], a[248:251]
ds_read_b64_tr_b16 v[128:129], v236 offset:21760
ds_read_b64_tr_b16 v[130:131], v236 offset:23296
s_add_u32 s41, s41, s99
s_add_u32 s41, s41, 1
s_and_b32 s41, s41, 3
s_lshl2_add_u32 s41, s97, s41
s_mul_i32 s81, s41, 245760
s_mul_i32 s74, s40, 81920
s_add_u32 s81, s81, s74
v_mfma_f32_32x32x16_bf16 a[144:159], v[132:135], v[156:159], a[144:159]
s_waitcnt lgkmcnt(7)
v_mfma_f32_32x32x16_bf16 a[160:175], v[136:139], v[156:159], a[160:175]
ds_read_b64_tr_b16 v[132:133], v235 offset:27648
ds_read_b64_tr_b16 v[134:135], v235 offset:29184
ds_read_b128 v[164:167], v241 offset:21504
ds_read_b64_tr_b16 v[136:137], v236 offset:27648
ds_read_b64_tr_b16 v[138:139], v236 offset:29184
s_add_u32 s41, s41, s101
s_mul_i32 s90, s41, 55296
s_lshl_b32 s74, s40, 12
s_add_u32 s90, s90, s74
v_mfma_f32_32x32x16_bf16 a[176:191], v[140:143], v[156:159], a[176:191]
ds_read_b64_tr_b16 v[140:141], v238 offset:21504
ds_read_b64_tr_b16 v[142:143], v238 offset:23040
v_mfma_f32_32x32x16_bf16 a[192:207], v[144:147], v[156:159], a[192:207]
ds_read_b64_tr_b16 v[144:145], v235 offset:27776
ds_read_b64_tr_b16 v[146:147], v235 offset:29312
s_add_u32 m0, s34, 0x18000
s_add_u32 s37, s37, 64
s_cmp_eq_u32 s37, 0x500
s_cselect_b32 s37, 0, s37
s_mul_i32 s38, s37, 6144
buffer_load_dwordx4 v229, s[12:15], s38 offen offset:0 lds
s_waitcnt lgkmcnt(4)
v_mfma_f32_16x16x32_bf16 a[240:243], v[148:151], v[160:163], a[240:243]
buffer_load_dwordx4 v230, s[12:15], s38 offen offset:1024 lds
v_mfma_f32_32x32x16_bf16 a[208:223], v[152:155], v[156:159], a[208:223]
ds_read_b64_tr_b16 v[148:149], v236 offset:27776
ds_read_b64_tr_b16 v[150:151], v236 offset:29312
ds_read_b64_tr_b16 v[152:153], v235 offset:27904
ds_read_b64_tr_b16 v[154:155], v235 offset:29440
buffer_load_dwordx4 v231, s[12:15], s38 offen offset:2048 lds
v_mfma_f32_32x32x16_bf16 a[224:239], v[128:131], v[156:159], a[224:239]
ds_read_b64_tr_b16 v[128:129], v236 offset:27904
ds_read_b64_tr_b16 v[130:131], v236 offset:29440
s_add_u32 s40, s98, 4
s_cmp_ge_u32 s40, 9
s_cselect_b32 s41, 9, 0
s_sub_u32 s40, s40, s41
s_mul_i32 s41, s40, 43
s_lshr_b32 s41, s41, 7
s_mul_i32 s74, s41, 3
s_sub_u32 s40, s40, s74
s_add_u32 m0, s35, 0x1b000
s_nop 0
buffer_load_dwordx4 v232, s[16:19], s37 offen lds
v_mfma_f32_32x32x16_bf16 a[144:159], v[132:135], v[164:167], a[144:159]
buffer_load_dwordx4 v233, s[16:19], s37 offen offset:1024 lds
v_mfma_f32_32x32x16_bf16 a[160:175], v[136:139], v[164:167], a[160:175]
ds_read_b64_tr_b16 v[132:133], v239 offset:21504
ds_read_b64_tr_b16 v[134:135], v239 offset:23040
s_waitcnt vmcnt(29)
s_barrier
s_mov_b32 m0, 0x1d000
s_mov_b64 exec, s[42:43]
buffer_load_dwordx4 v234, s[16:19], s37 offen lds
s_mov_b64 exec, -1
s_waitcnt lgkmcnt(2)
v_mfma_f32_16x16x32_bf16 a[244:247], v[140:143], v[160:163], a[244:247]
v_mfma_f32_32x32x16_bf16 a[176:191], v[144:147], v[164:167], a[176:191]
ds_read_b64_tr_b16 v[136:137], v235 offset:43008
ds_read_b64_tr_b16 v[138:139], v235 offset:44544
ds_read_b128 v[168:171], v240 offset:43008
s_add_u32 s41, s41, s99
s_add_u32 s41, s41, 1
s_and_b32 s41, s41, 3
s_lshl2_add_u32 s41, s97, s41
s_mul_i32 s82, s41, 245760
s_mul_i32 s74, s40, 81920
s_add_u32 s82, s82, s74
v_mfma_f32_32x32x16_bf16 a[192:207], v[148:151], v[164:167], a[192:207]
v_mfma_f32_32x32x16_bf16 a[208:223], v[152:155], v[164:167], a[208:223]
ds_read_b64_tr_b16 v[140:141], v236 offset:43008
ds_read_b64_tr_b16 v[142:143], v236 offset:44544
ds_read_b64_tr_b16 v[144:145], v235 offset:43136
ds_read_b64_tr_b16 v[146:147], v235 offset:44672
ds_read_b64_tr_b16 v[148:149], v236 offset:43136
ds_read_b64_tr_b16 v[150:151], v236 offset:44672
s_add_u32 s41, s41, s101
s_mul_i32 s91, s41, 55296
s_lshl_b32 s74, s40, 12
s_add_u32 s91, s91, s74
v_mfma_f32_32x32x16_bf16 a[224:239], v[128:131], v[164:167], a[224:239]
ds_read_b64_tr_b16 v[152:153], v237 offset:43008
ds_read_b64_tr_b16 v[154:155], v237 offset:44544
s_waitcnt lgkmcnt(8)
v_mfma_f32_16x16x32_bf16 a[248:251], v[132:135], v[160:163], a[248:251]
ds_read_b128 v[172:175], v242 offset:43008
ds_read_b64_tr_b16 v[128:129], v235 offset:43264
ds_read_b64_tr_b16 v[130:131], v235 offset:44800
v_mfma_f32_32x32x16_bf16 a[144:159], v[136:139], v[168:171], a[144:159]
ds_read_b64_tr_b16 v[132:133], v236 offset:43264
ds_read_b64_tr_b16 v[134:135], v236 offset:44800
ds_read_b64_tr_b16 v[136:137], v235 offset:49152
ds_read_b64_tr_b16 v[138:139], v235 offset:50688
ds_read_b128 v[176:179], v241 offset:43008
s_waitcnt lgkmcnt(10)
v_mfma_f32_32x32x16_bf16 a[160:175], v[140:143], v[168:171], a[160:175]
ds_read_b64_tr_b16 v[140:141], v236 offset:49152
ds_read_b64_tr_b16 v[142:143], v236 offset:50688
s_add_u32 s40, s98, 5
s_cmp_ge_u32 s40, 9
s_cselect_b32 s41, 9, 0
s_sub_u32 s40, s40, s41
s_mul_i32 s41, s40, 43
s_lshr_b32 s41, s41, 7
s_mul_i32 s74, s41, 3
s_sub_u32 s40, s40, s74
v_mfma_f32_32x32x16_bf16 a[176:191], v[144:147], v[168:171], a[176:191]
ds_read_b64_tr_b16 v[144:145], v238 offset:43008
ds_read_b64_tr_b16 v[146:147], v238 offset:44544
v_mfma_f32_32x32x16_bf16 a[192:207], v[148:151], v[168:171], a[192:207]
ds_read_b64_tr_b16 v[148:149], v235 offset:49280
ds_read_b64_tr_b16 v[150:151], v235 offset:50816
s_add_u32 m0, s34, 0x1d400
s_add_u32 s37, s37, 64
s_cmp_eq_u32 s37, 0x500
s_cselect_b32 s37, 0, s37
s_mul_i32 s38, s37, 6144
buffer_load_dwordx4 v229, s[12:15], s38 offen offset:0 lds
s_waitcnt lgkmcnt(4)
v_mfma_f32_16x16x32_bf16 a[240:243], v[152:155], v[172:175], a[240:243]
buffer_load_dwordx4 v230, s[12:15], s38 offen offset:1024 lds
v_mfma_f32_32x32x16_bf16 a[208:223], v[128:131], v[168:171], a[208:223]
ds_read_b64_tr_b16 v[152:153], v236 offset:49280
ds_read_b64_tr_b16 v[154:155], v236 offset:50816
ds_read_b64_tr_b16 v[128:129], v235 offset:49408
ds_read_b64_tr_b16 v[130:131], v235 offset:50944
buffer_load_dwordx4 v231, s[12:15], s38 offen offset:2048 lds
v_mfma_f32_32x32x16_bf16 a[224:239], v[132:135], v[168:171], a[224:239]
ds_read_b64_tr_b16 v[132:133], v236 offset:49408
ds_read_b64_tr_b16 v[134:135], v236 offset:50944
s_add_u32 s41, s41, s99
s_add_u32 s41, s41, 1
s_and_b32 s41, s41, 3
s_lshl2_add_u32 s41, s97, s41
s_mul_i32 s83, s41, 245760
s_mul_i32 s74, s40, 81920
s_add_u32 s83, s83, s74
s_add_u32 m0, s35, 0x20400
s_nop 0
buffer_load_dwordx4 v232, s[16:19], s37 offen lds
v_mfma_f32_32x32x16_bf16 a[144:159], v[136:139], v[176:179], a[144:159]
buffer_load_dwordx4 v233, s[16:19], s37 offen offset:1024 lds
v_mfma_f32_32x32x16_bf16 a[160:175], v[140:143], v[176:179], a[160:175]
ds_read_b64_tr_b16 v[136:137], v239 offset:43008
ds_read_b64_tr_b16 v[138:139], v239 offset:44544
s_waitcnt vmcnt(29)
s_barrier
s_add_u32 s41, s41, s101
s_mul_i32 s92, s41, 55296
s_lshl_b32 s74, s40, 12
s_add_u32 s92, s92, s74
s_mov_b32 m0, 0x22400
s_mov_b64 exec, s[42:43]
buffer_load_dwordx4 v234, s[16:19], s37 offen lds
s_mov_b64 exec, -1
s_waitcnt lgkmcnt(2)
v_mfma_f32_16x16x32_bf16 a[244:247], v[144:147], v[172:175], a[244:247]
v_mfma_f32_32x32x16_bf16 a[176:191], v[148:151], v[176:179], a[176:191]
ds_read_b64_tr_b16 v[140:141], v72 offset:0
ds_read_b64_tr_b16 v[142:143], v72 offset:1536
v_mfma_f32_32x32x16_bf16 a[192:207], v[152:155], v[176:179], a[192:207]
ds_read_b128 v[156:159], v77 offset:0
ds_read_b64_tr_b16 v[144:145], v73 offset:0
ds_read_b64_tr_b16 v[146:147], v73 offset:1536
ds_read_b64_tr_b16 v[148:149], v72 offset:128
ds_read_b64_tr_b16 v[150:151], v72 offset:1664
ds_read_b64_tr_b16 v[152:153], v73 offset:128
ds_read_b64_tr_b16 v[154:155], v73 offset:1664
v_mfma_f32_32x32x16_bf16 a[208:223], v[128:131], v[176:179], a[208:223]
ds_read_b64_tr_b16 v[128:129], v74 offset:0
ds_read_b64_tr_b16 v[130:131], v74 offset:1536
ds_read_b128 v[164:167], v79 offset:0
s_add_u32 s40, s98, 6
s_cmp_ge_u32 s40, 9
s_cselect_b32 s41, 9, 0
s_sub_u32 s40, s40, s41
s_mul_i32 s41, s40, 43
s_lshr_b32 s41, s41, 7
s_mul_i32 s74, s41, 3
s_sub_u32 s40, s40, s74
v_mfma_f32_32x32x16_bf16 a[224:239], v[132:135], v[176:179], a[224:239]
s_waitcnt lgkmcnt(7)
v_mfma_f32_16x16x32_bf16 a[248:251], v[136:139], v[172:175], a[248:251]
ds_read_b64_tr_b16 v[132:133], v72 offset:256
ds_read_b64_tr_b16 v[134:135], v72 offset:1792
v_mfma_f32_32x32x16_bf16 a[144:159], v[140:143], v[156:159], a[144:159]
ds_read_b64_tr_b16 v[136:137], v73 offset:256
ds_read_b64_tr_b16 v[138:139], v73 offset:1792
ds_read_b64_tr_b16 v[140:141], v72 offset:6144
ds_read_b64_tr_b16 v[142:143], v72 offset:7680
ds_read_b128 v[160:163], v78 offset:0
v_mfma_f32_32x32x16_bf16 a[160:175], v[144:147], v[156:159], a[160:175]
ds_read_b64_tr_b16 v[144:145], v73 offset:6144
ds_read_b64_tr_b16 v[146:147], v73 offset:7680
s_add_u32 s41, s41, s99
s_add_u32 s41, s41, 1
s_and_b32 s41, s41, 3
s_lshl2_add_u32 s41, s97, s41
s_mul_i32 s84, s41, 245760
s_mul_i32 s74, s40, 81920
s_add_u32 s84, s84, s74
s_waitcnt lgkmcnt(8)
v_mfma_f32_32x32x16_bf16 a[176:191], v[148:151], v[156:159], a[176:191]
ds_read_b64_tr_b16 v[148:149], v75 offset:0
ds_read_b64_tr_b16 v[150:151], v75 offset:1536
v_mfma_f32_32x32x16_bf16 a[192:207], v[152:155], v[156:159], a[192:207]
ds_read_b64_tr_b16 v[152:153], v72 offset:6272
ds_read_b64_tr_b16 v[154:155], v72 offset:7808
s_add_u32 m0, s34, 0x22800
s_add_u32 s37, s37, 64
s_cmp_eq_u32 s37, 0x500
s_cselect_b32 s37, 0, s37
s_mul_i32 s38, s37, 6144
buffer_load_dwordx4 v229, s[12:15], s38 offen offset:0 lds
v_mfma_f32_16x16x32_bf16 a[240:243], v[128:131], v[164:167], a[240:243]
s_add_u32 s41, s41, s101
s_mul_i32 s93, s41, 55296
s_lshl_b32 s74, s40, 12
s_add_u32 s93, s93, s74
buffer_load_dwordx4 v230, s[12:15], s38 offen offset:1024 lds
s_waitcnt lgkmcnt(4)
v_mfma_f32_32x32x16_bf16 a[208:223], v[132:135], v[156:159], a[208:223]
buffer_load_dwordx4 v231, s[12:15], s38 offen offset:2048 lds
v_mfma_f32_32x32x16_bf16 a[224:239], v[136:139], v[156:159], a[224:239]
ds_read_b64_tr_b16 v[128:129], v73 offset:6272
ds_read_b64_tr_b16 v[130:131], v73 offset:7808
ds_read_b64_tr_b16 v[132:133], v72 offset:6400
ds_read_b64_tr_b16 v[134:135], v72 offset:7936
s_add_u32 m0, s35, 0x25800
s_nop 0
buffer_load_dwordx4 v232, s[16:19], s37 offen lds
v_mfma_f32_32x32x16_bf16 a[144:159], v[140:143], v[160:163], a[144:159]
ds_read_b64_tr_b16 v[136:137], v73 offset:6400
ds_read_b64_tr_b16 v[138:139], v73 offset:7936
ds_read_b64_tr_b16 v[140:141], v76 offset:0
ds_read_b64_tr_b16 v[142:143], v76 offset:1536
buffer_load_dwordx4 v233, s[16:19], s37 offen offset:1024 lds
v_mfma_f32_32x32x16_bf16 a[160:175], v[144:147], v[160:163], a[160:175]
s_waitcnt vmcnt(29)
s_barrier
ds_read_b64_tr_b16 v[144:145], v72 offset:24576
ds_read_b64_tr_b16 v[146:147], v72 offset:26112
s_mov_b32 m0, 0x27800
s_mov_b64 exec, s[42:43]
buffer_load_dwordx4 v234, s[16:19], s37 offen lds
s_mov_b64 exec, -1
s_waitcnt lgkmcnt(6)
v_mfma_f32_16x16x32_bf16 a[244:247], v[148:151], v[164:167], a[244:247]
s_add_u32 s40, s98, 7
s_cmp_ge_u32 s40, 9
s_cselect_b32 s41, 9, 0
s_sub_u32 s40, s40, s41
s_mul_i32 s41, s40, 43
s_lshr_b32 s41, s41, 7
s_mul_i32 s74, s41, 3
s_sub_u32 s40, s40, s74
v_mfma_f32_32x32x16_bf16 a[176:191], v[152:155], v[160:163], a[176:191]
v_mfma_f32_32x32x16_bf16 a[192:207], v[128:131], v[160:163], a[192:207]
ds_read_b128 v[168:171], v77 offset:24576
ds_read_b64_tr_b16 v[148:149], v73 offset:24576
ds_read_b64_tr_b16 v[150:151], v73 offset:26112
ds_read_b64_tr_b16 v[152:153], v72 offset:24704
ds_read_b64_tr_b16 v[154:155], v72 offset:26240
ds_read_b64_tr_b16 v[128:129], v73 offset:24704
ds_read_b64_tr_b16 v[130:131], v73 offset:26240
v_mfma_f32_32x32x16_bf16 a[208:223], v[132:135], v[160:163], a[208:223]
ds_read_b64_tr_b16 v[132:133], v74 offset:24576
ds_read_b64_tr_b16 v[134:135], v74 offset:26112
ds_read_b128 v[176:179], v79 offset:24576
s_add_u32 s41, s41, s99
s_add_u32 s41, s41, 1
s_and_b32 s41, s41, 3
s_lshl2_add_u32 s41, s97, s41
s_mul_i32 s85, s41, 245760
s_mul_i32 s74, s40, 81920
s_add_u32 s85, s85, s74
s_waitcnt lgkmcnt(10)
v_mfma_f32_32x32x16_bf16 a[224:239], v[136:139], v[160:163], a[224:239]
ds_read_b64_tr_b16 v[136:137], v72 offset:24832
ds_read_b64_tr_b16 v[138:139], v72 offset:26368
v_mfma_f32_16x16x32_bf16 a[248:251], v[140:143], v[164:167], a[248:251]
ds_read_b64_tr_b16 v[140:141], v73 offset:24832
ds_read_b64_tr_b16 v[142:143], v73 offset:26368
s_waitcnt lgkmcnt(7)
v_mfma_f32_32x32x16_bf16 a[144:159], v[144:147], v[168:171], a[144:159]
ds_read_b64_tr_b16 v[144:145], v72 offset:30720
ds_read_b64_tr_b16 v[146:147], v72 offset:32256
ds_read_b128 v[172:175], v78 offset:24576
s_add_u32 s41, s41, s101
s_mul_i32 s94, s41, 55296
s_lshl_b32 s74, s40, 12
s_add_u32 s94, s94, s74
v_mfma_f32_32x32x16_bf16 a[160:175], v[148:151], v[168:171], a[160:175]
ds_read_b64_tr_b16 v[148:149], v73 offset:30720
ds_read_b64_tr_b16 v[150:151], v73 offset:32256
s_add_u32 m0, s33, 0x0
s_mov_b32 s39, 0x0
buffer_load_dwordx4 v208, s[4:7], s39 offen offset:0 nt lds
v_mfma_f32_32x32x16_bf16 a[176:191], v[152:155], v[168:171], a[176:191]
ds_read_b64_tr_b16 v[152:153], v75 offset:24576
ds_read_b64_tr_b16 v[154:155], v75 offset:26112
buffer_load_dwordx4 v209, s[4:7], s39 offen offset:1024 nt lds
v_mfma_f32_32x32x16_bf16 a[192:207], v[128:131], v[168:171], a[192:207]
ds_read_b64_tr_b16 v[128:129], v72 offset:30848
ds_read_b64_tr_b16 v[130:131], v72 offset:32384
s_add_u32 s40, s98, 8
s_cmp_ge_u32 s40, 9
s_cselect_b32 s41, 9, 0
s_sub_u32 s40, s40, s41
s_mul_i32 s41, s40, 43
s_lshr_b32 s41, s41, 7
s_mul_i32 s74, s41, 3
s_sub_u32 s40, s40, s74
s_waitcnt lgkmcnt(4)
v_mfma_f32_16x16x32_bf16 a[240:243], v[132:135], v[176:179], a[240:243]
v_mfma_f32_32x32x16_bf16 a[208:223], v[136:139], v[168:171], a[208:223]
ds_read_b64_tr_b16 v[132:133], v73 offset:30848
ds_read_b64_tr_b16 v[134:135], v73 offset:32384
ds_read_b64_tr_b16 v[136:137], v72 offset:30976
ds_read_b64_tr_b16 v[138:139], v72 offset:32512
buffer_load_dwordx4 v210, s[4:7], s39 offen offset:2048 nt lds
v_mfma_f32_32x32x16_bf16 a[224:239], v[140:143], v[168:171], a[224:239]
ds_read_b64_tr_b16 v[140:141], v73 offset:30976
ds_read_b64_tr_b16 v[142:143], v73 offset:32512
buffer_load_dwordx4 v211, s[4:7], s39 offen offset:3072 nt lds
v_mfma_f32_32x32x16_bf16 a[144:159], v[144:147], v[172:175], a[144:159]
ds_read_b64_tr_b16 v[144:145], v76 offset:24576
ds_read_b64_tr_b16 v[146:147], v76 offset:26112
s_waitcnt vmcnt(28)
s_barrier
s_add_u32 m0, s33, 0x1000
s_nop 0
buffer_load_dwordx4 v212, s[4:7], s39 offen offset:0 nt lds
v_mfma_f32_32x32x16_bf16 a[160:175], v[148:151], v[172:175], a[160:175]
ds_read_b64_tr_b16 v[148:149], v192 offset:0
ds_read_b64_tr_b16 v[150:151], v192 offset:1536
ds_read_b128 v[156:159], v197 offset:0
buffer_load_dwordx4 v213, s[4:7], s39 offen offset:1024 nt lds
s_waitcnt lgkmcnt(5)
v_mfma_f32_16x16x32_bf16 a[244:247], v[152:155], v[176:179], a[244:247]
ds_read_b64_tr_b16 v[152:153], v193 offset:0
ds_read_b64_tr_b16 v[154:155], v193 offset:1536
s_add_u32 s41, s41, s99
s_add_u32 s41, s41, 1
s_and_b32 s41, s41, 3
s_lshl2_add_u32 s41, s97, s41
s_mul_i32 s86, s41, 245760
s_mul_i32 s74, s40, 81920
s_add_u32 s86, s86, s74
v_mfma_f32_32x32x16_bf16 a[176:191], v[128:131], v[172:175], a[176:191]
v_mfma_f32_32x32x16_bf16 a[192:207], v[132:135], v[172:175], a[192:207]
ds_read_b64_tr_b16 v[128:129], v192 offset:128
ds_read_b64_tr_b16 v[130:131], v192 offset:1664
ds_read_b64_tr_b16 v[132:133], v193 offset:128
ds_read_b64_tr_b16 v[134:135], v193 offset:1664
s_add_u32 s41, s41, s101
s_mul_i32 s95, s41, 55296
s_lshl_b32 s74, s40, 12
s_add_u32 s95, s95, s74
v_mfma_f32_32x32x16_bf16 a[208:223], v[136:139], v[172:175], a[208:223]
ds_read_b64_tr_b16 v[136:137], v194 offset:0
ds_read_b64_tr_b16 v[138:139], v194 offset:1536
ds_read_b128 v[160:163], v199 offset:0
v_mfma_f32_32x32x16_bf16 a[224:239], v[140:143], v[172:175], a[224:239]
ds_read_b64_tr_b16 v[140:141], v192 offset:256
ds_read_b64_tr_b16 v[142:143], v192 offset:1792
s_mul_i32 s40, s32, 3
s_add_u32 s40, s40, 0
s_and_b32 s41, s40, 1
s_lshr_b32 s40, s40, 1
s_lshl_b32 s40, s40, 10
s_lshl_b32 s41, s41, 3
s_add_u32 s60, s40, s41
s_waitcnt lgkmcnt(5)
v_mfma_f32_16x16x32_bf16 a[248:251], v[144:147], v[176:179], a[248:251]
v_mfma_f32_32x32x16_bf16 a[144:159], v[148:151], v[156:159], a[144:159]
ds_read_b64_tr_b16 v[144:145], v193 offset:256
ds_read_b64_tr_b16 v[146:147], v193 offset:1792
ds_read_b64_tr_b16 v[148:149], v192 offset:6144
ds_read_b64_tr_b16 v[150:151], v192 offset:7680
ds_read_b128 v[164:167], v198 offset:0
v_mfma_f32_32x32x16_bf16 a[160:175], v[152:155], v[156:159], a[160:175]
ds_read_b64_tr_b16 v[152:153], v193 offset:6144
ds_read_b64_tr_b16 v[154:155], v193 offset:7680
s_add_u32 m0, s34, 0x6000
s_add_u32 s37, s37, 64
s_cmp_eq_u32 s37, 0x500
s_cselect_b32 s37, 0, s37
s_mul_i32 s38, s37, 6144
buffer_load_dwordx4 v229, s[12:15], s38 offen offset:0 lds
v_mfma_f32_32x32x16_bf16 a[176:191], v[128:131], v[156:159], a[176:191]
ds_read_b64_tr_b16 v[128:129], v195 offset:0
ds_read_b64_tr_b16 v[130:131], v195 offset:1536
v_mfma_f32_32x32x16_bf16 a[192:207], v[132:135], v[156:159], a[192:207]
ds_read_b64_tr_b16 v[132:133], v192 offset:6272
ds_read_b64_tr_b16 v[134:135], v192 offset:7808
s_mul_i32 s40, s32, 3
s_add_u32 s40, s40, 1
s_and_b32 s41, s40, 1
s_lshr_b32 s40, s40, 1
s_lshl_b32 s40, s40, 10
s_lshl_b32 s41, s41, 3
s_add_u32 s61, s40, s41
s_waitcnt lgkmcnt(4)
v_mfma_f32_16x16x32_bf16 a[240:243], v[136:139], v[160:163], a[240:243]
buffer_load_dwordx4 v230, s[12:15], s38 offen offset:1024 lds
v_mfma_f32_32x32x16_bf16 a[208:223], v[140:143], v[156:159], a[208:223]
ds_read_b64_tr_b16 v[136:137], v193 offset:6272
ds_read_b64_tr_b16 v[138:139], v193 offset:7808
ds_read_b64_tr_b16 v[140:141], v192 offset:6400
ds_read_b64_tr_b16 v[142:143], v192 offset:7936
buffer_load_dwordx4 v231, s[12:15], s38 offen offset:2048 lds
v_mfma_f32_32x32x16_bf16 a[224:239], v[144:147], v[156:159], a[224:239]
ds_read_b64_tr_b16 v[144:145], v193 offset:6400
ds_read_b64_tr_b16 v[146:147], v193 offset:7936
s_add_u32 m0, s35, 0x9000
s_nop 0
buffer_load_dwordx4 v232, s[16:19], s37 offen lds
v_mfma_f32_32x32x16_bf16 a[144:159], v[148:151], v[164:167], a[144:159]
ds_read_b64_tr_b16 v[148:149], v196 offset:0
ds_read_b64_tr_b16 v[150:151], v196 offset:1536
s_waitcnt vmcnt(28)
s_barrier
buffer_load_dwordx4 v233, s[16:19], s37 offen offset:1024 lds
v_mfma_f32_32x32x16_bf16 a[160:175], v[152:155], v[164:167], a[160:175]
ds_read_b64_tr_b16 v[152:153], v192 offset:24576
ds_read_b64_tr_b16 v[154:155], v192 offset:26112
ds_read_b128 v[168:171], v197 offset:24576
s_mul_i32 s40, s32, 3
s_add_u32 s40, s40, 2
s_and_b32 s41, s40, 1
s_lshr_b32 s40, s40, 1
s_lshl_b32 s40, s40, 10
s_lshl_b32 s41, s41, 3
s_add_u32 s62, s40, s41
s_mov_b32 m0, 0xb000
s_mov_b64 exec, s[42:43]
buffer_load_dwordx4 v234, s[16:19], s37 offen lds
s_mov_b64 exec, -1
s_waitcnt lgkmcnt(3)
v_mfma_f32_16x16x32_bf16 a[244:247], v[128:131], v[160:163], a[244:247]
v_mfma_f32_32x32x16_bf16 a[176:191], v[132:135], v[164:167], a[176:191]
ds_read_b64_tr_b16 v[128:129], v193 offset:24576
ds_read_b64_tr_b16 v[130:131], v193 offset:26112
v_mfma_f32_32x32x16_bf16 a[192:207], v[136:139], v[164:167], a[192:207]
ds_read_b64_tr_b16 v[132:133], v192 offset:24704
ds_read_b64_tr_b16 v[134:135], v192 offset:26240
ds_read_b64_tr_b16 v[136:137], v193 offset:24704
ds_read_b64_tr_b16 v[138:139], v193 offset:26240
s_lshl_b32 s60, s32, 10
s_and_b32 s61, s60, 0x400
s_add_u32 s61, s61, 0x1000
s_cmp_lt_u32 s32, 2
s_cselect_b32 s62, -1, 0
v_mfma_f32_32x32x16_bf16 a[208:223], v[140:143], v[164:167], a[208:223]
ds_read_b64_tr_b16 v[140:141], v194 offset:24576
ds_read_b64_tr_b16 v[142:143], v194 offset:26112
ds_read_b128 v[172:175], v199 offset:24576
s_lshl_b32 s3, s32, 13
s_sub_u32 s3, s3, 0x60000
v_lshrrev_b32 v48, 4, v244
v_mfma_f32_32x32x16_bf16 a[224:239], v[144:147], v[164:167], a[224:239]
ds_read_b64_tr_b16 v[144:145], v192 offset:24832
ds_read_b64_tr_b16 v[146:147], v192 offset:26368
v_and_b32 v48, 63, v48
v_mfma_f32_16x16x32_bf16 a[248:251], v[148:151], v[160:163], a[248:251]
ds_read_b64_tr_b16 v[148:149], v193 offset:24832
ds_read_b64_tr_b16 v[150:151], v193 offset:26368
v_and_b32 v49, 0, v48
v_add_u32 v49, s32, v49
s_waitcnt lgkmcnt(7)
v_mfma_f32_32x32x16_bf16 a[144:159], v[152:155], v[168:171], a[144:159]
ds_read_b64_tr_b16 v[152:153], v192 offset:30720
ds_read_b64_tr_b16 v[154:155], v192 offset:32256
ds_read_b128 v[176:179], v198 offset:24576
v_or_b32 v50, 0, v48
v_mul_u32_u24 v51, 0xccd, v50
v_mfma_f32_32x32x16_bf16 a[160:175], v[128:131], v[168:171], a[160:175]
ds_read_b64_tr_b16 v[128:129], v193 offset:30720
ds_read_b64_tr_b16 v[130:131], v193 offset:32256
v_lshrrev_b32 v51, 16, v51
v_mul_u32_u24 v52, 20, v51
v_subrev_u32 v52, v52, v50
v_mfma_f32_32x32x16_bf16 a[176:191], v[132:135], v[168:171], a[176:191]
ds_read_b64_tr_b16 v[132:133], v195 offset:24576
ds_read_b64_tr_b16 v[134:135], v195 offset:26112
v_lshlrev_b32 v53, 4, v49
v_add_u32 v53, v53, v51
s_add_u32 m0, s33, 0xc000
s_mov_b32 s39, 0x0
buffer_load_dwordx4 v214, s[8:11], s39 offen offset:0 nt lds
v_mfma_f32_32x32x16_bf16 a[192:207], v[136:139], v[168:171], a[192:207]
ds_read_b64_tr_b16 v[136:137], v192 offset:30848
ds_read_b64_tr_b16 v[138:139], v192 offset:32384
v_mul_u32_u24 v53, 0x500, v53
v_and_b32 v54, 4, v51
s_waitcnt lgkmcnt(4)
v_mfma_f32_16x16x32_bf16 a[240:243], v[140:143], v[172:175], a[240:243]
ds_read_b64_tr_b16 v[140:141], v193 offset:30848
ds_read_b64_tr_b16 v[142:143], v193 offset:32384
buffer_load_dwordx4 v215, s[8:11], s39 offen offset:1024 nt lds
v_mfma_f32_32x32x16_bf16 a[208:223], v[144:147], v[168:171], a[208:223]
ds_read_b64_tr_b16 v[144:145], v192 offset:30976
ds_read_b64_tr_b16 v[146:147], v192 offset:32512
v_lshrrev_b32 v54, 1, v54
v_xor_b32 v52, v52, v54
buffer_load_dwordx4 v216, s[8:11], s39 offen offset:2048 nt lds
v_mfma_f32_32x32x16_bf16 a[224:239], v[148:151], v[168:171], a[224:239]
ds_read_b64_tr_b16 v[148:149], v193 offset:30976
ds_read_b64_tr_b16 v[150:151], v193 offset:32512
v_lshlrev_b32 v52, 4, v52
s_add_u32 m0, s33, 0xcc00
s_add_u32 s39, s39, 0xc00
buffer_load_dwordx4 v214, s[8:11], s39 offen offset:0 nt lds
v_mfma_f32_32x32x16_bf16 a[144:159], v[152:155], v[176:179], a[144:159]
ds_read_b64_tr_b16 v[152:153], v196 offset:24576
ds_read_b64_tr_b16 v[154:155], v196 offset:26112
s_waitcnt vmcnt(28)
s_barrier
v_add_u32 v53, v53, v52
v_subrev_u32 v180, 0, v53
buffer_load_dwordx4 v215, s[8:11], s39 offen offset:1024 nt lds
v_mfma_f32_32x32x16_bf16 a[160:175], v[128:131], v[176:179], a[160:175]
ds_read_b64_tr_b16 v[128:129], v235 offset:0
ds_read_b64_tr_b16 v[130:131], v235 offset:1536
v_add_u32 v55, 64, v48
v_or_b32 v55, 0, v55
buffer_load_dwordx4 v216, s[8:11], s39 offen offset:2048 nt lds
s_waitcnt lgkmcnt(4)
v_mfma_f32_16x16x32_bf16 a[244:247], v[132:135], v[172:175], a[244:247]
v_mul_u32_u24 v56, 0xccd, v55
v_lshrrev_b32 v56, 16, v56
v_mfma_f32_32x32x16_bf16 a[176:191], v[136:139], v[176:179], a[176:191]
ds_read_b128 v[156:159], v240 offset:0
v_mul_u32_u24 v57, 20, v56
v_mfma_f32_32x32x16_bf16 a[192:207], v[140:143], v[176:179], a[192:207]
ds_read_b64_tr_b16 v[132:133], v236 offset:0
ds_read_b64_tr_b16 v[134:135], v236 offset:1536
ds_read_b64_tr_b16 v[136:137], v235 offset:128
ds_read_b64_tr_b16 v[138:139], v235 offset:1664
ds_read_b64_tr_b16 v[140:141], v236 offset:128
ds_read_b64_tr_b16 v[142:143], v236 offset:1664
v_subrev_u32 v57, v57, v55
v_lshlrev_b32 v58, 4, v49
v_mfma_f32_32x32x16_bf16 a[208:223], v[144:147], v[176:179], a[208:223]
ds_read_b64_tr_b16 v[144:145], v237 offset:0
ds_read_b64_tr_b16 v[146:147], v237 offset:1536
ds_read_b128 v[164:167], v242 offset:0
v_add_u32 v58, v58, v56
v_mul_u32_u24 v58, 0x500, v58
v_mfma_f32_32x32x16_bf16 a[224:239], v[148:151], v[176:179], a[224:239]
ds_read_b64_tr_b16 v[148:149], v235 offset:256
ds_read_b64_tr_b16 v[150:151], v235 offset:1792
v_and_b32 v59, 4, v56
v_lshrrev_b32 v59, 1, v59
s_waitcnt lgkmcnt(9)
v_mfma_f32_16x16x32_bf16 a[248:251], v[152:155], v[172:175], a[248:251]
ds_read_b64_tr_b16 v[152:153], v236 offset:256
ds_read_b64_tr_b16 v[154:155], v236 offset:1792
v_xor_b32 v57, v57, v59
v_mfma_f32_32x32x16_bf16 a[144:159], v[128:131], v[156:159], a[144:159]
ds_read_b64_tr_b16 v[128:129], v235 offset:6144
ds_read_b64_tr_b16 v[130:131], v235 offset:7680
ds_read_b128 v[160:163], v241 offset:0
v_lshlrev_b32 v57, 4, v57
v_add_u32 v58, v58, v57
v_mfma_f32_32x32x16_bf16 a[160:175], v[132:135], v[156:159], a[160:175]
ds_read_b64_tr_b16 v[132:133], v236 offset:6144
ds_read_b64_tr_b16 v[134:135], v236 offset:7680
v_subrev_u32 v181, 0x400, v58
v_add_u32 v60, 0x80, v48
v_or_b32 v60, 0, v60
v_mul_u32_u24 v61, 0xccd, v60
s_waitcnt lgkmcnt(7)
v_mfma_f32_32x32x16_bf16 a[176:191], v[136:139], v[156:159], a[176:191]
ds_read_b64_tr_b16 v[136:137], v238 offset:0
ds_read_b64_tr_b16 v[138:139], v238 offset:1536
v_lshrrev_b32 v61, 16, v61
s_add_u32 m0, s34, 0x12000
s_add_u32 s37, s37, 64
s_cmp_eq_u32 s37, 0x500
s_cselect_b32 s37, 0, s37
s_mul_i32 s38, s37, 6144
buffer_load_dwordx4 v229, s[12:15], s38 offen offset:0 lds
v_mfma_f32_32x32x16_bf16 a[192:207], v[140:143], v[156:159], a[192:207]
ds_read_b64_tr_b16 v[140:141], v235 offset:6272
ds_read_b64_tr_b16 v[142:143], v235 offset:7808
v_mfma_f32_16x16x32_bf16 a[240:243], v[144:147], v[164:167], a[240:243]
ds_read_b64_tr_b16 v[144:145], v236 offset:6272
ds_read_b64_tr_b16 v[146:147], v236 offset:7808
v_mul_u32_u24 v62, 20, v61
v_subrev_u32 v62, v62, v60
buffer_load_dwordx4 v230, s[12:15], s38 offen offset:1024 lds
v_mfma_f32_32x32x16_bf16 a[208:223], v[148:151], v[156:159], a[208:223]
ds_read_b64_tr_b16 v[148:149], v235 offset:6400
ds_read_b64_tr_b16 v[150:151], v235 offset:7936
v_lshlrev_b32 v63, 4, v49
v_add_u32 v63, v63, v61
buffer_load_dwordx4 v231, s[12:15], s38 offen offset:2048 lds
s_waitcnt lgkmcnt(6)
v_mfma_f32_32x32x16_bf16 a[224:239], v[152:155], v[156:159], a[224:239]
ds_read_b64_tr_b16 v[152:153], v236 offset:6400
ds_read_b64_tr_b16 v[154:155], v236 offset:7936
v_mul_u32_u24 v63, 0x500, v63
v_and_b32 v64, 4, v61
s_add_u32 m0, s35, 0x15000
s_nop 0
buffer_load_dwordx4 v232, s[16:19], s37 offen lds
v_mfma_f32_32x32x16_bf16 a[144:159], v[128:131], v[160:163], a[144:159]
ds_read_b64_tr_b16 v[128:129], v239 offset:0
ds_read_b64_tr_b16 v[130:131], v239 offset:1536
v_lshrrev_b32 v64, 1, v64
buffer_load_dwordx4 v233, s[16:19], s37 offen offset:1024 lds
v_mfma_f32_32x32x16_bf16 a[160:175], v[132:135], v[160:163], a[160:175]
s_waitcnt vmcnt(29)
s_barrier
v_xor_b32 v62, v62, v64
v_lshlrev_b32 v62, 4, v62
s_mov_b32 m0, 0x17000
s_mov_b64 exec, s[42:43]
buffer_load_dwordx4 v234, s[16:19], s37 offen lds
s_mov_b64 exec, -1
v_mfma_f32_16x16x32_bf16 a[244:247], v[136:139], v[164:167], a[244:247]
v_add_u32 v63, v63, v62
v_subrev_u32 v182, 0x800, v63
s_waitcnt lgkmcnt(2)
v_mfma_f32_32x32x16_bf16 a[176:191], v[140:143], v[160:163], a[176:191]
v_add_u32 v65, 0xc0, v48
v_or_b32 v65, 0, v65
v_mfma_f32_32x32x16_bf16 a[192:207], v[144:147], v[160:163], a[192:207]
ds_read_b64_tr_b16 v[132:133], v235 offset:21504
ds_read_b64_tr_b16 v[134:135], v235 offset:23040
ds_read_b128 v[168:171], v240 offset:21504
ds_read_b64_tr_b16 v[136:137], v236 offset:21504
ds_read_b64_tr_b16 v[138:139], v236 offset:23040
v_mul_u32_u24 v66, 0xccd, v65
v_mfma_f32_32x32x16_bf16 a[208:223], v[148:151], v[160:163], a[208:223]
ds_read_b64_tr_b16 v[140:141], v235 offset:21632
ds_read_b64_tr_b16 v[142:143], v235 offset:23168
ds_read_b64_tr_b16 v[144:145], v236 offset:21632
ds_read_b64_tr_b16 v[146:147], v236 offset:23168
v_lshrrev_b32 v66, 16, v66
v_mul_u32_u24 v67, 20, v66
v_mfma_f32_32x32x16_bf16 a[224:239], v[152:155], v[160:163], a[224:239]
ds_read_b64_tr_b16 v[148:149], v237 offset:21504
ds_read_b64_tr_b16 v[150:151], v237 offset:23040
ds_read_b128 v[176:179], v242 offset:21504
ds_read_b64_tr_b16 v[152:153], v235 offset:21760
ds_read_b64_tr_b16 v[154:155], v235 offset:23296
v_subrev_u32 v67, v67, v65
v_lshlrev_b32 v68, 4, v49
s_waitcnt lgkmcnt(10)
v_mfma_f32_16x16x32_bf16 a[248:251], v[128:131], v[164:167], a[248:251]
v_add_u32 v68, v68, v66
v_mul_u32_u24 v68, 0x500, v68
v_mfma_f32_32x32x16_bf16 a[144:159], v[132:135], v[168:171], a[144:159]
ds_read_b64_tr_b16 v[128:129], v236 offset:21760
ds_read_b64_tr_b16 v[130:131], v236 offset:23296
ds_read_b64_tr_b16 v[132:133], v235 offset:27648
ds_read_b64_tr_b16 v[134:135], v235 offset:29184
v_and_b32 v69, 4, v66
s_waitcnt lgkmcnt(9)
v_mfma_f32_32x32x16_bf16 a[160:175], v[136:139], v[168:171], a[160:175]
ds_read_b128 v[172:175], v241 offset:21504
ds_read_b64_tr_b16 v[136:137], v236 offset:27648
ds_read_b64_tr_b16 v[138:139], v236 offset:29184
v_lshrrev_b32 v69, 1, v69
v_xor_b32 v67, v67, v69
v_mfma_f32_32x32x16_bf16 a[176:191], v[140:143], v[168:171], a[176:191]
ds_read_b64_tr_b16 v[140:141], v238 offset:21504
ds_read_b64_tr_b16 v[142:143], v238 offset:23040
v_lshlrev_b32 v67, 4, v67
v_add_u32 v68, v68, v67
v_subrev_u32 v183, 0xc00, v68
v_mfma_f32_32x32x16_bf16 a[192:207], v[144:147], v[168:171], a[192:207]
ds_read_b64_tr_b16 v[144:145], v235 offset:27776
ds_read_b64_tr_b16 v[146:147], v235 offset:29312
v_add_u32 v70, 0x100, v48
v_or_b32 v70, 0, v70
v_mul_u32_u24 v71, 0xccd, v70
v_lshrrev_b32 v71, 16, v71
s_waitcnt lgkmcnt(6)
v_mfma_f32_16x16x32_bf16 a[240:243], v[148:151], v[176:179], a[240:243]
ds_read_b64_tr_b16 v[148:149], v236 offset:27776
ds_read_b64_tr_b16 v[150:151], v236 offset:29312
v_mfma_f32_32x32x16_bf16 a[208:223], v[152:155], v[168:171], a[208:223]
ds_read_b64_tr_b16 v[152:153], v235 offset:27904
ds_read_b64_tr_b16 v[154:155], v235 offset:29440
v_mul_u32_u24 v54, 20, v71
v_subrev_u32 v54, v54, v70
v_lshlrev_b32 v52, 4, v49
v_add_u32 v52, v52, v71
v_mfma_f32_32x32x16_bf16 a[224:239], v[128:131], v[168:171], a[224:239]
ds_read_b64_tr_b16 v[128:129], v236 offset:27904
ds_read_b64_tr_b16 v[130:131], v236 offset:29440
v_mul_u32_u24 v52, 0x500, v52
v_and_b32 v53, 4, v71
v_lshrrev_b32 v53, 1, v53
v_xor_b32 v54, v54, v53
v_mfma_f32_32x32x16_bf16 a[144:159], v[132:135], v[172:175], a[144:159]
ds_read_b64_tr_b16 v[132:133], v239 offset:21504
ds_read_b64_tr_b16 v[134:135], v239 offset:23040
s_waitcnt vmcnt(24)
s_barrier
v_lshlrev_b32 v54, 4, v54
v_add_u32 v52, v52, v54
s_waitcnt lgkmcnt(4)
v_mfma_f32_32x32x16_bf16 a[160:175], v[136:139], v[172:175], a[160:175]
ds_read_b64_tr_b16 v[136:137], v235 offset:43008
ds_read_b64_tr_b16 v[138:139], v235 offset:44544
ds_read_b128 v[156:159], v240 offset:43008
v_subrev_u32 v184, 0, v52
v_lshrrev_b32 v50, 2, v48
v_and_b32 v50, 3, v50
v_mfma_f32_16x16x32_bf16 a[244:247], v[140:143], v[176:179], a[244:247]
ds_read_b64_tr_b16 v[140:141], v236 offset:43008
ds_read_b64_tr_b16 v[142:143], v236 offset:44544
v_mfma_f32_32x32x16_bf16 a[176:191], v[144:147], v[172:175], a[176:191]
ds_read_b64_tr_b16 v[144:145], v235 offset:43136
ds_read_b64_tr_b16 v[146:147], v235 offset:44672
v_lshrrev_b32 v51, 5, v48
v_lshrrev_b32 v59, 4, v48
v_and_b32 v57, 1, v59
v_lshlrev_b32 v58, 2, v51
v_mfma_f32_32x32x16_bf16 a[192:207], v[148:151], v[172:175], a[192:207]
ds_read_b64_tr_b16 v[148:149], v236 offset:43136
ds_read_b64_tr_b16 v[150:151], v236 offset:44672
v_add_u32 v58, v58, v50
v_mul_u32_u24 v58, 0x140, v58
v_lshlrev_b32 v55, 1, v57
v_and_b32 v56, 1, v48
v_mfma_f32_32x32x16_bf16 a[208:223], v[152:155], v[172:175], a[208:223]
ds_read_b64_tr_b16 v[152:153], v237 offset:43008
ds_read_b64_tr_b16 v[154:155], v237 offset:44544
ds_read_b128 v[160:163], v242 offset:43008
v_add_u32 v55, v55, v56
v_lshlrev_b32 v64, 1, v51
v_xor_b32 v55, v55, v64
s_waitcnt lgkmcnt(5)
v_mfma_f32_32x32x16_bf16 a[224:239], v[128:131], v[172:175], a[224:239]
ds_read_b64_tr_b16 v[128:129], v235 offset:43264
ds_read_b64_tr_b16 v[130:131], v235 offset:44800
v_lshlrev_b32 v55, 4, v55
v_add_u32 v58, v58, v55
v_and_b32 v62, 2, v48
v_lshlrev_b32 v62, 2, v62
v_mfma_f32_16x16x32_bf16 a[248:251], v[132:135], v[176:179], a[248:251]
ds_read_b64_tr_b16 v[132:133], v236 offset:43264
ds_read_b64_tr_b16 v[134:135], v236 offset:44800
v_mfma_f32_32x32x16_bf16 a[144:159], v[136:139], v[156:159], a[144:159]
ds_read_b64_tr_b16 v[136:137], v235 offset:49152
ds_read_b64_tr_b16 v[138:139], v235 offset:50688
ds_read_b128 v[164:167], v241 offset:43008
v_add_u32 v58, v58, v62
v_add_u32 v185, 0x18000, v58
v_lshlrev_b32 v63, 2, v59
v_mfma_f32_32x32x16_bf16 a[160:175], v[140:143], v[156:159], a[160:175]
ds_read_b64_tr_b16 v[140:141], v236 offset:49152
ds_read_b64_tr_b16 v[142:143], v236 offset:50688
s_add_u32 m0, s34, 0x1d400
s_add_u32 s37, s37, 64
s_cmp_eq_u32 s37, 0x500
s_cselect_b32 s37, 0, s37
s_mul_i32 s38, s37, 6144
buffer_load_dwordx4 v229, s[12:15], s38 offen offset:0 lds
v_mfma_f32_32x32x16_bf16 a[176:191], v[144:147], v[156:159], a[176:191]
ds_read_b64_tr_b16 v[144:145], v238 offset:43008
ds_read_b64_tr_b16 v[146:147], v238 offset:44544
v_add_u32 v63, v63, v50
s_waitcnt lgkmcnt(4)
v_mfma_f32_32x32x16_bf16 a[192:207], v[148:151], v[156:159], a[192:207]
ds_read_b64_tr_b16 v[148:149], v235 offset:49280
ds_read_b64_tr_b16 v[150:151], v235 offset:50816
buffer_load_dwordx4 v230, s[12:15], s38 offen offset:1024 lds
buffer_load_dwordx4 v231, s[12:15], s38 offen offset:2048 lds
v_mfma_f32_16x16x32_bf16 a[240:243], v[152:155], v[160:163], a[240:243]
ds_read_b64_tr_b16 v[152:153], v236 offset:49280
ds_read_b64_tr_b16 v[154:155], v236 offset:50816
v_mfma_f32_32x32x16_bf16 a[208:223], v[128:131], v[156:159], a[208:223]
ds_read_b64_tr_b16 v[128:129], v235 offset:49408
ds_read_b64_tr_b16 v[130:131], v235 offset:50944
s_add_u32 m0, s35, 0x20400
s_nop 0
buffer_load_dwordx4 v232, s[16:19], s37 offen lds
v_mul_u32_u24 v63, 0x140, v63
v_mfma_f32_32x32x16_bf16 a[224:239], v[132:135], v[156:159], a[224:239]
ds_read_b64_tr_b16 v[132:133], v236 offset:49408
ds_read_b64_tr_b16 v[134:135], v236 offset:50944
buffer_load_dwordx4 v233, s[16:19], s37 offen offset:1024 lds
s_mov_b32 m0, 0x22400
s_mov_b64 exec, s[42:43]
buffer_load_dwordx4 v234, s[16:19], s37 offen lds
s_mov_b64 exec, -1
v_mfma_f32_32x32x16_bf16 a[144:159], v[136:139], v[164:167], a[144:159]
ds_read_b64_tr_b16 v[136:137], v239 offset:43008
ds_read_b64_tr_b16 v[138:139], v239 offset:44544
s_waitcnt vmcnt(18)
s_barrier
s_waitcnt lgkmcnt(4)
v_mfma_f32_32x32x16_bf16 a[160:175], v[140:143], v[164:167], a[160:175]
ds_read_b64_tr_b16 v[140:141], v72 offset:24576
ds_read_b64_tr_b16 v[142:143], v72 offset:26112
ds_read_b128 v[168:171], v77 offset:24576
v_and_b32 v60, 1, v48
v_lshlrev_b32 v60, 3, v60
v_mfma_f32_16x16x32_bf16 a[244:247], v[144:147], v[160:163], a[244:247]
ds_read_b64_tr_b16 v[144:145], v73 offset:24576
ds_read_b64_tr_b16 v[146:147], v73 offset:26112
v_mfma_f32_32x32x16_bf16 a[176:191], v[148:151], v[164:167], a[176:191]
ds_read_b64_tr_b16 v[148:149], v72 offset:24704
ds_read_b64_tr_b16 v[150:151], v72 offset:26240
v_add_u32 v63, v63, v60
v_add_u32 v63, 0x18000, v63
v_lshrrev_b32 v61, 1, v48
v_and_b32 v61, 1, v61
v_mfma_f32_32x32x16_bf16 a[192:207], v[152:155], v[164:167], a[192:207]
ds_read_b64_tr_b16 v[152:153], v73 offset:24704
ds_read_b64_tr_b16 v[154:155], v73 offset:26240
v_lshlrev_b32 v69, 1, v49
v_add_u32 v69, v69, v61
v_lshlrev_b32 v67, 1, v57
v_xor_b32 v69, v69, v67
v_mfma_f32_32x32x16_bf16 a[208:223], v[128:131], v[164:167], a[208:223]
ds_read_b64_tr_b16 v[128:129], v74 offset:24576
ds_read_b64_tr_b16 v[130:131], v74 offset:26112
ds_read_b128 v[172:175], v79 offset:24576
v_lshlrev_b32 v69, 4, v69
v_add_u32 v186, v63, v69
v_add_u32 v68, 4, v49
s_waitcnt lgkmcnt(5)
v_mfma_f32_32x32x16_bf16 a[224:239], v[132:135], v[164:167], a[224:239]
ds_read_b64_tr_b16 v[132:133], v72 offset:24832
ds_read_b64_tr_b16 v[134:135], v72 offset:26368
v_lshlrev_b32 v68, 1, v68
v_add_u32 v68, v68, v61
v_lshlrev_b32 v65, 1, v57
v_xor_b32 v68, v68, v65
v_mfma_f32_16x16x32_bf16 a[248:251], v[136:139], v[160:163], a[248:251]
ds_read_b64_tr_b16 v[136:137], v73 offset:24832
ds_read_b64_tr_b16 v[138:139], v73 offset:26368
v_mfma_f32_32x32x16_bf16 a[144:159], v[140:143], v[168:171], a[144:159]
ds_read_b64_tr_b16 v[140:141], v72 offset:30720
ds_read_b64_tr_b16 v[142:143], v72 offset:32256
ds_read_b128 v[176:179], v78 offset:24576
v_lshlrev_b32 v68, 4, v68
v_add_u32 v187, v63, v68
v_and_b32 v66, 1, v49
v_mfma_f32_32x32x16_bf16 a[160:175], v[144:147], v[168:171], a[160:175]
ds_read_b64_tr_b16 v[144:145], v73 offset:30720
ds_read_b64_tr_b16 v[146:147], v73 offset:32256
v_add_u32 v66, 8, v66
v_lshlrev_b32 v66, 1, v66
v_add_u32 v66, v66, v61
v_lshlrev_b32 v53, 1, v57
v_mfma_f32_32x32x16_bf16 a[176:191], v[148:151], v[168:171], a[176:191]
ds_read_b64_tr_b16 v[148:149], v75 offset:24576
ds_read_b64_tr_b16 v[150:151], v75 offset:26112
v_xor_b32 v66, v66, v53
v_lshlrev_b32 v66, 4, v66
v_add_u32 v188, v63, v66
s_waitcnt lgkmcnt(5)
v_mfma_f32_32x32x16_bf16 a[192:207], v[152:155], v[168:171], a[192:207]
ds_read_b64_tr_b16 v[152:153], v72 offset:30848
ds_read_b64_tr_b16 v[154:155], v72 offset:32384
v_mfma_f32_16x16x32_bf16 a[240:243], v[128:131], v[172:175], a[240:243]
ds_read_b64_tr_b16 v[128:129], v73 offset:30848
ds_read_b64_tr_b16 v[130:131], v73 offset:32384
v_mfma_f32_32x32x16_bf16 a[208:223], v[132:135], v[168:171], a[208:223]
ds_read_b64_tr_b16 v[132:133], v72 offset:30976
ds_read_b64_tr_b16 v[134:135], v72 offset:32512
v_mfma_f32_32x32x16_bf16 a[224:239], v[136:139], v[168:171], a[224:239]
ds_read_b64_tr_b16 v[136:137], v73 offset:30976
ds_read_b64_tr_b16 v[138:139], v73 offset:32512
s_waitcnt lgkmcnt(8)
v_mfma_f32_32x32x16_bf16 a[144:159], v[140:143], v[176:179], a[144:159]
ds_read_b64_tr_b16 v[140:141], v76 offset:24576
ds_read_b64_tr_b16 v[142:143], v76 offset:26112
s_waitcnt vmcnt(0)
s_barrier
v_mfma_f32_32x32x16_bf16 a[160:175], v[144:147], v[176:179], a[160:175]
ds_read_b64_tr_b16 v[144:145], v194 offset:24576
ds_read_b64_tr_b16 v[146:147], v194 offset:26112
ds_read_b128 v[156:159], v199 offset:24576
v_mfma_f32_16x16x32_bf16 a[244:247], v[148:151], v[172:175], a[244:247]
ds_read_b64_tr_b16 v[148:149], v192 offset:24576
ds_read_b64_tr_b16 v[150:151], v192 offset:26112
s_waitcnt lgkmcnt(9)
v_mfma_f32_32x32x16_bf16 a[176:191], v[152:155], v[176:179], a[176:191]
ds_read_b128 v[164:167], v197 offset:24576
ds_read_b64_tr_b16 v[152:153], v195 offset:24576
ds_read_b64_tr_b16 v[154:155], v195 offset:26112
v_mfma_f32_32x32x16_bf16 a[192:207], v[128:131], v[176:179], a[192:207]
ds_read_b64_tr_b16 v[128:129], v193 offset:24576
ds_read_b64_tr_b16 v[130:131], v193 offset:26112
v_mfma_f32_32x32x16_bf16 a[208:223], v[132:135], v[176:179], a[208:223]
ds_read_b64_tr_b16 v[132:133], v196 offset:24576
ds_read_b64_tr_b16 v[134:135], v196 offset:26112
s_waitcnt lgkmcnt(9)
v_mfma_f32_32x32x16_bf16 a[224:239], v[136:139], v[176:179], a[224:239]
ds_read_b64_tr_b16 v[136:137], v192 offset:24704
ds_read_b64_tr_b16 v[138:139], v192 offset:26240
v_mfma_f32_16x16x32_bf16 a[248:251], v[140:143], v[172:175], a[248:251]
ds_read_b64_tr_b16 v[140:141], v237 offset:21504
ds_read_b64_tr_b16 v[142:143], v237 offset:23040
v_mfma_f32_16x16x32_bf16 a[240:243], v[144:147], v[156:159], a[240:243]
ds_read_b128 v[160:163], v242 offset:21504
ds_read_b64_tr_b16 v[144:145], v193 offset:24704
ds_read_b64_tr_b16 v[146:147], v193 offset:26240
s_waitcnt lgkmcnt(9)
v_mfma_f32_32x32x16_bf16 a[144:159], v[148:151], v[164:167], a[144:159]
ds_read_b64_tr_b16 v[148:149], v238 offset:21504
ds_read_b64_tr_b16 v[150:151], v238 offset:23040
s_add_u32 m0, s33, 0x6000
s_mov_b32 s39, 0x6000
buffer_load_dwordx4 v208, s[4:7], s39 offen offset:0 nt lds
v_mfma_f32_16x16x32_bf16 a[244:247], v[152:155], v[156:159], a[244:247]
ds_read_b64_tr_b16 v[152:153], v192 offset:24832
ds_read_b64_tr_b16 v[154:155], v192 offset:26368
v_mfma_f32_32x32x16_bf16 a[160:175], v[128:131], v[164:167], a[160:175]
ds_read_b64_tr_b16 v[128:129], v239 offset:21504
ds_read_b64_tr_b16 v[130:131], v239 offset:23040
v_lshrrev_b32 v254, 4, v244
v_and_b32 v255, 15, v254
v_mul_u32_u24 v255, 0x190, v255
v_bfe_u32 v254, v254, 4, 2
s_waitcnt lgkmcnt(6)
v_mfma_f32_16x16x32_bf16 a[248:251], v[132:135], v[156:159], a[248:251]
ds_read_b64_tr_b16 v[132:133], v193 offset:24832
ds_read_b64_tr_b16 v[134:135], v193 offset:26368
v_mfma_f32_32x32x16_bf16 a[176:191], v[136:139], v[164:167], a[176:191]
ds_read_b64_tr_b16 v[136:137], v192 offset:30720
ds_read_b64_tr_b16 v[138:139], v192 offset:32256
ds_read_b128 v[168:171], v198 offset:24576
buffer_load_dwordx4 v209, s[4:7], s39 offen offset:1024 nt lds
v_mfma_f32_16x16x32_bf16 a[240:243], v[140:143], v[160:163], a[240:243]
ds_read_b64_tr_b16 v[140:141], v235 offset:21504
ds_read_b64_tr_b16 v[142:143], v235 offset:23040
v_mfma_f32_32x32x16_bf16 a[192:207], v[144:147], v[164:167], a[192:207]
ds_read_b128 v[176:179], v240 offset:21504
ds_read_b64_tr_b16 v[144:145], v235 offset:27648
ds_read_b64_tr_b16 v[146:147], v235 offset:29184
ds_read_b128 v[172:175], v241 offset:21504
buffer_load_dwordx4 v210, s[4:7], s39 offen offset:2048 nt lds
s_waitcnt lgkmcnt(9)
v_mfma_f32_16x16x32_bf16 a[244:247], v[148:151], v[160:163], a[244:247]
ds_read_b64_tr_b16 v[148:149], v193 offset:30720
ds_read_b64_tr_b16 v[150:151], v193 offset:32256
v_mfma_f32_32x32x16_bf16 a[208:223], v[152:155], v[164:167], a[208:223]
ds_read_b64_tr_b16 v[152:153], v236 offset:21504
ds_read_b64_tr_b16 v[154:155], v236 offset:23040
v_lshl_add_u32 v251, v254, 4, v255
v_lshl_add_u32 v254, v254, 3, v255
s_mul_i32 s40, s32, 96
v_add_u32 v254, s40, v254
v_add_u32 v251, 0x18000, v251
v_add_u32 v254, 0x18000, v254
v_mfma_f32_16x16x32_bf16 a[248:251], v[128:131], v[160:163], a[248:251]
v_mfma_f32_32x32x16_bf16 a[224:239], v[132:135], v[164:167], a[224:239]
ds_read_b64_tr_b16 v[128:129], v236 offset:27648
ds_read_b64_tr_b16 v[130:131], v236 offset:29184
ds_read_b64_tr_b16 v[132:133], v192 offset:30848
ds_read_b64_tr_b16 v[134:135], v192 offset:32384
buffer_load_dwordx4 v211, s[4:7], s39 offen offset:3072 nt lds
s_waitcnt lgkmcnt(6)
v_mfma_f32_32x32x16_bf16 a[144:159], v[136:139], v[168:171], a[144:159]
ds_read_b64_tr_b16 v[136:137], v235 offset:21632
ds_read_b64_tr_b16 v[138:139], v235 offset:23168
v_accvgpr_read_b32 v88, a240
v_accvgpr_read_b32 v89, a241
v_accvgpr_read_b32 v90, a242
v_accvgpr_read_b32 v91, a243
v_mfma_f32_32x32x16_bf16 a[144:159], v[140:143], v[176:179], a[144:159]
ds_read_b64_tr_b16 v[140:141], v235 offset:27776
ds_read_b64_tr_b16 v[142:143], v235 offset:29312
s_add_u32 m0, s33, 0x7000
s_nop 0
buffer_load_dwordx4 v212, s[4:7], s39 offen offset:0 nt lds
v_mfma_f32_32x32x16_bf16 a[144:159], v[144:147], v[172:175], a[144:159]
ds_read_b64_tr_b16 v[144:145], v193 offset:30848
ds_read_b64_tr_b16 v[146:147], v193 offset:32384
v_pk_mul_f32 v[88:89], v[88:89], s[2:3] op_sel_hi:[1,0]
v_pk_mul_f32 v[90:91], v[90:91], s[2:3] op_sel_hi:[1,0]
v_cvt_pk_bf16_f32 v88, v88, v89
v_cvt_pk_bf16_f32 v89, v90, v91
v_mfma_f32_32x32x16_bf16 a[160:175], v[148:151], v[168:171], a[160:175]
ds_read_b64_tr_b16 v[148:149], v236 offset:21632
ds_read_b64_tr_b16 v[150:151], v236 offset:23168
ds_write_b64 v254, v[88:89] offset:0
v_accvgpr_read_b32 v96, a244
v_accvgpr_read_b32 v97, a245
v_accvgpr_read_b32 v98, a246
v_accvgpr_read_b32 v99, a247
s_waitcnt lgkmcnt(5)
v_mfma_f32_32x32x16_bf16 a[160:175], v[152:155], v[176:179], a[160:175]
ds_read_b64_tr_b16 v[152:153], v236 offset:27776
ds_read_b64_tr_b16 v[154:155], v236 offset:29312
buffer_load_dwordx4 v213, s[4:7], s39 offen offset:1024 nt lds
v_mfma_f32_32x32x16_bf16 a[160:175], v[128:131], v[172:175], a[160:175]
ds_read_b64_tr_b16 v[128:129], v192 offset:30976
ds_read_b64_tr_b16 v[130:131], v192 offset:32512
v_pk_mul_f32 v[96:97], v[96:97], s[2:3] op_sel_hi:[1,0]
v_pk_mul_f32 v[98:99], v[98:99], s[2:3] op_sel_hi:[1,0]
v_cvt_pk_bf16_f32 v96, v96, v97
v_cvt_pk_bf16_f32 v97, v98, v99
v_mfma_f32_32x32x16_bf16 a[176:191], v[132:135], v[168:171], a[176:191]
ds_read_b64_tr_b16 v[132:133], v235 offset:21760
ds_read_b64_tr_b16 v[134:135], v235 offset:23296
s_waitcnt lgkmcnt(6)
ds_write_b64 v254, v[96:97] offset:32
v_accvgpr_read_b32 v108, a248
v_accvgpr_read_b32 v109, a249
v_accvgpr_read_b32 v110, a250
v_accvgpr_read_b32 v111, a251
v_mfma_f32_32x32x16_bf16 a[176:191], v[136:139], v[176:179], a[176:191]
ds_read_b64_tr_b16 v[136:137], v235 offset:27904
ds_read_b64_tr_b16 v[138:139], v235 offset:29440
v_pk_mul_f32 v[108:109], v[108:109], s[2:3] op_sel_hi:[1,0]
v_pk_mul_f32 v[110:111], v[110:111], s[2:3] op_sel_hi:[1,0]
v_mfma_f32_32x32x16_bf16 a[176:191], v[140:143], v[172:175], a[176:191]
ds_read_b64_tr_b16 v[140:141], v193 offset:30976
ds_read_b64_tr_b16 v[142:143], v193 offset:32512
v_cvt_pk_bf16_f32 v108, v108, v109
v_cvt_pk_bf16_f32 v109, v110, v111
s_waitcnt lgkmcnt(4)
ds_write_b64 v254, v[108:109] offset:64
v_mfma_f32_32x32x16_bf16 a[192:207], v[144:147], v[168:171], a[192:207]
ds_read_b64_tr_b16 v[144:145], v236 offset:21760
ds_read_b64_tr_b16 v[146:147], v236 offset:23296
v_accvgpr_read_b32 v116, a144
v_accvgpr_read_b32 v117, a145
v_accvgpr_read_b32 v118, a146
v_accvgpr_read_b32 v119, a147
v_mfma_f32_32x32x16_bf16 a[192:207], v[148:151], v[176:179], a[192:207]
ds_read_b64_tr_b16 v[148:149], v236 offset:27904
ds_read_b64_tr_b16 v[150:151], v236 offset:29440
v_accvgpr_read_b32 v120, a148
v_accvgpr_read_b32 v121, a149
v_accvgpr_read_b32 v122, a150
v_accvgpr_read_b32 v123, a151
v_mfma_f32_32x32x16_bf16 a[192:207], v[152:155], v[172:175], a[192:207]
s_waitcnt lgkmcnt(0)
s_barrier
ds_read_b128 v[152:155], v217 offset:0
v_pk_mul_f32 v[116:117], v[116:117], s[2:3] op_sel_hi:[1,0]
v_pk_mul_f32 v[118:119], v[118:119], s[2:3] op_sel_hi:[1,0]
v_mfma_f32_32x32x16_bf16 a[208:223], v[128:131], v[168:171], a[208:223]
ds_read_b128 v[128:131], v218 offset:0
v_pk_mul_f32 v[120:121], v[120:121], s[2:3] op_sel_hi:[1,0]
v_pk_mul_f32 v[122:123], v[122:123], s[2:3] op_sel_hi:[1,0]
v_cvt_pk_bf16_f32 v0, v116, v117
v_cvt_pk_bf16_f32 v1, v118, v119
v_cvt_pk_bf16_f32 v2, v120, v121
v_cvt_pk_bf16_f32 v3, v122, v123
v_mfma_f32_32x32x16_bf16 a[208:223], v[132:135], v[176:179], a[208:223]
ds_read_b128 v[132:135], v219 offset:0
v_accvgpr_read_b32 v88, a152
v_accvgpr_read_b32 v89, a153
v_accvgpr_read_b32 v90, a154
v_accvgpr_read_b32 v91, a155
v_mfma_f32_32x32x16_bf16 a[208:223], v[136:139], v[172:175], a[208:223]
ds_read_b128 v[136:139], v220 offset:0
v_accvgpr_read_b32 v92, a156
v_accvgpr_read_b32 v93, a157
v_accvgpr_read_b32 v94, a158
v_accvgpr_read_b32 v95, a159
v_mfma_f32_32x32x16_bf16 a[224:239], v[140:143], v[168:171], a[224:239]
ds_read_b128 v[140:143], v217 offset:128
v_pk_mul_f32 v[88:89], v[88:89], s[2:3] op_sel_hi:[1,0]
v_pk_mul_f32 v[90:91], v[90:91], s[2:3] op_sel_hi:[1,0]
v_pk_mul_f32 v[92:93], v[92:93], s[2:3] op_sel_hi:[1,0]
v_pk_mul_f32 v[94:95], v[94:95], s[2:3] op_sel_hi:[1,0]
v_mfma_f32_32x32x16_bf16 a[224:239], v[144:147], v[176:179], a[224:239]
ds_read_b128 v[144:147], v218 offset:128
v_cvt_pk_bf16_f32 v4, v88, v89
v_cvt_pk_bf16_f32 v5, v90, v91
v_cvt_pk_bf16_f32 v6, v92, v93
v_cvt_pk_bf16_f32 v7, v94, v95
v_mfma_f32_32x32x16_bf16 a[224:239], v[148:151], v[172:175], a[224:239]
ds_read_b128 v[148:151], v219 offset:128
v_accvgpr_read_b32 v96, a160
v_accvgpr_read_b32 v97, a161
v_accvgpr_read_b32 v98, a162
v_accvgpr_read_b32 v99, a163
s_waitcnt lgkmcnt(3)
v_mfma_f32_32x32x16_bf16 v[72:87], v[152:155], v[0:3], 0
ds_read_b128 v[152:155], v220 offset:128
v_accvgpr_read_b32 v100, a164
v_accvgpr_read_b32 v101, a165
v_accvgpr_read_b32 v102, a166
v_accvgpr_read_b32 v103, a167
ds_read_b128 v[48:51], v251 offset:0
v_mfma_f32_32x32x16_bf16 v[72:87], v[128:131], v[4:7], v[72:87]
ds_read_b128 v[128:131], v217 offset:256
v_pk_mul_f32 v[96:97], v[96:97], s[2:3] op_sel_hi:[1,0]
v_pk_mul_f32 v[98:99], v[98:99], s[2:3] op_sel_hi:[1,0]
v_pk_mul_f32 v[100:101], v[100:101], s[2:3] op_sel_hi:[1,0]
v_pk_mul_f32 v[102:103], v[102:103], s[2:3] op_sel_hi:[1,0]
v_cvt_pk_bf16_f32 v8, v96, v97
v_cvt_pk_bf16_f32 v9, v98, v99
v_cvt_pk_bf16_f32 v10, v100, v101
v_cvt_pk_bf16_f32 v11, v102, v103
s_nop 1
v_mfma_f32_32x32x16_bf16 v[72:87], v[132:135], v[8:11], v[72:87]
ds_read_b128 v[132:135], v218 offset:256
v_accvgpr_read_b32 v108, a168
v_accvgpr_read_b32 v109, a169
v_accvgpr_read_b32 v110, a170
v_accvgpr_read_b32 v111, a171
v_accvgpr_read_b32 v112, a172
v_accvgpr_read_b32 v113, a173
v_accvgpr_read_b32 v114, a174
v_accvgpr_read_b32 v115, a175
v_pk_mul_f32 v[108:109], v[108:109], s[2:3] op_sel_hi:[1,0]
v_pk_mul_f32 v[110:111], v[110:111], s[2:3] op_sel_hi:[1,0]
v_pk_mul_f32 v[112:113], v[112:113], s[2:3] op_sel_hi:[1,0]
v_pk_mul_f32 v[114:115], v[114:115], s[2:3] op_sel_hi:[1,0]
v_cvt_pk_bf16_f32 v12, v108, v109
v_cvt_pk_bf16_f32 v13, v110, v111
v_cvt_pk_bf16_f32 v14, v112, v113
v_cvt_pk_bf16_f32 v15, v114, v115
s_nop 1
v_mfma_f32_32x32x16_bf16 v[72:87], v[136:139], v[12:15], v[72:87]
s_add_u32 m0, s34, 0x1d400
s_add_u32 s37, s37, 64
s_cmp_eq_u32 s37, 0x500
s_cselect_b32 s37, 0, s37
s_mul_i32 s38, s37, 6144
s_add_u32 s38, s38, 6144
buffer_load_dwordx4 v229, s[12:15], s38 offen offset:0 lds
buffer_load_dwordx4 v230, s[12:15], s38 offen offset:1024 lds
v_accvgpr_read_b32 v116, a176
v_accvgpr_read_b32 v117, a177
v_accvgpr_read_b32 v118, a178
v_accvgpr_read_b32 v119, a179
v_accvgpr_read_b32 v120, a180
v_accvgpr_read_b32 v121, a181
v_accvgpr_read_b32 v122, a182
v_accvgpr_read_b32 v123, a183
v_pk_mul_f32 v[116:117], v[116:117], s[2:3] op_sel_hi:[1,0]
v_pk_mul_f32 v[118:119], v[118:119], s[2:3] op_sel_hi:[1,0]
v_pk_mul_f32 v[120:121], v[120:121], s[2:3] op_sel_hi:[1,0]
v_pk_mul_f32 v[122:123], v[122:123], s[2:3] op_sel_hi:[1,0]
v_cvt_pk_bf16_f32 v16, v116, v117
v_cvt_pk_bf16_f32 v17, v118, v119
v_cvt_pk_bf16_f32 v18, v120, v121
v_cvt_pk_bf16_f32 v19, v122, v123
s_waitcnt lgkmcnt(0)
s_nop 0
v_mfma_f32_32x32x16_bf16 v[72:87], v[140:143], v[16:19], v[72:87]
buffer_load_dwordx4 v231, s[12:15], s38 offen offset:2048 lds
v_accvgpr_read_b32 v88, a184
v_accvgpr_read_b32 v89, a185
v_accvgpr_read_b32 v90, a186
v_accvgpr_read_b32 v91, a187
v_accvgpr_read_b32 v92, a188
v_accvgpr_read_b32 v93, a189
v_accvgpr_read_b32 v94, a190
v_accvgpr_read_b32 v95, a191
v_pk_mul_f32 v[88:89], v[88:89], s[2:3] op_sel_hi:[1,0]
v_pk_mul_f32 v[90:91], v[90:91], s[2:3] op_sel_hi:[1,0]
v_pk_mul_f32 v[92:93], v[92:93], s[2:3] op_sel_hi:[1,0]
v_pk_mul_f32 v[94:95], v[94:95], s[2:3] op_sel_hi:[1,0]
v_cvt_pk_bf16_f32 v20, v88, v89
v_cvt_pk_bf16_f32 v21, v90, v91
v_cvt_pk_bf16_f32 v22, v92, v93
v_cvt_pk_bf16_f32 v23, v94, v95
s_nop 1
v_mfma_f32_32x32x16_bf16 v[72:87], v[144:147], v[20:23], v[72:87]
s_add_u32 m0, s35, 0x20400
s_nop 0
buffer_load_dwordx4 v232, s[16:19], s37 offen lds
v_accvgpr_read_b32 v96, a192
v_accvgpr_read_b32 v97, a193
v_accvgpr_read_b32 v98, a194
v_accvgpr_read_b32 v99, a195
v_accvgpr_read_b32 v100, a196
v_accvgpr_read_b32 v101, a197
v_accvgpr_read_b32 v102, a198
v_accvgpr_read_b32 v103, a199
v_pk_mul_f32 v[96:97], v[96:97], s[2:3] op_sel_hi:[1,0]
v_pk_mul_f32 v[98:99], v[98:99], s[2:3] op_sel_hi:[1,0]
v_pk_mul_f32 v[100:101], v[100:101], s[2:3] op_sel_hi:[1,0]
v_pk_mul_f32 v[102:103], v[102:103], s[2:3] op_sel_hi:[1,0]
v_cvt_pk_bf16_f32 v24, v96, v97
v_cvt_pk_bf16_f32 v25, v98, v99
v_cvt_pk_bf16_f32 v26, v100, v101
v_cvt_pk_bf16_f32 v27, v102, v103
s_nop 1
v_mfma_f32_32x32x16_bf16 v[72:87], v[148:151], v[24:27], v[72:87]
ds_read_b128 v[136:139], v219 offset:256
buffer_load_dwordx4 v233, s[16:19], s37 offen offset:1024 lds
v_accvgpr_read_b32 v108, a200
v_accvgpr_read_b32 v109, a201
v_accvgpr_read_b32 v110, a202
v_accvgpr_read_b32 v111, a203
v_accvgpr_read_b32 v112, a204
v_accvgpr_read_b32 v113, a205
v_accvgpr_read_b32 v114, a206
v_accvgpr_read_b32 v115, a207
v_pk_mul_f32 v[108:109], v[108:109], s[2:3] op_sel_hi:[1,0]
v_pk_mul_f32 v[110:111], v[110:111], s[2:3] op_sel_hi:[1,0]
v_pk_mul_f32 v[112:113], v[112:113], s[2:3] op_sel_hi:[1,0]
v_pk_mul_f32 v[114:115], v[114:115], s[2:3] op_sel_hi:[1,0]
v_cvt_pk_bf16_f32 v28, v108, v109
v_cvt_pk_bf16_f32 v29, v110, v111
v_cvt_pk_bf16_f32 v30, v112, v113
v_cvt_pk_bf16_f32 v31, v114, v115
s_nop 1
v_mfma_f32_32x32x16_bf16 v[72:87], v[152:155], v[28:31], v[72:87]
ds_read_b128 v[140:143], v220 offset:256
s_mov_b32 m0, 0x22400
s_mov_b64 exec, s[42:43]
buffer_load_dwordx4 v234, s[16:19], s37 offen lds
s_mov_b64 exec, -1
v_accvgpr_read_b32 v116, a208
v_accvgpr_read_b32 v117, a209
v_accvgpr_read_b32 v118, a210
v_accvgpr_read_b32 v119, a211
v_accvgpr_read_b32 v120, a212
v_accvgpr_read_b32 v121, a213
v_accvgpr_read_b32 v122, a214
v_accvgpr_read_b32 v123, a215
v_pk_mul_f32 v[116:117], v[116:117], s[2:3] op_sel_hi:[1,0]
v_pk_mul_f32 v[118:119], v[118:119], s[2:3] op_sel_hi:[1,0]
v_pk_mul_f32 v[120:121], v[120:121], s[2:3] op_sel_hi:[1,0]
v_pk_mul_f32 v[122:123], v[122:123], s[2:3] op_sel_hi:[1,0]
v_cvt_pk_bf16_f32 v32, v116, v117
v_cvt_pk_bf16_f32 v33, v118, v119
v_cvt_pk_bf16_f32 v34, v120, v121
v_cvt_pk_bf16_f32 v35, v122, v123
s_nop 1
v_mfma_f32_32x32x16_bf16 v[72:87], v[128:131], v[32:35], v[72:87]
ds_read_b128 v[144:147], v221 offset:0
s_add_u32 m0, s34, 0x22800
s_add_u32 s37, s37, 64
s_cmp_eq_u32 s37, 0x500
s_cselect_b32 s37, 0, s37
s_mul_i32 s38, s37, 6144
s_add_u32 s38, s38, 6144
buffer_load_dwordx4 v229, s[12:15], s38 offen offset:0 lds
v_accvgpr_read_b32 v88, a216
v_accvgpr_read_b32 v89, a217
v_accvgpr_read_b32 v90, a218
v_accvgpr_read_b32 v91, a219
v_accvgpr_read_b32 v92, a220
v_accvgpr_read_b32 v93, a221
v_accvgpr_read_b32 v94, a222
v_accvgpr_read_b32 v95, a223
v_pk_mul_f32 v[88:89], v[88:89], s[2:3] op_sel_hi:[1,0]
v_pk_mul_f32 v[90:91], v[90:91], s[2:3] op_sel_hi:[1,0]
v_pk_mul_f32 v[92:93], v[92:93], s[2:3] op_sel_hi:[1,0]
v_pk_mul_f32 v[94:95], v[94:95], s[2:3] op_sel_hi:[1,0]
v_cvt_pk_bf16_f32 v36, v88, v89
v_cvt_pk_bf16_f32 v37, v90, v91
v_cvt_pk_bf16_f32 v38, v92, v93
v_cvt_pk_bf16_f32 v39, v94, v95
s_nop 1
v_mfma_f32_32x32x16_bf16 v[72:87], v[132:135], v[36:39], v[72:87]
ds_read_b128 v[148:151], v222 offset:0
ds_read_b128 v[152:155], v221 offset:128
buffer_load_dwordx4 v230, s[12:15], s38 offen offset:1024 lds
v_accvgpr_read_b32 v96, a224
v_accvgpr_read_b32 v97, a225
v_accvgpr_read_b32 v98, a226
v_accvgpr_read_b32 v99, a227
v_accvgpr_read_b32 v100, a228
v_accvgpr_read_b32 v101, a229
v_accvgpr_read_b32 v102, a230
v_accvgpr_read_b32 v103, a231
v_pk_mul_f32 v[96:97], v[96:97], s[2:3] op_sel_hi:[1,0]
v_pk_mul_f32 v[98:99], v[98:99], s[2:3] op_sel_hi:[1,0]
v_pk_mul_f32 v[100:101], v[100:101], s[2:3] op_sel_hi:[1,0]
v_pk_mul_f32 v[102:103], v[102:103], s[2:3] op_sel_hi:[1,0]
v_cvt_pk_bf16_f32 v40, v96, v97
v_cvt_pk_bf16_f32 v41, v98, v99
v_cvt_pk_bf16_f32 v42, v100, v101
v_cvt_pk_bf16_f32 v43, v102, v103
ds_read_b128 v[52:55], v251 offset:64
ds_read_b128 v[56:59], v251 offset:128
ds_read_b128 v[60:63], v251 offset:192
ds_read_b128 v[64:67], v251 offset:256
ds_read_b128 v[68:71], v251 offset:320
s_waitcnt lgkmcnt(5)
v_mfma_f32_32x32x16_bf16 v[72:87], v[136:139], v[40:43], v[72:87]
ds_read_b128 v[128:131], v222 offset:128
ds_read_b128 v[132:135], v221 offset:256
buffer_load_dwordx4 v231, s[12:15], s38 offen offset:2048 lds
v_accvgpr_read_b32 v108, a232
v_accvgpr_read_b32 v109, a233
v_accvgpr_read_b32 v110, a234
v_accvgpr_read_b32 v111, a235
v_accvgpr_read_b32 v112, a236
v_accvgpr_read_b32 v113, a237
v_accvgpr_read_b32 v114, a238
v_accvgpr_read_b32 v115, a239
v_pk_mul_f32 v[108:109], v[108:109], s[2:3] op_sel_hi:[1,0]
v_pk_mul_f32 v[110:111], v[110:111], s[2:3] op_sel_hi:[1,0]
v_pk_mul_f32 v[112:113], v[112:113], s[2:3] op_sel_hi:[1,0]
v_pk_mul_f32 v[114:115], v[114:115], s[2:3] op_sel_hi:[1,0]
v_cvt_pk_bf16_f32 v44, v108, v109
v_cvt_pk_bf16_f32 v45, v110, v111
v_cvt_pk_bf16_f32 v46, v112, v113
v_cvt_pk_bf16_f32 v47, v114, v115
s_nop 1
v_mfma_f32_32x32x16_bf16 v[72:87], v[140:143], v[44:47], v[72:87]
ds_read_b128 v[136:139], v222 offset:256
ds_read_b128 v[140:143], v217 offset:12288
s_add_u32 m0, s35, 0x25800
s_nop 0
buffer_load_dwordx4 v232, s[16:19], s37 offen lds
v_mfma_f32_16x16x32_bf16 v[104:107], v[144:147], v[48:51], 0
buffer_load_dwordx4 v233, s[16:19], s37 offen offset:1024 lds
s_waitcnt lgkmcnt(2)
v_mfma_f32_16x16x32_bf16 v[104:107], v[148:151], v[52:55], v[104:107]
ds_read_b128 v[144:147], v218 offset:12288
s_mov_b32 m0, 0x27800
s_mov_b64 exec, s[42:43]
buffer_load_dwordx4 v234, s[16:19], s37 offen lds
s_mov_b64 exec, -1
v_mfma_f32_16x16x32_bf16 v[104:107], v[152:155], v[56:59], v[104:107]
v_mfma_f32_16x16x32_bf16 v[104:107], v[128:131], v[60:63], v[104:107]
ds_read_b128 v[148:151], v219 offset:12288
v_mfma_f32_16x16x32_bf16 v[104:107], v[132:135], v[64:67], v[104:107]
s_waitcnt lgkmcnt(2)
v_mfma_f32_16x16x32_bf16 v[104:107], v[136:139], v[68:71], v[104:107]
ds_read_b128 v[152:155], v220 offset:12288
v_max3_f32 v249, v72, v73, v74
v_max3_f32 v249, v249, v75, v76
v_max3_f32 v249, v249, v77, v78
v_max3_f32 v249, v249, v79, v80
v_max3_f32 v249, v249, v81, v82
v_max3_f32 v249, v249, v83, v84
v_max3_f32 v249, v249, v85, v86
v_max_f32 v249, v249, v87
v_mov_b32 v250, v249
s_nop 0
s_nop 0
v_permlane32_swap_b32 v249, v250
v_max_f32 v249, v249, v250
v_sub_f32 v108, 0, v249
v_sub_f32 v109, 0, v249
v_sub_f32 v110, 0, v249
v_sub_f32 v111, 0, v249
v_sub_f32 v112, 0, v249
v_sub_f32 v113, 0, v249
v_sub_f32 v114, 0, v249
v_sub_f32 v115, 0, v249
v_sub_f32 v116, 0, v249
v_sub_f32 v117, 0, v249
v_sub_f32 v118, 0, v249
v_sub_f32 v119, 0, v249
v_sub_f32 v120, 0, v249
v_sub_f32 v121, 0, v249
v_sub_f32 v122, 0, v249
v_sub_f32 v123, 0, v249
s_nop 1
v_mfma_f32_32x32x16_bf16 v[88:103], v[140:143], v[0:3], v[108:123]
ds_read_b128 v[128:131], v217 offset:12416
s_add_u32 m0, s33, 0x12000
s_mov_b32 s39, 0x6000
buffer_load_dwordx4 v214, s[8:11], s39 offen offset:0 nt lds
s_waitcnt lgkmcnt(1)
v_mfma_f32_32x32x16_bf16 v[88:103], v[144:147], v[4:7], v[88:103]
ds_read_b128 v[132:135], v218 offset:12416
v_mfma_f32_32x32x16_bf16 v[88:103], v[148:151], v[8:11], v[88:103]
ds_read_b128 v[136:139], v219 offset:12416
ds_read_b128 v[140:143], v220 offset:12416
ds_read_b128 v[144:147], v217 offset:12544
ds_read_b128 v[148:151], v218 offset:12544
buffer_load_dwordx4 v215, s[8:11], s39 offen offset:1024 nt lds
v_mfma_f32_32x32x16_bf16 v[88:103], v[152:155], v[12:15], v[88:103]
ds_read_b128 v[152:155], v219 offset:12544
buffer_load_dwordx4 v216, s[8:11], s39 offen offset:2048 nt lds
v_sub_f32 v72, v72, v249
v_sub_f32 v73, v73, v249
v_sub_f32 v74, v74, v249
s_waitcnt lgkmcnt(6)
v_mfma_f32_32x32x16_bf16 v[88:103], v[128:131], v[16:19], v[88:103]
ds_read_b128 v[128:131], v220 offset:12544
v_sub_f32 v75, v75, v249
v_sub_f32 v76, v76, v249
v_sub_f32 v77, v77, v249
v_sub_f32 v78, v78, v249
v_sub_f32 v79, v79, v249
s_waitcnt lgkmcnt(2)
v_mfma_f32_32x32x16_bf16 v[88:103], v[132:135], v[20:23], v[88:103]
s_waitcnt vmcnt(9)
s_barrier
ds_read_b64_tr_b16 v[132:133], v223 offset:0
ds_read_b64_tr_b16 v[134:135], v223 offset:3072
v_sub_f32 v80, v80, v249
v_sub_f32 v81, v81, v249
v_mfma_f32_32x32x16_bf16 v[88:103], v[136:139], v[24:27], v[88:103]
ds_read_b64_tr_b16 v[136:137], v224 offset:0
ds_read_b64_tr_b16 v[138:139], v224 offset:3072
s_add_u32 m0, s33, 0x12c00
s_add_u32 s39, s39, 0xc00
buffer_load_dwordx4 v214, s[8:11], s39 offen offset:0 nt lds
v_mfma_f32_32x32x16_bf16 v[88:103], v[140:143], v[28:31], v[88:103]
ds_read_b64_tr_b16 v[140:141], v223 offset:128
ds_read_b64_tr_b16 v[142:143], v223 offset:3200
v_sub_f32 v82, v82, v249
v_sub_f32 v83, v83, v249
v_sub_f32 v84, v84, v249
v_sub_f32 v85, v85, v249
v_mfma_f32_32x32x16_bf16 v[88:103], v[144:147], v[32:35], v[88:103]
ds_read_b64_tr_b16 v[144:145], v224 offset:128
ds_read_b64_tr_b16 v[146:147], v224 offset:3200
v_sub_f32 v86, v86, v249
v_sub_f32 v87, v87, v249
v_exp_f32 v72, v72
v_exp_f32 v73, v73
v_mfma_f32_32x32x16_bf16 v[88:103], v[148:151], v[36:39], v[88:103]
ds_read_b64_tr_b16 v[148:149], v223 offset:256
ds_read_b64_tr_b16 v[150:151], v223 offset:3328
buffer_load_dwordx4 v215, s[8:11], s39 offen offset:1024 nt lds
s_waitcnt lgkmcnt(4)
v_mfma_f32_32x32x16_bf16 v[88:103], v[152:155], v[40:43], v[88:103]
ds_read_b64_tr_b16 v[152:153], v224 offset:256
ds_read_b64_tr_b16 v[154:155], v224 offset:3328
buffer_load_dwordx4 v216, s[8:11], s39 offen offset:2048 nt lds
v_max3_f32 v252, v104, v105, v106
v_max_f32 v252, v252, v107
v_mfma_f32_32x32x16_bf16 v[88:103], v[128:131], v[44:47], v[88:103]
ds_read_b64_tr_b16 v[128:129], v223 offset:6144
ds_read_b64_tr_b16 v[130:131], v223 offset:9216
v_add_f32 v246, 0, v72
v_add_f32 v247, 0, v73
v_cvt_pk_bf16_f32 v72, v72, v73
v_exp_f32 v74, v74
v_exp_f32 v75, v75
v_add_f32 v246, v246, v74
v_add_f32 v247, v247, v75
v_cvt_pk_bf16_f32 v73, v74, v75
v_exp_f32 v76, v76
v_exp_f32 v77, v77
v_add_f32 v246, v246, v76
v_add_f32 v247, v247, v77
v_cvt_pk_bf16_f32 v74, v76, v77
v_exp_f32 v78, v78
v_exp_f32 v79, v79
v_add_f32 v246, v246, v78
v_add_f32 v247, v247, v79
v_cvt_pk_bf16_f32 v75, v78, v79
v_exp_f32 v80, v80
v_exp_f32 v81, v81
v_add_f32 v246, v246, v80
v_add_f32 v247, v247, v81
v_cvt_pk_bf16_f32 v80, v80, v81
v_exp_f32 v82, v82
v_exp_f32 v83, v83
v_add_f32 v246, v246, v82
v_add_f32 v247, v247, v83
v_cvt_pk_bf16_f32 v81, v82, v83
v_exp_f32 v84, v84
v_exp_f32 v85, v85
v_add_f32 v246, v246, v84
v_add_f32 v247, v247, v85
v_cvt_pk_bf16_f32 v82, v84, v85
v_exp_f32 v86, v86
v_exp_f32 v87, v87
v_add_f32 v246, v246, v86
v_add_f32 v247, v247, v87
v_cvt_pk_bf16_f32 v83, v86, v87
v_mfma_f32_32x32x16_bf16 a[0:15], v[132:135], v[72:75], 0
v_max3_f32 v249, v88, v89, v90
v_max3_f32 v249, v249, v91, v92
v_max3_f32 v249, v249, v93, v94
v_max3_f32 v249, v249, v95, v96
v_max3_f32 v249, v249, v97, v98
v_max3_f32 v249, v249, v99, v100
v_max3_f32 v249, v249, v101, v102
v_max_f32 v249, v249, v103
v_cmp_lt_f32 vcc, 0x41000000, v249
s_nop 0
s_cbranch_vccnz L_fb0
L_rt0:
v_mfma_f32_32x32x16_bf16 a[16:31], v[136:139], v[72:75], 0
v_mfma_f32_32x32x16_bf16 a[32:47], v[140:143], v[72:75], 0
ds_read_b64_tr_b16 v[132:133], v224 offset:6144
ds_read_b64_tr_b16 v[134:135], v224 offset:9216
ds_read_b64_tr_b16 v[136:137], v223 offset:6272
ds_read_b64_tr_b16 v[138:139], v223 offset:9344
ds_read_b64_tr_b16 v[140:141], v224 offset:6272
ds_read_b64_tr_b16 v[142:143], v224 offset:9344
s_waitcnt lgkmcnt(6)
v_mfma_f32_32x32x16_bf16 a[48:63], v[144:147], v[72:75], 0
ds_read_b64_tr_b16 v[144:145], v223 offset:6400
ds_read_b64_tr_b16 v[146:147], v223 offset:9472
s_add_u32 m0, s34, 0x18000
s_add_u32 s37, s37, 64
s_cmp_eq_u32 s37, 0x500
s_cselect_b32 s37, 0, s37
s_mul_i32 s38, s37, 6144
s_add_u32 s38, s38, 6144
buffer_load_dwordx4 v229, s[12:15], s38 offen offset:0 lds
v_mfma_f32_32x32x16_bf16 a[64:79], v[148:151], v[72:75], 0
ds_read_b64_tr_b16 v[148:149], v224 offset:6400
ds_read_b64_tr_b16 v[150:151], v224 offset:9472
v_mfma_f32_32x32x16_bf16 a[80:95], v[152:155], v[72:75], 0
ds_read_b64_tr_b16 v[152:153], v235 offset:21504
ds_read_b64_tr_b16 v[154:155], v235 offset:23040
ds_read_b128 v[156:159], v240 offset:21504
buffer_load_dwordx4 v230, s[12:15], s38 offen offset:1024 lds
v_mfma_f32_32x32x16_bf16 a[0:15], v[128:131], v[80:83], a[0:15]
ds_read_b64_tr_b16 v[128:129], v236 offset:21504
ds_read_b64_tr_b16 v[130:131], v236 offset:23040
v_exp_f32 v88, v88
v_exp_f32 v89, v89
s_waitcnt lgkmcnt(7)
v_mfma_f32_32x32x16_bf16 a[16:31], v[132:135], v[80:83], a[16:31]
ds_read_b64_tr_b16 v[132:133], v235 offset:21632
ds_read_b64_tr_b16 v[134:135], v235 offset:23168
v_add_f32 v246, v246, v88
v_add_f32 v247, v247, v89
v_cvt_pk_bf16_f32 v88, v88, v89
v_mfma_f32_32x32x16_bf16 a[32:47], v[136:139], v[80:83], a[32:47]
ds_read_b64_tr_b16 v[136:137], v236 offset:21632
ds_read_b64_tr_b16 v[138:139], v236 offset:23168
v_exp_f32 v90, v90
v_exp_f32 v91, v91
v_mfma_f32_32x32x16_bf16 a[48:63], v[140:143], v[80:83], a[48:63]
ds_read_b64_tr_b16 v[140:141], v237 offset:21504
ds_read_b64_tr_b16 v[142:143], v237 offset:23040
ds_read_b128 v[160:163], v242 offset:21504
v_add_f32 v246, v246, v90
v_add_f32 v247, v247, v91
v_cvt_pk_bf16_f32 v89, v90, v91
v_mfma_f32_32x32x16_bf16 a[64:79], v[144:147], v[80:83], a[64:79]
ds_read_b64_tr_b16 v[144:145], v235 offset:21760
ds_read_b64_tr_b16 v[146:147], v235 offset:23296
buffer_load_dwordx4 v231, s[12:15], s38 offen offset:2048 lds
v_exp_f32 v92, v92
v_exp_f32 v93, v93
s_waitcnt lgkmcnt(5)
v_mfma_f32_32x32x16_bf16 a[80:95], v[148:151], v[80:83], a[80:95]
ds_read_b64_tr_b16 v[148:149], v236 offset:21760
ds_read_b64_tr_b16 v[150:151], v236 offset:23296
v_mfma_f32_32x32x16_bf16 a[144:159], v[152:155], v[156:159], 0
ds_read_b64_tr_b16 v[152:153], v235 offset:27648
ds_read_b64_tr_b16 v[154:155], v235 offset:29184
ds_read_b128 v[164:167], v241 offset:21504
v_add_f32 v246, v246, v92
v_add_f32 v247, v247, v93
v_cvt_pk_bf16_f32 v90, v92, v93
v_mfma_f32_32x32x16_bf16 a[160:175], v[128:131], v[156:159], 0
ds_read_b64_tr_b16 v[128:129], v236 offset:27648
ds_read_b64_tr_b16 v[130:131], v236 offset:29184
v_exp_f32 v94, v94
v_exp_f32 v95, v95
v_mfma_f32_32x32x16_bf16 a[176:191], v[132:135], v[156:159], 0
ds_read_b64_tr_b16 v[132:133], v238 offset:21504
ds_read_b64_tr_b16 v[134:135], v238 offset:23040
v_add_f32 v246, v246, v94
v_add_f32 v247, v247, v95
v_cvt_pk_bf16_f32 v91, v94, v95
v_mfma_f32_32x32x16_bf16 a[192:207], v[136:139], v[156:159], 0
ds_read_b64_tr_b16 v[136:137], v235 offset:27776
ds_read_b64_tr_b16 v[138:139], v235 offset:29312
s_add_u32 m0, s35, 0x1b000
s_nop 0
buffer_load_dwordx4 v232, s[16:19], s37 offen lds
s_waitcnt lgkmcnt(4)
v_mfma_f32_16x16x32_bf16 a[240:243], v[140:143], v[160:163], 0
ds_read_b64_tr_b16 v[140:141], v236 offset:27776
ds_read_b64_tr_b16 v[142:143], v236 offset:29312
v_mfma_f32_32x32x16_bf16 a[208:223], v[144:147], v[156:159], 0
ds_read_b64_tr_b16 v[144:145], v235 offset:27904
ds_read_b64_tr_b16 v[146:147], v235 offset:29440
v_exp_f32 v96, v96
v_exp_f32 v97, v97
v_mfma_f32_32x32x16_bf16 a[224:239], v[148:151], v[156:159], 0
ds_read_b64_tr_b16 v[148:149], v236 offset:27904
ds_read_b64_tr_b16 v[150:151], v236 offset:29440
v_add_f32 v246, v246, v96
v_add_f32 v247, v247, v97
v_cvt_pk_bf16_f32 v96, v96, v97
v_mfma_f32_32x32x16_bf16 a[144:159], v[152:155], v[164:167], a[144:159]
ds_read_b64_tr_b16 v[152:153], v239 offset:21504
ds_read_b64_tr_b16 v[154:155], v239 offset:23040
v_exp_f32 v98, v98
v_exp_f32 v99, v99
v_mfma_f32_32x32x16_bf16 a[160:175], v[128:131], v[164:167], a[160:175]
ds_read_b64_tr_b16 v[128:129], v223 offset:12288
ds_read_b64_tr_b16 v[130:131], v223 offset:15360
buffer_load_dwordx4 v233, s[16:19], s37 offen offset:1024 lds
s_waitcnt lgkmcnt(6)
v_mfma_f32_16x16x32_bf16 a[244:247], v[132:135], v[160:163], 0
ds_read_b64_tr_b16 v[132:133], v224 offset:12288
ds_read_b64_tr_b16 v[134:135], v224 offset:15360
v_mfma_f32_32x32x16_bf16 a[176:191], v[136:139], v[164:167], a[176:191]
ds_read_b64_tr_b16 v[136:137], v223 offset:12416
ds_read_b64_tr_b16 v[138:139], v223 offset:15488
v_add_f32 v246, v246, v98
v_add_f32 v247, v247, v99
v_cvt_pk_bf16_f32 v97, v98, v99
v_mfma_f32_32x32x16_bf16 a[192:207], v[140:143], v[164:167], a[192:207]
ds_read_b64_tr_b16 v[140:141], v224 offset:12416
ds_read_b64_tr_b16 v[142:143], v224 offset:15488
v_exp_f32 v100, v100
v_exp_f32 v101, v101
v_mfma_f32_32x32x16_bf16 a[208:223], v[144:147], v[164:167], a[208:223]
ds_read_b64_tr_b16 v[144:145], v223 offset:12544
ds_read_b64_tr_b16 v[146:147], v223 offset:15616
v_add_f32 v246, v246, v100
v_add_f32 v247, v247, v101
v_cvt_pk_bf16_f32 v98, v100, v101
s_waitcnt lgkmcnt(5)
v_mfma_f32_32x32x16_bf16 a[224:239], v[148:151], v[164:167], a[224:239]
ds_read_b64_tr_b16 v[148:149], v224 offset:12544
ds_read_b64_tr_b16 v[150:151], v224 offset:15616
s_mov_b32 m0, 0x1d000
s_mov_b64 exec, s[42:43]
buffer_load_dwordx4 v234, s[16:19], s37 offen lds
s_mov_b64 exec, -1
v_mfma_f32_16x16x32_bf16 a[248:251], v[152:155], v[160:163], 0
ds_read_b64_tr_b16 v[152:153], v223 offset:18432
ds_read_b64_tr_b16 v[154:155], v223 offset:21504
v_mfma_f32_32x32x16_bf16 a[0:15], v[128:131], v[88:91], a[0:15]
ds_read_b64_tr_b16 v[128:129], v224 offset:18432
ds_read_b64_tr_b16 v[130:131], v224 offset:21504
v_exp_f32 v102, v102
v_exp_f32 v103, v103
v_mfma_f32_32x32x16_bf16 a[16:31], v[132:135], v[88:91], a[16:31]
ds_read_b64_tr_b16 v[132:133], v223 offset:18560
ds_read_b64_tr_b16 v[134:135], v223 offset:21632
v_add_f32 v246, v246, v102
v_add_f32 v247, v247, v103
v_cvt_pk_bf16_f32 v99, v102, v103
s_waitcnt lgkmcnt(6)
v_mfma_f32_32x32x16_bf16 a[32:47], v[136:139], v[88:91], a[32:47]
ds_read_b64_tr_b16 v[136:137], v224 offset:18560
ds_read_b64_tr_b16 v[138:139], v224 offset:21632
v_mov_b32 v255, v252
s_nop 0
s_nop 0
v_permlane32_swap_b32 v252, v255
v_max_f32 v252, v252, v255
v_mov_b32 v255, v252
s_nop 0
s_nop 0
v_permlane16_swap_b32 v252, v255
v_max_f32 v252, v252, v255
v_mfma_f32_32x32x16_bf16 a[48:63], v[140:143], v[88:91], a[48:63]
ds_read_b64_tr_b16 v[140:141], v223 offset:18688
ds_read_b64_tr_b16 v[142:143], v223 offset:21760
v_mfma_f32_32x32x16_bf16 a[64:79], v[144:147], v[88:91], a[64:79]
ds_read_b64_tr_b16 v[144:145], v224 offset:18688
ds_read_b64_tr_b16 v[146:147], v224 offset:21760
s_add_u32 m0, s33, 0x0
s_mov_b32 s39, 0xc000
buffer_load_dwordx4 v208, s[4:7], s39 offen offset:0 nt lds
v_mfma_f32_32x32x16_bf16 a[80:95], v[148:151], v[88:91], a[80:95]
ds_read_b64_tr_b16 v[148:149], v225 offset:0
ds_read_b64_tr_b16 v[150:151], v226 offset:0
v_sub_f32 v124, 0, v252
v_sub_f32 v125, 0, v252
v_sub_f32 v126, 0, v252
v_sub_f32 v127, 0, v252
s_waitcnt lgkmcnt(6)
v_mfma_f32_32x32x16_bf16 a[0:15], v[152:155], v[96:99], a[0:15]
ds_read_b64_tr_b16 v[152:153], v227 offset:0
ds_read_b64_tr_b16 v[154:155], v228 offset:0
v_sub_f32 v104, v104, v252
v_sub_f32 v105, v105, v252
v_sub_f32 v106, v106, v252
v_sub_f32 v107, v107, v252
v_mfma_f32_32x32x16_bf16 a[16:31], v[128:131], v[96:99], a[16:31]
ds_read_b64_tr_b16 v[128:129], v225 offset:128
ds_read_b64_tr_b16 v[130:131], v226 offset:128
buffer_load_dwordx4 v209, s[4:7], s39 offen offset:1024 nt lds
v_exp_f32 v104, v104
v_exp_f32 v105, v105
v_mfma_f32_32x32x16_bf16 a[32:47], v[132:135], v[96:99], a[32:47]
ds_read_b64_tr_b16 v[132:133], v227 offset:128
ds_read_b64_tr_b16 v[134:135], v228 offset:128
v_mfma_f32_32x32x16_bf16 a[48:63], v[136:139], v[96:99], a[48:63]
ds_read_b64_tr_b16 v[136:137], v225 offset:256
ds_read_b64_tr_b16 v[138:139], v226 offset:256
v_add_f32 v248, 0, v104
v_add_f32 v248, v248, v105
v_cvt_pk_bf16_f32 v104, v104, v105
s_waitcnt lgkmcnt(6)
v_mfma_f32_32x32x16_bf16 a[64:79], v[140:143], v[96:99], a[64:79]
ds_read_b64_tr_b16 v[140:141], v227 offset:256
ds_read_b64_tr_b16 v[142:143], v228 offset:256
v_exp_f32 v106, v106
v_exp_f32 v107, v107
v_mfma_f32_32x32x16_bf16 a[80:95], v[144:147], v[96:99], a[80:95]
s_waitcnt vmcnt(14)
s_barrier
ds_read_b128 v[144:147], v217 offset:24576
v_add_f32 v248, v248, v106
v_add_f32 v248, v248, v107
v_cvt_pk_bf16_f32 v105, v106, v107
s_nop 1
v_mfma_f32_16x16x16_bf16 a[96:99], v[148:149], v[104:105], 0
buffer_load_dwordx4 v210, s[4:7], s39 offen offset:2048 nt lds
v_mfma_f32_16x16x16_bf16 a[100:103], v[150:151], v[104:105], 0
ds_read_b128 v[148:151], v218 offset:24576
v_mfma_f32_16x16x16_bf16 a[104:107], v[152:153], v[104:105], 0
v_mfma_f32_16x16x16_bf16 a[108:111], v[154:155], v[104:105], 0
ds_read_b128 v[152:155], v219 offset:24576
s_waitcnt lgkmcnt(3)
v_mfma_f32_16x16x16_bf16 a[112:115], v[128:129], v[104:105], 0
v_mfma_f32_16x16x16_bf16 a[116:119], v[130:131], v[104:105], 0
ds_read_b128 v[128:131], v220 offset:24576
v_mfma_f32_16x16x16_bf16 a[120:123], v[132:133], v[104:105], 0
buffer_load_dwordx4 v211, s[4:7], s39 offen offset:3072 nt lds
v_mfma_f32_16x16x16_bf16 a[124:127], v[134:135], v[104:105], 0
ds_read_b128 v[132:135], v217 offset:24704
v_mfma_f32_16x16x16_bf16 a[128:131], v[136:137], v[104:105], 0
v_mfma_f32_16x16x16_bf16 a[132:135], v[138:139], v[104:105], 0
ds_read_b128 v[136:139], v218 offset:24704
v_mfma_f32_16x16x16_bf16 a[136:139], v[140:141], v[104:105], 0
s_add_u32 m0, s33, 0x1000
s_nop 0
buffer_load_dwordx4 v212, s[4:7], s39 offen offset:0 nt lds
buffer_load_dwordx4 v213, s[4:7], s39 offen offset:1024 nt lds
v_mfma_f32_16x16x16_bf16 a[140:143], v[142:143], v[104:105], 0
s_waitcnt lgkmcnt(2)
v_mfma_f32_32x32x16_bf16 v[72:87], v[144:147], v[0:3], v[108:123]
ds_read_b128 v[140:143], v219 offset:24704
ds_read_b128 v[144:147], v220 offset:24704
v_mfma_f32_32x32x16_bf16 v[72:87], v[148:151], v[4:7], v[72:87]
ds_read_b128 v[148:151], v217 offset:24832
s_add_u32 m0, s34, 0x1d400
s_add_u32 s37, s37, 64
s_cmp_eq_u32 s37, 0x500
s_cselect_b32 s37, 0, s37
s_mul_i32 s38, s37, 6144
s_add_u32 s38, s38, 6144
buffer_load_dwordx4 v229, s[12:15], s38 offen offset:0 lds
v_mfma_f32_32x32x16_bf16 v[72:87], v[152:155], v[8:11], v[72:87]
ds_read_b128 v[152:155], v218 offset:24832
v_mfma_f32_32x32x16_bf16 v[72:87], v[128:131], v[12:15], v[72:87]
ds_read_b128 v[128:131], v219 offset:24832
s_waitcnt lgkmcnt(3)
v_mfma_f32_32x32x16_bf16 v[72:87], v[132:135], v[16:19], v[72:87]
ds_read_b128 v[132:135], v220 offset:24832
buffer_load_dwordx4 v230, s[12:15], s38 offen offset:1024 lds
v_mfma_f32_32x32x16_bf16 v[72:87], v[136:139], v[20:23], v[72:87]
ds_read_b64_tr_b16 v[136:137], v235 offset:43008
ds_read_b64_tr_b16 v[138:139], v235 offset:44544
ds_read_b128 v[168:171], v240 offset:43008
v_mfma_f32_32x32x16_bf16 v[72:87], v[140:143], v[24:27], v[72:87]
ds_read_b64_tr_b16 v[140:141], v236 offset:43008
ds_read_b64_tr_b16 v[142:143], v236 offset:44544
v_mfma_f32_32x32x16_bf16 v[72:87], v[144:147], v[28:31], v[72:87]
ds_read_b64_tr_b16 v[144:145], v235 offset:43136
ds_read_b64_tr_b16 v[146:147], v235 offset:44672
buffer_load_dwordx4 v231, s[12:15], s38 offen offset:2048 lds
s_waitcnt lgkmcnt(7)
v_mfma_f32_32x32x16_bf16 v[72:87], v[148:151], v[32:35], v[72:87]
ds_read_b128 v[148:151], v217 offset:36864
v_mfma_f32_32x32x16_bf16 v[72:87], v[152:155], v[36:39], v[72:87]
ds_read_b128 v[152:155], v218 offset:36864
v_mfma_f32_32x32x16_bf16 v[72:87], v[128:131], v[40:43], v[72:87]
ds_read_b128 v[128:131], v219 offset:36864
s_add_u32 m0, s35, 0x20400
s_nop 0
buffer_load_dwordx4 v232, s[16:19], s37 offen lds
v_mfma_f32_32x32x16_bf16 v[72:87], v[132:135], v[44:47], v[72:87]
ds_read_b128 v[132:135], v220 offset:36864
s_waitcnt lgkmcnt(4)
v_mfma_f32_32x32x16_bf16 a[144:159], v[136:139], v[168:171], a[144:159]
ds_read_b128 v[136:139], v217 offset:36992
s_nop 2
v_max3_f32 v249, v72, v73, v74
v_max3_f32 v249, v249, v75, v76
v_max3_f32 v249, v249, v77, v78
v_max3_f32 v249, v249, v79, v80
v_max3_f32 v249, v249, v81, v82
v_mfma_f32_32x32x16_bf16 a[160:175], v[140:143], v[168:171], a[160:175]
ds_read_b128 v[140:143], v218 offset:36992
v_max3_f32 v249, v249, v83, v84
v_max3_f32 v249, v249, v85, v86
v_max_f32 v249, v249, v87
v_cmp_lt_f32 vcc, 0x41000000, v249
s_nop 0
s_cbranch_vccnz L_fb1
L_rt1:
v_mfma_f32_32x32x16_bf16 a[176:191], v[144:147], v[168:171], a[176:191]
ds_read_b128 v[144:147], v219 offset:36992
buffer_load_dwordx4 v233, s[16:19], s37 offen offset:1024 lds
v_exp_f32 v72, v72
v_exp_f32 v73, v73
s_waitcnt lgkmcnt(2)
v_mfma_f32_32x32x16_bf16 v[88:103], v[148:151], v[0:3], v[108:123]
ds_read_b128 v[148:151], v220 offset:36992
v_add_f32 v246, v246, v72
v_add_f32 v247, v247, v73
v_cvt_pk_bf16_f32 v72, v72, v73
v_mfma_f32_32x32x16_bf16 v[88:103], v[152:155], v[4:7], v[88:103]
ds_read_b128 v[152:155], v217 offset:37120
s_mov_b32 m0, 0x22400
s_mov_b64 exec, s[42:43]
buffer_load_dwordx4 v234, s[16:19], s37 offen lds
s_mov_b64 exec, -1
v_mfma_f32_32x32x16_bf16 v[88:103], v[128:131], v[8:11], v[88:103]
ds_read_b128 v[128:131], v218 offset:37120
v_exp_f32 v74, v74
v_exp_f32 v75, v75
v_mfma_f32_32x32x16_bf16 v[88:103], v[132:135], v[12:15], v[88:103]
ds_read_b128 v[132:135], v219 offset:37120
v_add_f32 v246, v246, v74
v_add_f32 v247, v247, v75
v_cvt_pk_bf16_f32 v73, v74, v75
v_exp_f32 v76, v76
v_exp_f32 v77, v77
v_mfma_f32_32x32x16_bf16 v[88:103], v[136:139], v[16:19], v[88:103]
ds_read_b128 v[136:139], v220 offset:37120
v_add_f32 v246, v246, v76
v_add_f32 v247, v247, v77
v_cvt_pk_bf16_f32 v74, v76, v77
s_waitcnt lgkmcnt(2)
v_mfma_f32_32x32x16_bf16 v[88:103], v[140:143], v[20:23], v[88:103]
ds_read_b128 v[140:143], v221 offset:24576
v_exp_f32 v78, v78
v_exp_f32 v79, v79
v_mfma_f32_32x32x16_bf16 v[88:103], v[144:147], v[24:27], v[88:103]
ds_read_b64_tr_b16 v[144:145], v236 offset:43136
ds_read_b64_tr_b16 v[146:147], v236 offset:44672
v_add_f32 v246, v246, v78
v_add_f32 v247, v247, v79
v_cvt_pk_bf16_f32 v75, v78, v79
v_mfma_f32_32x32x16_bf16 v[88:103], v[148:151], v[28:31], v[88:103]
ds_read_b128 v[148:151], v222 offset:24576
v_exp_f32 v80, v80
v_exp_f32 v81, v81
v_mfma_f32_32x32x16_bf16 v[88:103], v[152:155], v[32:35], v[88:103]
ds_read_b64_tr_b16 v[152:153], v237 offset:43008
ds_read_b64_tr_b16 v[154:155], v237 offset:44544
ds_read_b128 v[176:179], v242 offset:43008
v_add_f32 v246, v246, v80
v_add_f32 v247, v247, v81
v_cvt_pk_bf16_f32 v80, v80, v81
v_mfma_f32_32x32x16_bf16 v[88:103], v[128:131], v[36:39], v[88:103]
ds_read_b128 v[128:131], v221 offset:24704
v_exp_f32 v82, v82
v_exp_f32 v83, v83
s_waitcnt lgkmcnt(4)
v_mfma_f32_32x32x16_bf16 v[88:103], v[132:135], v[40:43], v[88:103]
ds_read_b64_tr_b16 v[132:133], v235 offset:43264
ds_read_b64_tr_b16 v[134:135], v235 offset:44800
s_add_u32 m0, s33, 0xc000
s_mov_b32 s39, 0xc000
buffer_load_dwordx4 v214, s[8:11], s39 offen offset:0 nt lds
v_mfma_f32_32x32x16_bf16 v[88:103], v[136:139], v[44:47], v[88:103]
ds_read_b128 v[136:139], v222 offset:24704
v_add_f32 v246, v246, v82
v_add_f32 v247, v247, v83
v_cvt_pk_bf16_f32 v81, v82, v83
v_exp_f32 v84, v84
v_exp_f32 v85, v85
v_mfma_f32_16x16x32_bf16 v[104:107], v[140:143], v[48:51], v[124:127]
v_mfma_f32_32x32x16_bf16 a[192:207], v[144:147], v[168:171], a[192:207]
ds_read_b64_tr_b16 v[140:141], v236 offset:43264
ds_read_b64_tr_b16 v[142:143], v236 offset:44800
ds_read_b128 v[144:147], v221 offset:24832
v_add_f32 v246, v246, v84
v_add_f32 v247, v247, v85
v_cvt_pk_bf16_f32 v82, v84, v85
v_mfma_f32_16x16x32_bf16 v[104:107], v[148:151], v[52:55], v[104:107]
ds_read_b64_tr_b16 v[148:149], v235 offset:49152
ds_read_b64_tr_b16 v[150:151], v235 offset:50688
s_waitcnt lgkmcnt(5)
v_mfma_f32_16x16x32_bf16 a[240:243], v[152:155], v[176:179], a[240:243]
ds_read_b128 v[172:175], v241 offset:43008
ds_read_b128 v[152:155], v222 offset:24832
v_mfma_f32_16x16x32_bf16 v[104:107], v[128:131], v[56:59], v[104:107]
ds_read_b64_tr_b16 v[128:129], v236 offset:49152
ds_read_b64_tr_b16 v[130:131], v236 offset:50688
buffer_load_dwordx4 v215, s[8:11], s39 offen offset:1024 nt lds
v_mfma_f32_32x32x16_bf16 a[208:223], v[132:135], v[168:171], a[208:223]
ds_read_b64_tr_b16 v[132:133], v238 offset:43008
ds_read_b64_tr_b16 v[134:135], v238 offset:44544
v_exp_f32 v86, v86
v_exp_f32 v87, v87
v_mfma_f32_16x16x32_bf16 v[104:107], v[136:139], v[60:63], v[104:107]
s_waitcnt lgkmcnt(6)
v_mfma_f32_32x32x16_bf16 a[224:239], v[140:143], v[168:171], a[224:239]
ds_read_b64_tr_b16 v[136:137], v235 offset:49280
ds_read_b64_tr_b16 v[138:139], v235 offset:50816
ds_read_b64_tr_b16 v[140:141], v236 offset:49280
ds_read_b64_tr_b16 v[142:143], v236 offset:50816
buffer_load_dwordx4 v216, s[8:11], s39 offen offset:2048 nt lds
v_mfma_f32_16x16x32_bf16 v[104:107], v[144:147], v[64:67], v[104:107]
ds_read_b64_tr_b16 v[144:145], v235 offset:49408
ds_read_b64_tr_b16 v[146:147], v235 offset:50944
s_waitcnt lgkmcnt(7)
v_mfma_f32_32x32x16_bf16 a[144:159], v[148:151], v[172:175], a[144:159]
ds_read_b64_tr_b16 v[148:149], v236 offset:49408
ds_read_b64_tr_b16 v[150:151], v236 offset:50944
v_add_f32 v246, v246, v86
v_add_f32 v247, v247, v87
v_cvt_pk_bf16_f32 v83, v86, v87
v_max3_f32 v249, v88, v89, v90
v_mfma_f32_16x16x32_bf16 v[104:107], v[152:155], v[68:71], v[104:107]
ds_read_b64_tr_b16 v[152:153], v239 offset:43008
ds_read_b64_tr_b16 v[154:155], v239 offset:44544
v_mfma_f32_32x32x16_bf16 a[160:175], v[128:131], v[172:175], a[160:175]
s_waitcnt vmcnt(15)
s_barrier
ds_read_b64_tr_b16 v[128:129], v223 offset:24576
ds_read_b64_tr_b16 v[130:131], v223 offset:27648
s_add_u32 m0, s33, 0xcc00
s_add_u32 s39, s39, 0xc00
buffer_load_dwordx4 v214, s[8:11], s39 offen offset:0 nt lds
s_waitcnt lgkmcnt(6)
v_mfma_f32_16x16x32_bf16 a[244:247], v[132:135], v[176:179], a[244:247]
v_mfma_f32_32x32x16_bf16 a[176:191], v[136:139], v[172:175], a[176:191]
ds_read_b64_tr_b16 v[132:133], v224 offset:24576
ds_read_b64_tr_b16 v[134:135], v224 offset:27648
ds_read_b64_tr_b16 v[136:137], v223 offset:24704
ds_read_b64_tr_b16 v[138:139], v223 offset:27776
v_max3_f32 v249, v249, v91, v92
v_max3_f32 v249, v249, v93, v94
v_mfma_f32_32x32x16_bf16 a[192:207], v[140:143], v[172:175], a[192:207]
ds_read_b64_tr_b16 v[140:141], v224 offset:24704
ds_read_b64_tr_b16 v[142:143], v224 offset:27776
v_max3_f32 v249, v249, v95, v96
v_max3_f32 v249, v249, v97, v98
v_max3_f32 v249, v249, v99, v100
v_max3_f32 v249, v249, v101, v102
v_mfma_f32_32x32x16_bf16 a[208:223], v[144:147], v[172:175], a[208:223]
ds_read_b64_tr_b16 v[144:145], v223 offset:24832
ds_read_b64_tr_b16 v[146:147], v223 offset:27904
buffer_load_dwordx4 v215, s[8:11], s39 offen offset:1024 nt lds
v_max_f32 v249, v249, v103
v_max3_f32 v252, v104, v105, v106
s_waitcnt lgkmcnt(5)
v_mfma_f32_32x32x16_bf16 a[224:239], v[148:151], v[172:175], a[224:239]
ds_read_b64_tr_b16 v[148:149], v224 offset:24832
ds_read_b64_tr_b16 v[150:151], v224 offset:27904
buffer_load_dwordx4 v216, s[8:11], s39 offen offset:2048 nt lds
v_cmp_lt_f32 vcc, 0x41000000, v249
s_nop 0
s_cbranch_vccnz L_fb3
L_rt3:
v_mfma_f32_16x16x32_bf16 a[248:251], v[152:155], v[176:179], a[248:251]
ds_read_b64_tr_b16 v[152:153], v223 offset:30720
ds_read_b64_tr_b16 v[154:155], v223 offset:33792
v_mfma_f32_32x32x16_bf16 a[0:15], v[128:131], v[72:75], a[0:15]
ds_read_b64_tr_b16 v[128:129], v224 offset:30720
ds_read_b64_tr_b16 v[130:131], v224 offset:33792
v_exp_f32 v88, v88
v_exp_f32 v89, v89
v_mfma_f32_32x32x16_bf16 a[16:31], v[132:135], v[72:75], a[16:31]
ds_read_b64_tr_b16 v[132:133], v223 offset:30848
ds_read_b64_tr_b16 v[134:135], v223 offset:33920
s_add_u32 m0, s34, 0x22800
s_add_u32 s37, s37, 64
s_cmp_eq_u32 s37, 0x500
s_cselect_b32 s37, 0, s37
s_mul_i32 s38, s37, 6144
s_add_u32 s38, s38, 6144
buffer_load_dwordx4 v229, s[12:15], s38 offen offset:0 lds
s_waitcnt lgkmcnt(4)
v_mfma_f32_32x32x16_bf16 a[32:47], v[136:139], v[72:75], a[32:47]
ds_read_b64_tr_b16 v[136:137], v224 offset:30848
ds_read_b64_tr_b16 v[138:139], v224 offset:33920
v_mfma_f32_32x32x16_bf16 a[48:63], v[140:143], v[72:75], a[48:63]
ds_read_b64_tr_b16 v[140:141], v223 offset:30976
ds_read_b64_tr_b16 v[142:143], v223 offset:34048
v_add_f32 v246, v246, v88
v_add_f32 v247, v247, v89
v_cvt_pk_bf16_f32 v88, v88, v89
v_max_f32 v252, v252, v107
v_mfma_f32_32x32x16_bf16 a[64:79], v[144:147], v[72:75], a[64:79]
ds_read_b64_tr_b16 v[144:145], v224 offset:30976
ds_read_b64_tr_b16 v[146:147], v224 offset:34048
v_exp_f32 v90, v90
v_exp_f32 v91, v91
v_mfma_f32_32x32x16_bf16 a[80:95], v[148:151], v[72:75], a[80:95]
ds_read_b64_tr_b16 v[148:149], v235 offset:0
ds_read_b64_tr_b16 v[150:151], v235 offset:1536
ds_read_b128 v[156:159], v240 offset:0
buffer_load_dwordx4 v230, s[12:15], s38 offen offset:1024 lds
v_mfma_f32_32x32x16_bf16 a[0:15], v[152:155], v[80:83], a[0:15]
ds_read_b64_tr_b16 v[152:153], v236 offset:0
ds_read_b64_tr_b16 v[154:155], v236 offset:1536
v_add_f32 v246, v246, v90
v_add_f32 v247, v247, v91
v_cvt_pk_bf16_f32 v89, v90, v91
s_waitcnt lgkmcnt(6)
v_mfma_f32_32x32x16_bf16 a[16:31], v[128:131], v[80:83], a[16:31]
ds_read_b64_tr_b16 v[128:129], v235 offset:128
ds_read_b64_tr_b16 v[130:131], v235 offset:1664
v_exp_f32 v92, v92
v_exp_f32 v93, v93
v_mfma_f32_32x32x16_bf16 a[32:47], v[132:135], v[80:83], a[32:47]
ds_read_b64_tr_b16 v[132:133], v236 offset:128
ds_read_b64_tr_b16 v[134:135], v236 offset:1664
v_add_f32 v246, v246, v92
v_add_f32 v247, v247, v93
v_cvt_pk_bf16_f32 v90, v92, v93
v_mfma_f32_32x32x16_bf16 a[48:63], v[136:139], v[80:83], a[48:63]
ds_read_b64_tr_b16 v[136:137], v237 offset:0
ds_read_b64_tr_b16 v[138:139], v237 offset:1536
ds_read_b128 v[164:167], v242 offset:0
v_exp_f32 v94, v94
v_exp_f32 v95, v95
v_mfma_f32_32x32x16_bf16 a[64:79], v[140:143], v[80:83], a[64:79]
ds_read_b64_tr_b16 v[140:141], v235 offset:256
ds_read_b64_tr_b16 v[142:143], v235 offset:1792
buffer_load_dwordx4 v231, s[12:15], s38 offen offset:2048 lds
s_waitcnt lgkmcnt(6)
v_mfma_f32_32x32x16_bf16 a[80:95], v[144:147], v[80:83], a[80:95]
ds_read_b64_tr_b16 v[144:145], v236 offset:256
ds_read_b64_tr_b16 v[146:147], v236 offset:1792
v_add_f32 v246, v246, v94
v_add_f32 v247, v247, v95
v_cvt_pk_bf16_f32 v91, v94, v95
v_mfma_f32_32x32x16_bf16 a[144:159], v[148:151], v[156:159], a[144:159]
ds_read_b64_tr_b16 v[148:149], v235 offset:6144
ds_read_b64_tr_b16 v[150:151], v235 offset:7680
ds_read_b128 v[160:163], v241 offset:0
v_exp_f32 v96, v96
v_exp_f32 v97, v97
v_mfma_f32_32x32x16_bf16 a[160:175], v[152:155], v[156:159], a[160:175]
ds_read_b64_tr_b16 v[152:153], v236 offset:6144
ds_read_b64_tr_b16 v[154:155], v236 offset:7680
v_add_f32 v246, v246, v96
v_add_f32 v247, v247, v97
v_cvt_pk_bf16_f32 v96, v96, v97
v_mfma_f32_32x32x16_bf16 a[176:191], v[128:131], v[156:159], a[176:191]
ds_read_b64_tr_b16 v[128:129], v238 offset:0
ds_read_b64_tr_b16 v[130:131], v238 offset:1536
v_exp_f32 v98, v98
v_exp_f32 v99, v99
s_waitcnt lgkmcnt(4)
v_mfma_f32_32x32x16_bf16 a[192:207], v[132:135], v[156:159], a[192:207]
ds_read_b64_tr_b16 v[132:133], v235 offset:6272
ds_read_b64_tr_b16 v[134:135], v235 offset:7808
s_add_u32 m0, s35, 0x25800
s_nop 0
buffer_load_dwordx4 v232, s[16:19], s37 offen lds
v_mfma_f32_16x16x32_bf16 a[240:243], v[136:139], v[164:167], a[240:243]
ds_read_b64_tr_b16 v[136:137], v236 offset:6272
ds_read_b64_tr_b16 v[138:139], v236 offset:7808
v_mfma_f32_32x32x16_bf16 a[208:223], v[140:143], v[156:159], a[208:223]
ds_read_b64_tr_b16 v[140:141], v235 offset:6400
ds_read_b64_tr_b16 v[142:143], v235 offset:7936
v_add_f32 v246, v246, v98
v_add_f32 v247, v247, v99
v_cvt_pk_bf16_f32 v97, v98, v99
v_mfma_f32_32x32x16_bf16 a[224:239], v[144:147], v[156:159], a[224:239]
ds_read_b64_tr_b16 v[144:145], v236 offset:6400
ds_read_b64_tr_b16 v[146:147], v236 offset:7936
v_exp_f32 v100, v100
v_exp_f32 v101, v101
v_mfma_f32_32x32x16_bf16 a[144:159], v[148:151], v[160:163], a[144:159]
ds_read_b64_tr_b16 v[148:149], v239 offset:0
ds_read_b64_tr_b16 v[150:151], v239 offset:1536
v_add_f32 v246, v246, v100
v_add_f32 v247, v247, v101
v_cvt_pk_bf16_f32 v98, v100, v101
s_waitcnt lgkmcnt(5)
v_mfma_f32_32x32x16_bf16 a[160:175], v[152:155], v[160:163], a[160:175]
ds_read_b64_tr_b16 v[152:153], v223 offset:36864
ds_read_b64_tr_b16 v[154:155], v223 offset:39936
buffer_load_dwordx4 v233, s[16:19], s37 offen offset:1024 lds
v_exp_f32 v102, v102
v_exp_f32 v103, v103
v_mfma_f32_16x16x32_bf16 a[244:247], v[128:131], v[164:167], a[244:247]
v_mfma_f32_32x32x16_bf16 a[176:191], v[132:135], v[160:163], a[176:191]
ds_read_b64_tr_b16 v[128:129], v224 offset:36864
ds_read_b64_tr_b16 v[130:131], v224 offset:39936
ds_read_b64_tr_b16 v[132:133], v223 offset:36992
ds_read_b64_tr_b16 v[134:135], v223 offset:40064
v_cmp_lt_f32 vcc, 0x41000000, v252
s_nop 0
s_cbranch_vccnz L_fb2
L_rt2:
v_mfma_f32_32x32x16_bf16 a[192:207], v[136:139], v[160:163], a[192:207]
ds_read_b64_tr_b16 v[136:137], v224 offset:36992
ds_read_b64_tr_b16 v[138:139], v224 offset:40064
v_add_f32 v246, v246, v102
v_add_f32 v247, v247, v103
v_cvt_pk_bf16_f32 v99, v102, v103
s_waitcnt lgkmcnt(6)
v_mfma_f32_32x32x16_bf16 a[208:223], v[140:143], v[160:163], a[208:223]
ds_read_b64_tr_b16 v[140:141], v223 offset:37120
ds_read_b64_tr_b16 v[142:143], v223 offset:40192
v_exp_f32 v104, v104
v_exp_f32 v105, v105
v_mfma_f32_32x32x16_bf16 a[224:239], v[144:147], v[160:163], a[224:239]
ds_read_b64_tr_b16 v[144:145], v224 offset:37120
ds_read_b64_tr_b16 v[146:147], v224 offset:40192
s_mov_b32 m0, 0x27800
s_mov_b64 exec, s[42:43]
buffer_load_dwordx4 v234, s[16:19], s37 offen lds
s_mov_b64 exec, -1
v_mfma_f32_16x16x32_bf16 a[248:251], v[148:151], v[164:167], a[248:251]
ds_read_b64_tr_b16 v[148:149], v223 offset:43008
ds_read_b64_tr_b16 v[150:151], v223 offset:46080
v_mfma_f32_32x32x16_bf16 a[0:15], v[152:155], v[88:91], a[0:15]
ds_read_b64_tr_b16 v[152:153], v224 offset:43008
ds_read_b64_tr_b16 v[154:155], v224 offset:46080
v_add_f32 v248, v248, v104
v_add_f32 v248, v248, v105
v_cvt_pk_bf16_f32 v104, v104, v105
s_waitcnt lgkmcnt(6)
v_mfma_f32_32x32x16_bf16 a[16:31], v[128:131], v[88:91], a[16:31]
ds_read_b64_tr_b16 v[128:129], v223 offset:43136
ds_read_b64_tr_b16 v[130:131], v223 offset:46208
v_exp_f32 v106, v106
v_exp_f32 v107, v107
v_mfma_f32_32x32x16_bf16 a[32:47], v[132:135], v[88:91], a[32:47]
ds_read_b64_tr_b16 v[132:133], v224 offset:43136
ds_read_b64_tr_b16 v[134:135], v224 offset:46208
v_add_f32 v248, v248, v106
v_add_f32 v248, v248, v107
v_cvt_pk_bf16_f32 v105, v106, v107
v_mfma_f32_32x32x16_bf16 a[48:63], v[136:139], v[88:91], a[48:63]
ds_read_b64_tr_b16 v[136:137], v223 offset:43264
ds_read_b64_tr_b16 v[138:139], v223 offset:46336
s_add_u32 m0, s33, 0x6000
s_mov_b32 s39, 0x12000
buffer_load_dwordx4 v208, s[4:7], s39 offen offset:0 nt lds
v_mfma_f32_32x32x16_bf16 a[64:79], v[140:143], v[88:91], a[64:79]
ds_read_b64_tr_b16 v[140:141], v224 offset:43264
ds_read_b64_tr_b16 v[142:143], v224 offset:46336
s_waitcnt lgkmcnt(6)
v_mfma_f32_32x32x16_bf16 a[80:95], v[144:147], v[88:91], a[80:95]
ds_read_b64_tr_b16 v[144:145], v225 offset:24576
ds_read_b64_tr_b16 v[146:147], v226 offset:24576
v_mfma_f32_32x32x16_bf16 a[0:15], v[148:151], v[96:99], a[0:15]
ds_read_b64_tr_b16 v[148:149], v227 offset:24576
ds_read_b64_tr_b16 v[150:151], v228 offset:24576
v_mfma_f32_32x32x16_bf16 a[16:31], v[152:155], v[96:99], a[16:31]
ds_read_b64_tr_b16 v[152:153], v225 offset:24704
ds_read_b64_tr_b16 v[154:155], v226 offset:24704
buffer_load_dwordx4 v209, s[4:7], s39 offen offset:1024 nt lds
v_mfma_f32_32x32x16_bf16 a[32:47], v[128:131], v[96:99], a[32:47]
ds_read_b64_tr_b16 v[128:129], v227 offset:24704
ds_read_b64_tr_b16 v[130:131], v228 offset:24704
s_waitcnt lgkmcnt(8)
v_mfma_f32_32x32x16_bf16 a[48:63], v[132:135], v[96:99], a[48:63]
ds_read_b64_tr_b16 v[132:133], v225 offset:24832
ds_read_b64_tr_b16 v[134:135], v226 offset:24832
v_mfma_f32_32x32x16_bf16 a[64:79], v[136:139], v[96:99], a[64:79]
ds_read_b64_tr_b16 v[136:137], v227 offset:24832
ds_read_b64_tr_b16 v[138:139], v228 offset:24832
v_mfma_f32_32x32x16_bf16 a[80:95], v[140:143], v[96:99], a[80:95]
s_waitcnt vmcnt(14)
s_barrier
ds_read_b128 v[140:143], v217 offset:0
s_waitcnt lgkmcnt(7)
v_mfma_f32_16x16x16_bf16 a[96:99], v[144:145], v[104:105], a[96:99]
buffer_load_dwordx4 v210, s[4:7], s39 offen offset:2048 nt lds
v_mfma_f32_16x16x16_bf16 a[100:103], v[146:147], v[104:105], a[100:103]
ds_read_b128 v[144:147], v218 offset:0
v_mfma_f32_16x16x16_bf16 a[104:107], v[148:149], v[104:105], a[104:107]
v_mfma_f32_16x16x16_bf16 a[108:111], v[150:151], v[104:105], a[108:111]
ds_read_b128 v[148:151], v219 offset:0
v_mfma_f32_16x16x16_bf16 a[112:115], v[152:153], v[104:105], a[112:115]
v_mfma_f32_16x16x16_bf16 a[116:119], v[154:155], v[104:105], a[116:119]
ds_read_b128 v[152:155], v220 offset:0
s_waitcnt lgkmcnt(4)
v_mfma_f32_16x16x16_bf16 a[120:123], v[128:129], v[104:105], a[120:123]
buffer_load_dwordx4 v211, s[4:7], s39 offen offset:3072 nt lds
v_mfma_f32_16x16x16_bf16 a[124:127], v[130:131], v[104:105], a[124:127]
ds_read_b128 v[128:131], v217 offset:128
v_mfma_f32_16x16x16_bf16 a[128:131], v[132:133], v[104:105], a[128:131]
v_mfma_f32_16x16x16_bf16 a[132:135], v[134:135], v[104:105], a[132:135]
ds_read_b128 v[132:135], v218 offset:128
v_mfma_f32_16x16x16_bf16 a[136:139], v[136:137], v[104:105], a[136:139]
s_add_u32 m0, s33, 0x7000
s_nop 0
buffer_load_dwordx4 v212, s[4:7], s39 offen offset:0 nt lds
buffer_load_dwordx4 v213, s[4:7], s39 offen offset:1024 nt lds
v_mfma_f32_16x16x16_bf16 a[140:143], v[138:139], v[104:105], a[140:143]
s_waitcnt lgkmcnt(2)
v_mfma_f32_32x32x16_bf16 v[72:87], v[140:143], v[0:3], v[108:123]
ds_read_b128 v[136:139], v219 offset:128
ds_read_b128 v[140:143], v220 offset:128
v_mfma_f32_32x32x16_bf16 v[72:87], v[144:147], v[4:7], v[72:87]
ds_read_b128 v[144:147], v217 offset:256
s_add_u32 m0, s34, 0x18000
s_add_u32 s37, s37, 64
s_cmp_eq_u32 s37, 0x500
s_cselect_b32 s37, 0, s37
s_mul_i32 s38, s37, 6144
s_add_u32 s38, s38, 6144
buffer_load_dwordx4 v229, s[12:15], s38 offen offset:0 lds
v_mfma_f32_32x32x16_bf16 v[72:87], v[148:151], v[8:11], v[72:87]
ds_read_b128 v[148:151], v218 offset:256
v_mfma_f32_32x32x16_bf16 v[72:87], v[152:155], v[12:15], v[72:87]
ds_read_b128 v[152:155], v219 offset:256
s_waitcnt lgkmcnt(3)
v_mfma_f32_32x32x16_bf16 v[72:87], v[128:131], v[16:19], v[72:87]
ds_read_b128 v[128:131], v220 offset:256
buffer_load_dwordx4 v230, s[12:15], s38 offen offset:1024 lds
v_mfma_f32_32x32x16_bf16 v[72:87], v[132:135], v[20:23], v[72:87]
ds_read_b64_tr_b16 v[132:133], v235 offset:21504
ds_read_b64_tr_b16 v[134:135], v235 offset:23040
ds_read_b128 v[168:171], v240 offset:21504
v_mfma_f32_32x32x16_bf16 v[72:87], v[136:139], v[24:27], v[72:87]
ds_read_b64_tr_b16 v[136:137], v236 offset:21504
ds_read_b64_tr_b16 v[138:139], v236 offset:23040
v_mfma_f32_32x32x16_bf16 v[72:87], v[140:143], v[28:31], v[72:87]
ds_read_b64_tr_b16 v[140:141], v235 offset:21632
ds_read_b64_tr_b16 v[142:143], v235 offset:23168
buffer_load_dwordx4 v231, s[12:15], s38 offen offset:2048 lds
s_waitcnt lgkmcnt(7)
v_mfma_f32_32x32x16_bf16 v[72:87], v[144:147], v[32:35], v[72:87]
ds_read_b128 v[144:147], v217 offset:12288
v_mfma_f32_32x32x16_bf16 v[72:87], v[148:151], v[36:39], v[72:87]
ds_read_b128 v[148:151], v218 offset:12288
v_mfma_f32_32x32x16_bf16 v[72:87], v[152:155], v[40:43], v[72:87]
ds_read_b128 v[152:155], v219 offset:12288
s_add_u32 m0, s35, 0x1b000
s_nop 0
buffer_load_dwordx4 v232, s[16:19], s37 offen lds
v_mfma_f32_32x32x16_bf16 v[72:87], v[128:131], v[44:47], v[72:87]
ds_read_b128 v[128:131], v220 offset:12288
s_waitcnt lgkmcnt(4)
v_mfma_f32_32x32x16_bf16 a[144:159], v[132:135], v[168:171], a[144:159]
ds_read_b128 v[132:135], v217 offset:12416
s_nop 2
v_max3_f32 v249, v72, v73, v74
v_max3_f32 v249, v249, v75, v76
v_max3_f32 v249, v249, v77, v78
v_max3_f32 v249, v249, v79, v80
v_max3_f32 v249, v249, v81, v82
v_mfma_f32_32x32x16_bf16 a[160:175], v[136:139], v[168:171], a[160:175]
ds_read_b128 v[136:139], v218 offset:12416
v_max3_f32 v249, v249, v83, v84
v_max3_f32 v249, v249, v85, v86
v_max_f32 v249, v249, v87
v_cmp_lt_f32 vcc, 0x41000000, v249
s_nop 0
s_cbranch_vccnz L_fb4
L_rt4:
v_mfma_f32_32x32x16_bf16 a[176:191], v[140:143], v[168:171], a[176:191]
ds_read_b128 v[140:143], v219 offset:12416
buffer_load_dwordx4 v233, s[16:19], s37 offen offset:1024 lds
v_exp_f32 v72, v72
v_exp_f32 v73, v73
s_waitcnt lgkmcnt(2)
v_mfma_f32_32x32x16_bf16 v[88:103], v[144:147], v[0:3], v[108:123]
ds_read_b128 v[144:147], v220 offset:12416
v_add_f32 v246, v246, v72
v_add_f32 v247, v247, v73
v_cvt_pk_bf16_f32 v72, v72, v73
v_mfma_f32_32x32x16_bf16 v[88:103], v[148:151], v[4:7], v[88:103]
ds_read_b128 v[148:151], v217 offset:12544
s_mov_b32 m0, 0x1d000
s_mov_b64 exec, s[42:43]
buffer_load_dwordx4 v234, s[16:19], s37 offen lds
s_mov_b64 exec, -1
v_mfma_f32_32x32x16_bf16 v[88:103], v[152:155], v[8:11], v[88:103]
ds_read_b128 v[152:155], v218 offset:12544
v_exp_f32 v74, v74
v_exp_f32 v75, v75
v_mfma_f32_32x32x16_bf16 v[88:103], v[128:131], v[12:15], v[88:103]
ds_read_b128 v[128:131], v219 offset:12544
v_add_f32 v246, v246, v74
v_add_f32 v247, v247, v75
v_cvt_pk_bf16_f32 v73, v74, v75
v_exp_f32 v76, v76
v_exp_f32 v77, v77
v_mfma_f32_32x32x16_bf16 v[88:103], v[132:135], v[16:19], v[88:103]
ds_read_b128 v[132:135], v220 offset:12544
v_add_f32 v246, v246, v76
v_add_f32 v247, v247, v77
v_cvt_pk_bf16_f32 v74, v76, v77
s_waitcnt lgkmcnt(2)
v_mfma_f32_32x32x16_bf16 v[88:103], v[136:139], v[20:23], v[88:103]
ds_read_b128 v[136:139], v221 offset:0
v_exp_f32 v78, v78
v_exp_f32 v79, v79
v_mfma_f32_32x32x16_bf16 v[88:103], v[140:143], v[24:27], v[88:103]
ds_read_b64_tr_b16 v[140:141], v236 offset:21632
ds_read_b64_tr_b16 v[142:143], v236 offset:23168
v_add_f32 v246, v246, v78
v_add_f32 v247, v247, v79
v_cvt_pk_bf16_f32 v75, v78, v79
v_mfma_f32_32x32x16_bf16 v[88:103], v[144:147], v[28:31], v[88:103]
ds_read_b128 v[144:147], v222 offset:0
v_exp_f32 v80, v80
v_exp_f32 v81, v81
v_mfma_f32_32x32x16_bf16 v[88:103], v[148:151], v[32:35], v[88:103]
ds_read_b64_tr_b16 v[148:149], v237 offset:21504
ds_read_b64_tr_b16 v[150:151], v237 offset:23040
ds_read_b128 v[172:175], v242 offset:21504
v_add_f32 v246, v246, v80
v_add_f32 v247, v247, v81
v_cvt_pk_bf16_f32 v80, v80, v81
v_mfma_f32_32x32x16_bf16 v[88:103], v[152:155], v[36:39], v[88:103]
ds_read_b128 v[152:155], v221 offset:128
v_exp_f32 v82, v82
v_exp_f32 v83, v83
s_waitcnt lgkmcnt(4)
v_mfma_f32_32x32x16_bf16 v[88:103], v[128:131], v[40:43], v[88:103]
ds_read_b64_tr_b16 v[128:129], v235 offset:21760
ds_read_b64_tr_b16 v[130:131], v235 offset:23296
s_add_u32 m0, s33, 0x12000
s_mov_b32 s39, 0x12000
buffer_load_dwordx4 v214, s[8:11], s39 offen offset:0 nt lds
v_mfma_f32_32x32x16_bf16 v[88:103], v[132:135], v[44:47], v[88:103]
ds_read_b128 v[132:135], v222 offset:128
v_add_f32 v246, v246, v82
v_add_f32 v247, v247, v83
v_cvt_pk_bf16_f32 v81, v82, v83
v_exp_f32 v84, v84
v_exp_f32 v85, v85
v_mfma_f32_16x16x32_bf16 v[104:107], v[136:139], v[48:51], v[124:127]
v_mfma_f32_32x32x16_bf16 a[192:207], v[140:143], v[168:171], a[192:207]
ds_read_b64_tr_b16 v[136:137], v236 offset:21760
ds_read_b64_tr_b16 v[138:139], v236 offset:23296
ds_read_b128 v[140:143], v221 offset:256
v_add_f32 v246, v246, v84
v_add_f32 v247, v247, v85
v_cvt_pk_bf16_f32 v82, v84, v85
v_mfma_f32_16x16x32_bf16 v[104:107], v[144:147], v[52:55], v[104:107]
ds_read_b64_tr_b16 v[144:145], v235 offset:27648
ds_read_b64_tr_b16 v[146:147], v235 offset:29184
s_waitcnt lgkmcnt(5)
v_mfma_f32_16x16x32_bf16 a[240:243], v[148:151], v[172:175], a[240:243]
ds_read_b128 v[176:179], v241 offset:21504
ds_read_b128 v[148:151], v222 offset:256
v_mfma_f32_16x16x32_bf16 v[104:107], v[152:155], v[56:59], v[104:107]
ds_read_b64_tr_b16 v[152:153], v236 offset:27648
ds_read_b64_tr_b16 v[154:155], v236 offset:29184
buffer_load_dwordx4 v215, s[8:11], s39 offen offset:1024 nt lds
v_mfma_f32_32x32x16_bf16 a[208:223], v[128:131], v[168:171], a[208:223]
ds_read_b64_tr_b16 v[128:129], v238 offset:21504
ds_read_b64_tr_b16 v[130:131], v238 offset:23040
v_exp_f32 v86, v86
v_exp_f32 v87, v87
v_mfma_f32_16x16x32_bf16 v[104:107], v[132:135], v[60:63], v[104:107]
s_waitcnt lgkmcnt(6)
v_mfma_f32_32x32x16_bf16 a[224:239], v[136:139], v[168:171], a[224:239]
ds_read_b64_tr_b16 v[132:133], v235 offset:27776
ds_read_b64_tr_b16 v[134:135], v235 offset:29312
ds_read_b64_tr_b16 v[136:137], v236 offset:27776
ds_read_b64_tr_b16 v[138:139], v236 offset:29312
buffer_load_dwordx4 v216, s[8:11], s39 offen offset:2048 nt lds
v_mfma_f32_16x16x32_bf16 v[104:107], v[140:143], v[64:67], v[104:107]
ds_read_b64_tr_b16 v[140:141], v235 offset:27904
ds_read_b64_tr_b16 v[142:143], v235 offset:29440
s_waitcnt lgkmcnt(7)
v_mfma_f32_32x32x16_bf16 a[144:159], v[144:147], v[176:179], a[144:159]
ds_read_b64_tr_b16 v[144:145], v236 offset:27904
ds_read_b64_tr_b16 v[146:147], v236 offset:29440
v_add_f32 v246, v246, v86
v_add_f32 v247, v247, v87
v_cvt_pk_bf16_f32 v83, v86, v87
v_max3_f32 v249, v88, v89, v90
v_mfma_f32_16x16x32_bf16 v[104:107], v[148:151], v[68:71], v[104:107]
ds_read_b64_tr_b16 v[148:149], v239 offset:21504
ds_read_b64_tr_b16 v[150:151], v239 offset:23040
v_mfma_f32_32x32x16_bf16 a[160:175], v[152:155], v[176:179], a[160:175]
s_waitcnt vmcnt(15)
s_barrier
ds_read_b64_tr_b16 v[152:153], v223 offset:0
ds_read_b64_tr_b16 v[154:155], v223 offset:3072
s_add_u32 m0, s33, 0x12c00
s_add_u32 s39, s39, 0xc00
buffer_load_dwordx4 v214, s[8:11], s39 offen offset:0 nt lds
s_waitcnt lgkmcnt(6)
v_mfma_f32_16x16x32_bf16 a[244:247], v[128:131], v[172:175], a[244:247]
v_mfma_f32_32x32x16_bf16 a[176:191], v[132:135], v[176:179], a[176:191]
ds_read_b64_tr_b16 v[128:129], v224 offset:0
ds_read_b64_tr_b16 v[130:131], v224 offset:3072
ds_read_b64_tr_b16 v[132:133], v223 offset:128
ds_read_b64_tr_b16 v[134:135], v223 offset:3200
v_max3_f32 v249, v249, v91, v92
v_max3_f32 v249, v249, v93, v94
v_mfma_f32_32x32x16_bf16 a[192:207], v[136:139], v[176:179], a[192:207]
ds_read_b64_tr_b16 v[136:137], v224 offset:128
ds_read_b64_tr_b16 v[138:139], v224 offset:3200
v_max3_f32 v249, v249, v95, v96
v_max3_f32 v249, v249, v97, v98
v_max3_f32 v249, v249, v99, v100
v_max3_f32 v249, v249, v101, v102
v_mfma_f32_32x32x16_bf16 a[208:223], v[140:143], v[176:179], a[208:223]
ds_read_b64_tr_b16 v[140:141], v223 offset:256
ds_read_b64_tr_b16 v[142:143], v223 offset:3328
buffer_load_dwordx4 v215, s[8:11], s39 offen offset:1024 nt lds
v_max_f32 v249, v249, v103
v_max3_f32 v252, v104, v105, v106
s_waitcnt lgkmcnt(5)
v_mfma_f32_32x32x16_bf16 a[224:239], v[144:147], v[176:179], a[224:239]
ds_read_b64_tr_b16 v[144:145], v224 offset:256
ds_read_b64_tr_b16 v[146:147], v224 offset:3328
buffer_load_dwordx4 v216, s[8:11], s39 offen offset:2048 nt lds
v_cmp_lt_f32 vcc, 0x41000000, v249
s_nop 0
s_cbranch_vccnz L_fb6
L_rt6:
v_mfma_f32_16x16x32_bf16 a[248:251], v[148:151], v[172:175], a[248:251]
ds_read_b64_tr_b16 v[148:149], v223 offset:6144
ds_read_b64_tr_b16 v[150:151], v223 offset:9216
v_mfma_f32_32x32x16_bf16 a[0:15], v[152:155], v[72:75], a[0:15]
ds_read_b64_tr_b16 v[152:153], v224 offset:6144
ds_read_b64_tr_b16 v[154:155], v224 offset:9216
v_exp_f32 v88, v88
v_exp_f32 v89, v89
v_mfma_f32_32x32x16_bf16 a[16:31], v[128:131], v[72:75], a[16:31]
ds_read_b64_tr_b16 v[128:129], v223 offset:6272
ds_read_b64_tr_b16 v[130:131], v223 offset:9344
s_add_u32 m0, s34, 0x1d400
s_add_u32 s37, s37, 64
s_cmp_eq_u32 s37, 0x500
s_cselect_b32 s37, 0, s37
s_mul_i32 s38, s37, 6144
s_add_u32 s38, s38, 6144
buffer_load_dwordx4 v229, s[12:15], s38 offen offset:0 lds
s_waitcnt lgkmcnt(4)
v_mfma_f32_32x32x16_bf16 a[32:47], v[132:135], v[72:75], a[32:47]
ds_read_b64_tr_b16 v[132:133], v224 offset:6272
ds_read_b64_tr_b16 v[134:135], v224 offset:9344
v_mfma_f32_32x32x16_bf16 a[48:63], v[136:139], v[72:75], a[48:63]
ds_read_b64_tr_b16 v[136:137], v223 offset:6400
ds_read_b64_tr_b16 v[138:139], v223 offset:9472
v_add_f32 v246, v246, v88
v_add_f32 v247, v247, v89
v_cvt_pk_bf16_f32 v88, v88, v89
v_max_f32 v252, v252, v107
v_mfma_f32_32x32x16_bf16 a[64:79], v[140:143], v[72:75], a[64:79]
ds_read_b64_tr_b16 v[140:141], v224 offset:6400
ds_read_b64_tr_b16 v[142:143], v224 offset:9472
v_exp_f32 v90, v90
v_exp_f32 v91, v91
v_mfma_f32_32x32x16_bf16 a[80:95], v[144:147], v[72:75], a[80:95]
ds_read_b64_tr_b16 v[144:145], v235 offset:43008
ds_read_b64_tr_b16 v[146:147], v235 offset:44544
ds_read_b128 v[156:159], v240 offset:43008
buffer_load_dwordx4 v230, s[12:15], s38 offen offset:1024 lds
v_mfma_f32_32x32x16_bf16 a[0:15], v[148:151], v[80:83], a[0:15]
ds_read_b64_tr_b16 v[148:149], v236 offset:43008
ds_read_b64_tr_b16 v[150:151], v236 offset:44544
v_add_f32 v246, v246, v90
v_add_f32 v247, v247, v91
v_cvt_pk_bf16_f32 v89, v90, v91
s_waitcnt lgkmcnt(6)
v_mfma_f32_32x32x16_bf16 a[16:31], v[152:155], v[80:83], a[16:31]
ds_read_b64_tr_b16 v[152:153], v235 offset:43136
ds_read_b64_tr_b16 v[154:155], v235 offset:44672
v_exp_f32 v92, v92
v_exp_f32 v93, v93
v_mfma_f32_32x32x16_bf16 a[32:47], v[128:131], v[80:83], a[32:47]
ds_read_b64_tr_b16 v[128:129], v236 offset:43136
ds_read_b64_tr_b16 v[130:131], v236 offset:44672
v_add_f32 v246, v246, v92
v_add_f32 v247, v247, v93
v_cvt_pk_bf16_f32 v90, v92, v93
v_mfma_f32_32x32x16_bf16 a[48:63], v[132:135], v[80:83], a[48:63]
ds_read_b64_tr_b16 v[132:133], v237 offset:43008
ds_read_b64_tr_b16 v[134:135], v237 offset:44544
ds_read_b128 v[160:163], v242 offset:43008
v_exp_f32 v94, v94
v_exp_f32 v95, v95
v_mfma_f32_32x32x16_bf16 a[64:79], v[136:139], v[80:83], a[64:79]
ds_read_b64_tr_b16 v[136:137], v235 offset:43264
ds_read_b64_tr_b16 v[138:139], v235 offset:44800
buffer_load_dwordx4 v231, s[12:15], s38 offen offset:2048 lds
s_waitcnt lgkmcnt(6)
v_mfma_f32_32x32x16_bf16 a[80:95], v[140:143], v[80:83], a[80:95]
ds_read_b64_tr_b16 v[140:141], v236 offset:43264
ds_read_b64_tr_b16 v[142:143], v236 offset:44800
v_add_f32 v246, v246, v94
v_add_f32 v247, v247, v95
v_cvt_pk_bf16_f32 v91, v94, v95
v_mfma_f32_32x32x16_bf16 a[144:159], v[144:147], v[156:159], a[144:159]
ds_read_b64_tr_b16 v[144:145], v235 offset:49152
ds_read_b64_tr_b16 v[146:147], v235 offset:50688
ds_read_b128 v[164:167], v241 offset:43008
v_exp_f32 v96, v96
v_exp_f32 v97, v97
v_mfma_f32_32x32x16_bf16 a[160:175], v[148:151], v[156:159], a[160:175]
ds_read_b64_tr_b16 v[148:149], v236 offset:49152
ds_read_b64_tr_b16 v[150:151], v236 offset:50688
v_add_f32 v246, v246, v96
v_add_f32 v247, v247, v97
v_cvt_pk_bf16_f32 v96, v96, v97
v_mfma_f32_32x32x16_bf16 a[176:191], v[152:155], v[156:159], a[176:191]
ds_read_b64_tr_b16 v[152:153], v238 offset:43008
ds_read_b64_tr_b16 v[154:155], v238 offset:44544
v_exp_f32 v98, v98
v_exp_f32 v99, v99
s_waitcnt lgkmcnt(4)
v_mfma_f32_32x32x16_bf16 a[192:207], v[128:131], v[156:159], a[192:207]
ds_read_b64_tr_b16 v[128:129], v235 offset:49280
ds_read_b64_tr_b16 v[130:131], v235 offset:50816
s_add_u32 m0, s35, 0x20400
s_nop 0
buffer_load_dwordx4 v232, s[16:19], s37 offen lds
v_mfma_f32_16x16x32_bf16 a[240:243], v[132:135], v[160:163], a[240:243]
ds_read_b64_tr_b16 v[132:133], v236 offset:49280
ds_read_b64_tr_b16 v[134:135], v236 offset:50816
v_mfma_f32_32x32x16_bf16 a[208:223], v[136:139], v[156:159], a[208:223]
ds_read_b64_tr_b16 v[136:137], v235 offset:49408
ds_read_b64_tr_b16 v[138:139], v235 offset:50944
v_add_f32 v246, v246, v98
v_add_f32 v247, v247, v99
v_cvt_pk_bf16_f32 v97, v98, v99
v_mfma_f32_32x32x16_bf16 a[224:239], v[140:143], v[156:159], a[224:239]
ds_read_b64_tr_b16 v[140:141], v236 offset:49408
ds_read_b64_tr_b16 v[142:143], v236 offset:50944
v_exp_f32 v100, v100
v_exp_f32 v101, v101
v_mfma_f32_32x32x16_bf16 a[144:159], v[144:147], v[164:167], a[144:159]
ds_read_b64_tr_b16 v[144:145], v239 offset:43008
ds_read_b64_tr_b16 v[146:147], v239 offset:44544
v_add_f32 v246, v246, v100
v_add_f32 v247, v247, v101
v_cvt_pk_bf16_f32 v98, v100, v101
s_waitcnt lgkmcnt(5)
v_mfma_f32_32x32x16_bf16 a[160:175], v[148:151], v[164:167], a[160:175]
ds_read_b64_tr_b16 v[148:149], v223 offset:12288
ds_read_b64_tr_b16 v[150:151], v223 offset:15360
buffer_load_dwordx4 v233, s[16:19], s37 offen offset:1024 lds
v_exp_f32 v102, v102
v_exp_f32 v103, v103
v_mfma_f32_16x16x32_bf16 a[244:247], v[152:155], v[160:163], a[244:247]
v_mfma_f32_32x32x16_bf16 a[176:191], v[128:131], v[164:167], a[176:191]
ds_read_b64_tr_b16 v[152:153], v224 offset:12288
ds_read_b64_tr_b16 v[154:155], v224 offset:15360
ds_read_b64_tr_b16 v[128:129], v223 offset:12416
ds_read_b64_tr_b16 v[130:131], v223 offset:15488
v_cmp_lt_f32 vcc, 0x41000000, v252
s_nop 0
s_cbranch_vccnz L_fb5
L_rt5:
v_mfma_f32_32x32x16_bf16 a[192:207], v[132:135], v[164:167], a[192:207]
ds_read_b64_tr_b16 v[132:133], v224 offset:12416
ds_read_b64_tr_b16 v[134:135], v224 offset:15488
v_add_f32 v246, v246, v102
v_add_f32 v247, v247, v103
v_cvt_pk_bf16_f32 v99, v102, v103
s_waitcnt lgkmcnt(6)
v_mfma_f32_32x32x16_bf16 a[208:223], v[136:139], v[164:167], a[208:223]
ds_read_b64_tr_b16 v[136:137], v223 offset:12544
ds_read_b64_tr_b16 v[138:139], v223 offset:15616
v_exp_f32 v104, v104
v_exp_f32 v105, v105
v_mfma_f32_32x32x16_bf16 a[224:239], v[140:143], v[164:167], a[224:239]
ds_read_b64_tr_b16 v[140:141], v224 offset:12544
ds_read_b64_tr_b16 v[142:143], v224 offset:15616
s_mov_b32 m0, 0x22400
s_mov_b64 exec, s[42:43]
buffer_load_dwordx4 v234, s[16:19], s37 offen lds
s_mov_b64 exec, -1
v_mfma_f32_16x16x32_bf16 a[248:251], v[144:147], v[160:163], a[248:251]
ds_read_b64_tr_b16 v[144:145], v223 offset:18432
ds_read_b64_tr_b16 v[146:147], v223 offset:21504
v_mfma_f32_32x32x16_bf16 a[0:15], v[148:151], v[88:91], a[0:15]
ds_read_b64_tr_b16 v[148:149], v224 offset:18432
ds_read_b64_tr_b16 v[150:151], v224 offset:21504
v_add_f32 v248, v248, v104
v_add_f32 v248, v248, v105
v_cvt_pk_bf16_f32 v104, v104, v105
s_waitcnt lgkmcnt(6)
v_mfma_f32_32x32x16_bf16 a[16:31], v[152:155], v[88:91], a[16:31]
ds_read_b64_tr_b16 v[152:153], v223 offset:18560
ds_read_b64_tr_b16 v[154:155], v223 offset:21632
v_exp_f32 v106, v106
v_exp_f32 v107, v107
v_mfma_f32_32x32x16_bf16 a[32:47], v[128:131], v[88:91], a[32:47]
ds_read_b64_tr_b16 v[128:129], v224 offset:18560
ds_read_b64_tr_b16 v[130:131], v224 offset:21632
v_add_f32 v248, v248, v106
v_add_f32 v248, v248, v107
v_cvt_pk_bf16_f32 v105, v106, v107
v_mfma_f32_32x32x16_bf16 a[48:63], v[132:135], v[88:91], a[48:63]
ds_read_b64_tr_b16 v[132:133], v223 offset:18688
ds_read_b64_tr_b16 v[134:135], v223 offset:21760
s_add_u32 m0, s33, 0x0
s_mov_b32 s39, 0x18000
buffer_load_dwordx4 v208, s[4:7], s39 offen offset:0 nt lds
v_mfma_f32_32x32x16_bf16 a[64:79], v[136:139], v[88:91], a[64:79]
ds_read_b64_tr_b16 v[136:137], v224 offset:18688
ds_read_b64_tr_b16 v[138:139], v224 offset:21760
s_waitcnt lgkmcnt(6)
v_mfma_f32_32x32x16_bf16 a[80:95], v[140:143], v[88:91], a[80:95]
ds_read_b64_tr_b16 v[140:141], v225 offset:0
ds_read_b64_tr_b16 v[142:143], v226 offset:0
v_mfma_f32_32x32x16_bf16 a[0:15], v[144:147], v[96:99], a[0:15]
ds_read_b64_tr_b16 v[144:145], v227 offset:0
ds_read_b64_tr_b16 v[146:147], v228 offset:0
v_mfma_f32_32x32x16_bf16 a[16:31], v[148:151], v[96:99], a[16:31]
ds_read_b64_tr_b16 v[148:149], v225 offset:128
ds_read_b64_tr_b16 v[150:151], v226 offset:128
buffer_load_dwordx4 v209, s[4:7], s39 offen offset:1024 nt lds
v_mfma_f32_32x32x16_bf16 a[32:47], v[152:155], v[96:99], a[32:47]
ds_read_b64_tr_b16 v[152:153], v227 offset:128
ds_read_b64_tr_b16 v[154:155], v228 offset:128
s_waitcnt lgkmcnt(8)
v_mfma_f32_32x32x16_bf16 a[48:63], v[128:131], v[96:99], a[48:63]
ds_read_b64_tr_b16 v[128:129], v225 offset:256
ds_read_b64_tr_b16 v[130:131], v226 offset:256
v_mfma_f32_32x32x16_bf16 a[64:79], v[132:135], v[96:99], a[64:79]
ds_read_b64_tr_b16 v[132:133], v227 offset:256
ds_read_b64_tr_b16 v[134:135], v228 offset:256
v_mfma_f32_32x32x16_bf16 a[80:95], v[136:139], v[96:99], a[80:95]
s_waitcnt vmcnt(14)
s_barrier
ds_read_b128 v[136:139], v217 offset:24576
s_waitcnt lgkmcnt(7)
v_mfma_f32_16x16x16_bf16 a[96:99], v[140:141], v[104:105], a[96:99]
buffer_load_dwordx4 v210, s[4:7], s39 offen offset:2048 nt lds
v_mfma_f32_16x16x16_bf16 a[100:103], v[142:143], v[104:105], a[100:103]
ds_read_b128 v[140:143], v218 offset:24576
v_mfma_f32_16x16x16_bf16 a[104:107], v[144:145], v[104:105], a[104:107]
v_mfma_f32_16x16x16_bf16 a[108:111], v[146:147], v[104:105], a[108:111]
ds_read_b128 v[144:147], v219 offset:24576
v_mfma_f32_16x16x16_bf16 a[112:115], v[148:149], v[104:105], a[112:115]
v_mfma_f32_16x16x16_bf16 a[116:119], v[150:151], v[104:105], a[116:119]
ds_read_b128 v[148:151], v220 offset:24576
s_waitcnt lgkmcnt(4)
v_mfma_f32_16x16x16_bf16 a[120:123], v[152:153], v[104:105], a[120:123]
buffer_load_dwordx4 v211, s[4:7], s39 offen offset:3072 nt lds
v_mfma_f32_16x16x16_bf16 a[124:127], v[154:155], v[104:105], a[124:127]
ds_read_b128 v[152:155], v217 offset:24704
v_mfma_f32_16x16x16_bf16 a[128:131], v[128:129], v[104:105], a[128:131]
v_mfma_f32_16x16x16_bf16 a[132:135], v[130:131], v[104:105], a[132:135]
ds_read_b128 v[128:131], v218 offset:24704
v_mfma_f32_16x16x16_bf16 a[136:139], v[132:133], v[104:105], a[136:139]
s_add_u32 m0, s33, 0x1000
s_nop 0
buffer_load_dwordx4 v212, s[4:7], s39 offen offset:0 nt lds
buffer_load_dwordx4 v213, s[4:7], s39 offen offset:1024 nt lds
v_mfma_f32_16x16x16_bf16 a[140:143], v[134:135], v[104:105], a[140:143]
s_waitcnt lgkmcnt(2)
v_mfma_f32_32x32x16_bf16 v[72:87], v[136:139], v[0:3], v[108:123]
ds_read_b128 v[132:135], v219 offset:24704
ds_read_b128 v[136:139], v220 offset:24704
v_mfma_f32_32x32x16_bf16 v[72:87], v[140:143], v[4:7], v[72:87]
ds_read_b128 v[140:143], v217 offset:24832
s_add_u32 m0, s34, 0x22800
s_add_u32 s37, s37, 64
s_cmp_eq_u32 s37, 0x500
s_cselect_b32 s37, 0, s37
s_mul_i32 s38, s37, 6144
s_add_u32 s38, s38, 6144
buffer_load_dwordx4 v229, s[12:15], s38 offen offset:0 lds
v_mfma_f32_32x32x16_bf16 v[72:87], v[144:147], v[8:11], v[72:87]
ds_read_b128 v[144:147], v218 offset:24832
v_mfma_f32_32x32x16_bf16 v[72:87], v[148:151], v[12:15], v[72:87]
ds_read_b128 v[148:151], v219 offset:24832
s_waitcnt lgkmcnt(3)
v_mfma_f32_32x32x16_bf16 v[72:87], v[152:155], v[16:19], v[72:87]
ds_read_b128 v[152:155], v220 offset:24832
buffer_load_dwordx4 v230, s[12:15], s38 offen offset:1024 lds
v_mfma_f32_32x32x16_bf16 v[72:87], v[128:131], v[20:23], v[72:87]
ds_read_b64_tr_b16 v[128:129], v235 offset:0
ds_read_b64_tr_b16 v[130:131], v235 offset:1536
ds_read_b128 v[168:171], v240 offset:0
v_mfma_f32_32x32x16_bf16 v[72:87], v[132:135], v[24:27], v[72:87]
ds_read_b64_tr_b16 v[132:133], v236 offset:0
ds_read_b64_tr_b16 v[134:135], v236 offset:1536
v_mfma_f32_32x32x16_bf16 v[72:87], v[136:139], v[28:31], v[72:87]
ds_read_b64_tr_b16 v[136:137], v235 offset:128
ds_read_b64_tr_b16 v[138:139], v235 offset:1664
buffer_load_dwordx4 v231, s[12:15], s38 offen offset:2048 lds
s_waitcnt lgkmcnt(7)
v_mfma_f32_32x32x16_bf16 v[72:87], v[140:143], v[32:35], v[72:87]
ds_read_b128 v[140:143], v217 offset:36864
v_mfma_f32_32x32x16_bf16 v[72:87], v[144:147], v[36:39], v[72:87]
ds_read_b128 v[144:147], v218 offset:36864
v_mfma_f32_32x32x16_bf16 v[72:87], v[148:151], v[40:43], v[72:87]
ds_read_b128 v[148:151], v219 offset:36864
s_add_u32 m0, s35, 0x25800
s_nop 0
buffer_load_dwordx4 v232, s[16:19], s37 offen lds
v_mfma_f32_32x32x16_bf16 v[72:87], v[152:155], v[44:47], v[72:87]
ds_read_b128 v[152:155], v220 offset:36864
s_waitcnt lgkmcnt(4)
v_mfma_f32_32x32x16_bf16 a[144:159], v[128:131], v[168:171], a[144:159]
ds_read_b128 v[128:131], v217 offset:36992
s_nop 2
v_max3_f32 v249, v72, v73, v74
v_max3_f32 v249, v249, v75, v76
v_max3_f32 v249, v249, v77, v78
v_max3_f32 v249, v249, v79, v80
v_max3_f32 v249, v249, v81, v82
v_mfma_f32_32x32x16_bf16 a[160:175], v[132:135], v[168:171], a[160:175]
ds_read_b128 v[132:135], v218 offset:36992
v_max3_f32 v249, v249, v83, v84
v_max3_f32 v249, v249, v85, v86
v_max_f32 v249, v249, v87
v_cmp_lt_f32 vcc, 0x41000000, v249
s_nop 0
s_cbranch_vccnz L_fb7
L_rt7:
v_mfma_f32_32x32x16_bf16 a[176:191], v[136:139], v[168:171], a[176:191]
ds_read_b128 v[136:139], v219 offset:36992
buffer_load_dwordx4 v233, s[16:19], s37 offen offset:1024 lds
v_exp_f32 v72, v72
v_exp_f32 v73, v73
s_waitcnt lgkmcnt(2)
v_mfma_f32_32x32x16_bf16 v[88:103], v[140:143], v[0:3], v[108:123]
ds_read_b128 v[140:143], v220 offset:36992
v_add_f32 v246, v246, v72
v_add_f32 v247, v247, v73
v_cvt_pk_bf16_f32 v72, v72, v73
v_mfma_f32_32x32x16_bf16 v[88:103], v[144:147], v[4:7], v[88:103]
ds_read_b128 v[144:147], v217 offset:37120
s_mov_b32 m0, 0x27800
s_mov_b64 exec, s[42:43]
buffer_load_dwordx4 v234, s[16:19], s37 offen lds
s_mov_b64 exec, -1
v_mfma_f32_32x32x16_bf16 v[88:103], v[148:151], v[8:11], v[88:103]
ds_read_b128 v[148:151], v218 offset:37120
v_exp_f32 v74, v74
v_exp_f32 v75, v75
v_mfma_f32_32x32x16_bf16 v[88:103], v[152:155], v[12:15], v[88:103]
ds_read_b128 v[152:155], v219 offset:37120
v_add_f32 v246, v246, v74
v_add_f32 v247, v247, v75
v_cvt_pk_bf16_f32 v73, v74, v75
v_exp_f32 v76, v76
v_exp_f32 v77, v77
v_mfma_f32_32x32x16_bf16 v[88:103], v[128:131], v[16:19], v[88:103]
ds_read_b128 v[128:131], v220 offset:37120
v_add_f32 v246, v246, v76
v_add_f32 v247, v247, v77
v_cvt_pk_bf16_f32 v74, v76, v77
s_waitcnt lgkmcnt(2)
v_mfma_f32_32x32x16_bf16 v[88:103], v[132:135], v[20:23], v[88:103]
ds_read_b128 v[132:135], v221 offset:24576
v_exp_f32 v78, v78
v_exp_f32 v79, v79
v_mfma_f32_32x32x16_bf16 v[88:103], v[136:139], v[24:27], v[88:103]
ds_read_b64_tr_b16 v[136:137], v236 offset:128
ds_read_b64_tr_b16 v[138:139], v236 offset:1664
v_add_f32 v246, v246, v78
v_add_f32 v247, v247, v79
v_cvt_pk_bf16_f32 v75, v78, v79
v_mfma_f32_32x32x16_bf16 v[88:103], v[140:143], v[28:31], v[88:103]
ds_read_b128 v[140:143], v222 offset:24576
v_exp_f32 v80, v80
v_exp_f32 v81, v81
v_mfma_f32_32x32x16_bf16 v[88:103], v[144:147], v[32:35], v[88:103]
ds_read_b64_tr_b16 v[144:145], v237 offset:0
ds_read_b64_tr_b16 v[146:147], v237 offset:1536
ds_read_b128 v[176:179], v242 offset:0
v_add_f32 v246, v246, v80
v_add_f32 v247, v247, v81
v_cvt_pk_bf16_f32 v80, v80, v81
v_mfma_f32_32x32x16_bf16 v[88:103], v[148:151], v[36:39], v[88:103]
ds_read_b128 v[148:151], v221 offset:24704
v_exp_f32 v82, v82
v_exp_f32 v83, v83
s_waitcnt lgkmcnt(4)
v_mfma_f32_32x32x16_bf16 v[88:103], v[152:155], v[40:43], v[88:103]
ds_read_b64_tr_b16 v[152:153], v235 offset:256
ds_read_b64_tr_b16 v[154:155], v235 offset:1792
s_add_u32 m0, s33, 0xc000
s_mov_b32 s39, 0x18000
buffer_load_dwordx4 v214, s[8:11], s39 offen offset:0 nt lds
v_mfma_f32_32x32x16_bf16 v[88:103], v[128:131], v[44:47], v[88:103]
ds_read_b128 v[128:131], v222 offset:24704
v_add_f32 v246, v246, v82
v_add_f32 v247, v247, v83
v_cvt_pk_bf16_f32 v81, v82, v83
v_exp_f32 v84, v84
v_exp_f32 v85, v85
v_mfma_f32_16x16x32_bf16 v[104:107], v[132:135], v[48:51], v[124:127]
v_mfma_f32_32x32x16_bf16 a[192:207], v[136:139], v[168:171], a[192:207]
ds_read_b64_tr_b16 v[132:133], v236 offset:256
ds_read_b64_tr_b16 v[134:135], v236 offset:1792
ds_read_b128 v[136:139], v221 offset:24832
v_add_f32 v246, v246, v84
v_add_f32 v247, v247, v85
v_cvt_pk_bf16_f32 v82, v84, v85
v_mfma_f32_16x16x32_bf16 v[104:107], v[140:143], v[52:55], v[104:107]
ds_read_b64_tr_b16 v[140:141], v235 offset:6144
ds_read_b64_tr_b16 v[142:143], v235 offset:7680
s_waitcnt lgkmcnt(5)
v_mfma_f32_16x16x32_bf16 a[240:243], v[144:147], v[176:179], a[240:243]
ds_read_b128 v[172:175], v241 offset:0
ds_read_b128 v[144:147], v222 offset:24832
v_mfma_f32_16x16x32_bf16 v[104:107], v[148:151], v[56:59], v[104:107]
ds_read_b64_tr_b16 v[148:149], v236 offset:6144
ds_read_b64_tr_b16 v[150:151], v236 offset:7680
buffer_load_dwordx4 v215, s[8:11], s39 offen offset:1024 nt lds
v_mfma_f32_32x32x16_bf16 a[208:223], v[152:155], v[168:171], a[208:223]
ds_read_b64_tr_b16 v[152:153], v238 offset:0
ds_read_b64_tr_b16 v[154:155], v238 offset:1536
v_exp_f32 v86, v86
v_exp_f32 v87, v87
v_mfma_f32_16x16x32_bf16 v[104:107], v[128:131], v[60:63], v[104:107]
s_waitcnt lgkmcnt(6)
v_mfma_f32_32x32x16_bf16 a[224:239], v[132:135], v[168:171], a[224:239]
ds_read_b64_tr_b16 v[128:129], v235 offset:6272
ds_read_b64_tr_b16 v[130:131], v235 offset:7808
ds_read_b64_tr_b16 v[132:133], v236 offset:6272
ds_read_b64_tr_b16 v[134:135], v236 offset:7808
buffer_load_dwordx4 v216, s[8:11], s39 offen offset:2048 nt lds
v_mfma_f32_16x16x32_bf16 v[104:107], v[136:139], v[64:67], v[104:107]
ds_read_b64_tr_b16 v[136:137], v235 offset:6400
ds_read_b64_tr_b16 v[138:139], v235 offset:7936
s_waitcnt lgkmcnt(7)
v_mfma_f32_32x32x16_bf16 a[144:159], v[140:143], v[172:175], a[144:159]
ds_read_b64_tr_b16 v[140:141], v236 offset:6400
ds_read_b64_tr_b16 v[142:143], v236 offset:7936
v_add_f32 v246, v246, v86
v_add_f32 v247, v247, v87
v_cvt_pk_bf16_f32 v83, v86, v87
v_max3_f32 v249, v88, v89, v90
v_mfma_f32_16x16x32_bf16 v[104:107], v[144:147], v[68:71], v[104:107]
ds_read_b64_tr_b16 v[144:145], v239 offset:0
ds_read_b64_tr_b16 v[146:147], v239 offset:1536
v_mfma_f32_32x32x16_bf16 a[160:175], v[148:151], v[172:175], a[160:175]
s_waitcnt vmcnt(15)
s_barrier
ds_read_b64_tr_b16 v[148:149], v223 offset:24576
ds_read_b64_tr_b16 v[150:151], v223 offset:27648
s_add_u32 m0, s33, 0xcc00
s_add_u32 s39, s39, 0xc00
buffer_load_dwordx4 v214, s[8:11], s39 offen offset:0 nt lds
s_waitcnt lgkmcnt(6)
v_mfma_f32_16x16x32_bf16 a[244:247], v[152:155], v[176:179], a[244:247]
v_mfma_f32_32x32x16_bf16 a[176:191], v[128:131], v[172:175], a[176:191]
ds_read_b64_tr_b16 v[152:153], v224 offset:24576
ds_read_b64_tr_b16 v[154:155], v224 offset:27648
ds_read_b64_tr_b16 v[128:129], v223 offset:24704
ds_read_b64_tr_b16 v[130:131], v223 offset:27776
v_max3_f32 v249, v249, v91, v92
v_max3_f32 v249, v249, v93, v94
v_mfma_f32_32x32x16_bf16 a[192:207], v[132:135], v[172:175], a[192:207]
ds_read_b64_tr_b16 v[132:133], v224 offset:24704
ds_read_b64_tr_b16 v[134:135], v224 offset:27776
v_max3_f32 v249, v249, v95, v96
v_max3_f32 v249, v249, v97, v98
v_max3_f32 v249, v249, v99, v100
v_max3_f32 v249, v249, v101, v102
v_mfma_f32_32x32x16_bf16 a[208:223], v[136:139], v[172:175], a[208:223]
ds_read_b64_tr_b16 v[136:137], v223 offset:24832
ds_read_b64_tr_b16 v[138:139], v223 offset:27904
buffer_load_dwordx4 v215, s[8:11], s39 offen offset:1024 nt lds
v_max_f32 v249, v249, v103
v_max3_f32 v252, v104, v105, v106
s_waitcnt lgkmcnt(5)
v_mfma_f32_32x32x16_bf16 a[224:239], v[140:143], v[172:175], a[224:239]
ds_read_b64_tr_b16 v[140:141], v224 offset:24832
ds_read_b64_tr_b16 v[142:143], v224 offset:27904
buffer_load_dwordx4 v216, s[8:11], s39 offen offset:2048 nt lds
v_cmp_lt_f32 vcc, 0x41000000, v249
s_nop 0
s_cbranch_vccnz L_fb9
L_rt9:
v_mfma_f32_16x16x32_bf16 a[248:251], v[144:147], v[176:179], a[248:251]
ds_read_b64_tr_b16 v[144:145], v223 offset:30720
ds_read_b64_tr_b16 v[146:147], v223 offset:33792
v_mfma_f32_32x32x16_bf16 a[0:15], v[148:151], v[72:75], a[0:15]
ds_read_b64_tr_b16 v[148:149], v224 offset:30720
ds_read_b64_tr_b16 v[150:151], v224 offset:33792
v_exp_f32 v88, v88
v_exp_f32 v89, v89
v_mfma_f32_32x32x16_bf16 a[16:31], v[152:155], v[72:75], a[16:31]
ds_read_b64_tr_b16 v[152:153], v223 offset:30848
ds_read_b64_tr_b16 v[154:155], v223 offset:33920
s_add_u32 m0, s34, 0x18000
s_add_u32 s37, s37, 64
s_cmp_eq_u32 s37, 0x500
s_cselect_b32 s37, 0, s37
s_mul_i32 s38, s37, 6144
s_add_u32 s38, s38, 6144
buffer_load_dwordx4 v229, s[12:15], s38 offen offset:0 lds
s_waitcnt lgkmcnt(4)
v_mfma_f32_32x32x16_bf16 a[32:47], v[128:131], v[72:75], a[32:47]
ds_read_b64_tr_b16 v[128:129], v224 offset:30848
ds_read_b64_tr_b16 v[130:131], v224 offset:33920
v_mfma_f32_32x32x16_bf16 a[48:63], v[132:135], v[72:75], a[48:63]
ds_read_b64_tr_b16 v[132:133], v223 offset:30976
ds_read_b64_tr_b16 v[134:135], v223 offset:34048
v_add_f32 v246, v246, v88
v_add_f32 v247, v247, v89
v_cvt_pk_bf16_f32 v88, v88, v89
v_max_f32 v252, v252, v107
v_mfma_f32_32x32x16_bf16 a[64:79], v[136:139], v[72:75], a[64:79]
ds_read_b64_tr_b16 v[136:137], v224 offset:30976
ds_read_b64_tr_b16 v[138:139], v224 offset:34048
v_exp_f32 v90, v90
v_exp_f32 v91, v91
v_mfma_f32_32x32x16_bf16 a[80:95], v[140:143], v[72:75], a[80:95]
ds_read_b64_tr_b16 v[140:141], v235 offset:21504
ds_read_b64_tr_b16 v[142:143], v235 offset:23040
ds_read_b128 v[156:159], v240 offset:21504
buffer_load_dwordx4 v230, s[12:15], s38 offen offset:1024 lds
v_mfma_f32_32x32x16_bf16 a[0:15], v[144:147], v[80:83], a[0:15]
ds_read_b64_tr_b16 v[144:145], v236 offset:21504
ds_read_b64_tr_b16 v[146:147], v236 offset:23040
v_add_f32 v246, v246, v90
v_add_f32 v247, v247, v91
v_cvt_pk_bf16_f32 v89, v90, v91
s_waitcnt lgkmcnt(6)
v_mfma_f32_32x32x16_bf16 a[16:31], v[148:151], v[80:83], a[16:31]
ds_read_b64_tr_b16 v[148:149], v235 offset:21632
ds_read_b64_tr_b16 v[150:151], v235 offset:23168
v_exp_f32 v92, v92
v_exp_f32 v93, v93
v_mfma_f32_32x32x16_bf16 a[32:47], v[152:155], v[80:83], a[32:47]
ds_read_b64_tr_b16 v[152:153], v236 offset:21632
ds_read_b64_tr_b16 v[154:155], v236 offset:23168
v_add_f32 v246, v246, v92
v_add_f32 v247, v247, v93
v_cvt_pk_bf16_f32 v90, v92, v93
v_mfma_f32_32x32x16_bf16 a[48:63], v[128:131], v[80:83], a[48:63]
ds_read_b64_tr_b16 v[128:129], v237 offset:21504
ds_read_b64_tr_b16 v[130:131], v237 offset:23040
ds_read_b128 v[164:167], v242 offset:21504
v_exp_f32 v94, v94
v_exp_f32 v95, v95
v_mfma_f32_32x32x16_bf16 a[64:79], v[132:135], v[80:83], a[64:79]
ds_read_b64_tr_b16 v[132:133], v235 offset:21760
ds_read_b64_tr_b16 v[134:135], v235 offset:23296
buffer_load_dwordx4 v231, s[12:15], s38 offen offset:2048 lds
s_waitcnt lgkmcnt(6)
v_mfma_f32_32x32x16_bf16 a[80:95], v[136:139], v[80:83], a[80:95]
ds_read_b64_tr_b16 v[136:137], v236 offset:21760
ds_read_b64_tr_b16 v[138:139], v236 offset:23296
v_add_f32 v246, v246, v94
v_add_f32 v247, v247, v95
v_cvt_pk_bf16_f32 v91, v94, v95
v_mfma_f32_32x32x16_bf16 a[144:159], v[140:143], v[156:159], a[144:159]
ds_read_b64_tr_b16 v[140:141], v235 offset:27648
ds_read_b64_tr_b16 v[142:143], v235 offset:29184
ds_read_b128 v[160:163], v241 offset:21504
v_exp_f32 v96, v96
v_exp_f32 v97, v97
v_mfma_f32_32x32x16_bf16 a[160:175], v[144:147], v[156:159], a[160:175]
ds_read_b64_tr_b16 v[144:145], v236 offset:27648
ds_read_b64_tr_b16 v[146:147], v236 offset:29184
v_add_f32 v246, v246, v96
v_add_f32 v247, v247, v97
v_cvt_pk_bf16_f32 v96, v96, v97
v_mfma_f32_32x32x16_bf16 a[176:191], v[148:151], v[156:159], a[176:191]
ds_read_b64_tr_b16 v[148:149], v238 offset:21504
ds_read_b64_tr_b16 v[150:151], v238 offset:23040
v_exp_f32 v98, v98
v_exp_f32 v99, v99
s_waitcnt lgkmcnt(4)
v_mfma_f32_32x32x16_bf16 a[192:207], v[152:155], v[156:159], a[192:207]
ds_read_b64_tr_b16 v[152:153], v235 offset:27776
ds_read_b64_tr_b16 v[154:155], v235 offset:29312
s_add_u32 m0, s35, 0x1b000
s_nop 0
buffer_load_dwordx4 v232, s[16:19], s37 offen lds
v_mfma_f32_16x16x32_bf16 a[240:243], v[128:131], v[164:167], a[240:243]
ds_read_b64_tr_b16 v[128:129], v236 offset:27776
ds_read_b64_tr_b16 v[130:131], v236 offset:29312
v_mfma_f32_32x32x16_bf16 a[208:223], v[132:135], v[156:159], a[208:223]
ds_read_b64_tr_b16 v[132:133], v235 offset:27904
ds_read_b64_tr_b16 v[134:135], v235 offset:29440
v_add_f32 v246, v246, v98
v_add_f32 v247, v247, v99
v_cvt_pk_bf16_f32 v97, v98, v99
v_mfma_f32_32x32x16_bf16 a[224:239], v[136:139], v[156:159], a[224:239]
ds_read_b64_tr_b16 v[136:137], v236 offset:27904
ds_read_b64_tr_b16 v[138:139], v236 offset:29440
v_exp_f32 v100, v100
v_exp_f32 v101, v101
v_mfma_f32_32x32x16_bf16 a[144:159], v[140:143], v[160:163], a[144:159]
ds_read_b64_tr_b16 v[140:141], v239 offset:21504
ds_read_b64_tr_b16 v[142:143], v239 offset:23040
v_add_f32 v246, v246, v100
v_add_f32 v247, v247, v101
v_cvt_pk_bf16_f32 v98, v100, v101
s_waitcnt lgkmcnt(5)
v_mfma_f32_32x32x16_bf16 a[160:175], v[144:147], v[160:163], a[160:175]
ds_read_b64_tr_b16 v[144:145], v223 offset:36864
ds_read_b64_tr_b16 v[146:147], v223 offset:39936
buffer_load_dwordx4 v233, s[16:19], s37 offen offset:1024 lds
v_exp_f32 v102, v102
v_exp_f32 v103, v103
v_mfma_f32_16x16x32_bf16 a[244:247], v[148:151], v[164:167], a[244:247]
v_mfma_f32_32x32x16_bf16 a[176:191], v[152:155], v[160:163], a[176:191]
ds_read_b64_tr_b16 v[148:149], v224 offset:36864
ds_read_b64_tr_b16 v[150:151], v224 offset:39936
ds_read_b64_tr_b16 v[152:153], v223 offset:36992
ds_read_b64_tr_b16 v[154:155], v223 offset:40064
v_cmp_lt_f32 vcc, 0x41000000, v252
s_nop 0
s_cbranch_vccnz L_fb8
L_rt8:
v_mfma_f32_32x32x16_bf16 a[192:207], v[128:131], v[160:163], a[192:207]
ds_read_b64_tr_b16 v[128:129], v224 offset:36992
ds_read_b64_tr_b16 v[130:131], v224 offset:40064
v_add_f32 v246, v246, v102
v_add_f32 v247, v247, v103
v_cvt_pk_bf16_f32 v99, v102, v103
s_waitcnt lgkmcnt(6)
v_mfma_f32_32x32x16_bf16 a[208:223], v[132:135], v[160:163], a[208:223]
ds_read_b64_tr_b16 v[132:133], v223 offset:37120
ds_read_b64_tr_b16 v[134:135], v223 offset:40192
v_exp_f32 v104, v104
v_exp_f32 v105, v105
v_mfma_f32_32x32x16_bf16 a[224:239], v[136:139], v[160:163], a[224:239]
ds_read_b64_tr_b16 v[136:137], v224 offset:37120
ds_read_b64_tr_b16 v[138:139], v224 offset:40192
s_mov_b32 m0, 0x1d000
s_mov_b64 exec, s[42:43]
buffer_load_dwordx4 v234, s[16:19], s37 offen lds
s_mov_b64 exec, -1
v_mfma_f32_16x16x32_bf16 a[248:251], v[140:143], v[164:167], a[248:251]
ds_read_b64_tr_b16 v[140:141], v223 offset:43008
ds_read_b64_tr_b16 v[142:143], v223 offset:46080
v_mfma_f32_32x32x16_bf16 a[0:15], v[144:147], v[88:91], a[0:15]
ds_read_b64_tr_b16 v[144:145], v224 offset:43008
ds_read_b64_tr_b16 v[146:147], v224 offset:46080
v_add_f32 v248, v248, v104
v_add_f32 v248, v248, v105
v_cvt_pk_bf16_f32 v104, v104, v105
s_waitcnt lgkmcnt(6)
v_mfma_f32_32x32x16_bf16 a[16:31], v[148:151], v[88:91], a[16:31]
ds_read_b64_tr_b16 v[148:149], v223 offset:43136
ds_read_b64_tr_b16 v[150:151], v223 offset:46208
v_exp_f32 v106, v106
v_exp_f32 v107, v107
v_mfma_f32_32x32x16_bf16 a[32:47], v[152:155], v[88:91], a[32:47]
ds_read_b64_tr_b16 v[152:153], v224 offset:43136
ds_read_b64_tr_b16 v[154:155], v224 offset:46208
v_add_f32 v248, v248, v106
v_add_f32 v248, v248, v107
v_cvt_pk_bf16_f32 v105, v106, v107
v_mfma_f32_32x32x16_bf16 a[48:63], v[128:131], v[88:91], a[48:63]
ds_read_b64_tr_b16 v[128:129], v223 offset:43264
ds_read_b64_tr_b16 v[130:131], v223 offset:46336
s_add_u32 m0, s33, 0x6000
s_mov_b32 s39, 0x1e000
buffer_load_dwordx4 v208, s[4:7], s39 offen offset:0 nt lds
v_mfma_f32_32x32x16_bf16 a[64:79], v[132:135], v[88:91], a[64:79]
ds_read_b64_tr_b16 v[132:133], v224 offset:43264
ds_read_b64_tr_b16 v[134:135], v224 offset:46336
s_waitcnt lgkmcnt(6)
v_mfma_f32_32x32x16_bf16 a[80:95], v[136:139], v[88:91], a[80:95]
ds_read_b64_tr_b16 v[136:137], v225 offset:24576
ds_read_b64_tr_b16 v[138:139], v226 offset:24576
v_mfma_f32_32x32x16_bf16 a[0:15], v[140:143], v[96:99], a[0:15]
ds_read_b64_tr_b16 v[140:141], v227 offset:24576
ds_read_b64_tr_b16 v[142:143], v228 offset:24576
v_mfma_f32_32x32x16_bf16 a[16:31], v[144:147], v[96:99], a[16:31]
ds_read_b64_tr_b16 v[144:145], v225 offset:24704
ds_read_b64_tr_b16 v[146:147], v226 offset:24704
buffer_load_dwordx4 v209, s[4:7], s39 offen offset:1024 nt lds
v_mfma_f32_32x32x16_bf16 a[32:47], v[148:151], v[96:99], a[32:47]
ds_read_b64_tr_b16 v[148:149], v227 offset:24704
ds_read_b64_tr_b16 v[150:151], v228 offset:24704
s_waitcnt lgkmcnt(8)
v_mfma_f32_32x32x16_bf16 a[48:63], v[152:155], v[96:99], a[48:63]
ds_read_b64_tr_b16 v[152:153], v225 offset:24832
ds_read_b64_tr_b16 v[154:155], v226 offset:24832
v_mfma_f32_32x32x16_bf16 a[64:79], v[128:131], v[96:99], a[64:79]
ds_read_b64_tr_b16 v[128:129], v227 offset:24832
ds_read_b64_tr_b16 v[130:131], v228 offset:24832
v_mfma_f32_32x32x16_bf16 a[80:95], v[132:135], v[96:99], a[80:95]
s_waitcnt vmcnt(14)
s_barrier
ds_read_b128 v[132:135], v217 offset:0
s_waitcnt lgkmcnt(7)
v_mfma_f32_16x16x16_bf16 a[96:99], v[136:137], v[104:105], a[96:99]
buffer_load_dwordx4 v210, s[4:7], s39 offen offset:2048 nt lds
v_mfma_f32_16x16x16_bf16 a[100:103], v[138:139], v[104:105], a[100:103]
ds_read_b128 v[136:139], v218 offset:0
v_mfma_f32_16x16x16_bf16 a[104:107], v[140:141], v[104:105], a[104:107]
v_mfma_f32_16x16x16_bf16 a[108:111], v[142:143], v[104:105], a[108:111]
ds_read_b128 v[140:143], v219 offset:0
v_mfma_f32_16x16x16_bf16 a[112:115], v[144:145], v[104:105], a[112:115]
v_mfma_f32_16x16x16_bf16 a[116:119], v[146:147], v[104:105], a[116:119]
ds_read_b128 v[144:147], v220 offset:0
s_waitcnt lgkmcnt(4)
v_mfma_f32_16x16x16_bf16 a[120:123], v[148:149], v[104:105], a[120:123]
buffer_load_dwordx4 v211, s[4:7], s39 offen offset:3072 nt lds
v_mfma_f32_16x16x16_bf16 a[124:127], v[150:151], v[104:105], a[124:127]
ds_read_b128 v[148:151], v217 offset:128
v_mfma_f32_16x16x16_bf16 a[128:131], v[152:153], v[104:105], a[128:131]
v_mfma_f32_16x16x16_bf16 a[132:135], v[154:155], v[104:105], a[132:135]
ds_read_b128 v[152:155], v218 offset:128
v_mfma_f32_16x16x16_bf16 a[136:139], v[128:129], v[104:105], a[136:139]
s_add_u32 m0, s33, 0x7000
s_nop 0
buffer_load_dwordx4 v212, s[4:7], s39 offen offset:0 nt lds
buffer_load_dwordx4 v213, s[4:7], s39 offen offset:1024 nt lds
v_mfma_f32_16x16x16_bf16 a[140:143], v[130:131], v[104:105], a[140:143]
s_waitcnt lgkmcnt(2)
v_mfma_f32_32x32x16_bf16 v[72:87], v[132:135], v[0:3], v[108:123]
ds_read_b128 v[128:131], v219 offset:128
ds_read_b128 v[132:135], v220 offset:128
v_mfma_f32_32x32x16_bf16 v[72:87], v[136:139], v[4:7], v[72:87]
ds_read_b128 v[136:139], v217 offset:256
s_add_u32 m0, s34, 0x1d400
s_add_u32 s37, s37, 64
s_cmp_eq_u32 s37, 0x500
s_cselect_b32 s37, 0, s37
s_mul_i32 s38, s37, 6144
s_add_u32 s38, s38, 6144
buffer_load_dwordx4 v229, s[12:15], s38 offen offset:0 lds
v_mfma_f32_32x32x16_bf16 v[72:87], v[140:143], v[8:11], v[72:87]
ds_read_b128 v[140:143], v218 offset:256
v_mfma_f32_32x32x16_bf16 v[72:87], v[144:147], v[12:15], v[72:87]
ds_read_b128 v[144:147], v219 offset:256
s_waitcnt lgkmcnt(3)
v_mfma_f32_32x32x16_bf16 v[72:87], v[148:151], v[16:19], v[72:87]
ds_read_b128 v[148:151], v220 offset:256
buffer_load_dwordx4 v230, s[12:15], s38 offen offset:1024 lds
v_mfma_f32_32x32x16_bf16 v[72:87], v[152:155], v[20:23], v[72:87]
ds_read_b64_tr_b16 v[152:153], v235 offset:43008
ds_read_b64_tr_b16 v[154:155], v235 offset:44544
ds_read_b128 v[168:171], v240 offset:43008
v_mfma_f32_32x32x16_bf16 v[72:87], v[128:131], v[24:27], v[72:87]
ds_read_b64_tr_b16 v[128:129], v236 offset:43008
ds_read_b64_tr_b16 v[130:131], v236 offset:44544
v_mfma_f32_32x32x16_bf16 v[72:87], v[132:135], v[28:31], v[72:87]
ds_read_b64_tr_b16 v[132:133], v235 offset:43136
ds_read_b64_tr_b16 v[134:135], v235 offset:44672
buffer_load_dwordx4 v231, s[12:15], s38 offen offset:2048 lds
s_waitcnt lgkmcnt(7)
v_mfma_f32_32x32x16_bf16 v[72:87], v[136:139], v[32:35], v[72:87]
ds_read_b128 v[136:139], v217 offset:12288
v_mfma_f32_32x32x16_bf16 v[72:87], v[140:143], v[36:39], v[72:87]
ds_read_b128 v[140:143], v218 offset:12288
v_mfma_f32_32x32x16_bf16 v[72:87], v[144:147], v[40:43], v[72:87]
ds_read_b128 v[144:147], v219 offset:12288
s_add_u32 m0, s35, 0x20400
s_nop 0
buffer_load_dwordx4 v232, s[16:19], s37 offen lds
v_mfma_f32_32x32x16_bf16 v[72:87], v[148:151], v[44:47], v[72:87]
ds_read_b128 v[148:151], v220 offset:12288
s_waitcnt lgkmcnt(4)
v_mfma_f32_32x32x16_bf16 a[144:159], v[152:155], v[168:171], a[144:159]
ds_read_b128 v[152:155], v217 offset:12416
s_nop 2
v_max3_f32 v249, v72, v73, v74
v_max3_f32 v249, v249, v75, v76
v_max3_f32 v249, v249, v77, v78
v_max3_f32 v249, v249, v79, v80
v_max3_f32 v249, v249, v81, v82
v_mfma_f32_32x32x16_bf16 a[160:175], v[128:131], v[168:171], a[160:175]
ds_read_b128 v[128:131], v218 offset:12416
v_max3_f32 v249, v249, v83, v84
v_max3_f32 v249, v249, v85, v86
v_max_f32 v249, v249, v87
v_cmp_lt_f32 vcc, 0x41000000, v249
s_nop 0
s_cbranch_vccnz L_fb10
L_rt10:
v_mfma_f32_32x32x16_bf16 a[176:191], v[132:135], v[168:171], a[176:191]
ds_read_b128 v[132:135], v219 offset:12416
buffer_load_dwordx4 v233, s[16:19], s37 offen offset:1024 lds
v_exp_f32 v72, v72
v_exp_f32 v73, v73
s_waitcnt lgkmcnt(2)
v_mfma_f32_32x32x16_bf16 v[88:103], v[136:139], v[0:3], v[108:123]
ds_read_b128 v[136:139], v220 offset:12416
v_add_f32 v246, v246, v72
v_add_f32 v247, v247, v73
v_cvt_pk_bf16_f32 v72, v72, v73
v_mfma_f32_32x32x16_bf16 v[88:103], v[140:143], v[4:7], v[88:103]
ds_read_b128 v[140:143], v217 offset:12544
s_mov_b32 m0, 0x22400
s_mov_b64 exec, s[42:43]
buffer_load_dwordx4 v234, s[16:19], s37 offen lds
s_mov_b64 exec, -1
v_mfma_f32_32x32x16_bf16 v[88:103], v[144:147], v[8:11], v[88:103]
ds_read_b128 v[144:147], v218 offset:12544
v_exp_f32 v74, v74
v_exp_f32 v75, v75
v_mfma_f32_32x32x16_bf16 v[88:103], v[148:151], v[12:15], v[88:103]
ds_read_b128 v[148:151], v219 offset:12544
v_add_f32 v246, v246, v74
v_add_f32 v247, v247, v75
v_cvt_pk_bf16_f32 v73, v74, v75
v_exp_f32 v76, v76
v_exp_f32 v77, v77
v_mfma_f32_32x32x16_bf16 v[88:103], v[152:155], v[16:19], v[88:103]
ds_read_b128 v[152:155], v220 offset:12544
v_add_f32 v246, v246, v76
v_add_f32 v247, v247, v77
v_cvt_pk_bf16_f32 v74, v76, v77
s_waitcnt lgkmcnt(2)
v_mfma_f32_32x32x16_bf16 v[88:103], v[128:131], v[20:23], v[88:103]
ds_read_b128 v[128:131], v221 offset:0
v_exp_f32 v78, v78
v_exp_f32 v79, v79
v_mfma_f32_32x32x16_bf16 v[88:103], v[132:135], v[24:27], v[88:103]
ds_read_b64_tr_b16 v[132:133], v236 offset:43136
ds_read_b64_tr_b16 v[134:135], v236 offset:44672
v_add_f32 v246, v246, v78
v_add_f32 v247, v247, v79
v_cvt_pk_bf16_f32 v75, v78, v79
v_mfma_f32_32x32x16_bf16 v[88:103], v[136:139], v[28:31], v[88:103]
ds_read_b128 v[136:139], v222 offset:0
v_exp_f32 v80, v80
v_exp_f32 v81, v81
v_mfma_f32_32x32x16_bf16 v[88:103], v[140:143], v[32:35], v[88:103]
ds_read_b64_tr_b16 v[140:141], v237 offset:43008
ds_read_b64_tr_b16 v[142:143], v237 offset:44544
ds_read_b128 v[172:175], v242 offset:43008
v_add_f32 v246, v246, v80
v_add_f32 v247, v247, v81
v_cvt_pk_bf16_f32 v80, v80, v81
v_mfma_f32_32x32x16_bf16 v[88:103], v[144:147], v[36:39], v[88:103]
ds_read_b128 v[144:147], v221 offset:128
v_exp_f32 v82, v82
v_exp_f32 v83, v83
s_waitcnt lgkmcnt(4)
v_mfma_f32_32x32x16_bf16 v[88:103], v[148:151], v[40:43], v[88:103]
ds_read_b64_tr_b16 v[148:149], v235 offset:43264
ds_read_b64_tr_b16 v[150:151], v235 offset:44800
s_add_u32 m0, s33, 0x12000
s_mov_b32 s39, 0x1e000
buffer_load_dwordx4 v214, s[8:11], s39 offen offset:0 nt lds
v_mfma_f32_32x32x16_bf16 v[88:103], v[152:155], v[44:47], v[88:103]
ds_read_b128 v[152:155], v222 offset:128
v_add_f32 v246, v246, v82
v_add_f32 v247, v247, v83
v_cvt_pk_bf16_f32 v81, v82, v83
v_exp_f32 v84, v84
v_exp_f32 v85, v85
v_mfma_f32_16x16x32_bf16 v[104:107], v[128:131], v[48:51], v[124:127]
v_mfma_f32_32x32x16_bf16 a[192:207], v[132:135], v[168:171], a[192:207]
ds_read_b64_tr_b16 v[128:129], v236 offset:43264
ds_read_b64_tr_b16 v[130:131], v236 offset:44800
ds_read_b128 v[132:135], v221 offset:256
v_add_f32 v246, v246, v84
v_add_f32 v247, v247, v85
v_cvt_pk_bf16_f32 v82, v84, v85
v_mfma_f32_16x16x32_bf16 v[104:107], v[136:139], v[52:55], v[104:107]
ds_read_b64_tr_b16 v[136:137], v235 offset:49152
ds_read_b64_tr_b16 v[138:139], v235 offset:50688
s_waitcnt lgkmcnt(5)
v_mfma_f32_16x16x32_bf16 a[240:243], v[140:143], v[172:175], a[240:243]
ds_read_b128 v[176:179], v241 offset:43008
ds_read_b128 v[140:143], v222 offset:256
v_mfma_f32_16x16x32_bf16 v[104:107], v[144:147], v[56:59], v[104:107]
ds_read_b64_tr_b16 v[144:145], v236 offset:49152
ds_read_b64_tr_b16 v[146:147], v236 offset:50688
buffer_load_dwordx4 v215, s[8:11], s39 offen offset:1024 nt lds
v_mfma_f32_32x32x16_bf16 a[208:223], v[148:151], v[168:171], a[208:223]
ds_read_b64_tr_b16 v[148:149], v238 offset:43008
ds_read_b64_tr_b16 v[150:151], v238 offset:44544
v_exp_f32 v86, v86
v_exp_f32 v87, v87
v_mfma_f32_16x16x32_bf16 v[104:107], v[152:155], v[60:63], v[104:107]
s_waitcnt lgkmcnt(6)
v_mfma_f32_32x32x16_bf16 a[224:239], v[128:131], v[168:171], a[224:239]
ds_read_b64_tr_b16 v[152:153], v235 offset:49280
ds_read_b64_tr_b16 v[154:155], v235 offset:50816
ds_read_b64_tr_b16 v[128:129], v236 offset:49280
ds_read_b64_tr_b16 v[130:131], v236 offset:50816
buffer_load_dwordx4 v216, s[8:11], s39 offen offset:2048 nt lds
v_mfma_f32_16x16x32_bf16 v[104:107], v[132:135], v[64:67], v[104:107]
ds_read_b64_tr_b16 v[132:133], v235 offset:49408
ds_read_b64_tr_b16 v[134:135], v235 offset:50944
s_waitcnt lgkmcnt(7)
v_mfma_f32_32x32x16_bf16 a[144:159], v[136:139], v[176:179], a[144:159]
ds_read_b64_tr_b16 v[136:137], v236 offset:49408
ds_read_b64_tr_b16 v[138:139], v236 offset:50944
v_add_f32 v246, v246, v86
v_add_f32 v247, v247, v87
v_cvt_pk_bf16_f32 v83, v86, v87
v_max3_f32 v249, v88, v89, v90
v_mfma_f32_16x16x32_bf16 v[104:107], v[140:143], v[68:71], v[104:107]
ds_read_b64_tr_b16 v[140:141], v239 offset:43008
ds_read_b64_tr_b16 v[142:143], v239 offset:44544
v_mfma_f32_32x32x16_bf16 a[160:175], v[144:147], v[176:179], a[160:175]
s_waitcnt vmcnt(15)
s_barrier
ds_read_b64_tr_b16 v[144:145], v223 offset:0
ds_read_b64_tr_b16 v[146:147], v223 offset:3072
s_add_u32 m0, s33, 0x12c00
s_add_u32 s39, s39, 0xc00
buffer_load_dwordx4 v214, s[8:11], s39 offen offset:0 nt lds
s_waitcnt lgkmcnt(6)
v_mfma_f32_16x16x32_bf16 a[244:247], v[148:151], v[172:175], a[244:247]
v_mfma_f32_32x32x16_bf16 a[176:191], v[152:155], v[176:179], a[176:191]
ds_read_b64_tr_b16 v[148:149], v224 offset:0
ds_read_b64_tr_b16 v[150:151], v224 offset:3072
ds_read_b64_tr_b16 v[152:153], v223 offset:128
ds_read_b64_tr_b16 v[154:155], v223 offset:3200
v_max3_f32 v249, v249, v91, v92
v_max3_f32 v249, v249, v93, v94
v_mfma_f32_32x32x16_bf16 a[192:207], v[128:131], v[176:179], a[192:207]
ds_read_b64_tr_b16 v[128:129], v224 offset:128
ds_read_b64_tr_b16 v[130:131], v224 offset:3200
v_max3_f32 v249, v249, v95, v96
v_max3_f32 v249, v249, v97, v98
v_max3_f32 v249, v249, v99, v100
v_max3_f32 v249, v249, v101, v102
v_mfma_f32_32x32x16_bf16 a[208:223], v[132:135], v[176:179], a[208:223]
ds_read_b64_tr_b16 v[132:133], v223 offset:256
ds_read_b64_tr_b16 v[134:135], v223 offset:3328
buffer_load_dwordx4 v215, s[8:11], s39 offen offset:1024 nt lds
v_max_f32 v249, v249, v103
v_max3_f32 v252, v104, v105, v106
s_waitcnt lgkmcnt(5)
v_mfma_f32_32x32x16_bf16 a[224:239], v[136:139], v[176:179], a[224:239]
ds_read_b64_tr_b16 v[136:137], v224 offset:256
ds_read_b64_tr_b16 v[138:139], v224 offset:3328
buffer_load_dwordx4 v216, s[8:11], s39 offen offset:2048 nt lds
v_cmp_lt_f32 vcc, 0x41000000, v249
s_nop 0
s_cbranch_vccnz L_fb12
L_rt12:
v_mfma_f32_16x16x32_bf16 a[248:251], v[140:143], v[172:175], a[248:251]
ds_read_b64_tr_b16 v[140:141], v223 offset:6144
ds_read_b64_tr_b16 v[142:143], v223 offset:9216
v_mfma_f32_32x32x16_bf16 a[0:15], v[144:147], v[72:75], a[0:15]
ds_read_b64_tr_b16 v[144:145], v224 offset:6144
ds_read_b64_tr_b16 v[146:147], v224 offset:9216
v_exp_f32 v88, v88
v_exp_f32 v89, v89
v_mfma_f32_32x32x16_bf16 a[16:31], v[148:151], v[72:75], a[16:31]
ds_read_b64_tr_b16 v[148:149], v223 offset:6272
ds_read_b64_tr_b16 v[150:151], v223 offset:9344
s_add_u32 m0, s34, 0x22800
s_add_u32 s37, s37, 64
s_cmp_eq_u32 s37, 0x500
s_cselect_b32 s37, 0, s37
s_mul_i32 s38, s37, 6144
s_add_u32 s38, s38, 6144
buffer_load_dwordx4 v229, s[12:15], s38 offen offset:0 lds
s_waitcnt lgkmcnt(4)
v_mfma_f32_32x32x16_bf16 a[32:47], v[152:155], v[72:75], a[32:47]
ds_read_b64_tr_b16 v[152:153], v224 offset:6272
ds_read_b64_tr_b16 v[154:155], v224 offset:9344
v_mfma_f32_32x32x16_bf16 a[48:63], v[128:131], v[72:75], a[48:63]
ds_read_b64_tr_b16 v[128:129], v223 offset:6400
ds_read_b64_tr_b16 v[130:131], v223 offset:9472
v_add_f32 v246, v246, v88
v_add_f32 v247, v247, v89
v_cvt_pk_bf16_f32 v88, v88, v89
v_max_f32 v252, v252, v107
v_mfma_f32_32x32x16_bf16 a[64:79], v[132:135], v[72:75], a[64:79]
ds_read_b64_tr_b16 v[132:133], v224 offset:6400
ds_read_b64_tr_b16 v[134:135], v224 offset:9472
v_exp_f32 v90, v90
v_exp_f32 v91, v91
v_mfma_f32_32x32x16_bf16 a[80:95], v[136:139], v[72:75], a[80:95]
ds_read_b64_tr_b16 v[136:137], v235 offset:0
ds_read_b64_tr_b16 v[138:139], v235 offset:1536
ds_read_b128 v[156:159], v240 offset:0
buffer_load_dwordx4 v230, s[12:15], s38 offen offset:1024 lds
v_mfma_f32_32x32x16_bf16 a[0:15], v[140:143], v[80:83], a[0:15]
ds_read_b64_tr_b16 v[140:141], v236 offset:0
ds_read_b64_tr_b16 v[142:143], v236 offset:1536
v_add_f32 v246, v246, v90
v_add_f32 v247, v247, v91
v_cvt_pk_bf16_f32 v89, v90, v91
s_waitcnt lgkmcnt(6)
v_mfma_f32_32x32x16_bf16 a[16:31], v[144:147], v[80:83], a[16:31]
ds_read_b64_tr_b16 v[144:145], v235 offset:128
ds_read_b64_tr_b16 v[146:147], v235 offset:1664
v_exp_f32 v92, v92
v_exp_f32 v93, v93
v_mfma_f32_32x32x16_bf16 a[32:47], v[148:151], v[80:83], a[32:47]
ds_read_b64_tr_b16 v[148:149], v236 offset:128
ds_read_b64_tr_b16 v[150:151], v236 offset:1664
v_add_f32 v246, v246, v92
v_add_f32 v247, v247, v93
v_cvt_pk_bf16_f32 v90, v92, v93
v_mfma_f32_32x32x16_bf16 a[48:63], v[152:155], v[80:83], a[48:63]
ds_read_b64_tr_b16 v[152:153], v237 offset:0
ds_read_b64_tr_b16 v[154:155], v237 offset:1536
ds_read_b128 v[160:163], v242 offset:0
v_exp_f32 v94, v94
v_exp_f32 v95, v95
v_mfma_f32_32x32x16_bf16 a[64:79], v[128:131], v[80:83], a[64:79]
ds_read_b64_tr_b16 v[128:129], v235 offset:256
ds_read_b64_tr_b16 v[130:131], v235 offset:1792
buffer_load_dwordx4 v231, s[12:15], s38 offen offset:2048 lds
s_waitcnt lgkmcnt(6)
v_mfma_f32_32x32x16_bf16 a[80:95], v[132:135], v[80:83], a[80:95]
ds_read_b64_tr_b16 v[132:133], v236 offset:256
ds_read_b64_tr_b16 v[134:135], v236 offset:1792
v_add_f32 v246, v246, v94
v_add_f32 v247, v247, v95
v_cvt_pk_bf16_f32 v91, v94, v95
v_mfma_f32_32x32x16_bf16 a[144:159], v[136:139], v[156:159], a[144:159]
ds_read_b64_tr_b16 v[136:137], v235 offset:6144
ds_read_b64_tr_b16 v[138:139], v235 offset:7680
ds_read_b128 v[164:167], v241 offset:0
v_exp_f32 v96, v96
v_exp_f32 v97, v97
v_mfma_f32_32x32x16_bf16 a[160:175], v[140:143], v[156:159], a[160:175]
ds_read_b64_tr_b16 v[140:141], v236 offset:6144
ds_read_b64_tr_b16 v[142:143], v236 offset:7680
v_add_f32 v246, v246, v96
v_add_f32 v247, v247, v97
v_cvt_pk_bf16_f32 v96, v96, v97
v_mfma_f32_32x32x16_bf16 a[176:191], v[144:147], v[156:159], a[176:191]
ds_read_b64_tr_b16 v[144:145], v238 offset:0
ds_read_b64_tr_b16 v[146:147], v238 offset:1536
v_exp_f32 v98, v98
v_exp_f32 v99, v99
s_waitcnt lgkmcnt(4)
v_mfma_f32_32x32x16_bf16 a[192:207], v[148:151], v[156:159], a[192:207]
ds_read_b64_tr_b16 v[148:149], v235 offset:6272
ds_read_b64_tr_b16 v[150:151], v235 offset:7808
s_add_u32 m0, s35, 0x25800
s_nop 0
buffer_load_dwordx4 v232, s[16:19], s37 offen lds
v_mfma_f32_16x16x32_bf16 a[240:243], v[152:155], v[160:163], a[240:243]
ds_read_b64_tr_b16 v[152:153], v236 offset:6272
ds_read_b64_tr_b16 v[154:155], v236 offset:7808
v_mfma_f32_32x32x16_bf16 a[208:223], v[128:131], v[156:159], a[208:223]
ds_read_b64_tr_b16 v[128:129], v235 offset:6400
ds_read_b64_tr_b16 v[130:131], v235 offset:7936
v_add_f32 v246, v246, v98
v_add_f32 v247, v247, v99
v_cvt_pk_bf16_f32 v97, v98, v99
v_mfma_f32_32x32x16_bf16 a[224:239], v[132:135], v[156:159], a[224:239]
ds_read_b64_tr_b16 v[132:133], v236 offset:6400
ds_read_b64_tr_b16 v[134:135], v236 offset:7936
v_exp_f32 v100, v100
v_exp_f32 v101, v101
v_mfma_f32_32x32x16_bf16 a[144:159], v[136:139], v[164:167], a[144:159]
ds_read_b64_tr_b16 v[136:137], v239 offset:0
ds_read_b64_tr_b16 v[138:139], v239 offset:1536
v_add_f32 v246, v246, v100
v_add_f32 v247, v247, v101
v_cvt_pk_bf16_f32 v98, v100, v101
s_waitcnt lgkmcnt(5)
v_mfma_f32_32x32x16_bf16 a[160:175], v[140:143], v[164:167], a[160:175]
ds_read_b64_tr_b16 v[140:141], v223 offset:12288
ds_read_b64_tr_b16 v[142:143], v223 offset:15360
buffer_load_dwordx4 v233, s[16:19], s37 offen offset:1024 lds
v_exp_f32 v102, v102
v_exp_f32 v103, v103
v_mfma_f32_16x16x32_bf16 a[244:247], v[144:147], v[160:163], a[244:247]
v_mfma_f32_32x32x16_bf16 a[176:191], v[148:151], v[164:167], a[176:191]
ds_read_b64_tr_b16 v[144:145], v224 offset:12288
ds_read_b64_tr_b16 v[146:147], v224 offset:15360
ds_read_b64_tr_b16 v[148:149], v223 offset:12416
ds_read_b64_tr_b16 v[150:151], v223 offset:15488
v_cmp_lt_f32 vcc, 0x41000000, v252
s_nop 0
s_cbranch_vccnz L_fb11
L_rt11:
v_mfma_f32_32x32x16_bf16 a[192:207], v[152:155], v[164:167], a[192:207]
ds_read_b64_tr_b16 v[152:153], v224 offset:12416
ds_read_b64_tr_b16 v[154:155], v224 offset:15488
v_add_f32 v246, v246, v102
v_add_f32 v247, v247, v103
v_cvt_pk_bf16_f32 v99, v102, v103
s_waitcnt lgkmcnt(6)
v_mfma_f32_32x32x16_bf16 a[208:223], v[128:131], v[164:167], a[208:223]
ds_read_b64_tr_b16 v[128:129], v223 offset:12544
ds_read_b64_tr_b16 v[130:131], v223 offset:15616
v_exp_f32 v104, v104
v_exp_f32 v105, v105
v_mfma_f32_32x32x16_bf16 a[224:239], v[132:135], v[164:167], a[224:239]
ds_read_b64_tr_b16 v[132:133], v224 offset:12544
ds_read_b64_tr_b16 v[134:135], v224 offset:15616
s_mov_b32 m0, 0x27800
s_mov_b64 exec, s[42:43]
buffer_load_dwordx4 v234, s[16:19], s37 offen lds
s_mov_b64 exec, -1
v_mfma_f32_16x16x32_bf16 a[248:251], v[136:139], v[160:163], a[248:251]
ds_read_b64_tr_b16 v[136:137], v223 offset:18432
ds_read_b64_tr_b16 v[138:139], v223 offset:21504
v_mfma_f32_32x32x16_bf16 a[0:15], v[140:143], v[88:91], a[0:15]
ds_read_b64_tr_b16 v[140:141], v224 offset:18432
ds_read_b64_tr_b16 v[142:143], v224 offset:21504
v_add_f32 v248, v248, v104
v_add_f32 v248, v248, v105
v_cvt_pk_bf16_f32 v104, v104, v105
s_waitcnt lgkmcnt(6)
v_mfma_f32_32x32x16_bf16 a[16:31], v[144:147], v[88:91], a[16:31]
ds_read_b64_tr_b16 v[144:145], v223 offset:18560
ds_read_b64_tr_b16 v[146:147], v223 offset:21632
v_exp_f32 v106, v106
v_exp_f32 v107, v107
v_mfma_f32_32x32x16_bf16 a[32:47], v[148:151], v[88:91], a[32:47]
ds_read_b64_tr_b16 v[148:149], v224 offset:18560
ds_read_b64_tr_b16 v[150:151], v224 offset:21632
v_add_f32 v248, v248, v106
v_add_f32 v248, v248, v107
v_cvt_pk_bf16_f32 v105, v106, v107
v_mfma_f32_32x32x16_bf16 a[48:63], v[152:155], v[88:91], a[48:63]
ds_read_b64_tr_b16 v[152:153], v223 offset:18688
ds_read_b64_tr_b16 v[154:155], v223 offset:21760
s_add_u32 m0, s33, 0x0
s_mov_b32 s39, 0x24000
buffer_load_dwordx4 v208, s[4:7], s39 offen offset:0 nt lds
v_mfma_f32_32x32x16_bf16 a[64:79], v[128:131], v[88:91], a[64:79]
ds_read_b64_tr_b16 v[128:129], v224 offset:18688
ds_read_b64_tr_b16 v[130:131], v224 offset:21760
s_waitcnt lgkmcnt(6)
v_mfma_f32_32x32x16_bf16 a[80:95], v[132:135], v[88:91], a[80:95]
ds_read_b64_tr_b16 v[132:133], v225 offset:0
ds_read_b64_tr_b16 v[134:135], v226 offset:0
v_mfma_f32_32x32x16_bf16 a[0:15], v[136:139], v[96:99], a[0:15]
ds_read_b64_tr_b16 v[136:137], v227 offset:0
ds_read_b64_tr_b16 v[138:139], v228 offset:0
v_mfma_f32_32x32x16_bf16 a[16:31], v[140:143], v[96:99], a[16:31]
ds_read_b64_tr_b16 v[140:141], v225 offset:128
ds_read_b64_tr_b16 v[142:143], v226 offset:128
buffer_load_dwordx4 v209, s[4:7], s39 offen offset:1024 nt lds
v_mfma_f32_32x32x16_bf16 a[32:47], v[144:147], v[96:99], a[32:47]
ds_read_b64_tr_b16 v[144:145], v227 offset:128
ds_read_b64_tr_b16 v[146:147], v228 offset:128
s_waitcnt lgkmcnt(8)
v_mfma_f32_32x32x16_bf16 a[48:63], v[148:151], v[96:99], a[48:63]
ds_read_b64_tr_b16 v[148:149], v225 offset:256
ds_read_b64_tr_b16 v[150:151], v226 offset:256
v_mfma_f32_32x32x16_bf16 a[64:79], v[152:155], v[96:99], a[64:79]
ds_read_b64_tr_b16 v[152:153], v227 offset:256
ds_read_b64_tr_b16 v[154:155], v228 offset:256
v_mfma_f32_32x32x16_bf16 a[80:95], v[128:131], v[96:99], a[80:95]
s_waitcnt vmcnt(14)
s_barrier
ds_read_b128 v[128:131], v217 offset:24576
s_waitcnt lgkmcnt(7)
v_mfma_f32_16x16x16_bf16 a[96:99], v[132:133], v[104:105], a[96:99]
buffer_load_dwordx4 v210, s[4:7], s39 offen offset:2048 nt lds
v_mfma_f32_16x16x16_bf16 a[100:103], v[134:135], v[104:105], a[100:103]
ds_read_b128 v[132:135], v218 offset:24576
v_mfma_f32_16x16x16_bf16 a[104:107], v[136:137], v[104:105], a[104:107]
v_mfma_f32_16x16x16_bf16 a[108:111], v[138:139], v[104:105], a[108:111]
ds_read_b128 v[136:139], v219 offset:24576
v_mfma_f32_16x16x16_bf16 a[112:115], v[140:141], v[104:105], a[112:115]
v_mfma_f32_16x16x16_bf16 a[116:119], v[142:143], v[104:105], a[116:119]
ds_read_b128 v[140:143], v220 offset:24576
s_waitcnt lgkmcnt(4)
v_mfma_f32_16x16x16_bf16 a[120:123], v[144:145], v[104:105], a[120:123]
buffer_load_dwordx4 v211, s[4:7], s39 offen offset:3072 nt lds
v_mfma_f32_16x16x16_bf16 a[124:127], v[146:147], v[104:105], a[124:127]
ds_read_b128 v[144:147], v217 offset:24704
v_mfma_f32_16x16x16_bf16 a[128:131], v[148:149], v[104:105], a[128:131]
v_mfma_f32_16x16x16_bf16 a[132:135], v[150:151], v[104:105], a[132:135]
ds_read_b128 v[148:151], v218 offset:24704
v_mfma_f32_16x16x16_bf16 a[136:139], v[152:153], v[104:105], a[136:139]
s_add_u32 m0, s33, 0x1000
s_nop 0
buffer_load_dwordx4 v212, s[4:7], s39 offen offset:0 nt lds
buffer_load_dwordx4 v213, s[4:7], s39 offen offset:1024 nt lds
v_mfma_f32_16x16x16_bf16 a[140:143], v[154:155], v[104:105], a[140:143]
s_waitcnt lgkmcnt(2)
v_mfma_f32_32x32x16_bf16 v[72:87], v[128:131], v[0:3], v[108:123]
ds_read_b128 v[152:155], v219 offset:24704
ds_read_b128 v[128:131], v220 offset:24704
v_mfma_f32_32x32x16_bf16 v[72:87], v[132:135], v[4:7], v[72:87]
ds_read_b128 v[132:135], v217 offset:24832
s_add_u32 m0, s34, 0x18000
s_add_u32 s37, s37, 64
s_cmp_eq_u32 s37, 0x500
s_cselect_b32 s37, 0, s37
s_mul_i32 s38, s37, 6144
s_add_u32 s38, s38, 6144
buffer_load_dwordx4 v229, s[12:15], s38 offen offset:0 lds
v_mfma_f32_32x32x16_bf16 v[72:87], v[136:139], v[8:11], v[72:87]
ds_read_b128 v[136:139], v218 offset:24832
v_mfma_f32_32x32x16_bf16 v[72:87], v[140:143], v[12:15], v[72:87]
ds_read_b128 v[140:143], v219 offset:24832
s_waitcnt lgkmcnt(3)
v_mfma_f32_32x32x16_bf16 v[72:87], v[144:147], v[16:19], v[72:87]
ds_read_b128 v[144:147], v220 offset:24832
buffer_load_dwordx4 v230, s[12:15], s38 offen offset:1024 lds
v_mfma_f32_32x32x16_bf16 v[72:87], v[148:151], v[20:23], v[72:87]
ds_read_b64_tr_b16 v[148:149], v235 offset:21504
ds_read_b64_tr_b16 v[150:151], v235 offset:23040
ds_read_b128 v[168:171], v240 offset:21504
v_mfma_f32_32x32x16_bf16 v[72:87], v[152:155], v[24:27], v[72:87]
ds_read_b64_tr_b16 v[152:153], v236 offset:21504
ds_read_b64_tr_b16 v[154:155], v236 offset:23040
v_mfma_f32_32x32x16_bf16 v[72:87], v[128:131], v[28:31], v[72:87]
ds_read_b64_tr_b16 v[128:129], v235 offset:21632
ds_read_b64_tr_b16 v[130:131], v235 offset:23168
buffer_load_dwordx4 v231, s[12:15], s38 offen offset:2048 lds
s_waitcnt lgkmcnt(7)
v_mfma_f32_32x32x16_bf16 v[72:87], v[132:135], v[32:35], v[72:87]
ds_read_b128 v[132:135], v217 offset:36864
v_mfma_f32_32x32x16_bf16 v[72:87], v[136:139], v[36:39], v[72:87]
ds_read_b128 v[136:139], v218 offset:36864
v_mfma_f32_32x32x16_bf16 v[72:87], v[140:143], v[40:43], v[72:87]
ds_read_b128 v[140:143], v219 offset:36864
s_add_u32 m0, s35, 0x1b000
s_nop 0
buffer_load_dwordx4 v232, s[16:19], s37 offen lds
v_mfma_f32_32x32x16_bf16 v[72:87], v[144:147], v[44:47], v[72:87]
ds_read_b128 v[144:147], v220 offset:36864
s_waitcnt lgkmcnt(4)
v_mfma_f32_32x32x16_bf16 a[144:159], v[148:151], v[168:171], a[144:159]
ds_read_b128 v[148:151], v217 offset:36992
s_nop 2
v_max3_f32 v249, v72, v73, v74
v_max3_f32 v249, v249, v75, v76
v_max3_f32 v249, v249, v77, v78
v_max3_f32 v249, v249, v79, v80
v_max3_f32 v249, v249, v81, v82
v_mfma_f32_32x32x16_bf16 a[160:175], v[152:155], v[168:171], a[160:175]
ds_read_b128 v[152:155], v218 offset:36992
v_max3_f32 v249, v249, v83, v84
v_max3_f32 v249, v249, v85, v86
v_max_f32 v249, v249, v87
v_cmp_lt_f32 vcc, 0x41000000, v249
s_nop 0
s_cbranch_vccnz L_fb13
L_rt13:
v_mfma_f32_32x32x16_bf16 a[176:191], v[128:131], v[168:171], a[176:191]
ds_read_b128 v[128:131], v219 offset:36992
buffer_load_dwordx4 v233, s[16:19], s37 offen offset:1024 lds
v_exp_f32 v72, v72
v_exp_f32 v73, v73
s_waitcnt lgkmcnt(2)
v_mfma_f32_32x32x16_bf16 v[88:103], v[132:135], v[0:3], v[108:123]
ds_read_b128 v[132:135], v220 offset:36992
v_add_f32 v246, v246, v72
v_add_f32 v247, v247, v73
v_cvt_pk_bf16_f32 v72, v72, v73
v_mfma_f32_32x32x16_bf16 v[88:103], v[136:139], v[4:7], v[88:103]
ds_read_b128 v[136:139], v217 offset:37120
s_mov_b32 m0, 0x1d000
s_mov_b64 exec, s[42:43]
buffer_load_dwordx4 v234, s[16:19], s37 offen lds
s_mov_b64 exec, -1
v_mfma_f32_32x32x16_bf16 v[88:103], v[140:143], v[8:11], v[88:103]
ds_read_b128 v[140:143], v218 offset:37120
v_exp_f32 v74, v74
v_exp_f32 v75, v75
v_mfma_f32_32x32x16_bf16 v[88:103], v[144:147], v[12:15], v[88:103]
ds_read_b128 v[144:147], v219 offset:37120
v_add_f32 v246, v246, v74
v_add_f32 v247, v247, v75
v_cvt_pk_bf16_f32 v73, v74, v75
v_exp_f32 v76, v76
v_exp_f32 v77, v77
v_mfma_f32_32x32x16_bf16 v[88:103], v[148:151], v[16:19], v[88:103]
ds_read_b128 v[148:151], v220 offset:37120
v_add_f32 v246, v246, v76
v_add_f32 v247, v247, v77
v_cvt_pk_bf16_f32 v74, v76, v77
s_waitcnt lgkmcnt(2)
v_mfma_f32_32x32x16_bf16 v[88:103], v[152:155], v[20:23], v[88:103]
ds_read_b128 v[152:155], v221 offset:24576
v_exp_f32 v78, v78
v_exp_f32 v79, v79
v_mfma_f32_32x32x16_bf16 v[88:103], v[128:131], v[24:27], v[88:103]
ds_read_b64_tr_b16 v[128:129], v236 offset:21632
ds_read_b64_tr_b16 v[130:131], v236 offset:23168
v_add_f32 v246, v246, v78
v_add_f32 v247, v247, v79
v_cvt_pk_bf16_f32 v75, v78, v79
v_mfma_f32_32x32x16_bf16 v[88:103], v[132:135], v[28:31], v[88:103]
ds_read_b128 v[132:135], v222 offset:24576
v_exp_f32 v80, v80
v_exp_f32 v81, v81
v_mfma_f32_32x32x16_bf16 v[88:103], v[136:139], v[32:35], v[88:103]
ds_read_b64_tr_b16 v[136:137], v237 offset:21504
ds_read_b64_tr_b16 v[138:139], v237 offset:23040
ds_read_b128 v[176:179], v242 offset:21504
v_add_f32 v246, v246, v80
v_add_f32 v247, v247, v81
v_cvt_pk_bf16_f32 v80, v80, v81
v_mfma_f32_32x32x16_bf16 v[88:103], v[140:143], v[36:39], v[88:103]
ds_read_b128 v[140:143], v221 offset:24704
v_exp_f32 v82, v82
v_exp_f32 v83, v83
s_waitcnt lgkmcnt(4)
v_mfma_f32_32x32x16_bf16 v[88:103], v[144:147], v[40:43], v[88:103]
ds_read_b64_tr_b16 v[144:145], v235 offset:21760
ds_read_b64_tr_b16 v[146:147], v235 offset:23296
s_add_u32 m0, s33, 0xc000
s_mov_b32 s39, 0x24000
buffer_load_dwordx4 v214, s[8:11], s39 offen offset:0 nt lds
v_mfma_f32_32x32x16_bf16 v[88:103], v[148:151], v[44:47], v[88:103]
ds_read_b128 v[148:151], v222 offset:24704
v_add_f32 v246, v246, v82
v_add_f32 v247, v247, v83
v_cvt_pk_bf16_f32 v81, v82, v83
v_exp_f32 v84, v84
v_exp_f32 v85, v85
v_mfma_f32_16x16x32_bf16 v[104:107], v[152:155], v[48:51], v[124:127]
v_mfma_f32_32x32x16_bf16 a[192:207], v[128:131], v[168:171], a[192:207]
ds_read_b64_tr_b16 v[152:153], v236 offset:21760
ds_read_b64_tr_b16 v[154:155], v236 offset:23296
ds_read_b128 v[128:131], v221 offset:24832
v_add_f32 v246, v246, v84
v_add_f32 v247, v247, v85
v_cvt_pk_bf16_f32 v82, v84, v85
v_mfma_f32_16x16x32_bf16 v[104:107], v[132:135], v[52:55], v[104:107]
ds_read_b64_tr_b16 v[132:133], v235 offset:27648
ds_read_b64_tr_b16 v[134:135], v235 offset:29184
s_waitcnt lgkmcnt(5)
v_mfma_f32_16x16x32_bf16 a[240:243], v[136:139], v[176:179], a[240:243]
ds_read_b128 v[172:175], v241 offset:21504
ds_read_b128 v[136:139], v222 offset:24832
v_mfma_f32_16x16x32_bf16 v[104:107], v[140:143], v[56:59], v[104:107]
ds_read_b64_tr_b16 v[140:141], v236 offset:27648
ds_read_b64_tr_b16 v[142:143], v236 offset:29184
buffer_load_dwordx4 v215, s[8:11], s39 offen offset:1024 nt lds
v_mfma_f32_32x32x16_bf16 a[208:223], v[144:147], v[168:171], a[208:223]
ds_read_b64_tr_b16 v[144:145], v238 offset:21504
ds_read_b64_tr_b16 v[146:147], v238 offset:23040
v_exp_f32 v86, v86
v_exp_f32 v87, v87
v_mfma_f32_16x16x32_bf16 v[104:107], v[148:151], v[60:63], v[104:107]
s_waitcnt lgkmcnt(6)
v_mfma_f32_32x32x16_bf16 a[224:239], v[152:155], v[168:171], a[224:239]
ds_read_b64_tr_b16 v[148:149], v235 offset:27776
ds_read_b64_tr_b16 v[150:151], v235 offset:29312
ds_read_b64_tr_b16 v[152:153], v236 offset:27776
ds_read_b64_tr_b16 v[154:155], v236 offset:29312
buffer_load_dwordx4 v216, s[8:11], s39 offen offset:2048 nt lds
v_mfma_f32_16x16x32_bf16 v[104:107], v[128:131], v[64:67], v[104:107]
ds_read_b64_tr_b16 v[128:129], v235 offset:27904
ds_read_b64_tr_b16 v[130:131], v235 offset:29440
s_waitcnt lgkmcnt(7)
v_mfma_f32_32x32x16_bf16 a[144:159], v[132:135], v[172:175], a[144:159]
ds_read_b64_tr_b16 v[132:133], v236 offset:27904
ds_read_b64_tr_b16 v[134:135], v236 offset:29440
v_add_f32 v246, v246, v86
v_add_f32 v247, v247, v87
v_cvt_pk_bf16_f32 v83, v86, v87
v_max3_f32 v249, v88, v89, v90
v_mfma_f32_16x16x32_bf16 v[104:107], v[136:139], v[68:71], v[104:107]
ds_read_b64_tr_b16 v[136:137], v239 offset:21504
ds_read_b64_tr_b16 v[138:139], v239 offset:23040
v_mfma_f32_32x32x16_bf16 a[160:175], v[140:143], v[172:175], a[160:175]
s_waitcnt vmcnt(15)
s_barrier
ds_read_b64_tr_b16 v[140:141], v223 offset:24576
ds_read_b64_tr_b16 v[142:143], v223 offset:27648
s_add_u32 m0, s33, 0xcc00
s_add_u32 s39, s39, 0xc00
buffer_load_dwordx4 v214, s[8:11], s39 offen offset:0 nt lds
s_waitcnt lgkmcnt(6)
v_mfma_f32_16x16x32_bf16 a[244:247], v[144:147], v[176:179], a[244:247]
v_mfma_f32_32x32x16_bf16 a[176:191], v[148:151], v[172:175], a[176:191]
ds_read_b64_tr_b16 v[144:145], v224 offset:24576
ds_read_b64_tr_b16 v[146:147], v224 offset:27648
ds_read_b64_tr_b16 v[148:149], v223 offset:24704
ds_read_b64_tr_b16 v[150:151], v223 offset:27776
v_max3_f32 v249, v249, v91, v92
v_max3_f32 v249, v249, v93, v94
v_mfma_f32_32x32x16_bf16 a[192:207], v[152:155], v[172:175], a[192:207]
ds_read_b64_tr_b16 v[152:153], v224 offset:24704
ds_read_b64_tr_b16 v[154:155], v224 offset:27776
v_max3_f32 v249, v249, v95, v96
v_max3_f32 v249, v249, v97, v98
v_max3_f32 v249, v249, v99, v100
v_max3_f32 v249, v249, v101, v102
v_mfma_f32_32x32x16_bf16 a[208:223], v[128:131], v[172:175], a[208:223]
ds_read_b64_tr_b16 v[128:129], v223 offset:24832
ds_read_b64_tr_b16 v[130:131], v223 offset:27904
buffer_load_dwordx4 v215, s[8:11], s39 offen offset:1024 nt lds
v_max_f32 v249, v249, v103
v_max3_f32 v252, v104, v105, v106
s_waitcnt lgkmcnt(5)
v_mfma_f32_32x32x16_bf16 a[224:239], v[132:135], v[172:175], a[224:239]
ds_read_b64_tr_b16 v[132:133], v224 offset:24832
ds_read_b64_tr_b16 v[134:135], v224 offset:27904
buffer_load_dwordx4 v216, s[8:11], s39 offen offset:2048 nt lds
v_cmp_lt_f32 vcc, 0x41000000, v249
s_nop 0
s_cbranch_vccnz L_fb15
L_rt15:
v_mfma_f32_16x16x32_bf16 a[248:251], v[136:139], v[176:179], a[248:251]
ds_read_b64_tr_b16 v[136:137], v223 offset:30720
ds_read_b64_tr_b16 v[138:139], v223 offset:33792
v_mfma_f32_32x32x16_bf16 a[0:15], v[140:143], v[72:75], a[0:15]
ds_read_b64_tr_b16 v[140:141], v224 offset:30720
ds_read_b64_tr_b16 v[142:143], v224 offset:33792
v_exp_f32 v88, v88
v_exp_f32 v89, v89
v_mfma_f32_32x32x16_bf16 a[16:31], v[144:147], v[72:75], a[16:31]
ds_read_b64_tr_b16 v[144:145], v223 offset:30848
ds_read_b64_tr_b16 v[146:147], v223 offset:33920
s_add_u32 m0, s34, 0x1d400
s_add_u32 s37, s37, 64
s_cmp_eq_u32 s37, 0x500
s_cselect_b32 s37, 0, s37
s_mul_i32 s38, s37, 6144
s_add_u32 s38, s38, 6144
buffer_load_dwordx4 v229, s[12:15], s38 offen offset:0 lds
s_waitcnt lgkmcnt(4)
v_mfma_f32_32x32x16_bf16 a[32:47], v[148:151], v[72:75], a[32:47]
ds_read_b64_tr_b16 v[148:149], v224 offset:30848
ds_read_b64_tr_b16 v[150:151], v224 offset:33920
v_mfma_f32_32x32x16_bf16 a[48:63], v[152:155], v[72:75], a[48:63]
ds_read_b64_tr_b16 v[152:153], v223 offset:30976
ds_read_b64_tr_b16 v[154:155], v223 offset:34048
v_add_f32 v246, v246, v88
v_add_f32 v247, v247, v89
v_cvt_pk_bf16_f32 v88, v88, v89
v_max_f32 v252, v252, v107
v_mfma_f32_32x32x16_bf16 a[64:79], v[128:131], v[72:75], a[64:79]
ds_read_b64_tr_b16 v[128:129], v224 offset:30976
ds_read_b64_tr_b16 v[130:131], v224 offset:34048
v_exp_f32 v90, v90
v_exp_f32 v91, v91
v_mfma_f32_32x32x16_bf16 a[80:95], v[132:135], v[72:75], a[80:95]
ds_read_b64_tr_b16 v[132:133], v235 offset:43008
ds_read_b64_tr_b16 v[134:135], v235 offset:44544
ds_read_b128 v[156:159], v240 offset:43008
buffer_load_dwordx4 v230, s[12:15], s38 offen offset:1024 lds
v_mfma_f32_32x32x16_bf16 a[0:15], v[136:139], v[80:83], a[0:15]
ds_read_b64_tr_b16 v[136:137], v236 offset:43008
ds_read_b64_tr_b16 v[138:139], v236 offset:44544
v_add_f32 v246, v246, v90
v_add_f32 v247, v247, v91
v_cvt_pk_bf16_f32 v89, v90, v91
s_waitcnt lgkmcnt(6)
v_mfma_f32_32x32x16_bf16 a[16:31], v[140:143], v[80:83], a[16:31]
ds_read_b64_tr_b16 v[140:141], v235 offset:43136
ds_read_b64_tr_b16 v[142:143], v235 offset:44672
v_exp_f32 v92, v92
v_exp_f32 v93, v93
v_mfma_f32_32x32x16_bf16 a[32:47], v[144:147], v[80:83], a[32:47]
ds_read_b64_tr_b16 v[144:145], v236 offset:43136
ds_read_b64_tr_b16 v[146:147], v236 offset:44672
v_add_f32 v246, v246, v92
v_add_f32 v247, v247, v93
v_cvt_pk_bf16_f32 v90, v92, v93
v_mfma_f32_32x32x16_bf16 a[48:63], v[148:151], v[80:83], a[48:63]
ds_read_b64_tr_b16 v[148:149], v237 offset:43008
ds_read_b64_tr_b16 v[150:151], v237 offset:44544
ds_read_b128 v[164:167], v242 offset:43008
v_exp_f32 v94, v94
v_exp_f32 v95, v95
v_mfma_f32_32x32x16_bf16 a[64:79], v[152:155], v[80:83], a[64:79]
ds_read_b64_tr_b16 v[152:153], v235 offset:43264
ds_read_b64_tr_b16 v[154:155], v235 offset:44800
buffer_load_dwordx4 v231, s[12:15], s38 offen offset:2048 lds
s_waitcnt lgkmcnt(6)
v_mfma_f32_32x32x16_bf16 a[80:95], v[128:131], v[80:83], a[80:95]
ds_read_b64_tr_b16 v[128:129], v236 offset:43264
ds_read_b64_tr_b16 v[130:131], v236 offset:44800
v_add_f32 v246, v246, v94
v_add_f32 v247, v247, v95
v_cvt_pk_bf16_f32 v91, v94, v95
v_mfma_f32_32x32x16_bf16 a[144:159], v[132:135], v[156:159], a[144:159]
ds_read_b64_tr_b16 v[132:133], v235 offset:49152
ds_read_b64_tr_b16 v[134:135], v235 offset:50688
ds_read_b128 v[160:163], v241 offset:43008
v_exp_f32 v96, v96
v_exp_f32 v97, v97
v_mfma_f32_32x32x16_bf16 a[160:175], v[136:139], v[156:159], a[160:175]
ds_read_b64_tr_b16 v[136:137], v236 offset:49152
ds_read_b64_tr_b16 v[138:139], v236 offset:50688
v_add_f32 v246, v246, v96
v_add_f32 v247, v247, v97
v_cvt_pk_bf16_f32 v96, v96, v97
v_mfma_f32_32x32x16_bf16 a[176:191], v[140:143], v[156:159], a[176:191]
ds_read_b64_tr_b16 v[140:141], v238 offset:43008
ds_read_b64_tr_b16 v[142:143], v238 offset:44544
v_exp_f32 v98, v98
v_exp_f32 v99, v99
s_waitcnt lgkmcnt(4)
v_mfma_f32_32x32x16_bf16 a[192:207], v[144:147], v[156:159], a[192:207]
ds_read_b64_tr_b16 v[144:145], v235 offset:49280
ds_read_b64_tr_b16 v[146:147], v235 offset:50816
s_add_u32 m0, s35, 0x20400
s_nop 0
buffer_load_dwordx4 v232, s[16:19], s37 offen lds
v_mfma_f32_16x16x32_bf16 a[240:243], v[148:151], v[164:167], a[240:243]
ds_read_b64_tr_b16 v[148:149], v236 offset:49280
ds_read_b64_tr_b16 v[150:151], v236 offset:50816
v_mfma_f32_32x32x16_bf16 a[208:223], v[152:155], v[156:159], a[208:223]
ds_read_b64_tr_b16 v[152:153], v235 offset:49408
ds_read_b64_tr_b16 v[154:155], v235 offset:50944
v_add_f32 v246, v246, v98
v_add_f32 v247, v247, v99
v_cvt_pk_bf16_f32 v97, v98, v99
v_mfma_f32_32x32x16_bf16 a[224:239], v[128:131], v[156:159], a[224:239]
ds_read_b64_tr_b16 v[128:129], v236 offset:49408
ds_read_b64_tr_b16 v[130:131], v236 offset:50944
v_exp_f32 v100, v100
v_exp_f32 v101, v101
v_mfma_f32_32x32x16_bf16 a[144:159], v[132:135], v[160:163], a[144:159]
ds_read_b64_tr_b16 v[132:133], v239 offset:43008
ds_read_b64_tr_b16 v[134:135], v239 offset:44544
v_add_f32 v246, v246, v100
v_add_f32 v247, v247, v101
v_cvt_pk_bf16_f32 v98, v100, v101
s_waitcnt lgkmcnt(5)
v_mfma_f32_32x32x16_bf16 a[160:175], v[136:139], v[160:163], a[160:175]
ds_read_b64_tr_b16 v[136:137], v223 offset:36864
ds_read_b64_tr_b16 v[138:139], v223 offset:39936
buffer_load_dwordx4 v233, s[16:19], s37 offen offset:1024 lds
v_exp_f32 v102, v102
v_exp_f32 v103, v103
v_mfma_f32_16x16x32_bf16 a[244:247], v[140:143], v[164:167], a[244:247]
v_mfma_f32_32x32x16_bf16 a[176:191], v[144:147], v[160:163], a[176:191]
ds_read_b64_tr_b16 v[140:141], v224 offset:36864
ds_read_b64_tr_b16 v[142:143], v224 offset:39936
ds_read_b64_tr_b16 v[144:145], v223 offset:36992
ds_read_b64_tr_b16 v[146:147], v223 offset:40064
v_cmp_lt_f32 vcc, 0x41000000, v252
s_nop 0
s_cbranch_vccnz L_fb14
L_rt14:
v_mfma_f32_32x32x16_bf16 a[192:207], v[148:151], v[160:163], a[192:207]
ds_read_b64_tr_b16 v[148:149], v224 offset:36992
ds_read_b64_tr_b16 v[150:151], v224 offset:40064
v_add_f32 v246, v246, v102
v_add_f32 v247, v247, v103
v_cvt_pk_bf16_f32 v99, v102, v103
s_waitcnt lgkmcnt(6)
v_mfma_f32_32x32x16_bf16 a[208:223], v[152:155], v[160:163], a[208:223]
ds_read_b64_tr_b16 v[152:153], v223 offset:37120
ds_read_b64_tr_b16 v[154:155], v223 offset:40192
v_exp_f32 v104, v104
v_exp_f32 v105, v105
v_mfma_f32_32x32x16_bf16 a[224:239], v[128:131], v[160:163], a[224:239]
ds_read_b64_tr_b16 v[128:129], v224 offset:37120
ds_read_b64_tr_b16 v[130:131], v224 offset:40192
s_mov_b32 m0, 0x22400
s_mov_b64 exec, s[42:43]
buffer_load_dwordx4 v234, s[16:19], s37 offen lds
s_mov_b64 exec, -1
v_mfma_f32_16x16x32_bf16 a[248:251], v[132:135], v[164:167], a[248:251]
ds_read_b64_tr_b16 v[132:133], v223 offset:43008
ds_read_b64_tr_b16 v[134:135], v223 offset:46080
v_mfma_f32_32x32x16_bf16 a[0:15], v[136:139], v[88:91], a[0:15]
ds_read_b64_tr_b16 v[136:137], v224 offset:43008
ds_read_b64_tr_b16 v[138:139], v224 offset:46080
v_add_f32 v248, v248, v104
v_add_f32 v248, v248, v105
v_cvt_pk_bf16_f32 v104, v104, v105
s_waitcnt lgkmcnt(6)
v_mfma_f32_32x32x16_bf16 a[16:31], v[140:143], v[88:91], a[16:31]
ds_read_b64_tr_b16 v[140:141], v223 offset:43136
ds_read_b64_tr_b16 v[142:143], v223 offset:46208
v_exp_f32 v106, v106
v_exp_f32 v107, v107
v_mfma_f32_32x32x16_bf16 a[32:47], v[144:147], v[88:91], a[32:47]
ds_read_b64_tr_b16 v[144:145], v224 offset:43136
ds_read_b64_tr_b16 v[146:147], v224 offset:46208
v_add_f32 v248, v248, v106
v_add_f32 v248, v248, v107
v_cvt_pk_bf16_f32 v105, v106, v107
v_mfma_f32_32x32x16_bf16 a[48:63], v[148:151], v[88:91], a[48:63]
ds_read_b64_tr_b16 v[148:149], v223 offset:43264
ds_read_b64_tr_b16 v[150:151], v223 offset:46336
s_add_u32 m0, s33, 0x6000
s_mov_b32 s39, 0x2a000
buffer_load_dwordx4 v208, s[4:7], s39 offen offset:0 nt lds
v_mfma_f32_32x32x16_bf16 a[64:79], v[152:155], v[88:91], a[64:79]
ds_read_b64_tr_b16 v[152:153], v224 offset:43264
ds_read_b64_tr_b16 v[154:155], v224 offset:46336
s_waitcnt lgkmcnt(6)
v_mfma_f32_32x32x16_bf16 a[80:95], v[128:131], v[88:91], a[80:95]
ds_read_b64_tr_b16 v[128:129], v225 offset:24576
ds_read_b64_tr_b16 v[130:131], v226 offset:24576
v_mfma_f32_32x32x16_bf16 a[0:15], v[132:135], v[96:99], a[0:15]
ds_read_b64_tr_b16 v[132:133], v227 offset:24576
ds_read_b64_tr_b16 v[134:135], v228 offset:24576
v_mfma_f32_32x32x16_bf16 a[16:31], v[136:139], v[96:99], a[16:31]
ds_read_b64_tr_b16 v[136:137], v225 offset:24704
ds_read_b64_tr_b16 v[138:139], v226 offset:24704
buffer_load_dwordx4 v209, s[4:7], s39 offen offset:1024 nt lds
v_mfma_f32_32x32x16_bf16 a[32:47], v[140:143], v[96:99], a[32:47]
ds_read_b64_tr_b16 v[140:141], v227 offset:24704
ds_read_b64_tr_b16 v[142:143], v228 offset:24704
s_waitcnt lgkmcnt(8)
v_mfma_f32_32x32x16_bf16 a[48:63], v[144:147], v[96:99], a[48:63]
ds_read_b64_tr_b16 v[144:145], v225 offset:24832
ds_read_b64_tr_b16 v[146:147], v226 offset:24832
v_mfma_f32_32x32x16_bf16 a[64:79], v[148:151], v[96:99], a[64:79]
ds_read_b64_tr_b16 v[148:149], v227 offset:24832
ds_read_b64_tr_b16 v[150:151], v228 offset:24832
v_mfma_f32_32x32x16_bf16 a[80:95], v[152:155], v[96:99], a[80:95]
s_waitcnt vmcnt(14)
s_barrier
ds_read_b128 v[152:155], v217 offset:0
s_waitcnt lgkmcnt(7)
v_mfma_f32_16x16x16_bf16 a[96:99], v[128:129], v[104:105], a[96:99]
buffer_load_dwordx4 v210, s[4:7], s39 offen offset:2048 nt lds
v_mfma_f32_16x16x16_bf16 a[100:103], v[130:131], v[104:105], a[100:103]
ds_read_b128 v[128:131], v218 offset:0
v_mfma_f32_16x16x16_bf16 a[104:107], v[132:133], v[104:105], a[104:107]
v_mfma_f32_16x16x16_bf16 a[108:111], v[134:135], v[104:105], a[108:111]
ds_read_b128 v[132:135], v219 offset:0
v_mfma_f32_16x16x16_bf16 a[112:115], v[136:137], v[104:105], a[112:115]
v_mfma_f32_16x16x16_bf16 a[116:119], v[138:139], v[104:105], a[116:119]
ds_read_b128 v[136:139], v220 offset:0
s_waitcnt lgkmcnt(4)
v_mfma_f32_16x16x16_bf16 a[120:123], v[140:141], v[104:105], a[120:123]
buffer_load_dwordx4 v211, s[4:7], s39 offen offset:3072 nt lds
v_mfma_f32_16x16x16_bf16 a[124:127], v[142:143], v[104:105], a[124:127]
ds_read_b128 v[140:143], v217 offset:128
v_mfma_f32_16x16x16_bf16 a[128:131], v[144:145], v[104:105], a[128:131]
v_mfma_f32_16x16x16_bf16 a[132:135], v[146:147], v[104:105], a[132:135]
ds_read_b128 v[144:147], v218 offset:128
v_mfma_f32_16x16x16_bf16 a[136:139], v[148:149], v[104:105], a[136:139]
s_add_u32 m0, s33, 0x7000
s_nop 0
buffer_load_dwordx4 v212, s[4:7], s39 offen offset:0 nt lds
buffer_load_dwordx4 v213, s[4:7], s39 offen offset:1024 nt lds
v_mfma_f32_16x16x16_bf16 a[140:143], v[150:151], v[104:105], a[140:143]
s_waitcnt lgkmcnt(2)
v_mfma_f32_32x32x16_bf16 v[72:87], v[152:155], v[0:3], v[108:123]
ds_read_b128 v[148:151], v219 offset:128
ds_read_b128 v[152:155], v220 offset:128
v_mfma_f32_32x32x16_bf16 v[72:87], v[128:131], v[4:7], v[72:87]
ds_read_b128 v[128:131], v217 offset:256
s_add_u32 m0, s34, 0x22800
s_add_u32 s37, s37, 64
s_cmp_eq_u32 s37, 0x500
s_cselect_b32 s37, 0, s37
s_mul_i32 s38, s37, 6144
s_add_u32 s38, s38, 6144
buffer_load_dwordx4 v229, s[12:15], s38 offen offset:0 lds
v_mfma_f32_32x32x16_bf16 v[72:87], v[132:135], v[8:11], v[72:87]
ds_read_b128 v[132:135], v218 offset:256
v_mfma_f32_32x32x16_bf16 v[72:87], v[136:139], v[12:15], v[72:87]
ds_read_b128 v[136:139], v219 offset:256
s_waitcnt lgkmcnt(3)
v_mfma_f32_32x32x16_bf16 v[72:87], v[140:143], v[16:19], v[72:87]
ds_read_b128 v[140:143], v220 offset:256
buffer_load_dwordx4 v230, s[12:15], s38 offen offset:1024 lds
v_mfma_f32_32x32x16_bf16 v[72:87], v[144:147], v[20:23], v[72:87]
ds_read_b64_tr_b16 v[144:145], v235 offset:0
ds_read_b64_tr_b16 v[146:147], v235 offset:1536
ds_read_b128 v[168:171], v240 offset:0
v_mfma_f32_32x32x16_bf16 v[72:87], v[148:151], v[24:27], v[72:87]
ds_read_b64_tr_b16 v[148:149], v236 offset:0
ds_read_b64_tr_b16 v[150:151], v236 offset:1536
v_mfma_f32_32x32x16_bf16 v[72:87], v[152:155], v[28:31], v[72:87]
ds_read_b64_tr_b16 v[152:153], v235 offset:128
ds_read_b64_tr_b16 v[154:155], v235 offset:1664
buffer_load_dwordx4 v231, s[12:15], s38 offen offset:2048 lds
s_waitcnt lgkmcnt(7)
v_mfma_f32_32x32x16_bf16 v[72:87], v[128:131], v[32:35], v[72:87]
ds_read_b128 v[128:131], v217 offset:12288
v_mfma_f32_32x32x16_bf16 v[72:87], v[132:135], v[36:39], v[72:87]
ds_read_b128 v[132:135], v218 offset:12288
v_mfma_f32_32x32x16_bf16 v[72:87], v[136:139], v[40:43], v[72:87]
ds_read_b128 v[136:139], v219 offset:12288
s_add_u32 m0, s35, 0x25800
s_nop 0
buffer_load_dwordx4 v232, s[16:19], s37 offen lds
v_mfma_f32_32x32x16_bf16 v[72:87], v[140:143], v[44:47], v[72:87]
ds_read_b128 v[140:143], v220 offset:12288
s_waitcnt lgkmcnt(4)
v_mfma_f32_32x32x16_bf16 a[144:159], v[144:147], v[168:171], a[144:159]
ds_read_b128 v[144:147], v217 offset:12416
s_nop 2
v_max3_f32 v249, v72, v73, v74
v_max3_f32 v249, v249, v75, v76
v_max3_f32 v249, v249, v77, v78
v_max3_f32 v249, v249, v79, v80
v_max3_f32 v249, v249, v81, v82
v_mfma_f32_32x32x16_bf16 a[160:175], v[148:151], v[168:171], a[160:175]
ds_read_b128 v[148:151], v218 offset:12416
v_max3_f32 v249, v249, v83, v84
v_max3_f32 v249, v249, v85, v86
v_max_f32 v249, v249, v87
v_cmp_lt_f32 vcc, 0x41000000, v249
s_nop 0
s_cbranch_vccnz L_fb16
L_rt16:
v_mfma_f32_32x32x16_bf16 a[176:191], v[152:155], v[168:171], a[176:191]
ds_read_b128 v[152:155], v219 offset:12416
buffer_load_dwordx4 v233, s[16:19], s37 offen offset:1024 lds
v_exp_f32 v72, v72
v_exp_f32 v73, v73
s_waitcnt lgkmcnt(2)
v_mfma_f32_32x32x16_bf16 v[88:103], v[128:131], v[0:3], v[108:123]
ds_read_b128 v[128:131], v220 offset:12416
v_add_f32 v246, v246, v72
v_add_f32 v247, v247, v73
v_cvt_pk_bf16_f32 v72, v72, v73
v_mfma_f32_32x32x16_bf16 v[88:103], v[132:135], v[4:7], v[88:103]
ds_read_b128 v[132:135], v217 offset:12544
s_mov_b32 m0, 0x27800
s_mov_b64 exec, s[42:43]
buffer_load_dwordx4 v234, s[16:19], s37 offen lds
s_mov_b64 exec, -1
v_mfma_f32_32x32x16_bf16 v[88:103], v[136:139], v[8:11], v[88:103]
ds_read_b128 v[136:139], v218 offset:12544
v_exp_f32 v74, v74
v_exp_f32 v75, v75
v_mfma_f32_32x32x16_bf16 v[88:103], v[140:143], v[12:15], v[88:103]
ds_read_b128 v[140:143], v219 offset:12544
v_add_f32 v246, v246, v74
v_add_f32 v247, v247, v75
v_cvt_pk_bf16_f32 v73, v74, v75
v_exp_f32 v76, v76
v_exp_f32 v77, v77
v_mfma_f32_32x32x16_bf16 v[88:103], v[144:147], v[16:19], v[88:103]
ds_read_b128 v[144:147], v220 offset:12544
v_add_f32 v246, v246, v76
v_add_f32 v247, v247, v77
v_cvt_pk_bf16_f32 v74, v76, v77
s_waitcnt lgkmcnt(2)
v_mfma_f32_32x32x16_bf16 v[88:103], v[148:151], v[20:23], v[88:103]
ds_read_b128 v[148:151], v221 offset:0
v_exp_f32 v78, v78
v_exp_f32 v79, v79
v_mfma_f32_32x32x16_bf16 v[88:103], v[152:155], v[24:27], v[88:103]
ds_read_b64_tr_b16 v[152:153], v236 offset:128
ds_read_b64_tr_b16 v[154:155], v236 offset:1664
v_add_f32 v246, v246, v78
v_add_f32 v247, v247, v79
v_cvt_pk_bf16_f32 v75, v78, v79
v_mfma_f32_32x32x16_bf16 v[88:103], v[128:131], v[28:31], v[88:103]
ds_read_b128 v[128:131], v222 offset:0
v_exp_f32 v80, v80
v_exp_f32 v81, v81
v_mfma_f32_32x32x16_bf16 v[88:103], v[132:135], v[32:35], v[88:103]
ds_read_b64_tr_b16 v[132:133], v237 offset:0
ds_read_b64_tr_b16 v[134:135], v237 offset:1536
ds_read_b128 v[172:175], v242 offset:0
v_add_f32 v246, v246, v80
v_add_f32 v247, v247, v81
v_cvt_pk_bf16_f32 v80, v80, v81
v_mfma_f32_32x32x16_bf16 v[88:103], v[136:139], v[36:39], v[88:103]
ds_read_b128 v[136:139], v221 offset:128
v_exp_f32 v82, v82
v_exp_f32 v83, v83
s_waitcnt lgkmcnt(4)
v_mfma_f32_32x32x16_bf16 v[88:103], v[140:143], v[40:43], v[88:103]
ds_read_b64_tr_b16 v[140:141], v235 offset:256
ds_read_b64_tr_b16 v[142:143], v235 offset:1792
s_add_u32 m0, s33, 0x12000
s_mov_b32 s39, 0x2a000
buffer_load_dwordx4 v214, s[8:11], s39 offen offset:0 nt lds
v_mfma_f32_32x32x16_bf16 v[88:103], v[144:147], v[44:47], v[88:103]
ds_read_b128 v[144:147], v222 offset:128
v_add_f32 v246, v246, v82
v_add_f32 v247, v247, v83
v_cvt_pk_bf16_f32 v81, v82, v83
v_exp_f32 v84, v84
v_exp_f32 v85, v85
v_mfma_f32_16x16x32_bf16 v[104:107], v[148:151], v[48:51], v[124:127]
v_mfma_f32_32x32x16_bf16 a[192:207], v[152:155], v[168:171], a[192:207]
ds_read_b64_tr_b16 v[148:149], v236 offset:256
ds_read_b64_tr_b16 v[150:151], v236 offset:1792
ds_read_b128 v[152:155], v221 offset:256
v_add_f32 v246, v246, v84
v_add_f32 v247, v247, v85
v_cvt_pk_bf16_f32 v82, v84, v85
v_mfma_f32_16x16x32_bf16 v[104:107], v[128:131], v[52:55], v[104:107]
ds_read_b64_tr_b16 v[128:129], v235 offset:6144
ds_read_b64_tr_b16 v[130:131], v235 offset:7680
s_waitcnt lgkmcnt(5)
v_mfma_f32_16x16x32_bf16 a[240:243], v[132:135], v[172:175], a[240:243]
ds_read_b128 v[176:179], v241 offset:0
ds_read_b128 v[132:135], v222 offset:256
v_mfma_f32_16x16x32_bf16 v[104:107], v[136:139], v[56:59], v[104:107]
ds_read_b64_tr_b16 v[136:137], v236 offset:6144
ds_read_b64_tr_b16 v[138:139], v236 offset:7680
buffer_load_dwordx4 v215, s[8:11], s39 offen offset:1024 nt lds
v_mfma_f32_32x32x16_bf16 a[208:223], v[140:143], v[168:171], a[208:223]
ds_read_b64_tr_b16 v[140:141], v238 offset:0
ds_read_b64_tr_b16 v[142:143], v238 offset:1536
v_exp_f32 v86, v86
v_exp_f32 v87, v87
v_mfma_f32_16x16x32_bf16 v[104:107], v[144:147], v[60:63], v[104:107]
s_waitcnt lgkmcnt(6)
v_mfma_f32_32x32x16_bf16 a[224:239], v[148:151], v[168:171], a[224:239]
ds_read_b64_tr_b16 v[144:145], v235 offset:6272
ds_read_b64_tr_b16 v[146:147], v235 offset:7808
ds_read_b64_tr_b16 v[148:149], v236 offset:6272
ds_read_b64_tr_b16 v[150:151], v236 offset:7808
buffer_load_dwordx4 v216, s[8:11], s39 offen offset:2048 nt lds
v_mfma_f32_16x16x32_bf16 v[104:107], v[152:155], v[64:67], v[104:107]
ds_read_b64_tr_b16 v[152:153], v235 offset:6400
ds_read_b64_tr_b16 v[154:155], v235 offset:7936
s_waitcnt lgkmcnt(7)
v_mfma_f32_32x32x16_bf16 a[144:159], v[128:131], v[176:179], a[144:159]
ds_read_b64_tr_b16 v[128:129], v236 offset:6400
ds_read_b64_tr_b16 v[130:131], v236 offset:7936
v_add_f32 v246, v246, v86
v_add_f32 v247, v247, v87
v_cvt_pk_bf16_f32 v83, v86, v87
v_max3_f32 v249, v88, v89, v90
v_mfma_f32_16x16x32_bf16 v[104:107], v[132:135], v[68:71], v[104:107]
ds_read_b64_tr_b16 v[132:133], v239 offset:0
ds_read_b64_tr_b16 v[134:135], v239 offset:1536
v_mfma_f32_32x32x16_bf16 a[160:175], v[136:139], v[176:179], a[160:175]
s_waitcnt vmcnt(15)
s_barrier
ds_read_b64_tr_b16 v[136:137], v223 offset:0
ds_read_b64_tr_b16 v[138:139], v223 offset:3072
s_add_u32 m0, s33, 0x12c00
s_add_u32 s39, s39, 0xc00
buffer_load_dwordx4 v214, s[8:11], s39 offen offset:0 nt lds
s_waitcnt lgkmcnt(6)
v_mfma_f32_16x16x32_bf16 a[244:247], v[140:143], v[172:175], a[244:247]
v_mfma_f32_32x32x16_bf16 a[176:191], v[144:147], v[176:179], a[176:191]
ds_read_b64_tr_b16 v[140:141], v224 offset:0
ds_read_b64_tr_b16 v[142:143], v224 offset:3072
ds_read_b64_tr_b16 v[144:145], v223 offset:128
ds_read_b64_tr_b16 v[146:147], v223 offset:3200
v_max3_f32 v249, v249, v91, v92
v_max3_f32 v249, v249, v93, v94
v_mfma_f32_32x32x16_bf16 a[192:207], v[148:151], v[176:179], a[192:207]
ds_read_b64_tr_b16 v[148:149], v224 offset:128
ds_read_b64_tr_b16 v[150:151], v224 offset:3200
v_max3_f32 v249, v249, v95, v96
v_max3_f32 v249, v249, v97, v98
v_max3_f32 v249, v249, v99, v100
v_max3_f32 v249, v249, v101, v102
v_mfma_f32_32x32x16_bf16 a[208:223], v[152:155], v[176:179], a[208:223]
ds_read_b64_tr_b16 v[152:153], v223 offset:256
ds_read_b64_tr_b16 v[154:155], v223 offset:3328
buffer_load_dwordx4 v215, s[8:11], s39 offen offset:1024 nt lds
v_max_f32 v249, v249, v103
v_max3_f32 v252, v104, v105, v106
s_waitcnt lgkmcnt(5)
v_mfma_f32_32x32x16_bf16 a[224:239], v[128:131], v[176:179], a[224:239]
ds_read_b64_tr_b16 v[128:129], v224 offset:256
ds_read_b64_tr_b16 v[130:131], v224 offset:3328
buffer_load_dwordx4 v216, s[8:11], s39 offen offset:2048 nt lds
v_cmp_lt_f32 vcc, 0x41000000, v249
s_nop 0
s_cbranch_vccnz L_fb18
L_rt18:
v_mfma_f32_16x16x32_bf16 a[248:251], v[132:135], v[172:175], a[248:251]
ds_read_b64_tr_b16 v[132:133], v223 offset:6144
ds_read_b64_tr_b16 v[134:135], v223 offset:9216
v_mfma_f32_32x32x16_bf16 a[0:15], v[136:139], v[72:75], a[0:15]
ds_read_b64_tr_b16 v[136:137], v224 offset:6144
ds_read_b64_tr_b16 v[138:139], v224 offset:9216
v_exp_f32 v88, v88
v_exp_f32 v89, v89
v_mfma_f32_32x32x16_bf16 a[16:31], v[140:143], v[72:75], a[16:31]
ds_read_b64_tr_b16 v[140:141], v223 offset:6272
ds_read_b64_tr_b16 v[142:143], v223 offset:9344
s_add_u32 m0, s34, 0x18000
s_add_u32 s37, s37, 64
s_cmp_eq_u32 s37, 0x500
s_cselect_b32 s37, 0, s37
s_mul_i32 s38, s37, 6144
s_add_u32 s38, s38, 6144
buffer_load_dwordx4 v229, s[12:15], s38 offen offset:0 lds
s_waitcnt lgkmcnt(4)
v_mfma_f32_32x32x16_bf16 a[32:47], v[144:147], v[72:75], a[32:47]
ds_read_b64_tr_b16 v[144:145], v224 offset:6272
ds_read_b64_tr_b16 v[146:147], v224 offset:9344
v_mfma_f32_32x32x16_bf16 a[48:63], v[148:151], v[72:75], a[48:63]
ds_read_b64_tr_b16 v[148:149], v223 offset:6400
ds_read_b64_tr_b16 v[150:151], v223 offset:9472
v_add_f32 v246, v246, v88
v_add_f32 v247, v247, v89
v_cvt_pk_bf16_f32 v88, v88, v89
v_max_f32 v252, v252, v107
v_mfma_f32_32x32x16_bf16 a[64:79], v[152:155], v[72:75], a[64:79]
ds_read_b64_tr_b16 v[152:153], v224 offset:6400
ds_read_b64_tr_b16 v[154:155], v224 offset:9472
v_exp_f32 v90, v90
v_exp_f32 v91, v91
v_mfma_f32_32x32x16_bf16 a[80:95], v[128:131], v[72:75], a[80:95]
ds_read_b64_tr_b16 v[128:129], v235 offset:21504
ds_read_b64_tr_b16 v[130:131], v235 offset:23040
ds_read_b128 v[156:159], v240 offset:21504
buffer_load_dwordx4 v230, s[12:15], s38 offen offset:1024 lds
v_mfma_f32_32x32x16_bf16 a[0:15], v[132:135], v[80:83], a[0:15]
ds_read_b64_tr_b16 v[132:133], v236 offset:21504
ds_read_b64_tr_b16 v[134:135], v236 offset:23040
v_add_f32 v246, v246, v90
v_add_f32 v247, v247, v91
v_cvt_pk_bf16_f32 v89, v90, v91
s_waitcnt lgkmcnt(6)
v_mfma_f32_32x32x16_bf16 a[16:31], v[136:139], v[80:83], a[16:31]
ds_read_b64_tr_b16 v[136:137], v235 offset:21632
ds_read_b64_tr_b16 v[138:139], v235 offset:23168
v_exp_f32 v92, v92
v_exp_f32 v93, v93
v_mfma_f32_32x32x16_bf16 a[32:47], v[140:143], v[80:83], a[32:47]
ds_read_b64_tr_b16 v[140:141], v236 offset:21632
ds_read_b64_tr_b16 v[142:143], v236 offset:23168
v_add_f32 v246, v246, v92
v_add_f32 v247, v247, v93
v_cvt_pk_bf16_f32 v90, v92, v93
v_mfma_f32_32x32x16_bf16 a[48:63], v[144:147], v[80:83], a[48:63]
ds_read_b64_tr_b16 v[144:145], v237 offset:21504
ds_read_b64_tr_b16 v[146:147], v237 offset:23040
ds_read_b128 v[160:163], v242 offset:21504
v_exp_f32 v94, v94
v_exp_f32 v95, v95
v_mfma_f32_32x32x16_bf16 a[64:79], v[148:151], v[80:83], a[64:79]
ds_read_b64_tr_b16 v[148:149], v235 offset:21760
ds_read_b64_tr_b16 v[150:151], v235 offset:23296
buffer_load_dwordx4 v231, s[12:15], s38 offen offset:2048 lds
s_waitcnt lgkmcnt(6)
v_mfma_f32_32x32x16_bf16 a[80:95], v[152:155], v[80:83], a[80:95]
ds_read_b64_tr_b16 v[152:153], v236 offset:21760
ds_read_b64_tr_b16 v[154:155], v236 offset:23296
v_add_f32 v246, v246, v94
v_add_f32 v247, v247, v95
v_cvt_pk_bf16_f32 v91, v94, v95
v_mfma_f32_32x32x16_bf16 a[144:159], v[128:131], v[156:159], a[144:159]
ds_read_b64_tr_b16 v[128:129], v235 offset:27648
ds_read_b64_tr_b16 v[130:131], v235 offset:29184
ds_read_b128 v[164:167], v241 offset:21504
v_exp_f32 v96, v96
v_exp_f32 v97, v97
v_mfma_f32_32x32x16_bf16 a[160:175], v[132:135], v[156:159], a[160:175]
ds_read_b64_tr_b16 v[132:133], v236 offset:27648
ds_read_b64_tr_b16 v[134:135], v236 offset:29184
v_add_f32 v246, v246, v96
v_add_f32 v247, v247, v97
v_cvt_pk_bf16_f32 v96, v96, v97
v_mfma_f32_32x32x16_bf16 a[176:191], v[136:139], v[156:159], a[176:191]
ds_read_b64_tr_b16 v[136:137], v238 offset:21504
ds_read_b64_tr_b16 v[138:139], v238 offset:23040
v_exp_f32 v98, v98
v_exp_f32 v99, v99
s_waitcnt lgkmcnt(4)
v_mfma_f32_32x32x16_bf16 a[192:207], v[140:143], v[156:159], a[192:207]
ds_read_b64_tr_b16 v[140:141], v235 offset:27776
ds_read_b64_tr_b16 v[142:143], v235 offset:29312
s_add_u32 m0, s35, 0x1b000
s_nop 0
buffer_load_dwordx4 v232, s[16:19], s37 offen lds
v_mfma_f32_16x16x32_bf16 a[240:243], v[144:147], v[160:163], a[240:243]
ds_read_b64_tr_b16 v[144:145], v236 offset:27776
ds_read_b64_tr_b16 v[146:147], v236 offset:29312
v_mfma_f32_32x32x16_bf16 a[208:223], v[148:151], v[156:159], a[208:223]
ds_read_b64_tr_b16 v[148:149], v235 offset:27904
ds_read_b64_tr_b16 v[150:151], v235 offset:29440
v_add_f32 v246, v246, v98
v_add_f32 v247, v247, v99
v_cvt_pk_bf16_f32 v97, v98, v99
v_mfma_f32_32x32x16_bf16 a[224:239], v[152:155], v[156:159], a[224:239]
ds_read_b64_tr_b16 v[152:153], v236 offset:27904
ds_read_b64_tr_b16 v[154:155], v236 offset:29440
v_exp_f32 v100, v100
v_exp_f32 v101, v101
v_mfma_f32_32x32x16_bf16 a[144:159], v[128:131], v[164:167], a[144:159]
ds_read_b64_tr_b16 v[128:129], v239 offset:21504
ds_read_b64_tr_b16 v[130:131], v239 offset:23040
v_add_f32 v246, v246, v100
v_add_f32 v247, v247, v101
v_cvt_pk_bf16_f32 v98, v100, v101
s_waitcnt lgkmcnt(5)
v_mfma_f32_32x32x16_bf16 a[160:175], v[132:135], v[164:167], a[160:175]
ds_read_b64_tr_b16 v[132:133], v223 offset:12288
ds_read_b64_tr_b16 v[134:135], v223 offset:15360
buffer_load_dwordx4 v233, s[16:19], s37 offen offset:1024 lds
v_exp_f32 v102, v102
v_exp_f32 v103, v103
v_mfma_f32_16x16x32_bf16 a[244:247], v[136:139], v[160:163], a[244:247]
v_mfma_f32_32x32x16_bf16 a[176:191], v[140:143], v[164:167], a[176:191]
ds_read_b64_tr_b16 v[136:137], v224 offset:12288
ds_read_b64_tr_b16 v[138:139], v224 offset:15360
ds_read_b64_tr_b16 v[140:141], v223 offset:12416
ds_read_b64_tr_b16 v[142:143], v223 offset:15488
v_cmp_lt_f32 vcc, 0x41000000, v252
s_nop 0
s_cbranch_vccnz L_fb17
L_rt17:
v_mfma_f32_32x32x16_bf16 a[192:207], v[144:147], v[164:167], a[192:207]
ds_read_b64_tr_b16 v[144:145], v224 offset:12416
ds_read_b64_tr_b16 v[146:147], v224 offset:15488
v_add_f32 v246, v246, v102
v_add_f32 v247, v247, v103
v_cvt_pk_bf16_f32 v99, v102, v103
s_waitcnt lgkmcnt(6)
v_mfma_f32_32x32x16_bf16 a[208:223], v[148:151], v[164:167], a[208:223]
ds_read_b64_tr_b16 v[148:149], v223 offset:12544
ds_read_b64_tr_b16 v[150:151], v223 offset:15616
v_exp_f32 v104, v104
v_exp_f32 v105, v105
v_mfma_f32_32x32x16_bf16 a[224:239], v[152:155], v[164:167], a[224:239]
ds_read_b64_tr_b16 v[152:153], v224 offset:12544
ds_read_b64_tr_b16 v[154:155], v224 offset:15616
s_mov_b32 m0, 0x1d000
s_mov_b64 exec, s[42:43]
buffer_load_dwordx4 v234, s[16:19], s37 offen lds
s_mov_b64 exec, -1
v_mfma_f32_16x16x32_bf16 a[248:251], v[128:131], v[160:163], a[248:251]
ds_read_b64_tr_b16 v[128:129], v223 offset:18432
ds_read_b64_tr_b16 v[130:131], v223 offset:21504
v_mfma_f32_32x32x16_bf16 a[0:15], v[132:135], v[88:91], a[0:15]
ds_read_b64_tr_b16 v[132:133], v224 offset:18432
ds_read_b64_tr_b16 v[134:135], v224 offset:21504
v_add_f32 v248, v248, v104
v_add_f32 v248, v248, v105
v_cvt_pk_bf16_f32 v104, v104, v105
s_waitcnt lgkmcnt(6)
v_mfma_f32_32x32x16_bf16 a[16:31], v[136:139], v[88:91], a[16:31]
ds_read_b64_tr_b16 v[136:137], v223 offset:18560
ds_read_b64_tr_b16 v[138:139], v223 offset:21632
v_exp_f32 v106, v106
v_exp_f32 v107, v107
v_mfma_f32_32x32x16_bf16 a[32:47], v[140:143], v[88:91], a[32:47]
ds_read_b64_tr_b16 v[140:141], v224 offset:18560
ds_read_b64_tr_b16 v[142:143], v224 offset:21632
v_add_f32 v248, v248, v106
v_add_f32 v248, v248, v107
v_cvt_pk_bf16_f32 v105, v106, v107
v_mfma_f32_32x32x16_bf16 a[48:63], v[144:147], v[88:91], a[48:63]
ds_read_b64_tr_b16 v[144:145], v223 offset:18688
ds_read_b64_tr_b16 v[146:147], v223 offset:21760
s_add_u32 m0, s33, 0x0
s_mov_b32 s39, 0x300000
buffer_load_dwordx4 v208, s[4:7], s39 offen offset:0 nt lds
v_mfma_f32_32x32x16_bf16 a[64:79], v[148:151], v[88:91], a[64:79]
ds_read_b64_tr_b16 v[148:149], v224 offset:18688
ds_read_b64_tr_b16 v[150:151], v224 offset:21760
s_waitcnt lgkmcnt(6)
v_mfma_f32_32x32x16_bf16 a[80:95], v[152:155], v[88:91], a[80:95]
ds_read_b64_tr_b16 v[152:153], v225 offset:0
ds_read_b64_tr_b16 v[154:155], v226 offset:0
v_mfma_f32_32x32x16_bf16 a[0:15], v[128:131], v[96:99], a[0:15]
ds_read_b64_tr_b16 v[128:129], v227 offset:0
ds_read_b64_tr_b16 v[130:131], v228 offset:0
v_mfma_f32_32x32x16_bf16 a[16:31], v[132:135], v[96:99], a[16:31]
ds_read_b64_tr_b16 v[132:133], v225 offset:128
ds_read_b64_tr_b16 v[134:135], v226 offset:128
buffer_load_dwordx4 v209, s[4:7], s39 offen offset:1024 nt lds
v_mfma_f32_32x32x16_bf16 a[32:47], v[136:139], v[96:99], a[32:47]
ds_read_b64_tr_b16 v[136:137], v227 offset:128
ds_read_b64_tr_b16 v[138:139], v228 offset:128
s_waitcnt lgkmcnt(8)
v_mfma_f32_32x32x16_bf16 a[48:63], v[140:143], v[96:99], a[48:63]
ds_read_b64_tr_b16 v[140:141], v225 offset:256
ds_read_b64_tr_b16 v[142:143], v226 offset:256
v_mfma_f32_32x32x16_bf16 a[64:79], v[144:147], v[96:99], a[64:79]
ds_read_b64_tr_b16 v[144:145], v227 offset:256
ds_read_b64_tr_b16 v[146:147], v228 offset:256
v_mfma_f32_32x32x16_bf16 a[80:95], v[148:151], v[96:99], a[80:95]
s_waitcnt vmcnt(14)
s_barrier
ds_read_b128 v[148:151], v217 offset:24576
s_waitcnt lgkmcnt(7)
v_mfma_f32_16x16x16_bf16 a[96:99], v[152:153], v[104:105], a[96:99]
buffer_load_dwordx4 v210, s[4:7], s39 offen offset:2048 nt lds
v_mfma_f32_16x16x16_bf16 a[100:103], v[154:155], v[104:105], a[100:103]
ds_read_b128 v[152:155], v218 offset:24576
v_mfma_f32_16x16x16_bf16 a[104:107], v[128:129], v[104:105], a[104:107]
v_mfma_f32_16x16x16_bf16 a[108:111], v[130:131], v[104:105], a[108:111]
ds_read_b128 v[128:131], v219 offset:24576
v_mfma_f32_16x16x16_bf16 a[112:115], v[132:133], v[104:105], a[112:115]
v_mfma_f32_16x16x16_bf16 a[116:119], v[134:135], v[104:105], a[116:119]
ds_read_b128 v[132:135], v220 offset:24576
s_waitcnt lgkmcnt(4)
v_mfma_f32_16x16x16_bf16 a[120:123], v[136:137], v[104:105], a[120:123]
buffer_load_dwordx4 v211, s[4:7], s39 offen offset:3072 nt lds
v_mfma_f32_16x16x16_bf16 a[124:127], v[138:139], v[104:105], a[124:127]
ds_read_b128 v[136:139], v217 offset:24704
v_mfma_f32_16x16x16_bf16 a[128:131], v[140:141], v[104:105], a[128:131]
v_mfma_f32_16x16x16_bf16 a[132:135], v[142:143], v[104:105], a[132:135]
ds_read_b128 v[140:143], v218 offset:24704
v_mfma_f32_16x16x16_bf16 a[136:139], v[144:145], v[104:105], a[136:139]
s_add_u32 m0, s33, 0x1000
s_nop 0
buffer_load_dwordx4 v212, s[4:7], s39 offen offset:0 nt lds
buffer_load_dwordx4 v213, s[4:7], s39 offen offset:1024 nt lds
v_mfma_f32_16x16x16_bf16 a[140:143], v[146:147], v[104:105], a[140:143]
s_waitcnt lgkmcnt(2)
v_mfma_f32_32x32x16_bf16 v[72:87], v[148:151], v[0:3], v[108:123]
ds_read_b128 v[144:147], v219 offset:24704
ds_read_b128 v[148:151], v220 offset:24704
v_mfma_f32_32x32x16_bf16 v[72:87], v[152:155], v[4:7], v[72:87]
ds_read_b128 v[152:155], v217 offset:24832
s_add_u32 m0, s34, 0x1d400
s_add_u32 s37, s37, 64
s_cmp_eq_u32 s37, 0x500
s_cselect_b32 s37, 0, s37
s_mul_i32 s38, s37, 6144
s_add_u32 s38, s38, 6144
buffer_load_dwordx4 v229, s[12:15], s38 offen offset:0 lds
v_mfma_f32_32x32x16_bf16 v[72:87], v[128:131], v[8:11], v[72:87]
ds_read_b128 v[128:131], v218 offset:24832
v_mfma_f32_32x32x16_bf16 v[72:87], v[132:135], v[12:15], v[72:87]
ds_read_b128 v[132:135], v219 offset:24832
s_waitcnt lgkmcnt(3)
v_mfma_f32_32x32x16_bf16 v[72:87], v[136:139], v[16:19], v[72:87]
ds_read_b128 v[136:139], v220 offset:24832
buffer_load_dwordx4 v230, s[12:15], s38 offen offset:1024 lds
v_mfma_f32_32x32x16_bf16 v[72:87], v[140:143], v[20:23], v[72:87]
ds_read_b64_tr_b16 v[140:141], v235 offset:43008
ds_read_b64_tr_b16 v[142:143], v235 offset:44544
ds_read_b128 v[168:171], v240 offset:43008
v_mfma_f32_32x32x16_bf16 v[72:87], v[144:147], v[24:27], v[72:87]
ds_read_b64_tr_b16 v[144:145], v236 offset:43008
ds_read_b64_tr_b16 v[146:147], v236 offset:44544
v_mfma_f32_32x32x16_bf16 v[72:87], v[148:151], v[28:31], v[72:87]
ds_read_b64_tr_b16 v[148:149], v235 offset:43136
ds_read_b64_tr_b16 v[150:151], v235 offset:44672
buffer_load_dwordx4 v231, s[12:15], s38 offen offset:2048 lds
s_waitcnt lgkmcnt(7)
v_mfma_f32_32x32x16_bf16 v[72:87], v[152:155], v[32:35], v[72:87]
ds_read_b128 v[152:155], v217 offset:36864
v_mfma_f32_32x32x16_bf16 v[72:87], v[128:131], v[36:39], v[72:87]
ds_read_b128 v[128:131], v218 offset:36864
v_mfma_f32_32x32x16_bf16 v[72:87], v[132:135], v[40:43], v[72:87]
ds_read_b128 v[132:135], v219 offset:36864
s_add_u32 m0, s35, 0x20400
s_nop 0
buffer_load_dwordx4 v232, s[16:19], s37 offen lds
v_mfma_f32_32x32x16_bf16 v[72:87], v[136:139], v[44:47], v[72:87]
ds_read_b128 v[136:139], v220 offset:36864
s_waitcnt lgkmcnt(4)
v_mfma_f32_32x32x16_bf16 a[144:159], v[140:143], v[168:171], a[144:159]
ds_read_b128 v[140:143], v217 offset:36992
s_nop 2
v_max3_f32 v249, v72, v73, v74
v_max3_f32 v249, v249, v75, v76
v_max3_f32 v249, v249, v77, v78
v_max3_f32 v249, v249, v79, v80
v_max3_f32 v249, v249, v81, v82
v_mfma_f32_32x32x16_bf16 a[160:175], v[144:147], v[168:171], a[160:175]
ds_read_b128 v[144:147], v218 offset:36992
v_max3_f32 v249, v249, v83, v84
v_max3_f32 v249, v249, v85, v86
v_max_f32 v249, v249, v87
v_cmp_lt_f32 vcc, 0x41000000, v249
s_nop 0
s_cbranch_vccnz L_fb19
L_rt19:
v_mfma_f32_32x32x16_bf16 a[176:191], v[148:151], v[168:171], a[176:191]
ds_read_b128 v[148:151], v219 offset:36992
buffer_load_dwordx4 v233, s[16:19], s37 offen offset:1024 lds
v_exp_f32 v72, v72
v_exp_f32 v73, v73
s_waitcnt lgkmcnt(2)
v_mfma_f32_32x32x16_bf16 v[88:103], v[152:155], v[0:3], v[108:123]
ds_read_b128 v[152:155], v220 offset:36992
v_add_f32 v246, v246, v72
v_add_f32 v247, v247, v73
v_cvt_pk_bf16_f32 v72, v72, v73
v_mfma_f32_32x32x16_bf16 v[88:103], v[128:131], v[4:7], v[88:103]
ds_read_b128 v[128:131], v217 offset:37120
s_mov_b32 m0, 0x22400
s_mov_b64 exec, s[42:43]
buffer_load_dwordx4 v234, s[16:19], s37 offen lds
s_mov_b64 exec, -1
v_mfma_f32_32x32x16_bf16 v[88:103], v[132:135], v[8:11], v[88:103]
ds_read_b128 v[132:135], v218 offset:37120
v_exp_f32 v74, v74
v_exp_f32 v75, v75
v_mfma_f32_32x32x16_bf16 v[88:103], v[136:139], v[12:15], v[88:103]
ds_read_b128 v[136:139], v219 offset:37120
v_add_f32 v246, v246, v74
v_add_f32 v247, v247, v75
v_cvt_pk_bf16_f32 v73, v74, v75
v_exp_f32 v76, v76
v_exp_f32 v77, v77
v_mfma_f32_32x32x16_bf16 v[88:103], v[140:143], v[16:19], v[88:103]
ds_read_b128 v[140:143], v220 offset:37120
v_add_f32 v246, v246, v76
v_add_f32 v247, v247, v77
v_cvt_pk_bf16_f32 v74, v76, v77
s_waitcnt lgkmcnt(2)
v_mfma_f32_32x32x16_bf16 v[88:103], v[144:147], v[20:23], v[88:103]
ds_read_b128 v[144:147], v221 offset:24576
v_exp_f32 v78, v78
v_exp_f32 v79, v79
v_mfma_f32_32x32x16_bf16 v[88:103], v[148:151], v[24:27], v[88:103]
ds_read_b64_tr_b16 v[148:149], v236 offset:43136
ds_read_b64_tr_b16 v[150:151], v236 offset:44672
v_add_f32 v246, v246, v78
v_add_f32 v247, v247, v79
v_cvt_pk_bf16_f32 v75, v78, v79
v_mfma_f32_32x32x16_bf16 v[88:103], v[152:155], v[28:31], v[88:103]
ds_read_b128 v[152:155], v222 offset:24576
v_exp_f32 v80, v80
v_exp_f32 v81, v81
v_mfma_f32_32x32x16_bf16 v[88:103], v[128:131], v[32:35], v[88:103]
ds_read_b64_tr_b16 v[128:129], v237 offset:43008
ds_read_b64_tr_b16 v[130:131], v237 offset:44544
ds_read_b128 v[176:179], v242 offset:43008
v_add_f32 v246, v246, v80
v_add_f32 v247, v247, v81
v_cvt_pk_bf16_f32 v80, v80, v81
v_mfma_f32_32x32x16_bf16 v[88:103], v[132:135], v[36:39], v[88:103]
ds_read_b128 v[132:135], v221 offset:24704
v_exp_f32 v82, v82
v_exp_f32 v83, v83
s_waitcnt lgkmcnt(4)
v_mfma_f32_32x32x16_bf16 v[88:103], v[136:139], v[40:43], v[88:103]
ds_read_b64_tr_b16 v[136:137], v235 offset:43264
ds_read_b64_tr_b16 v[138:139], v235 offset:44800
s_add_u32 m0, s33, 0xc000
s_mov_b32 s39, 0x300000
buffer_load_dwordx4 v214, s[8:11], s39 offen offset:0 nt lds
v_mfma_f32_32x32x16_bf16 v[88:103], v[140:143], v[44:47], v[88:103]
ds_read_b128 v[140:143], v222 offset:24704
v_add_f32 v246, v246, v82
v_add_f32 v247, v247, v83
v_cvt_pk_bf16_f32 v81, v82, v83
v_exp_f32 v84, v84
v_exp_f32 v85, v85
v_mfma_f32_16x16x32_bf16 v[104:107], v[144:147], v[48:51], v[124:127]
v_mfma_f32_32x32x16_bf16 a[192:207], v[148:151], v[168:171], a[192:207]
ds_read_b64_tr_b16 v[144:145], v236 offset:43264
ds_read_b64_tr_b16 v[146:147], v236 offset:44800
ds_read_b128 v[148:151], v221 offset:24832
v_add_f32 v246, v246, v84
v_add_f32 v247, v247, v85
v_cvt_pk_bf16_f32 v82, v84, v85
v_mfma_f32_16x16x32_bf16 v[104:107], v[152:155], v[52:55], v[104:107]
ds_read_b64_tr_b16 v[152:153], v235 offset:49152
ds_read_b64_tr_b16 v[154:155], v235 offset:50688
s_waitcnt lgkmcnt(5)
v_mfma_f32_16x16x32_bf16 a[240:243], v[128:131], v[176:179], a[240:243]
ds_read_b128 v[172:175], v241 offset:43008
ds_read_b128 v[128:131], v222 offset:24832
v_mfma_f32_16x16x32_bf16 v[104:107], v[132:135], v[56:59], v[104:107]
ds_read_b64_tr_b16 v[132:133], v236 offset:49152
ds_read_b64_tr_b16 v[134:135], v236 offset:50688
buffer_load_dwordx4 v215, s[8:11], s39 offen offset:1024 nt lds
v_mfma_f32_32x32x16_bf16 a[208:223], v[136:139], v[168:171], a[208:223]
ds_read_b64_tr_b16 v[136:137], v238 offset:43008
ds_read_b64_tr_b16 v[138:139], v238 offset:44544
v_exp_f32 v86, v86
v_exp_f32 v87, v87
v_mfma_f32_16x16x32_bf16 v[104:107], v[140:143], v[60:63], v[104:107]
s_waitcnt lgkmcnt(6)
v_mfma_f32_32x32x16_bf16 a[224:239], v[144:147], v[168:171], a[224:239]
ds_read_b64_tr_b16 v[140:141], v235 offset:49280
ds_read_b64_tr_b16 v[142:143], v235 offset:50816
ds_read_b64_tr_b16 v[144:145], v236 offset:49280
ds_read_b64_tr_b16 v[146:147], v236 offset:50816
buffer_load_dwordx4 v216, s[8:11], s39 offen offset:2048 nt lds
v_mfma_f32_16x16x32_bf16 v[104:107], v[148:151], v[64:67], v[104:107]
ds_read_b64_tr_b16 v[148:149], v235 offset:49408
ds_read_b64_tr_b16 v[150:151], v235 offset:50944
s_waitcnt lgkmcnt(7)
v_mfma_f32_32x32x16_bf16 a[144:159], v[152:155], v[172:175], a[144:159]
ds_read_b64_tr_b16 v[152:153], v236 offset:49408
ds_read_b64_tr_b16 v[154:155], v236 offset:50944
v_add_f32 v246, v246, v86
v_add_f32 v247, v247, v87
v_cvt_pk_bf16_f32 v83, v86, v87
v_max3_f32 v249, v88, v89, v90
v_mfma_f32_16x16x32_bf16 v[104:107], v[128:131], v[68:71], v[104:107]
ds_read_b64_tr_b16 v[128:129], v239 offset:43008
ds_read_b64_tr_b16 v[130:131], v239 offset:44544
v_mfma_f32_32x32x16_bf16 a[160:175], v[132:135], v[172:175], a[160:175]
s_waitcnt vmcnt(15)
s_barrier
ds_read_b64_tr_b16 v[132:133], v223 offset:24576
ds_read_b64_tr_b16 v[134:135], v223 offset:27648
s_add_u32 m0, s33, 0xcc00
s_add_u32 s39, s39, 0xc00
buffer_load_dwordx4 v214, s[8:11], s39 offen offset:0 nt lds
s_waitcnt lgkmcnt(6)
v_mfma_f32_16x16x32_bf16 a[244:247], v[136:139], v[176:179], a[244:247]
v_mfma_f32_32x32x16_bf16 a[176:191], v[140:143], v[172:175], a[176:191]
ds_read_b64_tr_b16 v[136:137], v224 offset:24576
ds_read_b64_tr_b16 v[138:139], v224 offset:27648
ds_read_b64_tr_b16 v[140:141], v223 offset:24704
ds_read_b64_tr_b16 v[142:143], v223 offset:27776
v_max3_f32 v249, v249, v91, v92
v_max3_f32 v249, v249, v93, v94
v_mfma_f32_32x32x16_bf16 a[192:207], v[144:147], v[172:175], a[192:207]
ds_read_b64_tr_b16 v[144:145], v224 offset:24704
ds_read_b64_tr_b16 v[146:147], v224 offset:27776
v_max3_f32 v249, v249, v95, v96
v_max3_f32 v249, v249, v97, v98
v_max3_f32 v249, v249, v99, v100
v_max3_f32 v249, v249, v101, v102
v_mfma_f32_32x32x16_bf16 a[208:223], v[148:151], v[172:175], a[208:223]
ds_read_b64_tr_b16 v[148:149], v223 offset:24832
ds_read_b64_tr_b16 v[150:151], v223 offset:27904
buffer_load_dwordx4 v215, s[8:11], s39 offen offset:1024 nt lds
v_max_f32 v249, v249, v103
v_max3_f32 v252, v104, v105, v106
s_waitcnt lgkmcnt(5)
v_mfma_f32_32x32x16_bf16 a[224:239], v[152:155], v[172:175], a[224:239]
ds_read_b64_tr_b16 v[152:153], v224 offset:24832
ds_read_b64_tr_b16 v[154:155], v224 offset:27904
buffer_load_dwordx4 v216, s[8:11], s39 offen offset:2048 nt lds
v_cmp_lt_f32 vcc, 0x41000000, v249
s_nop 0
s_cbranch_vccnz L_fb21
L_rt21:
v_mfma_f32_16x16x32_bf16 a[248:251], v[128:131], v[176:179], a[248:251]
ds_read_b64_tr_b16 v[128:129], v223 offset:30720
ds_read_b64_tr_b16 v[130:131], v223 offset:33792
v_mfma_f32_32x32x16_bf16 a[0:15], v[132:135], v[72:75], a[0:15]
ds_read_b64_tr_b16 v[132:133], v224 offset:30720
ds_read_b64_tr_b16 v[134:135], v224 offset:33792
v_max_f32 v252, v252, v107
v_cmp_lt_f32 vcc, 0x41000000, v252
s_nop 0
s_cbranch_vccnz L_fb20
L_rt20:
v_mfma_f32_32x32x16_bf16 a[16:31], v[136:139], v[72:75], a[16:31]
ds_read_b64_tr_b16 v[136:137], v223 offset:30848
ds_read_b64_tr_b16 v[138:139], v223 offset:33920
s_add_u32 m0, s34, 0x22800
s_add_u32 s37, s37, 64
s_cmp_eq_u32 s37, 0x500
s_cselect_b32 s37, 0, s37
s_mul_i32 s38, s37, 6144
s_add_u32 s38, s38, 6144
buffer_load_dwordx4 v229, s[12:15], s38 offen offset:0 lds
s_waitcnt lgkmcnt(4)
v_mfma_f32_32x32x16_bf16 a[32:47], v[140:143], v[72:75], a[32:47]
ds_read_b64_tr_b16 v[140:141], v224 offset:30848
ds_read_b64_tr_b16 v[142:143], v224 offset:33920
v_mfma_f32_32x32x16_bf16 a[48:63], v[144:147], v[72:75], a[48:63]
ds_read_b64_tr_b16 v[144:145], v223 offset:30976
ds_read_b64_tr_b16 v[146:147], v223 offset:34048
v_exp_f32 v104, v104
v_exp_f32 v105, v105
v_mfma_f32_32x32x16_bf16 a[64:79], v[148:151], v[72:75], a[64:79]
ds_read_b64_tr_b16 v[148:149], v224 offset:30976
ds_read_b64_tr_b16 v[150:151], v224 offset:34048
v_add_f32 v248, v248, v104
v_add_f32 v248, v248, v105
v_cvt_pk_bf16_f32 v104, v104, v105
v_mfma_f32_32x32x16_bf16 a[80:95], v[152:155], v[72:75], a[80:95]
ds_read_b64_tr_b16 v[152:153], v235 offset:0
ds_read_b64_tr_b16 v[154:155], v235 offset:1536
ds_read_b128 v[156:159], v240 offset:0
buffer_load_dwordx4 v230, s[12:15], s38 offen offset:1024 lds
v_mfma_f32_32x32x16_bf16 a[0:15], v[128:131], v[80:83], a[0:15]
ds_read_b64_tr_b16 v[128:129], v236 offset:0
ds_read_b64_tr_b16 v[130:131], v236 offset:1536
v_exp_f32 v106, v106
v_exp_f32 v107, v107
s_waitcnt lgkmcnt(6)
v_mfma_f32_32x32x16_bf16 a[16:31], v[132:135], v[80:83], a[16:31]
ds_read_b64_tr_b16 v[132:133], v235 offset:128
ds_read_b64_tr_b16 v[134:135], v235 offset:1664
v_add_f32 v248, v248, v106
v_add_f32 v248, v248, v107
v_cvt_pk_bf16_f32 v105, v106, v107
v_mfma_f32_32x32x16_bf16 a[32:47], v[136:139], v[80:83], a[32:47]
ds_read_b64_tr_b16 v[136:137], v236 offset:128
ds_read_b64_tr_b16 v[138:139], v236 offset:1664
v_exp_f32 v88, v88
v_exp_f32 v89, v89
v_mfma_f32_32x32x16_bf16 a[48:63], v[140:143], v[80:83], a[48:63]
ds_read_b64_tr_b16 v[140:141], v237 offset:0
ds_read_b64_tr_b16 v[142:143], v237 offset:1536
ds_read_b128 v[164:167], v242 offset:0
v_add_f32 v246, v246, v88
v_add_f32 v247, v247, v89
v_cvt_pk_bf16_f32 v88, v88, v89
v_mfma_f32_32x32x16_bf16 a[64:79], v[144:147], v[80:83], a[64:79]
ds_read_b64_tr_b16 v[144:145], v235 offset:256
ds_read_b64_tr_b16 v[146:147], v235 offset:1792
buffer_load_dwordx4 v231, s[12:15], s38 offen offset:2048 lds
v_exp_f32 v90, v90
v_exp_f32 v91, v91
s_waitcnt lgkmcnt(5)
v_mfma_f32_32x32x16_bf16 a[80:95], v[148:151], v[80:83], a[80:95]
ds_read_b64_tr_b16 v[148:149], v236 offset:256
ds_read_b64_tr_b16 v[150:151], v236 offset:1792
v_mfma_f32_32x32x16_bf16 a[144:159], v[152:155], v[156:159], a[144:159]
ds_read_b64_tr_b16 v[152:153], v235 offset:6144
ds_read_b64_tr_b16 v[154:155], v235 offset:7680
ds_read_b128 v[160:163], v241 offset:0
v_add_f32 v246, v246, v90
v_add_f32 v247, v247, v91
v_cvt_pk_bf16_f32 v89, v90, v91
v_mfma_f32_32x32x16_bf16 a[160:175], v[128:131], v[156:159], a[160:175]
ds_read_b64_tr_b16 v[128:129], v236 offset:6144
ds_read_b64_tr_b16 v[130:131], v236 offset:7680
v_exp_f32 v92, v92
v_exp_f32 v93, v93
v_mfma_f32_32x32x16_bf16 a[176:191], v[132:135], v[156:159], a[176:191]
ds_read_b64_tr_b16 v[132:133], v238 offset:0
ds_read_b64_tr_b16 v[134:135], v238 offset:1536
v_add_f32 v246, v246, v92
v_add_f32 v247, v247, v93
v_cvt_pk_bf16_f32 v90, v92, v93
v_mfma_f32_32x32x16_bf16 a[192:207], v[136:139], v[156:159], a[192:207]
ds_read_b64_tr_b16 v[136:137], v235 offset:6272
ds_read_b64_tr_b16 v[138:139], v235 offset:7808
s_add_u32 m0, s35, 0x25800
s_nop 0
buffer_load_dwordx4 v232, s[16:19], s37 offen lds
s_waitcnt lgkmcnt(4)
v_mfma_f32_16x16x32_bf16 a[240:243], v[140:143], v[164:167], a[240:243]
ds_read_b64_tr_b16 v[140:141], v236 offset:6272
ds_read_b64_tr_b16 v[142:143], v236 offset:7808
v_mfma_f32_32x32x16_bf16 a[208:223], v[144:147], v[156:159], a[208:223]
ds_read_b64_tr_b16 v[144:145], v235 offset:6400
ds_read_b64_tr_b16 v[146:147], v235 offset:7936
v_exp_f32 v94, v94
v_exp_f32 v95, v95
v_mfma_f32_32x32x16_bf16 a[224:239], v[148:151], v[156:159], a[224:239]
ds_read_b64_tr_b16 v[148:149], v236 offset:6400
ds_read_b64_tr_b16 v[150:151], v236 offset:7936
v_add_f32 v246, v246, v94
v_add_f32 v247, v247, v95
v_cvt_pk_bf16_f32 v91, v94, v95
v_mfma_f32_32x32x16_bf16 a[144:159], v[152:155], v[160:163], a[144:159]
ds_read_b64_tr_b16 v[152:153], v239 offset:0
ds_read_b64_tr_b16 v[154:155], v239 offset:1536
v_exp_f32 v96, v96
v_exp_f32 v97, v97
v_mfma_f32_32x32x16_bf16 a[160:175], v[128:131], v[160:163], a[160:175]
ds_read_b64_tr_b16 v[128:129], v225 offset:24576
ds_read_b64_tr_b16 v[130:131], v226 offset:24576
buffer_load_dwordx4 v233, s[16:19], s37 offen offset:1024 lds
s_waitcnt lgkmcnt(6)
v_mfma_f32_16x16x32_bf16 a[244:247], v[132:135], v[164:167], a[244:247]
ds_read_b64_tr_b16 v[132:133], v227 offset:24576
ds_read_b64_tr_b16 v[134:135], v228 offset:24576
v_mfma_f32_32x32x16_bf16 a[176:191], v[136:139], v[160:163], a[176:191]
ds_read_b64_tr_b16 v[136:137], v225 offset:24704
ds_read_b64_tr_b16 v[138:139], v226 offset:24704
v_add_f32 v246, v246, v96
v_add_f32 v247, v247, v97
v_cvt_pk_bf16_f32 v96, v96, v97
v_mfma_f32_32x32x16_bf16 a[192:207], v[140:143], v[160:163], a[192:207]
ds_read_b64_tr_b16 v[140:141], v227 offset:24704
ds_read_b64_tr_b16 v[142:143], v228 offset:24704
v_exp_f32 v98, v98
v_exp_f32 v99, v99
v_mfma_f32_32x32x16_bf16 a[208:223], v[144:147], v[160:163], a[208:223]
ds_read_b64_tr_b16 v[144:145], v225 offset:24832
ds_read_b64_tr_b16 v[146:147], v226 offset:24832
v_add_f32 v246, v246, v98
v_add_f32 v247, v247, v99
v_cvt_pk_bf16_f32 v97, v98, v99
s_waitcnt lgkmcnt(5)
v_mfma_f32_32x32x16_bf16 a[224:239], v[148:151], v[160:163], a[224:239]
ds_read_b64_tr_b16 v[148:149], v227 offset:24832
ds_read_b64_tr_b16 v[150:151], v228 offset:24832
s_mov_b32 m0, 0x27800
s_mov_b64 exec, s[42:43]
buffer_load_dwordx4 v234, s[16:19], s37 offen lds
s_mov_b64 exec, -1
v_mfma_f32_16x16x32_bf16 a[248:251], v[152:155], v[164:167], a[248:251]
ds_read_b64_tr_b16 v[152:153], v223 offset:36864
ds_read_b64_tr_b16 v[154:155], v223 offset:39936
v_mfma_f32_16x16x16_bf16 a[96:99], v[128:129], v[104:105], a[96:99]
v_mfma_f32_16x16x16_bf16 a[100:103], v[130:131], v[104:105], a[100:103]
ds_read_b64_tr_b16 v[128:129], v223 offset:43008
ds_read_b64_tr_b16 v[130:131], v223 offset:46080
v_mfma_f32_16x16x16_bf16 a[104:107], v[132:133], v[104:105], a[104:107]
v_exp_f32 v100, v100
v_exp_f32 v101, v101
v_mfma_f32_16x16x16_bf16 a[108:111], v[134:135], v[104:105], a[108:111]
v_mfma_f32_16x16x16_bf16 a[112:115], v[136:137], v[104:105], a[112:115]
ds_read_b64_tr_b16 v[132:133], v224 offset:36864
ds_read_b64_tr_b16 v[134:135], v224 offset:39936
s_waitcnt lgkmcnt(6)
v_mfma_f32_16x16x16_bf16 a[116:119], v[138:139], v[104:105], a[116:119]
ds_read_b64_tr_b16 v[136:137], v224 offset:43008
ds_read_b64_tr_b16 v[138:139], v224 offset:46080
s_add_u32 m0, s33, 0x6000
s_mov_b32 s39, 0x306000
buffer_load_dwordx4 v208, s[4:7], s39 offen offset:0 nt lds
v_mfma_f32_16x16x16_bf16 a[120:123], v[140:141], v[104:105], a[120:123]
v_mfma_f32_16x16x16_bf16 a[124:127], v[142:143], v[104:105], a[124:127]
v_mfma_f32_16x16x16_bf16 a[128:131], v[144:145], v[104:105], a[128:131]
ds_read_b64_tr_b16 v[140:141], v223 offset:36992
ds_read_b64_tr_b16 v[142:143], v223 offset:40064
v_mfma_f32_16x16x16_bf16 a[132:135], v[146:147], v[104:105], a[132:135]
ds_read_b64_tr_b16 v[144:145], v223 offset:43136
ds_read_b64_tr_b16 v[146:147], v223 offset:46208
buffer_load_dwordx4 v209, s[4:7], s39 offen offset:1024 nt lds
v_mfma_f32_16x16x16_bf16 a[136:139], v[148:149], v[104:105], a[136:139]
v_mfma_f32_16x16x16_bf16 a[140:143], v[150:151], v[104:105], a[140:143]
ds_read_b64_tr_b16 v[148:149], v224 offset:36992
ds_read_b64_tr_b16 v[150:151], v224 offset:40064
s_waitcnt lgkmcnt(6)
v_mfma_f32_32x32x16_bf16 a[0:15], v[152:155], v[88:91], a[0:15]
ds_read_b64_tr_b16 v[152:153], v224 offset:43136
ds_read_b64_tr_b16 v[154:155], v224 offset:46208
v_add_f32 v246, v246, v100
v_add_f32 v247, v247, v101
v_cvt_pk_bf16_f32 v98, v100, v101
v_exp_f32 v102, v102
v_exp_f32 v103, v103
v_add_f32 v246, v246, v102
v_add_f32 v247, v247, v103
v_cvt_pk_bf16_f32 v99, v102, v103
s_nop 1
v_mfma_f32_32x32x16_bf16 a[0:15], v[128:131], v[96:99], a[0:15]
v_mfma_f32_32x32x16_bf16 a[16:31], v[132:135], v[88:91], a[16:31]
ds_read_b64_tr_b16 v[128:129], v223 offset:37120
ds_read_b64_tr_b16 v[130:131], v223 offset:40192
ds_read_b64_tr_b16 v[132:133], v223 offset:43264
ds_read_b64_tr_b16 v[134:135], v223 offset:46336
buffer_load_dwordx4 v210, s[4:7], s39 offen offset:2048 nt lds
v_mfma_f32_32x32x16_bf16 a[16:31], v[136:139], v[96:99], a[16:31]
ds_read_b64_tr_b16 v[136:137], v224 offset:37120
ds_read_b64_tr_b16 v[138:139], v224 offset:40192
v_add_f32 v246, v246, v247
v_mov_b32 v250, v246
s_nop 0
s_nop 0
v_permlane32_swap_b32 v246, v250
v_add_f32 v246, v246, v250
v_rcp_f32 v246, v246
s_waitcnt lgkmcnt(6)
v_mfma_f32_32x32x16_bf16 a[32:47], v[140:143], v[88:91], a[32:47]
ds_read_b64_tr_b16 v[140:141], v224 offset:43264
ds_read_b64_tr_b16 v[142:143], v224 offset:46336
v_mfma_f32_32x32x16_bf16 a[32:47], v[144:147], v[96:99], a[32:47]
buffer_load_dwordx4 v211, s[4:7], s39 offen offset:3072 nt lds
v_mov_b32 v255, v248
s_nop 0
s_nop 0
v_permlane32_swap_b32 v248, v255
v_add_f32 v248, v248, v255
v_mov_b32 v255, v248
s_nop 0
s_nop 0
v_permlane16_swap_b32 v248, v255
v_add_f32 v248, v248, v255
v_mfma_f32_32x32x16_bf16 a[48:63], v[148:151], v[88:91], a[48:63]
v_bfe_u32 v254, v244, 4, 4
v_lshlrev_b32 v254, 3, v254
v_add_u32 v254, 0x27c00, v254
s_lshl_b32 s40, s32, 7
v_add_u32 v255, s40, v254
v_mov_b32 v125, v248
v_mfma_f32_32x32x16_bf16 a[48:63], v[152:155], v[96:99], a[48:63]
ds_write_b64 v255, v[124:125]
s_waitcnt lgkmcnt(1)
v_mfma_f32_32x32x16_bf16 a[64:79], v[128:131], v[88:91], a[64:79]
s_waitcnt vmcnt(16)
s_waitcnt lgkmcnt(0)
s_barrier
ds_read_b64_tr_b16 v[144:145], v235 offset:21504
ds_read_b64_tr_b16 v[146:147], v235 offset:23040
ds_read_b128 v[168:171], v240 offset:21504
v_mfma_f32_32x32x16_bf16 a[64:79], v[132:135], v[96:99], a[64:79]
ds_read_b64_tr_b16 v[148:149], v236 offset:21504
ds_read_b64_tr_b16 v[150:151], v236 offset:23040
ds_read_b64_tr_b16 v[152:153], v235 offset:21632
ds_read_b64_tr_b16 v[154:155], v235 offset:23168
ds_read_b64_tr_b16 v[128:129], v236 offset:21632
ds_read_b64_tr_b16 v[130:131], v236 offset:23168
v_mfma_f32_32x32x16_bf16 a[80:95], v[136:139], v[88:91], a[80:95]
ds_read_b64_tr_b16 v[132:133], v237 offset:21504
ds_read_b64_tr_b16 v[134:135], v237 offset:23040
ds_read_b128 v[172:175], v242 offset:21504
ds_read_b64_tr_b16 v[136:137], v235 offset:21760
ds_read_b64_tr_b16 v[138:139], v235 offset:23296
s_add_u32 m0, s33, 0x7000
s_nop 0
buffer_load_dwordx4 v212, s[4:7], s39 offen offset:0 nt lds
buffer_load_dwordx4 v213, s[4:7], s39 offen offset:1024 nt lds
v_mfma_f32_32x32x16_bf16 a[80:95], v[140:143], v[96:99], a[80:95]
ds_read_b64_tr_b16 v[140:141], v236 offset:21760
ds_read_b64_tr_b16 v[142:143], v236 offset:23296
s_waitcnt lgkmcnt(9)
v_mfma_f32_32x32x16_bf16 a[144:159], v[144:147], v[168:171], a[144:159]
ds_read_b64_tr_b16 v[144:145], v235 offset:27648
ds_read_b64_tr_b16 v[146:147], v235 offset:29184
ds_read_b128 v[176:179], v241 offset:21504
ds_read_b64 v[48:49], v254 offset:0
ds_read_b64 v[50:51], v254 offset:128
ds_read_b64 v[52:53], v254 offset:256
ds_read_b64 v[54:55], v254 offset:384
v_mfma_f32_32x32x16_bf16 a[160:175], v[148:151], v[168:171], a[160:175]
ds_read_b64_tr_b16 v[148:149], v236 offset:27648
ds_read_b64_tr_b16 v[150:151], v236 offset:29184
s_add_u32 m0, s34, 0x18000
s_add_u32 s37, s37, 64
s_cmp_eq_u32 s37, 0x500
s_cselect_b32 s37, 0, s37
s_mul_i32 s38, s37, 6144
s_add_u32 s38, s38, 6144
buffer_load_dwordx4 v229, s[12:15], s38 offen offset:0 lds
v_mfma_f32_32x32x16_bf16 a[176:191], v[152:155], v[168:171], a[176:191]
ds_read_b64_tr_b16 v[152:153], v238 offset:21504
ds_read_b64_tr_b16 v[154:155], v238 offset:23040
s_waitcnt lgkmcnt(7)
v_mfma_f32_32x32x16_bf16 a[192:207], v[128:131], v[168:171], a[192:207]
ds_read_b64_tr_b16 v[128:129], v235 offset:27776
ds_read_b64_tr_b16 v[130:131], v235 offset:29312
buffer_load_dwordx4 v230, s[12:15], s38 offen offset:1024 lds
v_mfma_f32_16x16x32_bf16 a[240:243], v[132:135], v[172:175], a[240:243]
ds_read_b64_tr_b16 v[132:133], v236 offset:27776
ds_read_b64_tr_b16 v[134:135], v236 offset:29312
v_mfma_f32_32x32x16_bf16 a[208:223], v[136:139], v[168:171], a[208:223]
ds_read_b64_tr_b16 v[136:137], v235 offset:27904
ds_read_b64_tr_b16 v[138:139], v235 offset:29440
buffer_load_dwordx4 v231, s[12:15], s38 offen offset:2048 lds
v_mfma_f32_32x32x16_bf16 a[224:239], v[140:143], v[168:171], a[224:239]
ds_read_b64_tr_b16 v[140:141], v236 offset:27904
ds_read_b64_tr_b16 v[142:143], v236 offset:29440
s_add_u32 m0, s35, 0x1b000
s_nop 0
buffer_load_dwordx4 v232, s[16:19], s37 offen lds
v_mfma_f32_32x32x16_bf16 a[144:159], v[144:147], v[176:179], a[144:159]
ds_read_b64_tr_b16 v[144:145], v239 offset:21504
ds_read_b64_tr_b16 v[146:147], v239 offset:23040
buffer_load_dwordx4 v233, s[16:19], s37 offen offset:1024 lds
s_mov_b32 m0, 0x1d000
s_mov_b64 exec, s[42:43]
buffer_load_dwordx4 v234, s[16:19], s37 offen lds
s_mov_b64 exec, -1
s_waitcnt lgkmcnt(4)
v_mfma_f32_32x32x16_bf16 a[160:175], v[148:151], v[176:179], a[160:175]
v_min3_f32 v255, v48, v50, v52
v_min_f32 v255, v255, v54
v_sub_f32 v48, v255, v48
v_sub_f32 v50, v255, v50
v_sub_f32 v52, v255, v52
v_sub_f32 v54, v255, v54
v_sub_f32 v255, v255, v124
v_mfma_f32_16x16x32_bf16 a[244:247], v[152:155], v[172:175], a[244:247]
v_mfma_f32_32x32x16_bf16 a[176:191], v[128:131], v[176:179], a[176:191]
v_exp_f32 v48, v48
v_exp_f32 v50, v50
v_exp_f32 v52, v52
v_exp_f32 v54, v54
v_exp_f32 v255, v255
v_mfma_f32_32x32x16_bf16 a[192:207], v[132:135], v[176:179], a[192:207]
v_mfma_f32_32x32x16_bf16 a[208:223], v[136:139], v[176:179], a[208:223]
v_mul_f32 v248, v48, v49
v_fmac_f32 v248, v50, v51
v_fmac_f32 v248, v52, v53
v_fmac_f32 v248, v54, v55
v_rcp_f32 v248, v248
v_lshrrev_b32 v254, 1, v244
v_mul_f32 v248, v248, v255
v_add_u32 v254, 0xc000, v254
v_add_u32 v255, s33, v254
v_add_u32 v250, s61, v254
v_add_u32 v254, s60, v254
s_waitcnt lgkmcnt(0)
v_mfma_f32_32x32x16_bf16 a[224:239], v[140:143], v[176:179], a[224:239]
v_mfma_f32_16x16x32_bf16 a[248:251], v[144:147], v[172:175], a[248:251]
v_accvgpr_read_b32 v96, a96
v_accvgpr_read_b32 v97, a97
v_accvgpr_read_b32 v98, a98
v_accvgpr_read_b32 v99, a99
v_pk_mul_f32 v[96:97], v[96:97], v[248:249] op_sel_hi:[1,0]
v_pk_mul_f32 v[98:99], v[98:99], v[248:249] op_sel_hi:[1,0]
v_cvt_pk_bf16_f32 v96, v96, v97
v_cvt_pk_bf16_f32 v97, v98, v99
ds_write_b64 v255, v[96:97] offset:0
v_accvgpr_read_b32 v72, a100
v_accvgpr_read_b32 v73, a101
v_accvgpr_read_b32 v74, a102
v_accvgpr_read_b32 v75, a103
v_pk_mul_f32 v[72:73], v[72:73], v[248:249] op_sel_hi:[1,0]
v_pk_mul_f32 v[74:75], v[74:75], v[248:249] op_sel_hi:[1,0]
v_cvt_pk_bf16_f32 v72, v72, v73
v_cvt_pk_bf16_f32 v73, v74, v75
s_waitcnt lgkmcnt(0)
ds_write_b64 v255, v[72:73] offset:512
v_accvgpr_read_b32 v80, a104
v_accvgpr_read_b32 v81, a105
v_accvgpr_read_b32 v82, a106
v_accvgpr_read_b32 v83, a107
v_pk_mul_f32 v[80:81], v[80:81], v[248:249] op_sel_hi:[1,0]
v_pk_mul_f32 v[82:83], v[82:83], v[248:249] op_sel_hi:[1,0]
v_cvt_pk_bf16_f32 v80, v80, v81
v_cvt_pk_bf16_f32 v81, v82, v83
s_waitcnt lgkmcnt(0)
ds_write_b64 v255, v[80:81] offset:1024
v_accvgpr_read_b32 v88, a108
v_accvgpr_read_b32 v89, a109
v_accvgpr_read_b32 v90, a110
v_accvgpr_read_b32 v91, a111
v_pk_mul_f32 v[88:89], v[88:89], v[248:249] op_sel_hi:[1,0]
v_pk_mul_f32 v[90:91], v[90:91], v[248:249] op_sel_hi:[1,0]
v_cvt_pk_bf16_f32 v88, v88, v89
v_cvt_pk_bf16_f32 v89, v90, v91
s_waitcnt lgkmcnt(0)
ds_write_b64 v255, v[88:89] offset:1536
v_accvgpr_read_b32 v96, a112
v_accvgpr_read_b32 v97, a113
v_accvgpr_read_b32 v98, a114
v_accvgpr_read_b32 v99, a115
v_pk_mul_f32 v[96:97], v[96:97], v[248:249] op_sel_hi:[1,0]
v_pk_mul_f32 v[98:99], v[98:99], v[248:249] op_sel_hi:[1,0]
v_cvt_pk_bf16_f32 v96, v96, v97
v_cvt_pk_bf16_f32 v97, v98, v99
s_waitcnt lgkmcnt(0)
ds_write_b64 v255, v[96:97] offset:2048
v_accvgpr_read_b32 v72, a116
v_accvgpr_read_b32 v73, a117
v_accvgpr_read_b32 v74, a118
v_accvgpr_read_b32 v75, a119
v_pk_mul_f32 v[72:73], v[72:73], v[248:249] op_sel_hi:[1,0]
v_pk_mul_f32 v[74:75], v[74:75], v[248:249] op_sel_hi:[1,0]
v_cvt_pk_bf16_f32 v72, v72, v73
v_cvt_pk_bf16_f32 v73, v74, v75
s_waitcnt lgkmcnt(0)
ds_write_b64 v255, v[72:73] offset:2560
v_accvgpr_read_b32 v80, a120
v_accvgpr_read_b32 v81, a121
v_accvgpr_read_b32 v82, a122
v_accvgpr_read_b32 v83, a123
v_pk_mul_f32 v[80:81], v[80:81], v[248:249] op_sel_hi:[1,0]
v_pk_mul_f32 v[82:83], v[82:83], v[248:249] op_sel_hi:[1,0]
v_cvt_pk_bf16_f32 v80, v80, v81
v_cvt_pk_bf16_f32 v81, v82, v83
s_waitcnt lgkmcnt(0)
ds_write_b64 v255, v[80:81] offset:3072
v_accvgpr_read_b32 v88, a124
v_accvgpr_read_b32 v89, a125
v_accvgpr_read_b32 v90, a126
v_accvgpr_read_b32 v91, a127
v_pk_mul_f32 v[88:89], v[88:89], v[248:249] op_sel_hi:[1,0]
v_pk_mul_f32 v[90:91], v[90:91], v[248:249] op_sel_hi:[1,0]
v_cvt_pk_bf16_f32 v88, v88, v89
v_cvt_pk_bf16_f32 v89, v90, v91
s_waitcnt lgkmcnt(0)
ds_write_b64 v255, v[88:89] offset:3584
v_accvgpr_read_b32 v96, a128
v_accvgpr_read_b32 v97, a129
v_accvgpr_read_b32 v98, a130
v_accvgpr_read_b32 v99, a131
v_pk_mul_f32 v[96:97], v[96:97], v[248:249] op_sel_hi:[1,0]
v_pk_mul_f32 v[98:99], v[98:99], v[248:249] op_sel_hi:[1,0]
v_cvt_pk_bf16_f32 v96, v96, v97
v_cvt_pk_bf16_f32 v97, v98, v99
s_waitcnt lgkmcnt(0)
ds_write_b64 v255, v[96:97] offset:4096
v_accvgpr_read_b32 v72, a132
v_accvgpr_read_b32 v73, a133
v_accvgpr_read_b32 v74, a134
v_accvgpr_read_b32 v75, a135
v_pk_mul_f32 v[72:73], v[72:73], v[248:249] op_sel_hi:[1,0]
v_pk_mul_f32 v[74:75], v[74:75], v[248:249] op_sel_hi:[1,0]
v_cvt_pk_bf16_f32 v72, v72, v73
v_cvt_pk_bf16_f32 v73, v74, v75
s_waitcnt lgkmcnt(0)
ds_write_b64 v255, v[72:73] offset:4608
v_accvgpr_read_b32 v80, a136
v_accvgpr_read_b32 v81, a137
v_accvgpr_read_b32 v82, a138
v_accvgpr_read_b32 v83, a139
v_pk_mul_f32 v[80:81], v[80:81], v[248:249] op_sel_hi:[1,0]
v_pk_mul_f32 v[82:83], v[82:83], v[248:249] op_sel_hi:[1,0]
v_cvt_pk_bf16_f32 v80, v80, v81
v_cvt_pk_bf16_f32 v81, v82, v83
s_waitcnt lgkmcnt(0)
ds_write_b64 v255, v[80:81] offset:5120
v_accvgpr_read_b32 v88, a140
v_accvgpr_read_b32 v89, a141
v_accvgpr_read_b32 v90, a142
v_accvgpr_read_b32 v91, a143
v_pk_mul_f32 v[88:89], v[88:89], v[248:249] op_sel_hi:[1,0]
v_pk_mul_f32 v[90:91], v[90:91], v[248:249] op_sel_hi:[1,0]
v_cvt_pk_bf16_f32 v88, v88, v89
v_cvt_pk_bf16_f32 v89, v90, v91
s_waitcnt lgkmcnt(0)
ds_write_b64 v255, v[88:89] offset:5632
s_waitcnt vmcnt(12)
s_waitcnt lgkmcnt(0)
s_barrier
ds_read_b64_tr_b16 v[148:149], v235 offset:43008
ds_read_b64_tr_b16 v[150:151], v235 offset:44544
ds_read_b128 v[156:159], v240 offset:43008
ds_read_b64_tr_b16 v[152:153], v236 offset:43008
ds_read_b64_tr_b16 v[154:155], v236 offset:44544
ds_read_b64_tr_b16 v[128:129], v235 offset:43136
ds_read_b64_tr_b16 v[130:131], v235 offset:44672
ds_read_b64_tr_b16 v[132:133], v236 offset:43136
ds_read_b64_tr_b16 v[134:135], v236 offset:44672
s_waitcnt lgkmcnt(6)
v_mfma_f32_32x32x16_bf16 a[144:159], v[148:151], v[156:159], a[144:159]
ds_read_b64_tr_b16 v[136:137], v237 offset:43008
ds_read_b64_tr_b16 v[138:139], v237 offset:44544
ds_read_b128 v[160:163], v242 offset:43008
s_waitcnt lgkmcnt(7)
v_mfma_f32_32x32x16_bf16 a[160:175], v[152:155], v[156:159], a[160:175]
ds_read_b64_tr_b16 v[140:141], v235 offset:43264
ds_read_b64_tr_b16 v[142:143], v235 offset:44800
ds_read_b64_tr_b16 v[144:145], v236 offset:43264
ds_read_b64_tr_b16 v[146:147], v236 offset:44800
v_accvgpr_read_b32 v96, a0
v_accvgpr_read_b32 v97, a1
v_accvgpr_read_b32 v98, a2
v_accvgpr_read_b32 v99, a3
v_accvgpr_read_b32 v100, a4
v_accvgpr_read_b32 v101, a5
v_accvgpr_read_b32 v102, a6
v_accvgpr_read_b32 v103, a7
v_pk_mul_f32 v[96:97], v[96:97], v[246:247] op_sel_hi:[1,0]
v_pk_mul_f32 v[98:99], v[98:99], v[246:247] op_sel_hi:[1,0]
v_pk_mul_f32 v[100:101], v[100:101], v[246:247] op_sel_hi:[1,0]
v_pk_mul_f32 v[102:103], v[102:103], v[246:247] op_sel_hi:[1,0]
v_cvt_pk_bf16_f32 v16, v96, v97
v_cvt_pk_bf16_f32 v17, v98, v99
v_cvt_pk_bf16_f32 v18, v100, v101
v_cvt_pk_bf16_f32 v19, v102, v103
s_waitcnt lgkmcnt(4)
v_mfma_f32_32x32x16_bf16 a[176:191], v[128:131], v[156:159], a[176:191]
v_mfma_f32_32x32x16_bf16 a[192:207], v[132:135], v[156:159], a[192:207]
ds_read_b64_tr_b16 v[148:149], v235 offset:49152
ds_read_b64_tr_b16 v[150:151], v235 offset:50688
ds_read_b128 v[164:167], v241 offset:43008
ds_read_b64_tr_b16 v[152:153], v236 offset:49152
ds_read_b64_tr_b16 v[154:155], v236 offset:50688
ds_read_b64_tr_b16 v[128:129], v238 offset:43008
ds_read_b64_tr_b16 v[130:131], v238 offset:44544
s_add_u32 m0, s34, 0x1d400
s_add_u32 s37, s37, 64
s_cmp_eq_u32 s37, 0x500
s_cselect_b32 s37, 0, s37
s_mul_i32 s38, s37, 6144
s_add_u32 s38, s38, 6144
buffer_load_dwordx4 v229, s[12:15], s38 offen offset:0 lds
v_accvgpr_read_b32 v72, a8
v_accvgpr_read_b32 v73, a9
v_accvgpr_read_b32 v74, a10
v_accvgpr_read_b32 v75, a11
v_accvgpr_read_b32 v76, a12
v_accvgpr_read_b32 v77, a13
v_accvgpr_read_b32 v78, a14
v_accvgpr_read_b32 v79, a15
v_pk_mul_f32 v[72:73], v[72:73], v[246:247] op_sel_hi:[1,0]
v_pk_mul_f32 v[74:75], v[74:75], v[246:247] op_sel_hi:[1,0]
v_pk_mul_f32 v[76:77], v[76:77], v[246:247] op_sel_hi:[1,0]
v_pk_mul_f32 v[78:79], v[78:79], v[246:247] op_sel_hi:[1,0]
v_cvt_pk_bf16_f32 v20, v72, v73
v_cvt_pk_bf16_f32 v21, v74, v75
v_cvt_pk_bf16_f32 v22, v76, v77
v_cvt_pk_bf16_f32 v23, v78, v79
v_mfma_f32_16x16x32_bf16 a[240:243], v[136:139], v[160:163], a[240:243]
buffer_load_dwordx4 v230, s[12:15], s38 offen offset:1024 lds
s_waitcnt lgkmcnt(0)
v_mfma_f32_32x32x16_bf16 a[208:223], v[140:143], v[156:159], a[208:223]
buffer_load_dwordx4 v231, s[12:15], s38 offen offset:2048 lds
v_mfma_f32_32x32x16_bf16 a[224:239], v[144:147], v[156:159], a[224:239]
ds_read_b64_tr_b16 v[132:133], v235 offset:49280
ds_read_b64_tr_b16 v[134:135], v235 offset:50816
ds_read_b64_tr_b16 v[136:137], v236 offset:49280
ds_read_b64_tr_b16 v[138:139], v236 offset:50816
s_add_u32 m0, s35, 0x20400
s_nop 0
buffer_load_dwordx4 v232, s[16:19], s37 offen lds
v_mfma_f32_32x32x16_bf16 a[144:159], v[148:151], v[164:167], a[144:159]
ds_read_b64_tr_b16 v[140:141], v235 offset:49408
ds_read_b64_tr_b16 v[142:143], v235 offset:50944
ds_read_b64_tr_b16 v[144:145], v236 offset:49408
ds_read_b64_tr_b16 v[146:147], v236 offset:50944
buffer_load_dwordx4 v233, s[16:19], s37 offen offset:1024 lds
v_mfma_f32_32x32x16_bf16 a[160:175], v[152:155], v[164:167], a[160:175]
ds_read_b64_tr_b16 v[148:149], v239 offset:43008
ds_read_b64_tr_b16 v[150:151], v239 offset:44544
s_mov_b32 m0, 0x22400
s_mov_b64 exec, s[42:43]
buffer_load_dwordx4 v234, s[16:19], s37 offen lds
s_mov_b64 exec, -1
ds_read_b64 v[48:49], v254 offset:0
ds_read_b64 v[50:51], v254 offset:6144
ds_read_b64 v[52:53], v254 offset:12288
ds_read_b64 v[54:55], v254 offset:18432
s_waitcnt lgkmcnt(3)
v_lshlrev_b32 v56, 16, v48
v_and_b32 v57, 0xffff0000, v48
v_lshlrev_b32 v58, 16, v49
v_and_b32 v59, 0xffff0000, v49
s_waitcnt lgkmcnt(2)
v_lshlrev_b32 v60, 16, v50
v_and_b32 v61, 0xffff0000, v50
v_add_f32 v56, v56, v60
v_add_f32 v57, v57, v61
v_lshlrev_b32 v60, 16, v51
v_and_b32 v61, 0xffff0000, v51
v_add_f32 v58, v58, v60
v_add_f32 v59, v59, v61
s_waitcnt lgkmcnt(1)
v_lshlrev_b32 v60, 16, v52
v_and_b32 v61, 0xffff0000, v52
v_add_f32 v56, v56, v60
v_add_f32 v57, v57, v61
v_lshlrev_b32 v60, 16, v53
v_and_b32 v61, 0xffff0000, v53
v_add_f32 v58, v58, v60
v_add_f32 v59, v59, v61
s_waitcnt lgkmcnt(0)
v_lshlrev_b32 v60, 16, v54
v_and_b32 v61, 0xffff0000, v54
v_add_f32 v56, v56, v60
v_add_f32 v57, v57, v61
v_lshlrev_b32 v60, 16, v55
v_and_b32 v61, 0xffff0000, v55
v_add_f32 v58, v58, v60
v_add_f32 v59, v59, v61
v_cvt_pk_bf16_f32 v64, v56, v57
v_cvt_pk_bf16_f32 v65, v58, v59
ds_read_b64 v[48:49], v254 offset:512
ds_read_b64 v[50:51], v254 offset:6656
ds_read_b64 v[52:53], v254 offset:12800
ds_read_b64 v[54:55], v254 offset:18944
s_waitcnt lgkmcnt(3)
v_lshlrev_b32 v56, 16, v48
v_and_b32 v57, 0xffff0000, v48
v_lshlrev_b32 v58, 16, v49
v_and_b32 v59, 0xffff0000, v49
s_waitcnt lgkmcnt(2)
v_lshlrev_b32 v60, 16, v50
v_and_b32 v61, 0xffff0000, v50
v_add_f32 v56, v56, v60
v_add_f32 v57, v57, v61
v_lshlrev_b32 v60, 16, v51
v_and_b32 v61, 0xffff0000, v51
v_add_f32 v58, v58, v60
v_add_f32 v59, v59, v61
s_waitcnt lgkmcnt(1)
v_lshlrev_b32 v60, 16, v52
v_and_b32 v61, 0xffff0000, v52
v_add_f32 v56, v56, v60
v_add_f32 v57, v57, v61
v_lshlrev_b32 v60, 16, v53
v_and_b32 v61, 0xffff0000, v53
v_add_f32 v58, v58, v60
v_add_f32 v59, v59, v61
s_waitcnt lgkmcnt(0)
v_lshlrev_b32 v60, 16, v54
v_and_b32 v61, 0xffff0000, v54
v_add_f32 v56, v56, v60
v_add_f32 v57, v57, v61
v_lshlrev_b32 v60, 16, v55
v_and_b32 v61, 0xffff0000, v55
v_add_f32 v58, v58, v60
v_add_f32 v59, v59, v61
v_cvt_pk_bf16_f32 v66, v56, v57
v_cvt_pk_bf16_f32 v67, v58, v59
ds_read_b64 v[48:49], v250 offset:0
ds_read_b64 v[50:51], v250 offset:6144
ds_read_b64 v[52:53], v250 offset:12288
ds_read_b64 v[54:55], v250 offset:18432
s_waitcnt lgkmcnt(3)
v_lshlrev_b32 v56, 16, v48
v_and_b32 v57, 0xffff0000, v48
v_lshlrev_b32 v58, 16, v49
v_and_b32 v59, 0xffff0000, v49
s_waitcnt lgkmcnt(2)
v_lshlrev_b32 v60, 16, v50
v_and_b32 v61, 0xffff0000, v50
v_add_f32 v56, v56, v60
v_add_f32 v57, v57, v61
v_lshlrev_b32 v60, 16, v51
v_and_b32 v61, 0xffff0000, v51
v_add_f32 v58, v58, v60
v_add_f32 v59, v59, v61
s_waitcnt lgkmcnt(1)
v_lshlrev_b32 v60, 16, v52
v_and_b32 v61, 0xffff0000, v52
v_add_f32 v56, v56, v60
v_add_f32 v57, v57, v61
v_lshlrev_b32 v60, 16, v53
v_and_b32 v61, 0xffff0000, v53
v_add_f32 v58, v58, v60
v_add_f32 v59, v59, v61
s_waitcnt lgkmcnt(0)
v_lshlrev_b32 v60, 16, v54
v_and_b32 v61, 0xffff0000, v54
v_add_f32 v56, v56, v60
v_add_f32 v57, v57, v61
v_lshlrev_b32 v60, 16, v55
v_and_b32 v61, 0xffff0000, v55
v_add_f32 v58, v58, v60
v_add_f32 v59, v59, v61
v_cvt_pk_bf16_f32 v68, v56, v57
v_cvt_pk_bf16_f32 v69, v58, v59
ds_read_b64 v[48:49], v250 offset:512
ds_read_b64 v[50:51], v250 offset:6656
ds_read_b64 v[52:53], v250 offset:12800
ds_read_b64 v[54:55], v250 offset:18944
v_mfma_f32_16x16x32_bf16 a[244:247], v[128:131], v[160:163], a[244:247]
v_mfma_f32_32x32x16_bf16 a[176:191], v[132:135], v[164:167], a[176:191]
s_waitcnt vmcnt(6)
s_barrier
s_waitcnt lgkmcnt(3)
v_lshlrev_b32 v56, 16, v48
v_and_b32 v57, 0xffff0000, v48
v_lshlrev_b32 v58, 16, v49
v_and_b32 v59, 0xffff0000, v49
s_waitcnt lgkmcnt(2)
v_lshlrev_b32 v60, 16, v50
v_and_b32 v61, 0xffff0000, v50
v_add_f32 v56, v56, v60
v_add_f32 v57, v57, v61
v_lshlrev_b32 v60, 16, v51
v_and_b32 v61, 0xffff0000, v51
v_add_f32 v58, v58, v60
v_add_f32 v59, v59, v61
s_waitcnt lgkmcnt(1)
v_lshlrev_b32 v60, 16, v52
v_and_b32 v61, 0xffff0000, v52
v_add_f32 v56, v56, v60
v_add_f32 v57, v57, v61
v_lshlrev_b32 v60, 16, v53
v_and_b32 v61, 0xffff0000, v53
v_add_f32 v58, v58, v60
v_add_f32 v59, v59, v61
s_waitcnt lgkmcnt(0)
v_lshlrev_b32 v60, 16, v54
v_and_b32 v61, 0xffff0000, v54
v_add_f32 v56, v56, v60
v_add_f32 v57, v57, v61
v_lshlrev_b32 v60, 16, v55
v_and_b32 v61, 0xffff0000, v55
v_add_f32 v58, v58, v60
v_add_f32 v59, v59, v61
v_mfma_f32_32x32x16_bf16 a[192:207], v[136:139], v[164:167], a[192:207]
ds_read_b64_tr_b16 v[152:153], v235 offset:0
ds_read_b64_tr_b16 v[154:155], v235 offset:1536
ds_read_b128 v[168:171], v240 offset:0
v_mfma_f32_32x32x16_bf16 a[208:223], v[140:143], v[164:167], a[208:223]
ds_read_b64_tr_b16 v[128:129], v236 offset:0
ds_read_b64_tr_b16 v[130:131], v236 offset:1536
ds_read_b64_tr_b16 v[132:133], v235 offset:128
ds_read_b64_tr_b16 v[134:135], v235 offset:1664
v_cvt_pk_bf16_f32 v70, v56, v57
v_cvt_pk_bf16_f32 v71, v58, v59
v_mfma_f32_32x32x16_bf16 a[224:239], v[144:147], v[164:167], a[224:239]
ds_read_b64_tr_b16 v[136:137], v236 offset:128
ds_read_b64_tr_b16 v[138:139], v236 offset:1664
ds_read_b64_tr_b16 v[140:141], v237 offset:0
ds_read_b64_tr_b16 v[142:143], v237 offset:1536
v_mfma_f32_16x16x32_bf16 a[248:251], v[148:151], v[160:163], a[248:251]
ds_read_b128 v[176:179], v242 offset:0
s_waitcnt lgkmcnt(9)
v_mfma_f32_32x32x16_bf16 a[144:159], v[152:155], v[168:171], a[144:159]
ds_read_b64_tr_b16 v[144:145], v235 offset:256
ds_read_b64_tr_b16 v[146:147], v235 offset:1792
ds_read_b64_tr_b16 v[148:149], v236 offset:256
ds_read_b64_tr_b16 v[150:151], v236 offset:1792
ds_read_b64_tr_b16 v[152:153], v235 offset:6144
ds_read_b64_tr_b16 v[154:155], v235 offset:7680
v_accvgpr_read_b32 v80, a16
v_accvgpr_read_b32 v81, a17
v_accvgpr_read_b32 v82, a18
v_accvgpr_read_b32 v83, a19
v_accvgpr_read_b32 v84, a20
v_accvgpr_read_b32 v85, a21
v_accvgpr_read_b32 v86, a22
v_accvgpr_read_b32 v87, a23
v_pk_mul_f32 v[80:81], v[80:81], v[246:247] op_sel_hi:[1,0]
v_pk_mul_f32 v[82:83], v[82:83], v[246:247] op_sel_hi:[1,0]
v_pk_mul_f32 v[84:85], v[84:85], v[246:247] op_sel_hi:[1,0]
v_pk_mul_f32 v[86:87], v[86:87], v[246:247] op_sel_hi:[1,0]
v_cvt_pk_bf16_f32 v24, v80, v81
v_cvt_pk_bf16_f32 v25, v82, v83
v_cvt_pk_bf16_f32 v26, v84, v85
v_cvt_pk_bf16_f32 v27, v86, v87
s_waitcnt lgkmcnt(6)
v_mfma_f32_32x32x16_bf16 a[160:175], v[128:131], v[168:171], a[160:175]
v_accvgpr_read_b32 v88, a24
v_accvgpr_read_b32 v89, a25
v_accvgpr_read_b32 v90, a26
v_accvgpr_read_b32 v91, a27
v_accvgpr_read_b32 v92, a28
v_accvgpr_read_b32 v93, a29
v_accvgpr_read_b32 v94, a30
v_accvgpr_read_b32 v95, a31
v_pk_mul_f32 v[88:89], v[88:89], v[246:247] op_sel_hi:[1,0]
v_pk_mul_f32 v[90:91], v[90:91], v[246:247] op_sel_hi:[1,0]
v_pk_mul_f32 v[92:93], v[92:93], v[246:247] op_sel_hi:[1,0]
v_pk_mul_f32 v[94:95], v[94:95], v[246:247] op_sel_hi:[1,0]
v_cvt_pk_bf16_f32 v28, v88, v89
v_cvt_pk_bf16_f32 v29, v90, v91
v_cvt_pk_bf16_f32 v30, v92, v93
v_cvt_pk_bf16_f32 v31, v94, v95
v_mfma_f32_32x32x16_bf16 a[176:191], v[132:135], v[168:171], a[176:191]
v_accvgpr_read_b32 v96, a32
v_accvgpr_read_b32 v97, a33
v_accvgpr_read_b32 v98, a34
v_accvgpr_read_b32 v99, a35
v_accvgpr_read_b32 v100, a36
v_accvgpr_read_b32 v101, a37
v_accvgpr_read_b32 v102, a38
v_accvgpr_read_b32 v103, a39
v_pk_mul_f32 v[96:97], v[96:97], v[246:247] op_sel_hi:[1,0]
v_pk_mul_f32 v[98:99], v[98:99], v[246:247] op_sel_hi:[1,0]
v_pk_mul_f32 v[100:101], v[100:101], v[246:247] op_sel_hi:[1,0]
v_pk_mul_f32 v[102:103], v[102:103], v[246:247] op_sel_hi:[1,0]
v_cvt_pk_bf16_f32 v32, v96, v97
v_cvt_pk_bf16_f32 v33, v98, v99
v_cvt_pk_bf16_f32 v34, v100, v101
v_cvt_pk_bf16_f32 v35, v102, v103
v_mfma_f32_32x32x16_bf16 a[192:207], v[136:139], v[168:171], a[192:207]
ds_read_b128 v[172:175], v241 offset:0
s_add_u32 m0, s34, 0x22800
s_add_u32 s37, s37, 64
s_cmp_eq_u32 s37, 0x500
s_cselect_b32 s37, 0, s37
s_mul_i32 s38, s37, 6144
s_add_u32 s38, s38, 6144
buffer_load_dwordx4 v229, s[12:15], s38 offen offset:0 lds
buffer_load_dwordx4 v230, s[12:15], s38 offen offset:1024 lds
buffer_load_dwordx4 v231, s[12:15], s38 offen offset:2048 lds
s_add_u32 m0, s35, 0x25800
s_nop 0
buffer_load_dwordx4 v232, s[16:19], s37 offen lds
buffer_load_dwordx4 v233, s[16:19], s37 offen offset:1024 lds
s_mov_b32 m0, 0x27800
s_mov_b64 exec, s[42:43]
buffer_load_dwordx4 v234, s[16:19], s37 offen lds
s_mov_b64 exec, -1
v_mfma_f32_16x16x32_bf16 a[240:243], v[140:143], v[176:179], a[240:243]
ds_read_b64_tr_b16 v[128:129], v236 offset:6144
ds_read_b64_tr_b16 v[130:131], v236 offset:7680
s_add_u32 m0, s33, 0x12000
s_mov_b32 s39, 0x306000
buffer_load_dwordx4 v214, s[8:11], s39 offen offset:0 nt lds
buffer_load_dwordx4 v215, s[8:11], s39 offen offset:1024 nt lds
buffer_load_dwordx4 v216, s[8:11], s39 offen offset:2048 nt lds
s_add_u32 m0, s33, 0x12c00
s_add_u32 s39, s39, 0xc00
buffer_load_dwordx4 v214, s[8:11], s39 offen offset:0 nt lds
buffer_load_dwordx4 v215, s[8:11], s39 offen offset:1024 nt lds
buffer_load_dwordx4 v216, s[8:11], s39 offen offset:2048 nt lds
v_accvgpr_read_b32 v72, a40
v_accvgpr_read_b32 v73, a41
v_accvgpr_read_b32 v74, a42
v_accvgpr_read_b32 v75, a43
v_accvgpr_read_b32 v76, a44
v_accvgpr_read_b32 v77, a45
v_accvgpr_read_b32 v78, a46
v_accvgpr_read_b32 v79, a47
v_pk_mul_f32 v[72:73], v[72:73], v[246:247] op_sel_hi:[1,0]
v_pk_mul_f32 v[74:75], v[74:75], v[246:247] op_sel_hi:[1,0]
v_pk_mul_f32 v[76:77], v[76:77], v[246:247] op_sel_hi:[1,0]
v_pk_mul_f32 v[78:79], v[78:79], v[246:247] op_sel_hi:[1,0]
v_cvt_pk_bf16_f32 v36, v72, v73
v_cvt_pk_bf16_f32 v37, v74, v75
v_cvt_pk_bf16_f32 v38, v76, v77
v_cvt_pk_bf16_f32 v39, v78, v79
s_waitcnt lgkmcnt(0)
v_mfma_f32_32x32x16_bf16 a[208:223], v[144:147], v[168:171], a[208:223]
ds_read_b64_tr_b16 v[132:133], v238 offset:0
ds_read_b64_tr_b16 v[134:135], v238 offset:1536
v_accvgpr_read_b32 v80, a48
v_accvgpr_read_b32 v81, a49
v_accvgpr_read_b32 v82, a50
v_accvgpr_read_b32 v83, a51
v_accvgpr_read_b32 v84, a52
v_accvgpr_read_b32 v85, a53
v_accvgpr_read_b32 v86, a54
v_accvgpr_read_b32 v87, a55
v_pk_mul_f32 v[80:81], v[80:81], v[246:247] op_sel_hi:[1,0]
v_pk_mul_f32 v[82:83], v[82:83], v[246:247] op_sel_hi:[1,0]
v_pk_mul_f32 v[84:85], v[84:85], v[246:247] op_sel_hi:[1,0]
v_pk_mul_f32 v[86:87], v[86:87], v[246:247] op_sel_hi:[1,0]
v_cvt_pk_bf16_f32 v40, v80, v81
v_cvt_pk_bf16_f32 v41, v82, v83
v_cvt_pk_bf16_f32 v42, v84, v85
v_cvt_pk_bf16_f32 v43, v86, v87
v_mfma_f32_32x32x16_bf16 a[224:239], v[148:151], v[168:171], a[224:239]
ds_read_b64_tr_b16 v[136:137], v235 offset:6272
ds_read_b64_tr_b16 v[138:139], v235 offset:7808
v_accvgpr_read_b32 v88, a56
v_accvgpr_read_b32 v89, a57
v_accvgpr_read_b32 v90, a58
v_accvgpr_read_b32 v91, a59
v_accvgpr_read_b32 v92, a60
v_accvgpr_read_b32 v93, a61
v_accvgpr_read_b32 v94, a62
v_accvgpr_read_b32 v95, a63
v_pk_mul_f32 v[88:89], v[88:89], v[246:247] op_sel_hi:[1,0]
v_pk_mul_f32 v[90:91], v[90:91], v[246:247] op_sel_hi:[1,0]
v_pk_mul_f32 v[92:93], v[92:93], v[246:247] op_sel_hi:[1,0]
v_pk_mul_f32 v[94:95], v[94:95], v[246:247] op_sel_hi:[1,0]
v_cvt_pk_bf16_f32 v44, v88, v89
v_cvt_pk_bf16_f32 v45, v90, v91
v_cvt_pk_bf16_f32 v46, v92, v93
v_cvt_pk_bf16_f32 v47, v94, v95
v_mfma_f32_32x32x16_bf16 a[144:159], v[152:155], v[172:175], a[144:159]
ds_read_b64_tr_b16 v[140:141], v236 offset:6272
ds_read_b64_tr_b16 v[142:143], v236 offset:7808
v_mfma_f32_32x32x16_bf16 a[160:175], v[128:131], v[172:175], a[160:175]
ds_read_b64_tr_b16 v[144:145], v235 offset:6400
ds_read_b64_tr_b16 v[146:147], v235 offset:7936
ds_read_b64_tr_b16 v[148:149], v236 offset:6400
ds_read_b64_tr_b16 v[150:151], v236 offset:7936
v_accvgpr_read_b32 v96, a64
v_accvgpr_read_b32 v97, a65
v_accvgpr_read_b32 v98, a66
v_accvgpr_read_b32 v99, a67
v_accvgpr_read_b32 v100, a68
v_accvgpr_read_b32 v101, a69
v_accvgpr_read_b32 v102, a70
v_accvgpr_read_b32 v103, a71
v_pk_mul_f32 v[96:97], v[96:97], v[246:247] op_sel_hi:[1,0]
v_pk_mul_f32 v[98:99], v[98:99], v[246:247] op_sel_hi:[1,0]
v_pk_mul_f32 v[100:101], v[100:101], v[246:247] op_sel_hi:[1,0]
v_pk_mul_f32 v[102:103], v[102:103], v[246:247] op_sel_hi:[1,0]
v_cvt_pk_bf16_f32 v192, v96, v97
v_cvt_pk_bf16_f32 v193, v98, v99
v_cvt_pk_bf16_f32 v194, v100, v101
v_cvt_pk_bf16_f32 v195, v102, v103
s_waitcnt lgkmcnt(4)
v_mfma_f32_16x16x32_bf16 a[244:247], v[132:135], v[176:179], a[244:247]
v_accvgpr_read_b32 v72, a72
v_accvgpr_read_b32 v73, a73
v_accvgpr_read_b32 v74, a74
v_accvgpr_read_b32 v75, a75
v_accvgpr_read_b32 v76, a76
v_accvgpr_read_b32 v77, a77
v_accvgpr_read_b32 v78, a78
v_accvgpr_read_b32 v79, a79
v_pk_mul_f32 v[72:73], v[72:73], v[246:247] op_sel_hi:[1,0]
v_pk_mul_f32 v[74:75], v[74:75], v[246:247] op_sel_hi:[1,0]
v_pk_mul_f32 v[76:77], v[76:77], v[246:247] op_sel_hi:[1,0]
v_pk_mul_f32 v[78:79], v[78:79], v[246:247] op_sel_hi:[1,0]
v_cvt_pk_bf16_f32 v196, v72, v73
v_cvt_pk_bf16_f32 v197, v74, v75
v_cvt_pk_bf16_f32 v198, v76, v77
v_cvt_pk_bf16_f32 v199, v78, v79
v_mfma_f32_32x32x16_bf16 a[176:191], v[136:139], v[172:175], a[176:191]
ds_read_b64_tr_b16 v[152:153], v239 offset:0
ds_read_b64_tr_b16 v[154:155], v239 offset:1536
v_accvgpr_read_b32 v80, a80
v_accvgpr_read_b32 v81, a81
v_accvgpr_read_b32 v82, a82
v_accvgpr_read_b32 v83, a83
v_accvgpr_read_b32 v84, a84
v_accvgpr_read_b32 v85, a85
v_accvgpr_read_b32 v86, a86
v_accvgpr_read_b32 v87, a87
v_pk_mul_f32 v[80:81], v[80:81], v[246:247] op_sel_hi:[1,0]
v_pk_mul_f32 v[82:83], v[82:83], v[246:247] op_sel_hi:[1,0]
v_pk_mul_f32 v[84:85], v[84:85], v[246:247] op_sel_hi:[1,0]
v_pk_mul_f32 v[86:87], v[86:87], v[246:247] op_sel_hi:[1,0]
v_cvt_pk_bf16_f32 v200, v80, v81
v_cvt_pk_bf16_f32 v201, v82, v83
v_cvt_pk_bf16_f32 v202, v84, v85
v_cvt_pk_bf16_f32 v203, v86, v87
v_mfma_f32_32x32x16_bf16 a[192:207], v[140:143], v[172:175], a[192:207]
s_waitcnt vmcnt(6)
s_barrier
ds_read_b64_tr_b16 v[128:129], v237 offset:21504
ds_read_b64_tr_b16 v[130:131], v237 offset:23040
ds_read_b128 v[156:159], v242 offset:21504
ds_read_b64_tr_b16 v[132:133], v235 offset:21504
ds_read_b64_tr_b16 v[134:135], v235 offset:23040
ds_read_b128 v[164:167], v240 offset:21504
s_add_u32 s41, s52, 0x0
buffer_store_dwordx4 v[16:19], v243, s[24:27], s41 offen offset:0 sc1
s_waitcnt lgkmcnt(6)
v_mfma_f32_32x32x16_bf16 a[208:223], v[144:147], v[172:175], a[208:223]
ds_read_b64_tr_b16 v[136:137], v238 offset:21504
ds_read_b64_tr_b16 v[138:139], v238 offset:23040
v_accvgpr_read_b32 v88, a88
v_accvgpr_read_b32 v89, a89
v_accvgpr_read_b32 v90, a90
v_accvgpr_read_b32 v91, a91
v_accvgpr_read_b32 v92, a92
v_accvgpr_read_b32 v93, a93
v_accvgpr_read_b32 v94, a94
v_accvgpr_read_b32 v95, a95
v_pk_mul_f32 v[88:89], v[88:89], v[246:247] op_sel_hi:[1,0]
v_pk_mul_f32 v[90:91], v[90:91], v[246:247] op_sel_hi:[1,0]
v_pk_mul_f32 v[92:93], v[92:93], v[246:247] op_sel_hi:[1,0]
v_pk_mul_f32 v[94:95], v[94:95], v[246:247] op_sel_hi:[1,0]
v_cvt_pk_bf16_f32 v204, v88, v89
v_cvt_pk_bf16_f32 v205, v90, v91
v_cvt_pk_bf16_f32 v206, v92, v93
v_cvt_pk_bf16_f32 v207, v94, v95
v_mfma_f32_32x32x16_bf16 a[224:239], v[148:151], v[172:175], a[224:239]
ds_read_b64_tr_b16 v[140:141], v236 offset:21504
ds_read_b64_tr_b16 v[142:143], v236 offset:23040
v_mfma_f32_16x16x32_bf16 a[248:251], v[152:155], v[176:179], a[248:251]
ds_read_b64_tr_b16 v[144:145], v239 offset:21504
ds_read_b64_tr_b16 v[146:147], v239 offset:23040
s_add_u32 s41, s52, 0x0
buffer_store_dwordx4 v[20:23], v243, s[24:27], s41 offen offset:1024 sc1
s_waitcnt lgkmcnt(4)
v_mfma_f32_16x16x32_bf16 a[240:243], v[128:131], v[156:159], a[240:243]
ds_read_b64_tr_b16 v[148:149], v235 offset:21632
ds_read_b64_tr_b16 v[150:151], v235 offset:23168
v_mfma_f32_32x32x16_bf16 a[144:159], v[132:135], v[164:167], a[144:159]
ds_read_b64_tr_b16 v[152:153], v237 offset:43008
ds_read_b64_tr_b16 v[154:155], v237 offset:44544
ds_read_b128 v[160:163], v242 offset:43008
v_mfma_f32_16x16x32_bf16 a[244:247], v[136:139], v[156:159], a[244:247]
ds_read_b64_tr_b16 v[128:129], v236 offset:21632
ds_read_b64_tr_b16 v[130:131], v236 offset:23168
s_add_u32 s41, s52, 0x0
buffer_store_dwordx4 v[24:27], v243, s[24:27], s41 offen offset:2048 sc1
s_waitcnt lgkmcnt(7)
v_mfma_f32_32x32x16_bf16 a[160:175], v[140:143], v[164:167], a[160:175]
ds_read_b64_tr_b16 v[132:133], v238 offset:43008
ds_read_b64_tr_b16 v[134:135], v238 offset:44544
v_mfma_f32_16x16x32_bf16 a[248:251], v[144:147], v[156:159], a[248:251]
ds_read_b64_tr_b16 v[136:137], v235 offset:21760
ds_read_b64_tr_b16 v[138:139], v235 offset:23296
s_waitcnt lgkmcnt(9)
v_mfma_f32_32x32x16_bf16 a[176:191], v[148:151], v[164:167], a[176:191]
ds_read_b64_tr_b16 v[140:141], v239 offset:43008
ds_read_b64_tr_b16 v[142:143], v239 offset:44544
ds_read_b64_tr_b16 v[144:145], v236 offset:21760
ds_read_b64_tr_b16 v[146:147], v236 offset:23296
ds_read_b64_tr_b16 v[148:149], v235 offset:27648
ds_read_b64_tr_b16 v[150:151], v235 offset:29184
s_add_u32 s41, s52, 0x0
buffer_store_dwordx4 v[28:31], v243, s[24:27], s41 offen offset:3072 sc1
s_waitcnt lgkmcnt(10)
v_mfma_f32_16x16x32_bf16 a[240:243], v[152:155], v[160:163], a[240:243]
v_mfma_f32_32x32x16_bf16 a[192:207], v[128:131], v[164:167], a[192:207]
ds_read_b128 v[168:171], v241 offset:21504
ds_read_b64_tr_b16 v[152:153], v235 offset:43008
ds_read_b64_tr_b16 v[154:155], v235 offset:44544
ds_read_b128 v[172:175], v240 offset:43008
s_waitcnt lgkmcnt(10)
v_mfma_f32_16x16x32_bf16 a[244:247], v[132:135], v[160:163], a[244:247]
ds_read_b64_tr_b16 v[128:129], v235 offset:49152
ds_read_b64_tr_b16 v[130:131], v235 offset:50688
s_add_u32 s40, s52, s60
s_add_u32 s40, s40, 0x0
buffer_store_dwordx4 v[64:67], v244, s[24:27], s40 offen sc1
v_mfma_f32_32x32x16_bf16 a[208:223], v[136:139], v[164:167], a[208:223]
ds_read_b128 v[176:179], v241 offset:43008
ds_read_b64_tr_b16 v[132:133], v236 offset:27648
ds_read_b64_tr_b16 v[134:135], v236 offset:29184
s_waitcnt lgkmcnt(9)
v_mfma_f32_16x16x32_bf16 a[248:251], v[140:143], v[160:163], a[248:251]
ds_read_b64_tr_b16 v[136:137], v236 offset:43008
ds_read_b64_tr_b16 v[138:139], v236 offset:44544
v_mfma_f32_32x32x16_bf16 a[224:239], v[144:147], v[164:167], a[224:239]
ds_read_b64_tr_b16 v[140:141], v236 offset:49152
ds_read_b64_tr_b16 v[142:143], v236 offset:50688
ds_read_b64_tr_b16 v[144:145], v235 offset:27776
ds_read_b64_tr_b16 v[146:147], v235 offset:29312
s_add_u32 s40, s52, s61
s_add_u32 s40, s40, 0x0
s_mov_b32 exec_lo, s62
s_mov_b32 exec_hi, s62
buffer_store_dwordx4 v[68:71], v244, s[24:27], s40 offen sc1
s_mov_b64 exec, -1
s_waitcnt lgkmcnt(9)
v_mfma_f32_32x32x16_bf16 a[144:159], v[148:151], v[168:171], a[144:159]
v_mfma_f32_32x32x16_bf16 a[144:159], v[152:155], v[172:175], a[144:159]
ds_read_b64_tr_b16 v[148:149], v235 offset:43136
ds_read_b64_tr_b16 v[150:151], v235 offset:44672
ds_read_b64_tr_b16 v[152:153], v235 offset:49280
ds_read_b64_tr_b16 v[154:155], v235 offset:50816
s_waitcnt lgkmcnt(7)
v_mfma_f32_32x32x16_bf16 a[144:159], v[128:131], v[176:179], a[144:159]
ds_read_b64_tr_b16 v[128:129], v236 offset:27776
ds_read_b64_tr_b16 v[130:131], v236 offset:29312
s_add_u32 s41, s52, 0x1000
buffer_store_dwordx4 v[32:35], v243, s[24:27], s41 offen offset:0 sc1
v_mfma_f32_32x32x16_bf16 a[160:175], v[132:135], v[168:171], a[160:175]
ds_read_b64_tr_b16 v[132:133], v236 offset:43136
ds_read_b64_tr_b16 v[134:135], v236 offset:44672
s_add_u32 s41, s52, 0x1000
buffer_store_dwordx4 v[36:39], v243, s[24:27], s41 offen offset:1024 sc1
v_mfma_f32_32x32x16_bf16 a[160:175], v[136:139], v[172:175], a[160:175]
ds_read_b64_tr_b16 v[136:137], v236 offset:49280
ds_read_b64_tr_b16 v[138:139], v236 offset:50816
v_mov_b32 v229, v180
v_mov_b32 v230, v181
v_mov_b32 v231, v182
v_mov_b32 v232, v183
v_mov_b32 v233, v184
s_waitcnt lgkmcnt(4)
v_mfma_f32_32x32x16_bf16 a[160:175], v[140:143], v[176:179], a[160:175]
ds_read_b64_tr_b16 v[140:141], v235 offset:27904
ds_read_b64_tr_b16 v[142:143], v235 offset:29440
v_lshrrev_b32 v254, 4, v244
v_and_b32 v255, 15, v254
v_mul_u32_u24 v255, 0x190, v255
v_bfe_u32 v254, v254, 4, 2
v_mfma_f32_32x32x16_bf16 a[176:191], v[144:147], v[168:171], a[176:191]
ds_read_b64_tr_b16 v[144:145], v235 offset:43264
ds_read_b64_tr_b16 v[146:147], v235 offset:44800
s_add_u32 s41, s52, 0x1000
buffer_store_dwordx4 v[40:43], v243, s[24:27], s41 offen offset:2048 sc1
v_mfma_f32_32x32x16_bf16 a[176:191], v[148:151], v[172:175], a[176:191]
ds_read_b64_tr_b16 v[148:149], v235 offset:49408
ds_read_b64_tr_b16 v[150:151], v235 offset:50944
v_lshl_add_u32 v251, v254, 4, v255
v_lshl_add_u32 v254, v254, 3, v255
s_mul_i32 s40, s32, 96
v_add_u32 v254, s40, v254
v_add_u32 v251, 0x18000, v251
v_add_u32 v254, 0x18000, v254
v_mfma_f32_32x32x16_bf16 a[176:191], v[152:155], v[176:179], a[176:191]
ds_read_b64_tr_b16 v[152:153], v236 offset:27904
ds_read_b64_tr_b16 v[154:155], v236 offset:29440
v_accvgpr_read_b32 v116, a240
v_accvgpr_read_b32 v117, a241
v_accvgpr_read_b32 v118, a242
v_accvgpr_read_b32 v119, a243
v_mfma_f32_32x32x16_bf16 a[192:207], v[128:131], v[168:171], a[192:207]
ds_read_b64_tr_b16 v[128:129], v236 offset:43264
ds_read_b64_tr_b16 v[130:131], v236 offset:44800
v_pk_mul_f32 v[116:117], v[116:117], s[2:3] op_sel_hi:[1,0]
v_pk_mul_f32 v[118:119], v[118:119], s[2:3] op_sel_hi:[1,0]
s_waitcnt lgkmcnt(4)
v_mfma_f32_32x32x16_bf16 a[192:207], v[132:135], v[172:175], a[192:207]
ds_read_b64_tr_b16 v[132:133], v236 offset:49408
ds_read_b64_tr_b16 v[134:135], v236 offset:50944
s_add_u32 s41, s52, 0x1000
buffer_store_dwordx4 v[44:47], v243, s[24:27], s41 offen offset:3072 sc1
v_mfma_f32_32x32x16_bf16 a[192:207], v[136:139], v[176:179], a[192:207]
v_cvt_pk_bf16_f32 v116, v116, v117
v_cvt_pk_bf16_f32 v117, v118, v119
ds_write_b64 v254, v[116:117] offset:0
v_accvgpr_read_b32 v88, a244
v_accvgpr_read_b32 v89, a245
v_accvgpr_read_b32 v90, a246
v_accvgpr_read_b32 v91, a247
v_mfma_f32_32x32x16_bf16 a[208:223], v[140:143], v[168:171], a[208:223]
s_add_u32 s41, s52, 0x2000
buffer_store_dwordx4 v[192:195], v243, s[24:27], s41 offen offset:0 sc1
v_pk_mul_f32 v[88:89], v[88:89], s[2:3] op_sel_hi:[1,0]
v_pk_mul_f32 v[90:91], v[90:91], s[2:3] op_sel_hi:[1,0]
v_mfma_f32_32x32x16_bf16 a[208:223], v[144:147], v[172:175], a[208:223]
v_cvt_pk_bf16_f32 v88, v88, v89
v_cvt_pk_bf16_f32 v89, v90, v91
s_waitcnt lgkmcnt(0)
ds_write_b64 v254, v[88:89] offset:32
v_accvgpr_read_b32 v96, a248
v_accvgpr_read_b32 v97, a249
v_accvgpr_read_b32 v98, a250
v_accvgpr_read_b32 v99, a251
v_mfma_f32_32x32x16_bf16 a[208:223], v[148:151], v[176:179], a[208:223]
v_pk_mul_f32 v[96:97], v[96:97], s[2:3] op_sel_hi:[1,0]
v_pk_mul_f32 v[98:99], v[98:99], s[2:3] op_sel_hi:[1,0]
v_cvt_pk_bf16_f32 v96, v96, v97
v_cvt_pk_bf16_f32 v97, v98, v99
s_waitcnt lgkmcnt(0)
ds_write_b64 v254, v[96:97] offset:64
v_mfma_f32_32x32x16_bf16 a[224:239], v[152:155], v[168:171], a[224:239]
s_waitcnt lgkmcnt(0)
s_barrier
ds_read_b128 v[136:139], v217 offset:0
ds_read_b128 v[140:143], v218 offset:0
ds_read_b128 v[144:147], v219 offset:0
v_mfma_f32_32x32x16_bf16 a[224:239], v[128:131], v[172:175], a[224:239]
ds_read_b128 v[148:151], v220 offset:0
ds_read_b128 v[152:155], v217 offset:128
ds_read_b128 v[128:131], v218 offset:128
v_accvgpr_read_b32 v108, a144
v_accvgpr_read_b32 v109, a145
v_accvgpr_read_b32 v110, a146
v_accvgpr_read_b32 v111, a147
v_mfma_f32_32x32x16_bf16 a[224:239], v[132:135], v[176:179], a[224:239]
ds_read_b128 v[132:135], v219 offset:128
v_accvgpr_read_b32 v112, a148
v_accvgpr_read_b32 v113, a149
v_accvgpr_read_b32 v114, a150
v_accvgpr_read_b32 v115, a151
v_pk_mul_f32 v[108:109], v[108:109], s[2:3] op_sel_hi:[1,0]
v_pk_mul_f32 v[110:111], v[110:111], s[2:3] op_sel_hi:[1,0]
v_pk_mul_f32 v[112:113], v[112:113], s[2:3] op_sel_hi:[1,0]
v_pk_mul_f32 v[114:115], v[114:115], s[2:3] op_sel_hi:[1,0]
v_cvt_pk_bf16_f32 v0, v108, v109
v_cvt_pk_bf16_f32 v1, v110, v111
v_cvt_pk_bf16_f32 v2, v112, v113
v_cvt_pk_bf16_f32 v3, v114, v115
s_add_u32 s41, s52, 0x2000
buffer_store_dwordx4 v[196:199], v243, s[24:27], s41 offen offset:1024 sc1
s_waitcnt lgkmcnt(1)
v_mfma_f32_32x32x16_bf16 v[72:87], v[136:139], v[0:3], 0
v_accvgpr_read_b32 v116, a152
v_accvgpr_read_b32 v117, a153
v_accvgpr_read_b32 v118, a154
v_accvgpr_read_b32 v119, a155
v_accvgpr_read_b32 v120, a156
v_accvgpr_read_b32 v121, a157
v_accvgpr_read_b32 v122, a158
v_accvgpr_read_b32 v123, a159
v_pk_mul_f32 v[116:117], v[116:117], s[2:3] op_sel_hi:[1,0]
v_pk_mul_f32 v[118:119], v[118:119], s[2:3] op_sel_hi:[1,0]
v_pk_mul_f32 v[120:121], v[120:121], s[2:3] op_sel_hi:[1,0]
v_pk_mul_f32 v[122:123], v[122:123], s[2:3] op_sel_hi:[1,0]
v_cvt_pk_bf16_f32 v4, v116, v117
v_cvt_pk_bf16_f32 v5, v118, v119
v_cvt_pk_bf16_f32 v6, v120, v121
v_cvt_pk_bf16_f32 v7, v122, v123
s_nop 1
v_mfma_f32_32x32x16_bf16 v[72:87], v[140:143], v[4:7], v[72:87]
v_accvgpr_read_b32 v88, a160
v_accvgpr_read_b32 v89, a161
v_accvgpr_read_b32 v90, a162
v_accvgpr_read_b32 v91, a163
v_accvgpr_read_b32 v92, a164
v_accvgpr_read_b32 v93, a165
v_accvgpr_read_b32 v94, a166
v_accvgpr_read_b32 v95, a167
v_pk_mul_f32 v[88:89], v[88:89], s[2:3] op_sel_hi:[1,0]
v_pk_mul_f32 v[90:91], v[90:91], s[2:3] op_sel_hi:[1,0]
v_pk_mul_f32 v[92:93], v[92:93], s[2:3] op_sel_hi:[1,0]
v_pk_mul_f32 v[94:95], v[94:95], s[2:3] op_sel_hi:[1,0]
v_cvt_pk_bf16_f32 v8, v88, v89
v_cvt_pk_bf16_f32 v9, v90, v91
v_cvt_pk_bf16_f32 v10, v92, v93
v_cvt_pk_bf16_f32 v11, v94, v95
s_nop 1
v_mfma_f32_32x32x16_bf16 v[72:87], v[144:147], v[8:11], v[72:87]
v_accvgpr_read_b32 v96, a168
v_accvgpr_read_b32 v97, a169
v_accvgpr_read_b32 v98, a170
v_accvgpr_read_b32 v99, a171
v_accvgpr_read_b32 v100, a172
v_accvgpr_read_b32 v101, a173
v_accvgpr_read_b32 v102, a174
v_accvgpr_read_b32 v103, a175
v_pk_mul_f32 v[96:97], v[96:97], s[2:3] op_sel_hi:[1,0]
v_pk_mul_f32 v[98:99], v[98:99], s[2:3] op_sel_hi:[1,0]
v_pk_mul_f32 v[100:101], v[100:101], s[2:3] op_sel_hi:[1,0]
v_pk_mul_f32 v[102:103], v[102:103], s[2:3] op_sel_hi:[1,0]
v_cvt_pk_bf16_f32 v12, v96, v97
v_cvt_pk_bf16_f32 v13, v98, v99
v_cvt_pk_bf16_f32 v14, v100, v101
v_cvt_pk_bf16_f32 v15, v102, v103
s_add_u32 s41, s52, 0x2000
buffer_store_dwordx4 v[200:203], v243, s[24:27], s41 offen offset:2048 sc1
v_mfma_f32_32x32x16_bf16 v[72:87], v[148:151], v[12:15], v[72:87]
ds_read_b128 v[136:139], v220 offset:128
s_add_u32 m0, s36, 0x1d400
s_add_u32 s38, s48, 0x0
buffer_load_dwordx4 v229, s[20:23], s38 offen offset:0 lds
v_accvgpr_read_b32 v108, a176
v_accvgpr_read_b32 v109, a177
v_accvgpr_read_b32 v110, a178
v_accvgpr_read_b32 v111, a179
v_accvgpr_read_b32 v112, a180
v_accvgpr_read_b32 v113, a181
v_accvgpr_read_b32 v114, a182
v_accvgpr_read_b32 v115, a183
v_pk_mul_f32 v[108:109], v[108:109], s[2:3] op_sel_hi:[1,0]
v_pk_mul_f32 v[110:111], v[110:111], s[2:3] op_sel_hi:[1,0]
v_pk_mul_f32 v[112:113], v[112:113], s[2:3] op_sel_hi:[1,0]
v_pk_mul_f32 v[114:115], v[114:115], s[2:3] op_sel_hi:[1,0]
v_cvt_pk_bf16_f32 v16, v108, v109
v_cvt_pk_bf16_f32 v17, v110, v111
v_cvt_pk_bf16_f32 v18, v112, v113
v_cvt_pk_bf16_f32 v19, v114, v115
s_nop 1
v_mfma_f32_32x32x16_bf16 v[72:87], v[152:155], v[16:19], v[72:87]
ds_read_b128 v[140:143], v217 offset:256
v_accvgpr_read_b32 v116, a184
v_accvgpr_read_b32 v117, a185
v_accvgpr_read_b32 v118, a186
v_accvgpr_read_b32 v119, a187
v_accvgpr_read_b32 v120, a188
v_accvgpr_read_b32 v121, a189
v_accvgpr_read_b32 v122, a190
v_accvgpr_read_b32 v123, a191
v_pk_mul_f32 v[116:117], v[116:117], s[2:3] op_sel_hi:[1,0]
v_pk_mul_f32 v[118:119], v[118:119], s[2:3] op_sel_hi:[1,0]
v_pk_mul_f32 v[120:121], v[120:121], s[2:3] op_sel_hi:[1,0]
v_pk_mul_f32 v[122:123], v[122:123], s[2:3] op_sel_hi:[1,0]
v_cvt_pk_bf16_f32 v20, v116, v117
v_cvt_pk_bf16_f32 v21, v118, v119
v_cvt_pk_bf16_f32 v22, v120, v121
v_cvt_pk_bf16_f32 v23, v122, v123
s_nop 1
v_mfma_f32_32x32x16_bf16 v[72:87], v[128:131], v[20:23], v[72:87]
ds_read_b128 v[144:147], v218 offset:256
v_accvgpr_read_b32 v88, a192
v_accvgpr_read_b32 v89, a193
v_accvgpr_read_b32 v90, a194
v_accvgpr_read_b32 v91, a195
v_accvgpr_read_b32 v92, a196
v_accvgpr_read_b32 v93, a197
v_accvgpr_read_b32 v94, a198
v_accvgpr_read_b32 v95, a199
v_pk_mul_f32 v[88:89], v[88:89], s[2:3] op_sel_hi:[1,0]
v_pk_mul_f32 v[90:91], v[90:91], s[2:3] op_sel_hi:[1,0]
v_pk_mul_f32 v[92:93], v[92:93], s[2:3] op_sel_hi:[1,0]
v_pk_mul_f32 v[94:95], v[94:95], s[2:3] op_sel_hi:[1,0]
v_cvt_pk_bf16_f32 v24, v88, v89
v_cvt_pk_bf16_f32 v25, v90, v91
v_cvt_pk_bf16_f32 v26, v92, v93
v_cvt_pk_bf16_f32 v27, v94, v95
s_add_u32 s41, s52, 0x2000
buffer_store_dwordx4 v[204:207], v243, s[24:27], s41 offen offset:3072 sc1
s_waitcnt lgkmcnt(1)
v_mfma_f32_32x32x16_bf16 v[72:87], v[132:135], v[24:27], v[72:87]
ds_read_b128 v[148:151], v219 offset:256
buffer_load_dwordx4 v230, s[20:23], s38 offen offset:1024 lds
v_accvgpr_read_b32 v96, a200
v_accvgpr_read_b32 v97, a201
v_accvgpr_read_b32 v98, a202
v_accvgpr_read_b32 v99, a203
v_accvgpr_read_b32 v100, a204
v_accvgpr_read_b32 v101, a205
v_accvgpr_read_b32 v102, a206
v_accvgpr_read_b32 v103, a207
v_pk_mul_f32 v[96:97], v[96:97], s[2:3] op_sel_hi:[1,0]
v_pk_mul_f32 v[98:99], v[98:99], s[2:3] op_sel_hi:[1,0]
v_pk_mul_f32 v[100:101], v[100:101], s[2:3] op_sel_hi:[1,0]
v_pk_mul_f32 v[102:103], v[102:103], s[2:3] op_sel_hi:[1,0]
v_cvt_pk_bf16_f32 v28, v96, v97
v_cvt_pk_bf16_f32 v29, v98, v99
v_cvt_pk_bf16_f32 v30, v100, v101
v_cvt_pk_bf16_f32 v31, v102, v103
s_nop 1
v_mfma_f32_32x32x16_bf16 v[72:87], v[136:139], v[28:31], v[72:87]
ds_read_b128 v[152:155], v220 offset:256
v_accvgpr_read_b32 v108, a208
v_accvgpr_read_b32 v109, a209
v_accvgpr_read_b32 v110, a210
v_accvgpr_read_b32 v111, a211
v_accvgpr_read_b32 v112, a212
v_accvgpr_read_b32 v113, a213
v_accvgpr_read_b32 v114, a214
v_accvgpr_read_b32 v115, a215
v_pk_mul_f32 v[108:109], v[108:109], s[2:3] op_sel_hi:[1,0]
v_pk_mul_f32 v[110:111], v[110:111], s[2:3] op_sel_hi:[1,0]
v_pk_mul_f32 v[112:113], v[112:113], s[2:3] op_sel_hi:[1,0]
v_pk_mul_f32 v[114:115], v[114:115], s[2:3] op_sel_hi:[1,0]
v_cvt_pk_bf16_f32 v32, v108, v109
v_cvt_pk_bf16_f32 v33, v110, v111
v_cvt_pk_bf16_f32 v34, v112, v113
v_cvt_pk_bf16_f32 v35, v114, v115
s_nop 1
v_mfma_f32_32x32x16_bf16 v[72:87], v[140:143], v[32:35], v[72:87]
ds_read_b128 v[128:131], v221 offset:0
v_accvgpr_read_b32 v116, a216
v_accvgpr_read_b32 v117, a217
v_accvgpr_read_b32 v118, a218
v_accvgpr_read_b32 v119, a219
v_accvgpr_read_b32 v120, a220
v_accvgpr_read_b32 v121, a221
v_accvgpr_read_b32 v122, a222
v_accvgpr_read_b32 v123, a223
v_pk_mul_f32 v[116:117], v[116:117], s[2:3] op_sel_hi:[1,0]
v_pk_mul_f32 v[118:119], v[118:119], s[2:3] op_sel_hi:[1,0]
v_pk_mul_f32 v[120:121], v[120:121], s[2:3] op_sel_hi:[1,0]
v_pk_mul_f32 v[122:123], v[122:123], s[2:3] op_sel_hi:[1,0]
v_cvt_pk_bf16_f32 v36, v116, v117
v_cvt_pk_bf16_f32 v37, v118, v119
v_cvt_pk_bf16_f32 v38, v120, v121
v_cvt_pk_bf16_f32 v39, v122, v123
s_waitcnt lgkmcnt(1)
s_nop 0
v_mfma_f32_32x32x16_bf16 v[72:87], v[144:147], v[36:39], v[72:87]
ds_read_b128 v[132:135], v222 offset:0
ds_read_b128 v[136:139], v221 offset:128
buffer_load_dwordx4 v231, s[20:23], s38 offen offset:2048 lds
v_accvgpr_read_b32 v88, a224
v_accvgpr_read_b32 v89, a225
v_accvgpr_read_b32 v90, a226
v_accvgpr_read_b32 v91, a227
v_accvgpr_read_b32 v92, a228
v_accvgpr_read_b32 v93, a229
v_accvgpr_read_b32 v94, a230
v_accvgpr_read_b32 v95, a231
v_pk_mul_f32 v[88:89], v[88:89], s[2:3] op_sel_hi:[1,0]
v_pk_mul_f32 v[90:91], v[90:91], s[2:3] op_sel_hi:[1,0]
v_pk_mul_f32 v[92:93], v[92:93], s[2:3] op_sel_hi:[1,0]
v_pk_mul_f32 v[94:95], v[94:95], s[2:3] op_sel_hi:[1,0]
v_cvt_pk_bf16_f32 v40, v88, v89
v_cvt_pk_bf16_f32 v41, v90, v91
v_cvt_pk_bf16_f32 v42, v92, v93
v_cvt_pk_bf16_f32 v43, v94, v95
ds_read_b128 v[48:51], v251 offset:0
ds_read_b128 v[52:55], v251 offset:64
ds_read_b128 v[56:59], v251 offset:128
ds_read_b128 v[60:63], v251 offset:192
ds_read_b128 v[64:67], v251 offset:256
ds_read_b128 v[68:71], v251 offset:320
v_mfma_f32_32x32x16_bf16 v[72:87], v[148:151], v[40:43], v[72:87]
ds_read_b128 v[140:143], v222 offset:128
ds_read_b128 v[144:147], v221 offset:256
v_accvgpr_read_b32 v96, a232
v_accvgpr_read_b32 v97, a233
v_accvgpr_read_b32 v98, a234
v_accvgpr_read_b32 v99, a235
v_accvgpr_read_b32 v100, a236
v_accvgpr_read_b32 v101, a237
v_accvgpr_read_b32 v102, a238
v_accvgpr_read_b32 v103, a239
v_pk_mul_f32 v[96:97], v[96:97], s[2:3] op_sel_hi:[1,0]
v_pk_mul_f32 v[98:99], v[98:99], s[2:3] op_sel_hi:[1,0]
v_pk_mul_f32 v[100:101], v[100:101], s[2:3] op_sel_hi:[1,0]
v_pk_mul_f32 v[102:103], v[102:103], s[2:3] op_sel_hi:[1,0]
v_cvt_pk_bf16_f32 v44, v96, v97
v_cvt_pk_bf16_f32 v45, v98, v99
v_cvt_pk_bf16_f32 v46, v100, v101
v_cvt_pk_bf16_f32 v47, v102, v103
s_nop 1
v_mfma_f32_32x32x16_bf16 v[72:87], v[152:155], v[44:47], v[72:87]
ds_read_b128 v[148:151], v222 offset:256
ds_read_b128 v[152:155], v217 offset:12288
s_waitcnt lgkmcnt(2)
v_mfma_f32_16x16x32_bf16 v[104:107], v[128:131], v[48:51], 0
buffer_load_dwordx4 v232, s[20:23], s38 offen offset:3072 lds
v_mfma_f32_16x16x32_bf16 v[104:107], v[132:135], v[52:55], v[104:107]
ds_read_b128 v[128:131], v218 offset:12288
v_mfma_f32_16x16x32_bf16 v[104:107], v[136:139], v[56:59], v[104:107]
ds_read_b128 v[132:135], v219 offset:12288
v_mfma_f32_16x16x32_bf16 v[104:107], v[140:143], v[60:63], v[104:107]
ds_read_b128 v[136:139], v220 offset:12288
ds_read_b128 v[140:143], v217 offset:12416
s_add_u32 m0, s36, 0x1e400
s_nop 0
buffer_load_dwordx4 v233, s[20:23], s38 offen offset:0 lds
v_mfma_f32_16x16x32_bf16 v[104:107], v[144:147], v[64:67], v[104:107]
s_waitcnt lgkmcnt(4)
v_mfma_f32_16x16x32_bf16 v[104:107], v[148:151], v[68:71], v[104:107]
ds_read_b128 v[144:147], v218 offset:12416
v_max3_f32 v249, v72, v73, v74
v_max3_f32 v249, v249, v75, v76
v_max3_f32 v249, v249, v77, v78
v_max3_f32 v249, v249, v79, v80
v_max3_f32 v249, v249, v81, v82
v_max3_f32 v249, v249, v83, v84
v_max3_f32 v249, v249, v85, v86
v_max_f32 v249, v249, v87
v_mov_b32 v250, v249
s_nop 0
s_nop 0
v_permlane32_swap_b32 v249, v250
v_max_f32 v249, v249, v250
v_sub_f32 v108, 0, v249
v_sub_f32 v109, 0, v249
v_sub_f32 v110, 0, v249
v_sub_f32 v111, 0, v249
v_sub_f32 v112, 0, v249
v_sub_f32 v113, 0, v249
v_sub_f32 v114, 0, v249
v_sub_f32 v115, 0, v249
v_sub_f32 v116, 0, v249
v_sub_f32 v117, 0, v249
v_sub_f32 v118, 0, v249
v_sub_f32 v119, 0, v249
v_sub_f32 v120, 0, v249
v_sub_f32 v121, 0, v249
v_sub_f32 v122, 0, v249
v_sub_f32 v123, 0, v249
s_nop 1
v_mfma_f32_32x32x16_bf16 v[88:103], v[152:155], v[0:3], v[108:123]
s_waitcnt lgkmcnt(0)
v_mfma_f32_32x32x16_bf16 v[88:103], v[128:131], v[4:7], v[88:103]
ds_read_b128 v[148:151], v219 offset:12416
ds_read_b128 v[152:155], v220 offset:12416
ds_read_b128 v[128:131], v217 offset:12544
v_mov_b32 v235, v185
v_mov_b32 v237, v186
v_mov_b32 v238, v187
v_mov_b32 v239, v188
v_mfma_f32_32x32x16_bf16 v[88:103], v[132:135], v[8:11], v[88:103]
ds_read_b128 v[132:135], v218 offset:12544
v_sub_f32 v72, v72, v249
v_sub_f32 v73, v73, v249
v_sub_f32 v74, v74, v249
v_sub_f32 v75, v75, v249
v_mfma_f32_32x32x16_bf16 v[88:103], v[136:139], v[12:15], v[88:103]
ds_read_b128 v[136:139], v219 offset:12544
v_sub_f32 v76, v76, v249
v_sub_f32 v77, v77, v249
v_sub_f32 v78, v78, v249
v_sub_f32 v79, v79, v249
v_sub_f32 v80, v80, v249
v_mfma_f32_32x32x16_bf16 v[88:103], v[140:143], v[16:19], v[88:103]
ds_read_b128 v[140:143], v220 offset:12544
v_sub_f32 v81, v81, v249
v_sub_f32 v82, v82, v249
v_sub_f32 v83, v83, v249
v_sub_f32 v84, v84, v249
v_sub_f32 v85, v85, v249
v_mfma_f32_32x32x16_bf16 v[88:103], v[144:147], v[20:23], v[88:103]
s_barrier
ds_read_b64_tr_b16 v[144:145], v223 offset:0
ds_read_b64_tr_b16 v[146:147], v223 offset:3072
v_sub_f32 v86, v86, v249
v_sub_f32 v87, v87, v249
s_waitcnt lgkmcnt(3)
v_mfma_f32_32x32x16_bf16 v[88:103], v[148:151], v[24:27], v[88:103]
ds_read_b64_tr_b16 v[148:149], v224 offset:0
ds_read_b64_tr_b16 v[150:151], v224 offset:3072
v_exp_f32 v72, v72
v_exp_f32 v73, v73
v_mfma_f32_32x32x16_bf16 v[88:103], v[152:155], v[28:31], v[88:103]
ds_read_b64_tr_b16 v[152:153], v223 offset:128
ds_read_b64_tr_b16 v[154:155], v223 offset:3200
v_add_f32 v246, 0, v72
v_add_f32 v247, 0, v73
v_cvt_pk_bf16_f32 v72, v72, v73
v_max3_f32 v252, v104, v105, v106
v_mfma_f32_32x32x16_bf16 v[88:103], v[128:131], v[32:35], v[88:103]
ds_read_b64_tr_b16 v[128:129], v224 offset:128
ds_read_b64_tr_b16 v[130:131], v224 offset:3200
v_exp_f32 v74, v74
v_exp_f32 v75, v75
v_mfma_f32_32x32x16_bf16 v[88:103], v[132:135], v[36:39], v[88:103]
ds_read_b64_tr_b16 v[132:133], v223 offset:256
ds_read_b64_tr_b16 v[134:135], v223 offset:3328
v_add_f32 v246, v246, v74
v_add_f32 v247, v247, v75
v_cvt_pk_bf16_f32 v73, v74, v75
v_max_f32 v252, v252, v107
v_mfma_f32_32x32x16_bf16 v[88:103], v[136:139], v[40:43], v[88:103]
ds_read_b64_tr_b16 v[136:137], v224 offset:256
ds_read_b64_tr_b16 v[138:139], v224 offset:3328
v_exp_f32 v76, v76
v_exp_f32 v77, v77
s_waitcnt lgkmcnt(4)
v_mfma_f32_32x32x16_bf16 v[88:103], v[140:143], v[44:47], v[88:103]
ds_read_b64_tr_b16 v[140:141], v223 offset:6144
ds_read_b64_tr_b16 v[142:143], v223 offset:9216
v_add_f32 v246, v246, v76
v_add_f32 v247, v247, v77
v_cvt_pk_bf16_f32 v74, v76, v77
v_exp_f32 v78, v78
v_exp_f32 v79, v79
v_add_f32 v246, v246, v78
v_add_f32 v247, v247, v79
v_cvt_pk_bf16_f32 v75, v78, v79
v_exp_f32 v80, v80
v_exp_f32 v81, v81
v_add_f32 v246, v246, v80
v_add_f32 v247, v247, v81
v_cvt_pk_bf16_f32 v80, v80, v81
v_exp_f32 v82, v82
v_exp_f32 v83, v83
v_add_f32 v246, v246, v82
v_add_f32 v247, v247, v83
v_cvt_pk_bf16_f32 v81, v82, v83
v_exp_f32 v84, v84
v_exp_f32 v85, v85
v_add_f32 v246, v246, v84
v_add_f32 v247, v247, v85
v_cvt_pk_bf16_f32 v82, v84, v85
v_exp_f32 v86, v86
v_exp_f32 v87, v87
v_add_f32 v246, v246, v86
v_add_f32 v247, v247, v87
v_cvt_pk_bf16_f32 v83, v86, v87
v_mfma_f32_32x32x16_bf16 a[0:15], v[144:147], v[72:75], 0
v_max3_f32 v249, v88, v89, v90
v_max3_f32 v249, v249, v91, v92
v_max3_f32 v249, v249, v93, v94
v_max3_f32 v249, v249, v95, v96
v_max3_f32 v249, v249, v97, v98
v_max3_f32 v249, v249, v99, v100
v_max3_f32 v249, v249, v101, v102
v_max_f32 v249, v249, v103
v_cmp_lt_f32 vcc, 0x41000000, v249
s_nop 0
s_cbranch_vccnz L_fb22
L_rt22:
v_mfma_f32_32x32x16_bf16 a[16:31], v[148:151], v[72:75], 0
v_mfma_f32_32x32x16_bf16 a[32:47], v[152:155], v[72:75], 0
ds_read_b64_tr_b16 v[144:145], v224 offset:6144
ds_read_b64_tr_b16 v[146:147], v224 offset:9216
ds_read_b64_tr_b16 v[148:149], v223 offset:6272
ds_read_b64_tr_b16 v[150:151], v223 offset:9344
ds_read_b64_tr_b16 v[152:153], v224 offset:6272
ds_read_b64_tr_b16 v[154:155], v224 offset:9344
v_mfma_f32_32x32x16_bf16 a[48:63], v[128:131], v[72:75], 0
ds_read_b64_tr_b16 v[128:129], v223 offset:6400
ds_read_b64_tr_b16 v[130:131], v223 offset:9472
s_add_u32 m0, s33, 0x0
s_mov_b32 s39, 0x30c000
buffer_load_dwordx4 v208, s[4:7], s39 offen offset:0 nt lds
s_waitcnt lgkmcnt(8)
v_mfma_f32_32x32x16_bf16 a[64:79], v[132:135], v[72:75], 0
ds_read_b64_tr_b16 v[132:133], v224 offset:6400
ds_read_b64_tr_b16 v[134:135], v224 offset:9472
v_exp_f32 v88, v88
v_exp_f32 v89, v89
v_mfma_f32_32x32x16_bf16 a[80:95], v[136:139], v[72:75], 0
ds_read_b64_tr_b16 v[136:137], v223 offset:12288
ds_read_b64_tr_b16 v[138:139], v223 offset:15360
v_add_f32 v246, v246, v88
v_add_f32 v247, v247, v89
v_cvt_pk_bf16_f32 v88, v88, v89
v_mfma_f32_32x32x16_bf16 a[0:15], v[140:143], v[80:83], a[0:15]
ds_read_b64_tr_b16 v[140:141], v224 offset:12288
ds_read_b64_tr_b16 v[142:143], v224 offset:15360
v_exp_f32 v90, v90
v_exp_f32 v91, v91
s_waitcnt lgkmcnt(4)
v_mfma_f32_32x32x16_bf16 a[16:31], v[144:147], v[80:83], a[16:31]
ds_read_b64_tr_b16 v[144:145], v223 offset:12416
ds_read_b64_tr_b16 v[146:147], v223 offset:15488
buffer_load_dwordx4 v209, s[4:7], s39 offen offset:1024 nt lds
v_mfma_f32_32x32x16_bf16 a[32:47], v[148:151], v[80:83], a[32:47]
ds_read_b64_tr_b16 v[148:149], v224 offset:12416
ds_read_b64_tr_b16 v[150:151], v224 offset:15488
v_add_f32 v246, v246, v90
v_add_f32 v247, v247, v91
v_cvt_pk_bf16_f32 v89, v90, v91
v_mfma_f32_32x32x16_bf16 a[48:63], v[152:155], v[80:83], a[48:63]
ds_read_b64_tr_b16 v[152:153], v223 offset:12544
ds_read_b64_tr_b16 v[154:155], v223 offset:15616
v_exp_f32 v92, v92
v_exp_f32 v93, v93
v_mfma_f32_32x32x16_bf16 a[64:79], v[128:131], v[80:83], a[64:79]
ds_read_b64_tr_b16 v[128:129], v224 offset:12544
ds_read_b64_tr_b16 v[130:131], v224 offset:15616
v_add_f32 v246, v246, v92
v_add_f32 v247, v247, v93
v_cvt_pk_bf16_f32 v90, v92, v93
v_mfma_f32_32x32x16_bf16 a[80:95], v[132:135], v[80:83], a[80:95]
ds_read_b64_tr_b16 v[132:133], v223 offset:18432
ds_read_b64_tr_b16 v[134:135], v223 offset:21504
v_exp_f32 v94, v94
v_exp_f32 v95, v95
v_add_f32 v246, v246, v94
v_add_f32 v247, v247, v95
v_cvt_pk_bf16_f32 v91, v94, v95
s_waitcnt lgkmcnt(4)
s_nop 0
v_mfma_f32_32x32x16_bf16 a[0:15], v[136:139], v[88:91], a[0:15]
ds_read_b64_tr_b16 v[136:137], v224 offset:18432
ds_read_b64_tr_b16 v[138:139], v224 offset:21504
v_mfma_f32_32x32x16_bf16 a[16:31], v[140:143], v[88:91], a[16:31]
ds_read_b64_tr_b16 v[140:141], v223 offset:18560
ds_read_b64_tr_b16 v[142:143], v223 offset:21632
v_exp_f32 v96, v96
v_exp_f32 v97, v97
v_mfma_f32_32x32x16_bf16 a[32:47], v[144:147], v[88:91], a[32:47]
ds_read_b64_tr_b16 v[144:145], v224 offset:18560
ds_read_b64_tr_b16 v[146:147], v224 offset:21632
buffer_load_dwordx4 v210, s[4:7], s39 offen offset:2048 nt lds
v_mfma_f32_32x32x16_bf16 a[48:63], v[148:151], v[88:91], a[48:63]
ds_read_b64_tr_b16 v[148:149], v223 offset:18688
ds_read_b64_tr_b16 v[150:151], v223 offset:21760
v_add_f32 v246, v246, v96
v_add_f32 v247, v247, v97
v_cvt_pk_bf16_f32 v96, v96, v97
v_mfma_f32_32x32x16_bf16 a[64:79], v[152:155], v[88:91], a[64:79]
ds_read_b64_tr_b16 v[152:153], v224 offset:18688
ds_read_b64_tr_b16 v[154:155], v224 offset:21760
v_exp_f32 v98, v98
v_exp_f32 v99, v99
s_waitcnt lgkmcnt(6)
v_mfma_f32_32x32x16_bf16 a[80:95], v[128:131], v[88:91], a[80:95]
ds_read_b64_tr_b16 v[128:129], v225 offset:0
ds_read_b64_tr_b16 v[130:131], v226 offset:0
v_add_f32 v246, v246, v98
v_add_f32 v247, v247, v99
v_cvt_pk_bf16_f32 v97, v98, v99
v_exp_f32 v100, v100
v_exp_f32 v101, v101
v_add_f32 v246, v246, v100
v_add_f32 v247, v247, v101
v_cvt_pk_bf16_f32 v98, v100, v101
v_exp_f32 v102, v102
v_exp_f32 v103, v103
v_add_f32 v246, v246, v102
v_add_f32 v247, v247, v103
v_cvt_pk_bf16_f32 v99, v102, v103
s_nop 1
v_mfma_f32_32x32x16_bf16 a[0:15], v[132:135], v[96:99], a[0:15]
v_mfma_f32_32x32x16_bf16 a[16:31], v[136:139], v[96:99], a[16:31]
ds_read_b64_tr_b16 v[132:133], v227 offset:0
ds_read_b64_tr_b16 v[134:135], v228 offset:0
ds_read_b64_tr_b16 v[136:137], v225 offset:128
ds_read_b64_tr_b16 v[138:139], v226 offset:128
v_mov_b32 v255, v252
s_nop 0
s_nop 0
v_permlane32_swap_b32 v252, v255
v_max_f32 v252, v252, v255
v_mov_b32 v255, v252
s_nop 0
s_nop 0
v_permlane16_swap_b32 v252, v255
v_max_f32 v252, v252, v255
v_mfma_f32_32x32x16_bf16 a[32:47], v[140:143], v[96:99], a[32:47]
s_waitcnt lgkmcnt(4)
v_mfma_f32_32x32x16_bf16 a[48:63], v[144:147], v[96:99], a[48:63]
ds_read_b64_tr_b16 v[140:141], v227 offset:128
ds_read_b64_tr_b16 v[142:143], v228 offset:128
ds_read_b64_tr_b16 v[144:145], v225 offset:256
ds_read_b64_tr_b16 v[146:147], v226 offset:256
buffer_load_dwordx4 v211, s[4:7], s39 offen offset:3072 nt lds
v_mfma_f32_32x32x16_bf16 a[64:79], v[148:151], v[96:99], a[64:79]
ds_read_b64_tr_b16 v[148:149], v227 offset:256
ds_read_b64_tr_b16 v[150:151], v228 offset:256
v_sub_f32 v124, 0, v252
v_sub_f32 v125, 0, v252
v_sub_f32 v126, 0, v252
v_sub_f32 v127, 0, v252
v_mfma_f32_32x32x16_bf16 a[80:95], v[152:155], v[96:99], a[80:95]
s_waitcnt vmcnt(8)
s_barrier
ds_read_b128 v[152:155], v217 offset:24576
v_sub_f32 v104, v104, v252
v_sub_f32 v105, v105, v252
v_sub_f32 v106, v106, v252
v_sub_f32 v107, v107, v252
v_exp_f32 v104, v104
v_exp_f32 v105, v105
v_add_f32 v248, 0, v104
v_add_f32 v248, v248, v105
v_cvt_pk_bf16_f32 v104, v104, v105
v_exp_f32 v106, v106
v_exp_f32 v107, v107
v_add_f32 v248, v248, v106
v_add_f32 v248, v248, v107
v_cvt_pk_bf16_f32 v105, v106, v107
s_nop 1
v_mfma_f32_16x16x16_bf16 a[96:99], v[128:129], v[104:105], 0
v_mfma_f32_16x16x16_bf16 a[100:103], v[130:131], v[104:105], 0
s_waitcnt lgkmcnt(0)
v_mfma_f32_16x16x16_bf16 a[104:107], v[132:133], v[104:105], 0
v_mfma_f32_16x16x16_bf16 a[108:111], v[134:135], v[104:105], 0
ds_read_b128 v[128:131], v218 offset:24576
ds_read_b128 v[132:135], v219 offset:24576
v_mfma_f32_16x16x16_bf16 a[112:115], v[136:137], v[104:105], 0
v_mfma_f32_16x16x16_bf16 a[116:119], v[138:139], v[104:105], 0
ds_read_b128 v[136:139], v220 offset:24576
s_add_u32 m0, s33, 0x1000
s_nop 0
buffer_load_dwordx4 v212, s[4:7], s39 offen offset:0 nt lds
v_mfma_f32_16x16x16_bf16 a[120:123], v[140:141], v[104:105], 0
v_mfma_f32_16x16x16_bf16 a[124:127], v[142:143], v[104:105], 0
ds_read_b128 v[140:143], v217 offset:24704
v_mfma_f32_16x16x16_bf16 a[128:131], v[144:145], v[104:105], 0
v_mfma_f32_16x16x16_bf16 a[132:135], v[146:147], v[104:105], 0
ds_read_b128 v[144:147], v218 offset:24704
v_mfma_f32_16x16x16_bf16 a[136:139], v[148:149], v[104:105], 0
buffer_load_dwordx4 v213, s[4:7], s39 offen offset:1024 nt lds
v_mfma_f32_16x16x16_bf16 a[140:143], v[150:151], v[104:105], 0
ds_read_b128 v[148:151], v219 offset:24704
v_mfma_f32_32x32x16_bf16 v[72:87], v[152:155], v[0:3], v[108:123]
ds_read_b128 v[152:155], v220 offset:24704
s_waitcnt lgkmcnt(4)
v_mfma_f32_32x32x16_bf16 v[72:87], v[128:131], v[4:7], v[72:87]
ds_read_b128 v[128:131], v217 offset:24832
v_mov_b32 v253, 0x1
s_mov_b64 exec, s[44:45]
buffer_atomic_add v253, off, s[28:31], 0 sc1
s_mov_b64 exec, -1
v_mfma_f32_32x32x16_bf16 v[72:87], v[132:135], v[8:11], v[72:87]
ds_read_b128 v[132:135], v218 offset:24832
s_add_u32 m0, s36, 0x22800
s_add_u32 s38, s48, 0x14000
buffer_load_dwordx4 v229, s[20:23], s38 offen offset:0 lds
v_mfma_f32_32x32x16_bf16 v[72:87], v[136:139], v[12:15], v[72:87]
ds_read_b128 v[136:139], v219 offset:24832
buffer_load_dwordx4 v230, s[20:23], s38 offen offset:1024 lds
s_waitcnt lgkmcnt(3)
v_mfma_f32_32x32x16_bf16 v[72:87], v[140:143], v[16:19], v[72:87]
ds_read_b128 v[140:143], v220 offset:24832
buffer_load_dwordx4 v231, s[20:23], s38 offen offset:2048 lds
v_mfma_f32_32x32x16_bf16 v[72:87], v[144:147], v[20:23], v[72:87]
ds_read_b128 v[144:147], v221 offset:24576
v_mfma_f32_32x32x16_bf16 v[72:87], v[148:151], v[24:27], v[72:87]
ds_read_b128 v[148:151], v222 offset:24576
buffer_load_dwordx4 v232, s[20:23], s38 offen offset:3072 lds
v_mfma_f32_32x32x16_bf16 v[72:87], v[152:155], v[28:31], v[72:87]
ds_read_b128 v[152:155], v221 offset:24704
s_add_u32 m0, s36, 0x23800
s_nop 0
buffer_load_dwordx4 v233, s[20:23], s38 offen offset:0 lds
s_waitcnt lgkmcnt(3)
v_mfma_f32_32x32x16_bf16 v[72:87], v[128:131], v[32:35], v[72:87]
ds_read_b128 v[128:131], v222 offset:24704
s_add_u32 m0, s33, 0xc000
s_mov_b32 s39, 0x30c000
buffer_load_dwordx4 v214, s[8:11], s39 offen offset:0 nt lds
v_mfma_f32_32x32x16_bf16 v[72:87], v[132:135], v[36:39], v[72:87]
ds_read_b128 v[132:135], v221 offset:24832
buffer_load_dwordx4 v215, s[8:11], s39 offen offset:1024 nt lds
v_mfma_f32_32x32x16_bf16 v[72:87], v[136:139], v[40:43], v[72:87]
ds_read_b128 v[136:139], v222 offset:24832
v_mfma_f32_32x32x16_bf16 v[72:87], v[140:143], v[44:47], v[72:87]
ds_read_b128 v[140:143], v217 offset:36864
buffer_load_dwordx4 v216, s[8:11], s39 offen offset:2048 nt lds
s_waitcnt lgkmcnt(3)
v_mfma_f32_16x16x32_bf16 v[104:107], v[144:147], v[48:51], v[124:127]
ds_read_b128 v[144:147], v218 offset:36864
s_nop 2
v_max3_f32 v249, v72, v73, v74
v_mfma_f32_16x16x32_bf16 v[104:107], v[148:151], v[52:55], v[104:107]
ds_read_b128 v[148:151], v219 offset:36864
v_max3_f32 v249, v249, v75, v76
v_mfma_f32_16x16x32_bf16 v[104:107], v[152:155], v[56:59], v[104:107]
ds_read_b128 v[152:155], v220 offset:36864
s_add_u32 m0, s33, 0xcc00
s_add_u32 s39, s39, 0xc00
buffer_load_dwordx4 v214, s[8:11], s39 offen offset:0 nt lds
v_mfma_f32_16x16x32_bf16 v[104:107], v[128:131], v[60:63], v[104:107]
buffer_load_dwordx4 v215, s[8:11], s39 offen offset:1024 nt lds
s_waitcnt lgkmcnt(3)
v_mfma_f32_16x16x32_bf16 v[104:107], v[132:135], v[64:67], v[104:107]
buffer_load_dwordx4 v216, s[8:11], s39 offen offset:2048 nt lds
v_mfma_f32_16x16x32_bf16 v[104:107], v[136:139], v[68:71], v[104:107]
v_max3_f32 v249, v249, v77, v78
v_max3_f32 v249, v249, v79, v80
v_max3_f32 v249, v249, v81, v82
v_max3_f32 v249, v249, v83, v84
v_max3_f32 v249, v249, v85, v86
v_max_f32 v249, v249, v87
v_cmp_lt_f32 vcc, 0x41000000, v249
s_nop 0
s_cbranch_vccnz L_fb23
L_rt23:
v_mfma_f32_32x32x16_bf16 v[88:103], v[140:143], v[0:3], v[108:123]
ds_read_b128 v[128:131], v217 offset:36992
s_waitcnt lgkmcnt(1)
v_mfma_f32_32x32x16_bf16 v[88:103], v[144:147], v[4:7], v[88:103]
ds_read_b128 v[132:135], v218 offset:36992
ds_read_b128 v[136:139], v219 offset:36992
ds_read_b128 v[140:143], v220 offset:36992
ds_read_b128 v[144:147], v217 offset:37120
v_max3_f32 v252, v104, v105, v106
v_mfma_f32_32x32x16_bf16 v[88:103], v[148:151], v[8:11], v[88:103]
ds_read_b128 v[148:151], v218 offset:37120
v_exp_f32 v72, v72
v_exp_f32 v73, v73
v_max_f32 v252, v252, v107
v_mfma_f32_32x32x16_bf16 v[88:103], v[152:155], v[12:15], v[88:103]
ds_read_b128 v[152:155], v219 offset:37120
v_add_f32 v246, v246, v72
v_add_f32 v247, v247, v73
v_cvt_pk_bf16_f32 v72, v72, v73
v_exp_f32 v74, v74
v_exp_f32 v75, v75
s_waitcnt lgkmcnt(2)
v_mfma_f32_32x32x16_bf16 v[88:103], v[128:131], v[16:19], v[88:103]
ds_read_b128 v[128:131], v220 offset:37120
v_add_f32 v246, v246, v74
v_add_f32 v247, v247, v75
v_cvt_pk_bf16_f32 v73, v74, v75
v_mfma_f32_32x32x16_bf16 v[88:103], v[132:135], v[20:23], v[88:103]
s_barrier
ds_read_b64_tr_b16 v[132:133], v223 offset:24576
ds_read_b64_tr_b16 v[134:135], v223 offset:27648
v_exp_f32 v76, v76
v_exp_f32 v77, v77
v_mfma_f32_32x32x16_bf16 v[88:103], v[136:139], v[24:27], v[88:103]
ds_read_b64_tr_b16 v[136:137], v224 offset:24576
ds_read_b64_tr_b16 v[138:139], v224 offset:27648
v_cmp_lt_f32 vcc, 0x41000000, v252
s_nop 0
s_cbranch_vccnz L_fb24
L_rt24:
v_mfma_f32_32x32x16_bf16 v[88:103], v[140:143], v[28:31], v[88:103]
ds_read_b64_tr_b16 v[140:141], v223 offset:24704
ds_read_b64_tr_b16 v[142:143], v223 offset:27776
v_add_f32 v246, v246, v76
v_add_f32 v247, v247, v77
v_cvt_pk_bf16_f32 v74, v76, v77
v_mfma_f32_32x32x16_bf16 v[88:103], v[144:147], v[32:35], v[88:103]
ds_read_b64_tr_b16 v[144:145], v224 offset:24704
ds_read_b64_tr_b16 v[146:147], v224 offset:27776
v_exp_f32 v78, v78
v_exp_f32 v79, v79
s_waitcnt lgkmcnt(5)
v_mfma_f32_32x32x16_bf16 v[88:103], v[148:151], v[36:39], v[88:103]
ds_read_b64_tr_b16 v[148:149], v223 offset:24832
ds_read_b64_tr_b16 v[150:151], v223 offset:27904
v_add_f32 v246, v246, v78
v_add_f32 v247, v247, v79
v_cvt_pk_bf16_f32 v75, v78, v79
v_mfma_f32_32x32x16_bf16 v[88:103], v[152:155], v[40:43], v[88:103]
ds_read_b64_tr_b16 v[152:153], v224 offset:24832
ds_read_b64_tr_b16 v[154:155], v224 offset:27904
v_exp_f32 v80, v80
v_exp_f32 v81, v81
v_mfma_f32_32x32x16_bf16 v[88:103], v[128:131], v[44:47], v[88:103]
ds_read_b64_tr_b16 v[128:129], v223 offset:30720
ds_read_b64_tr_b16 v[130:131], v223 offset:33792
v_add_f32 v246, v246, v80
v_add_f32 v247, v247, v81
v_cvt_pk_bf16_f32 v80, v80, v81
v_exp_f32 v82, v82
v_exp_f32 v83, v83
v_add_f32 v246, v246, v82
v_add_f32 v247, v247, v83
v_cvt_pk_bf16_f32 v81, v82, v83
v_exp_f32 v84, v84
v_exp_f32 v85, v85
v_add_f32 v246, v246, v84
v_add_f32 v247, v247, v85
v_cvt_pk_bf16_f32 v82, v84, v85
v_exp_f32 v86, v86
v_exp_f32 v87, v87
v_add_f32 v246, v246, v86
v_add_f32 v247, v247, v87
v_cvt_pk_bf16_f32 v83, v86, v87
v_mfma_f32_32x32x16_bf16 a[0:15], v[132:135], v[72:75], a[0:15]
v_max3_f32 v249, v88, v89, v90
v_max3_f32 v249, v249, v91, v92
v_max3_f32 v249, v249, v93, v94
v_max3_f32 v249, v249, v95, v96
v_max3_f32 v249, v249, v97, v98
v_max3_f32 v249, v249, v99, v100
v_max3_f32 v249, v249, v101, v102
v_max_f32 v249, v249, v103
v_cmp_lt_f32 vcc, 0x41000000, v249
s_nop 0
s_cbranch_vccnz L_fb25
L_rt25:
s_waitcnt lgkmcnt(0)
v_mfma_f32_32x32x16_bf16 a[16:31], v[136:139], v[72:75], a[16:31]
v_mfma_f32_32x32x16_bf16 a[32:47], v[140:143], v[72:75], a[32:47]
ds_read_b64_tr_b16 v[132:133], v224 offset:30720
ds_read_b64_tr_b16 v[134:135], v224 offset:33792
ds_read_b64_tr_b16 v[136:137], v223 offset:30848
ds_read_b64_tr_b16 v[138:139], v223 offset:33920
ds_read_b64_tr_b16 v[140:141], v224 offset:30848
ds_read_b64_tr_b16 v[142:143], v224 offset:33920
v_mfma_f32_32x32x16_bf16 a[48:63], v[144:147], v[72:75], a[48:63]
ds_read_b64_tr_b16 v[144:145], v223 offset:30976
ds_read_b64_tr_b16 v[146:147], v223 offset:34048
s_add_u32 s59, s52, 0x0
buffer_load_dwordx4 v[156:159], v243, s[24:27], s59 offen offset:0 sc1
v_mfma_f32_32x32x16_bf16 a[64:79], v[148:151], v[72:75], a[64:79]
ds_read_b64_tr_b16 v[148:149], v224 offset:30976
ds_read_b64_tr_b16 v[150:151], v224 offset:34048
buffer_load_dwordx4 v[160:163], v243, s[24:27], s59 offen offset:1024 sc1
v_exp_f32 v88, v88
v_exp_f32 v89, v89
v_mfma_f32_32x32x16_bf16 a[80:95], v[152:155], v[72:75], a[80:95]
ds_read_b64_tr_b16 v[152:153], v223 offset:36864
ds_read_b64_tr_b16 v[154:155], v223 offset:39936
v_mfma_f32_32x32x16_bf16 a[0:15], v[128:131], v[80:83], a[0:15]
ds_read_b64_tr_b16 v[128:129], v224 offset:36864
ds_read_b64_tr_b16 v[130:131], v224 offset:39936
v_add_f32 v246, v246, v88
v_add_f32 v247, v247, v89
v_cvt_pk_bf16_f32 v88, v88, v89
s_waitcnt lgkmcnt(6)
v_mfma_f32_32x32x16_bf16 a[16:31], v[132:135], v[80:83], a[16:31]
ds_read_b64_tr_b16 v[132:133], v223 offset:36992
ds_read_b64_tr_b16 v[134:135], v223 offset:40064
buffer_load_dwordx4 v[164:167], v243, s[24:27], s59 offen offset:2048 sc1
v_exp_f32 v90, v90
v_exp_f32 v91, v91
v_mfma_f32_32x32x16_bf16 a[32:47], v[136:139], v[80:83], a[32:47]
ds_read_b64_tr_b16 v[136:137], v224 offset:36992
ds_read_b64_tr_b16 v[138:139], v224 offset:40064
v_mfma_f32_32x32x16_bf16 a[48:63], v[140:143], v[80:83], a[48:63]
ds_read_b64_tr_b16 v[140:141], v223 offset:37120
ds_read_b64_tr_b16 v[142:143], v223 offset:40192
v_add_f32 v246, v246, v90
v_add_f32 v247, v247, v91
v_cvt_pk_bf16_f32 v89, v90, v91
v_mfma_f32_32x32x16_bf16 a[64:79], v[144:147], v[80:83], a[64:79]
ds_read_b64_tr_b16 v[144:145], v224 offset:37120
ds_read_b64_tr_b16 v[146:147], v224 offset:40192
v_exp_f32 v92, v92
v_exp_f32 v93, v93
s_waitcnt lgkmcnt(6)
v_mfma_f32_32x32x16_bf16 a[80:95], v[148:151], v[80:83], a[80:95]
ds_read_b64_tr_b16 v[148:149], v223 offset:43008
ds_read_b64_tr_b16 v[150:151], v223 offset:46080
v_add_f32 v246, v246, v92
v_add_f32 v247, v247, v93
v_cvt_pk_bf16_f32 v90, v92, v93
v_exp_f32 v94, v94
v_exp_f32 v95, v95
v_add_f32 v246, v246, v94
v_add_f32 v247, v247, v95
v_cvt_pk_bf16_f32 v91, v94, v95
s_nop 1
v_mfma_f32_32x32x16_bf16 a[0:15], v[152:155], v[88:91], a[0:15]
v_mfma_f32_32x32x16_bf16 a[16:31], v[128:131], v[88:91], a[16:31]
ds_read_b64_tr_b16 v[152:153], v224 offset:43008
ds_read_b64_tr_b16 v[154:155], v224 offset:46080
ds_read_b64_tr_b16 v[128:129], v223 offset:43136
ds_read_b64_tr_b16 v[130:131], v223 offset:46208
buffer_load_dwordx4 v[168:171], v243, s[24:27], s59 offen offset:3072 sc1
v_mfma_f32_32x32x16_bf16 a[32:47], v[132:135], v[88:91], a[32:47]
ds_read_b64_tr_b16 v[132:133], v224 offset:43136
ds_read_b64_tr_b16 v[134:135], v224 offset:46208
s_add_u32 s59, s52, 0x0
buffer_load_dwordx4 v[172:175], v244, s[24:27], s59 offen offset:0 sc1
s_waitcnt lgkmcnt(6)
v_mfma_f32_32x32x16_bf16 a[48:63], v[136:139], v[88:91], a[48:63]
ds_read_b64_tr_b16 v[136:137], v223 offset:43264
ds_read_b64_tr_b16 v[138:139], v223 offset:46336
v_exp_f32 v96, v96
v_exp_f32 v97, v97
v_mfma_f32_32x32x16_bf16 a[64:79], v[140:143], v[88:91], a[64:79]
ds_read_b64_tr_b16 v[140:141], v224 offset:43264
ds_read_b64_tr_b16 v[142:143], v224 offset:46336
v_add_f32 v246, v246, v96
v_add_f32 v247, v247, v97
v_cvt_pk_bf16_f32 v96, v96, v97
v_mfma_f32_32x32x16_bf16 a[80:95], v[144:147], v[88:91], a[80:95]
ds_read_b64_tr_b16 v[144:145], v225 offset:24576
ds_read_b64_tr_b16 v[146:147], v226 offset:24576
v_exp_f32 v98, v98
v_exp_f32 v99, v99
v_add_f32 v246, v246, v98
v_add_f32 v247, v247, v99
v_cvt_pk_bf16_f32 v97, v98, v99
v_exp_f32 v100, v100
v_exp_f32 v101, v101
v_add_f32 v246, v246, v100
v_add_f32 v247, v247, v101
v_cvt_pk_bf16_f32 v98, v100, v101
v_exp_f32 v102, v102
v_exp_f32 v103, v103
v_add_f32 v246, v246, v102
v_add_f32 v247, v247, v103
v_cvt_pk_bf16_f32 v99, v102, v103
s_nop 1
v_mfma_f32_32x32x16_bf16 a[0:15], v[148:151], v[96:99], a[0:15]
s_waitcnt lgkmcnt(0)
v_mfma_f32_32x32x16_bf16 a[16:31], v[152:155], v[96:99], a[16:31]
ds_read_b64_tr_b16 v[148:149], v227 offset:24576
ds_read_b64_tr_b16 v[150:151], v228 offset:24576
ds_read_b64_tr_b16 v[152:153], v225 offset:24704
ds_read_b64_tr_b16 v[154:155], v226 offset:24704
buffer_load_dwordx4 v[176:179], v244, s[24:27], s59 offen offset:1024 sc1
v_mfma_f32_32x32x16_bf16 a[32:47], v[128:131], v[96:99], a[32:47]
ds_read_b64_tr_b16 v[128:129], v227 offset:24704
ds_read_b64_tr_b16 v[130:131], v228 offset:24704
v_exp_f32 v104, v104
v_exp_f32 v105, v105
v_mfma_f32_32x32x16_bf16 a[48:63], v[132:135], v[96:99], a[48:63]
ds_read_b64_tr_b16 v[132:133], v225 offset:24832
ds_read_b64_tr_b16 v[134:135], v226 offset:24832
s_add_u32 m0, s33, 0x6000
s_mov_b32 s39, 0x312000
buffer_load_dwordx4 v208, s[4:7], s39 offen offset:0 nt lds
v_mfma_f32_32x32x16_bf16 a[64:79], v[136:139], v[96:99], a[64:79]
ds_read_b64_tr_b16 v[136:137], v227 offset:24832
ds_read_b64_tr_b16 v[138:139], v228 offset:24832
v_add_f32 v248, v248, v104
v_add_f32 v248, v248, v105
v_cvt_pk_bf16_f32 v104, v104, v105
v_mfma_f32_32x32x16_bf16 a[80:95], v[140:143], v[96:99], a[80:95]
s_waitcnt vmcnt(19)
s_barrier
ds_read_b128 v[140:143], v217 offset:0
v_exp_f32 v106, v106
v_exp_f32 v107, v107
v_add_f32 v248, v248, v106
v_add_f32 v248, v248, v107
v_cvt_pk_bf16_f32 v105, v106, v107
s_nop 1
v_mfma_f32_16x16x16_bf16 a[96:99], v[144:145], v[104:105], a[96:99]
v_mfma_f32_16x16x16_bf16 a[100:103], v[146:147], v[104:105], a[100:103]
s_waitcnt lgkmcnt(1)
v_mfma_f32_16x16x16_bf16 a[104:107], v[148:149], v[104:105], a[104:107]
ds_read_b128 v[144:147], v218 offset:0
buffer_load_dwordx4 v209, s[4:7], s39 offen offset:1024 nt lds
v_mfma_f32_16x16x16_bf16 a[108:111], v[150:151], v[104:105], a[108:111]
ds_read_b128 v[148:151], v219 offset:0
v_mfma_f32_16x16x16_bf16 a[112:115], v[152:153], v[104:105], a[112:115]
buffer_load_dwordx4 v210, s[4:7], s39 offen offset:2048 nt lds
v_mfma_f32_16x16x16_bf16 a[116:119], v[154:155], v[104:105], a[116:119]
ds_read_b128 v[152:155], v220 offset:0
v_mfma_f32_16x16x16_bf16 a[120:123], v[128:129], v[104:105], a[120:123]
v_mfma_f32_16x16x16_bf16 a[124:127], v[130:131], v[104:105], a[124:127]
ds_read_b128 v[128:131], v217 offset:128
v_mfma_f32_16x16x16_bf16 a[128:131], v[132:133], v[104:105], a[128:131]
buffer_load_dwordx4 v211, s[4:7], s39 offen offset:3072 nt lds
v_mfma_f32_16x16x16_bf16 a[132:135], v[134:135], v[104:105], a[132:135]
ds_read_b128 v[132:135], v218 offset:128
v_mfma_f32_16x16x16_bf16 a[136:139], v[136:137], v[104:105], a[136:139]
s_add_u32 m0, s33, 0x7000
s_nop 0
buffer_load_dwordx4 v212, s[4:7], s39 offen offset:0 nt lds
buffer_load_dwordx4 v213, s[4:7], s39 offen offset:1024 nt lds
v_mfma_f32_16x16x16_bf16 a[140:143], v[138:139], v[104:105], a[140:143]
s_waitcnt lgkmcnt(2)
v_mfma_f32_32x32x16_bf16 v[72:87], v[140:143], v[0:3], v[108:123]
ds_read_b128 v[136:139], v219 offset:128
ds_read_b128 v[140:143], v220 offset:128
v_mfma_f32_32x32x16_bf16 v[72:87], v[144:147], v[4:7], v[72:87]
ds_read_b128 v[144:147], v217 offset:256
s_add_u32 s59, s52, 0x1000
buffer_load_dwordx4 v[180:183], v243, s[24:27], s59 offen offset:0 sc1
v_mfma_f32_32x32x16_bf16 v[72:87], v[148:151], v[8:11], v[72:87]
ds_read_b128 v[148:151], v218 offset:256
buffer_load_dwordx4 v[184:187], v243, s[24:27], s59 offen offset:1024 sc1
v_mfma_f32_32x32x16_bf16 v[72:87], v[152:155], v[12:15], v[72:87]
ds_read_b128 v[152:155], v219 offset:256
buffer_load_dwordx4 v[188:191], v243, s[24:27], s59 offen offset:2048 sc1
s_waitcnt lgkmcnt(4)
v_mfma_f32_32x32x16_bf16 v[72:87], v[128:131], v[16:19], v[72:87]
ds_read_b128 v[128:131], v220 offset:256
buffer_load_dwordx4 v[192:195], v243, s[24:27], s59 offen offset:3072 sc1
v_mfma_f32_32x32x16_bf16 v[72:87], v[132:135], v[20:23], v[72:87]
ds_read_b128 v[132:135], v221 offset:0
v_mfma_f32_32x32x16_bf16 v[72:87], v[136:139], v[24:27], v[72:87]
ds_read_b128 v[136:139], v222 offset:0
s_add_u32 s59, s52, 0x800
buffer_load_dwordx4 v[196:199], v244, s[24:27], s59 offen offset:0 sc1
s_waitcnt lgkmcnt(3)
v_mfma_f32_32x32x16_bf16 v[72:87], v[140:143], v[28:31], v[72:87]
ds_read_b128 v[140:143], v221 offset:128
buffer_load_dwordx4 v[200:203], v244, s[24:27], s59 offen offset:1024 sc1
v_mfma_f32_32x32x16_bf16 v[72:87], v[144:147], v[32:35], v[72:87]
ds_read_b128 v[144:147], v222 offset:128
s_add_u32 m0, s33, 0x12000
s_mov_b32 s39, 0x312000
buffer_load_dwordx4 v214, s[8:11], s39 offen offset:0 nt lds
v_mfma_f32_32x32x16_bf16 v[72:87], v[148:151], v[36:39], v[72:87]
ds_read_b128 v[148:151], v221 offset:256
buffer_load_dwordx4 v215, s[8:11], s39 offen offset:1024 nt lds
v_mfma_f32_32x32x16_bf16 v[72:87], v[152:155], v[40:43], v[72:87]
ds_read_b128 v[152:155], v222 offset:256
s_waitcnt lgkmcnt(3)
v_mfma_f32_32x32x16_bf16 v[72:87], v[128:131], v[44:47], v[72:87]
ds_read_b128 v[128:131], v217 offset:12288
buffer_load_dwordx4 v216, s[8:11], s39 offen offset:2048 nt lds
v_mfma_f32_16x16x32_bf16 v[104:107], v[132:135], v[48:51], v[124:127]
ds_read_b128 v[132:135], v218 offset:12288
s_nop 2
v_max3_f32 v249, v72, v73, v74
v_mfma_f32_16x16x32_bf16 v[104:107], v[136:139], v[52:55], v[104:107]
ds_read_b128 v[136:139], v219 offset:12288
v_max3_f32 v249, v249, v75, v76
v_mfma_f32_16x16x32_bf16 v[104:107], v[140:143], v[56:59], v[104:107]
ds_read_b128 v[140:143], v220 offset:12288
s_add_u32 m0, s33, 0x12c00
s_add_u32 s39, s39, 0xc00
buffer_load_dwordx4 v214, s[8:11], s39 offen offset:0 nt lds
s_waitcnt lgkmcnt(4)
v_mfma_f32_16x16x32_bf16 v[104:107], v[144:147], v[60:63], v[104:107]
buffer_load_dwordx4 v215, s[8:11], s39 offen offset:1024 nt lds
v_mfma_f32_16x16x32_bf16 v[104:107], v[148:151], v[64:67], v[104:107]
buffer_load_dwordx4 v216, s[8:11], s39 offen offset:2048 nt lds
v_mfma_f32_16x16x32_bf16 v[104:107], v[152:155], v[68:71], v[104:107]
v_max3_f32 v249, v249, v77, v78
v_max3_f32 v249, v249, v79, v80
v_max3_f32 v249, v249, v81, v82
v_max3_f32 v249, v249, v83, v84
v_max3_f32 v249, v249, v85, v86
v_max_f32 v249, v249, v87
v_cmp_lt_f32 vcc, 0x41000000, v249
s_nop 0
s_cbranch_vccnz L_fb26
L_rt26:
s_waitcnt lgkmcnt(0)
v_mfma_f32_32x32x16_bf16 v[88:103], v[128:131], v[0:3], v[108:123]
ds_read_b128 v[144:147], v217 offset:12416
v_mfma_f32_32x32x16_bf16 v[88:103], v[132:135], v[4:7], v[88:103]
ds_read_b128 v[148:151], v218 offset:12416
ds_read_b128 v[152:155], v219 offset:12416
ds_read_b128 v[128:131], v220 offset:12416
ds_read_b128 v[132:135], v217 offset:12544
v_max3_f32 v252, v104, v105, v106
v_mfma_f32_32x32x16_bf16 v[88:103], v[136:139], v[8:11], v[88:103]
ds_read_b128 v[136:139], v218 offset:12544
v_exp_f32 v72, v72
v_exp_f32 v73, v73
v_max_f32 v252, v252, v107
v_mfma_f32_32x32x16_bf16 v[88:103], v[140:143], v[12:15], v[88:103]
ds_read_b128 v[140:143], v219 offset:12544
v_add_f32 v246, v246, v72
v_add_f32 v247, v247, v73
v_cvt_pk_bf16_f32 v72, v72, v73
v_exp_f32 v74, v74
v_exp_f32 v75, v75
s_waitcnt lgkmcnt(2)
v_mfma_f32_32x32x16_bf16 v[88:103], v[144:147], v[16:19], v[88:103]
ds_read_b128 v[144:147], v220 offset:12544
v_add_f32 v246, v246, v74
v_add_f32 v247, v247, v75
v_cvt_pk_bf16_f32 v73, v74, v75
v_mfma_f32_32x32x16_bf16 v[88:103], v[148:151], v[20:23], v[88:103]
s_waitcnt vmcnt(24)
s_barrier
ds_read_b64_tr_b16 v[148:149], v223 offset:0
ds_read_b64_tr_b16 v[150:151], v223 offset:3072
v_exp_f32 v76, v76
v_exp_f32 v77, v77
v_mfma_f32_32x32x16_bf16 v[88:103], v[152:155], v[24:27], v[88:103]
ds_read_b64_tr_b16 v[152:153], v224 offset:0
ds_read_b64_tr_b16 v[154:155], v224 offset:3072
v_cmp_lt_f32 vcc, 0x41000000, v252
s_nop 0
s_cbranch_vccnz L_fb27
L_rt27:
v_mfma_f32_32x32x16_bf16 v[88:103], v[128:131], v[28:31], v[88:103]
ds_read_b64_tr_b16 v[128:129], v223 offset:128
ds_read_b64_tr_b16 v[130:131], v223 offset:3200
v_add_f32 v246, v246, v76
v_add_f32 v247, v247, v77
v_cvt_pk_bf16_f32 v74, v76, v77
v_mfma_f32_32x32x16_bf16 v[88:103], v[132:135], v[32:35], v[88:103]
ds_read_b64_tr_b16 v[132:133], v224 offset:128
ds_read_b64_tr_b16 v[134:135], v224 offset:3200
v_exp_f32 v78, v78
v_exp_f32 v79, v79
s_waitcnt lgkmcnt(5)
v_mfma_f32_32x32x16_bf16 v[88:103], v[136:139], v[36:39], v[88:103]
ds_read_b64_tr_b16 v[136:137], v223 offset:256
ds_read_b64_tr_b16 v[138:139], v223 offset:3328
v_add_f32 v246, v246, v78
v_add_f32 v247, v247, v79
v_cvt_pk_bf16_f32 v75, v78, v79
v_mfma_f32_32x32x16_bf16 v[88:103], v[140:143], v[40:43], v[88:103]
ds_read_b64_tr_b16 v[140:141], v224 offset:256
ds_read_b64_tr_b16 v[142:143], v224 offset:3328
v_exp_f32 v80, v80
v_exp_f32 v81, v81
v_mfma_f32_32x32x16_bf16 v[88:103], v[144:147], v[44:47], v[88:103]
ds_read_b64_tr_b16 v[144:145], v223 offset:6144
ds_read_b64_tr_b16 v[146:147], v223 offset:9216
v_add_f32 v246, v246, v80
v_add_f32 v247, v247, v81
v_cvt_pk_bf16_f32 v80, v80, v81
v_exp_f32 v82, v82
v_exp_f32 v83, v83
v_add_f32 v246, v246, v82
v_add_f32 v247, v247, v83
v_cvt_pk_bf16_f32 v81, v82, v83
v_exp_f32 v84, v84
v_exp_f32 v85, v85
v_add_f32 v246, v246, v84
v_add_f32 v247, v247, v85
v_cvt_pk_bf16_f32 v82, v84, v85
v_exp_f32 v86, v86
v_exp_f32 v87, v87
v_add_f32 v246, v246, v86
v_add_f32 v247, v247, v87
v_cvt_pk_bf16_f32 v83, v86, v87
v_mfma_f32_32x32x16_bf16 a[0:15], v[148:151], v[72:75], a[0:15]
v_max3_f32 v249, v88, v89, v90
v_max3_f32 v249, v249, v91, v92
v_max3_f32 v249, v249, v93, v94
v_max3_f32 v249, v249, v95, v96
v_max3_f32 v249, v249, v97, v98
v_max3_f32 v249, v249, v99, v100
v_max3_f32 v249, v249, v101, v102
v_max_f32 v249, v249, v103
v_cmp_lt_f32 vcc, 0x41000000, v249
s_nop 0
s_cbranch_vccnz L_fb28
L_rt28:
s_waitcnt lgkmcnt(0)
v_mfma_f32_32x32x16_bf16 a[16:31], v[152:155], v[72:75], a[16:31]
v_mfma_f32_32x32x16_bf16 a[32:47], v[128:131], v[72:75], a[32:47]
ds_read_b64_tr_b16 v[148:149], v224 offset:6144
ds_read_b64_tr_b16 v[150:151], v224 offset:9216
ds_read_b64_tr_b16 v[152:153], v223 offset:6272
ds_read_b64_tr_b16 v[154:155], v223 offset:9344
ds_read_b64_tr_b16 v[128:129], v224 offset:6272
ds_read_b64_tr_b16 v[130:131], v224 offset:9344
v_mfma_f32_32x32x16_bf16 a[48:63], v[132:135], v[72:75], a[48:63]
ds_read_b64_tr_b16 v[132:133], v223 offset:6400
ds_read_b64_tr_b16 v[134:135], v223 offset:9472
s_add_u32 m0, s36, 0x18000
s_add_u32 s38, s48, 0x28000
buffer_load_dwordx4 v229, s[20:23], s38 offen offset:0 lds
v_mfma_f32_32x32x16_bf16 a[64:79], v[136:139], v[72:75], a[64:79]
ds_read_b64_tr_b16 v[136:137], v224 offset:6400
ds_read_b64_tr_b16 v[138:139], v224 offset:9472
v_exp_f32 v88, v88
v_exp_f32 v89, v89
v_mfma_f32_32x32x16_bf16 a[80:95], v[140:143], v[72:75], a[80:95]
ds_read_b64_tr_b16 v[140:141], v235 offset:21504
ds_read_b64_tr_b16 v[142:143], v235 offset:24064
v_add_f32 v246, v246, v88
v_add_f32 v247, v247, v89
v_cvt_pk_bf16_f32 v88, v88, v89
v_mfma_f32_32x32x16_bf16 a[0:15], v[144:147], v[80:83], a[0:15]
ds_read_b64_tr_b16 v[144:145], v235 offset:21568
ds_read_b64_tr_b16 v[146:147], v235 offset:24128
v_exp_f32 v90, v90
v_exp_f32 v91, v91
s_waitcnt lgkmcnt(4)
v_mfma_f32_32x32x16_bf16 a[16:31], v[148:151], v[80:83], a[16:31]
ds_read_b64_tr_b16 v[148:149], v235 offset:21632
ds_read_b64_tr_b16 v[150:151], v235 offset:24192
buffer_load_dwordx4 v230, s[20:23], s38 offen offset:1024 lds
v_mfma_f32_32x32x16_bf16 a[32:47], v[152:155], v[80:83], a[32:47]
ds_read_b64_tr_b16 v[152:153], v237 offset:21504
ds_read_b64_tr_b16 v[154:155], v237 offset:26624
v_add_f32 v246, v246, v90
v_add_f32 v247, v247, v91
v_cvt_pk_bf16_f32 v89, v90, v91
v_mfma_f32_32x32x16_bf16 a[48:63], v[128:131], v[80:83], a[48:63]
ds_read_b64_tr_b16 v[128:129], v235 offset:21696
ds_read_b64_tr_b16 v[130:131], v235 offset:24256
v_exp_f32 v92, v92
v_exp_f32 v93, v93
v_mfma_f32_32x32x16_bf16 a[64:79], v[132:135], v[80:83], a[64:79]
ds_read_b64_tr_b16 v[132:133], v235 offset:21760
ds_read_b64_tr_b16 v[134:135], v235 offset:24320
v_add_f32 v246, v246, v92
v_add_f32 v247, v247, v93
v_cvt_pk_bf16_f32 v90, v92, v93
v_mfma_f32_32x32x16_bf16 a[80:95], v[136:139], v[80:83], a[80:95]
ds_read_b64_tr_b16 v[136:137], v235 offset:26624
ds_read_b64_tr_b16 v[138:139], v235 offset:29184
v_exp_f32 v94, v94
v_exp_f32 v95, v95
s_waitcnt lgkmcnt(4)
s_waitcnt vmcnt(25)
v_mfma_f32_32x32x16_bf16 a[144:159], v[140:143], v[156:159], 0
ds_read_b64_tr_b16 v[140:141], v238 offset:21504
ds_read_b64_tr_b16 v[142:143], v238 offset:26624
v_add_f32 v246, v246, v94
v_add_f32 v247, v247, v95
v_cvt_pk_bf16_f32 v91, v94, v95
v_mfma_f32_32x32x16_bf16 a[160:175], v[144:147], v[156:159], 0
ds_read_b64_tr_b16 v[144:145], v235 offset:26688
ds_read_b64_tr_b16 v[146:147], v235 offset:29248
v_exp_f32 v96, v96
v_exp_f32 v97, v97
v_mfma_f32_32x32x16_bf16 a[176:191], v[148:151], v[156:159], 0
ds_read_b64_tr_b16 v[148:149], v235 offset:26752
ds_read_b64_tr_b16 v[150:151], v235 offset:29312
buffer_load_dwordx4 v231, s[20:23], s38 offen offset:2048 lds
s_waitcnt vmcnt(22)
v_mfma_f32_16x16x32_bf16 a[240:243], v[152:155], v[172:175], 0
ds_read_b64_tr_b16 v[152:153], v235 offset:26816
ds_read_b64_tr_b16 v[154:155], v235 offset:29376
v_mfma_f32_32x32x16_bf16 a[192:207], v[128:131], v[156:159], 0
ds_read_b64_tr_b16 v[128:129], v239 offset:21504
ds_read_b64_tr_b16 v[130:131], v239 offset:26624
v_add_f32 v246, v246, v96
v_add_f32 v247, v247, v97
v_cvt_pk_bf16_f32 v96, v96, v97
s_waitcnt lgkmcnt(6)
v_mfma_f32_32x32x16_bf16 a[208:223], v[132:135], v[156:159], 0
ds_read_b64_tr_b16 v[132:133], v235 offset:26880
ds_read_b64_tr_b16 v[134:135], v235 offset:29440
v_exp_f32 v98, v98
v_exp_f32 v99, v99
v_mfma_f32_32x32x16_bf16 a[144:159], v[136:139], v[160:163], a[144:159]
ds_read_b64_tr_b16 v[136:137], v235 offset:31744
ds_read_b64_tr_b16 v[138:139], v235 offset:34304
v_add_f32 v246, v246, v98
v_add_f32 v247, v247, v99
v_cvt_pk_bf16_f32 v97, v98, v99
v_mfma_f32_16x16x32_bf16 a[244:247], v[140:143], v[172:175], 0
ds_read_b64_tr_b16 v[140:141], v235 offset:31808
ds_read_b64_tr_b16 v[142:143], v235 offset:34368
v_mfma_f32_32x32x16_bf16 a[160:175], v[144:147], v[160:163], a[160:175]
ds_read_b64_tr_b16 v[144:145], v237 offset:31744
ds_read_b64_tr_b16 v[146:147], v237 offset:36864
buffer_load_dwordx4 v232, s[20:23], s38 offen offset:3072 lds
v_exp_f32 v100, v100
v_exp_f32 v101, v101
s_waitcnt lgkmcnt(6)
v_mfma_f32_32x32x16_bf16 a[176:191], v[148:151], v[160:163], a[176:191]
ds_read_b64_tr_b16 v[148:149], v235 offset:31872
ds_read_b64_tr_b16 v[150:151], v235 offset:34432
v_mfma_f32_32x32x16_bf16 a[192:207], v[152:155], v[160:163], a[192:207]
ds_read_b64_tr_b16 v[152:153], v235 offset:31936
ds_read_b64_tr_b16 v[154:155], v235 offset:34496
v_add_f32 v246, v246, v100
v_add_f32 v247, v247, v101
v_cvt_pk_bf16_f32 v98, v100, v101
v_mfma_f32_16x16x32_bf16 a[248:251], v[128:131], v[172:175], 0
ds_read_b64_tr_b16 v[128:129], v235 offset:32000
ds_read_b64_tr_b16 v[130:131], v235 offset:34560
v_mfma_f32_32x32x16_bf16 a[208:223], v[132:135], v[160:163], a[208:223]
ds_read_b64_tr_b16 v[132:133], v238 offset:31744
ds_read_b64_tr_b16 v[134:135], v238 offset:36864
v_exp_f32 v102, v102
v_exp_f32 v103, v103
s_waitcnt lgkmcnt(6)
v_mfma_f32_32x32x16_bf16 a[144:159], v[136:139], v[164:167], a[144:159]
ds_read_b64_tr_b16 v[136:137], v235 offset:36864
ds_read_b64_tr_b16 v[138:139], v235 offset:39424
v_add_f32 v246, v246, v102
v_add_f32 v247, v247, v103
v_cvt_pk_bf16_f32 v99, v102, v103
v_mfma_f32_32x32x16_bf16 a[160:175], v[140:143], v[164:167], a[160:175]
ds_read_b64_tr_b16 v[140:141], v235 offset:36928
ds_read_b64_tr_b16 v[142:143], v235 offset:39488
v_exp_f32 v104, v104
v_exp_f32 v105, v105
s_waitcnt vmcnt(22)
v_mfma_f32_16x16x32_bf16 a[240:243], v[144:147], v[176:179], a[240:243]
ds_read_b64_tr_b16 v[144:145], v235 offset:36992
ds_read_b64_tr_b16 v[146:147], v235 offset:39552
v_mfma_f32_32x32x16_bf16 a[176:191], v[148:151], v[164:167], a[176:191]
ds_read_b64_tr_b16 v[148:149], v239 offset:31744
ds_read_b64_tr_b16 v[150:151], v239 offset:36864
s_add_u32 m0, s36, 0x19000
s_nop 0
buffer_load_dwordx4 v233, s[20:23], s38 offen offset:0 lds
s_waitcnt lgkmcnt(6)
v_mfma_f32_32x32x16_bf16 a[192:207], v[152:155], v[164:167], a[192:207]
ds_read_b64_tr_b16 v[152:153], v235 offset:37056
ds_read_b64_tr_b16 v[154:155], v235 offset:39616
v_add_f32 v248, v248, v104
v_add_f32 v248, v248, v105
v_cvt_pk_bf16_f32 v104, v104, v105
v_mfma_f32_32x32x16_bf16 a[208:223], v[128:131], v[164:167], a[208:223]
ds_read_b64_tr_b16 v[128:129], v235 offset:37120
ds_read_b64_tr_b16 v[130:131], v235 offset:39680
v_exp_f32 v106, v106
v_exp_f32 v107, v107
v_mfma_f32_16x16x32_bf16 a[244:247], v[132:135], v[176:179], a[244:247]
ds_read_b64_tr_b16 v[132:133], v223 offset:12288
ds_read_b64_tr_b16 v[134:135], v223 offset:15360
v_mfma_f32_32x32x16_bf16 a[144:159], v[136:139], v[168:171], a[144:159]
ds_read_b64_tr_b16 v[136:137], v224 offset:12288
ds_read_b64_tr_b16 v[138:139], v224 offset:15360
v_add_f32 v248, v248, v106
v_add_f32 v248, v248, v107
v_cvt_pk_bf16_f32 v105, v106, v107
s_waitcnt lgkmcnt(6)
v_mfma_f32_32x32x16_bf16 a[160:175], v[140:143], v[168:171], a[160:175]
ds_read_b64_tr_b16 v[140:141], v223 offset:12416
ds_read_b64_tr_b16 v[142:143], v223 offset:15488
s_add_u32 m0, s33, 0x0
s_mov_b32 s39, 0x318000
buffer_load_dwordx4 v208, s[4:7], s39 offen offset:0 nt lds
v_mfma_f32_32x32x16_bf16 a[176:191], v[144:147], v[168:171], a[176:191]
ds_read_b64_tr_b16 v[144:145], v224 offset:12416
ds_read_b64_tr_b16 v[146:147], v224 offset:15488
v_mfma_f32_16x16x32_bf16 a[248:251], v[148:151], v[176:179], a[248:251]
ds_read_b64_tr_b16 v[148:149], v223 offset:12544
ds_read_b64_tr_b16 v[150:151], v223 offset:15616
v_mfma_f32_32x32x16_bf16 a[192:207], v[152:155], v[168:171], a[192:207]
ds_read_b64_tr_b16 v[152:153], v224 offset:12544
ds_read_b64_tr_b16 v[154:155], v224 offset:15616
s_waitcnt lgkmcnt(8)
v_mfma_f32_32x32x16_bf16 a[208:223], v[128:131], v[168:171], a[208:223]
ds_read_b64_tr_b16 v[128:129], v223 offset:18432
ds_read_b64_tr_b16 v[130:131], v223 offset:21504
v_mfma_f32_32x32x16_bf16 a[0:15], v[132:135], v[88:91], a[0:15]
ds_read_b64_tr_b16 v[132:133], v224 offset:18432
ds_read_b64_tr_b16 v[134:135], v224 offset:21504
v_mfma_f32_32x32x16_bf16 a[16:31], v[136:139], v[88:91], a[16:31]
ds_read_b64_tr_b16 v[136:137], v223 offset:18560
ds_read_b64_tr_b16 v[138:139], v223 offset:21632
s_waitcnt lgkmcnt(8)
v_mfma_f32_32x32x16_bf16 a[32:47], v[140:143], v[88:91], a[32:47]
ds_read_b64_tr_b16 v[140:141], v224 offset:18560
ds_read_b64_tr_b16 v[142:143], v224 offset:21632
buffer_load_dwordx4 v209, s[4:7], s39 offen offset:1024 nt lds
v_mfma_f32_32x32x16_bf16 a[48:63], v[144:147], v[88:91], a[48:63]
ds_read_b64_tr_b16 v[144:145], v223 offset:18688
ds_read_b64_tr_b16 v[146:147], v223 offset:21760
v_mfma_f32_32x32x16_bf16 a[64:79], v[148:151], v[88:91], a[64:79]
ds_read_b64_tr_b16 v[148:149], v224 offset:18688
ds_read_b64_tr_b16 v[150:151], v224 offset:21760
s_waitcnt lgkmcnt(8)
v_mfma_f32_32x32x16_bf16 a[80:95], v[152:155], v[88:91], a[80:95]
ds_read_b64_tr_b16 v[152:153], v225 offset:0
ds_read_b64_tr_b16 v[154:155], v226 offset:0
v_mfma_f32_32x32x16_bf16 a[0:15], v[128:131], v[96:99], a[0:15]
ds_read_b64_tr_b16 v[128:129], v227 offset:0
ds_read_b64_tr_b16 v[130:131], v228 offset:0
v_mfma_f32_32x32x16_bf16 a[16:31], v[132:135], v[96:99], a[16:31]
ds_read_b64_tr_b16 v[132:133], v225 offset:128
ds_read_b64_tr_b16 v[134:135], v226 offset:128
s_waitcnt lgkmcnt(8)
v_mfma_f32_32x32x16_bf16 a[32:47], v[136:139], v[96:99], a[32:47]
ds_read_b64_tr_b16 v[136:137], v227 offset:128
ds_read_b64_tr_b16 v[138:139], v228 offset:128
buffer_load_dwordx4 v210, s[4:7], s39 offen offset:2048 nt lds
v_mfma_f32_32x32x16_bf16 a[48:63], v[140:143], v[96:99], a[48:63]
ds_read_b64_tr_b16 v[140:141], v225 offset:256
ds_read_b64_tr_b16 v[142:143], v226 offset:256
v_mfma_f32_32x32x16_bf16 a[64:79], v[144:147], v[96:99], a[64:79]
ds_read_b64_tr_b16 v[144:145], v227 offset:256
ds_read_b64_tr_b16 v[146:147], v228 offset:256
s_waitcnt lgkmcnt(8)
v_mfma_f32_32x32x16_bf16 a[80:95], v[148:151], v[96:99], a[80:95]
s_waitcnt vmcnt(20)
s_barrier
ds_read_b128 v[148:151], v217 offset:24576
v_mfma_f32_16x16x16_bf16 a[96:99], v[152:153], v[104:105], a[96:99]
v_mfma_f32_16x16x16_bf16 a[100:103], v[154:155], v[104:105], a[100:103]
ds_read_b128 v[152:155], v218 offset:24576
v_mfma_f32_16x16x16_bf16 a[104:107], v[128:129], v[104:105], a[104:107]
v_mfma_f32_16x16x16_bf16 a[108:111], v[130:131], v[104:105], a[108:111]
ds_read_b128 v[128:131], v219 offset:24576
s_waitcnt lgkmcnt(5)
v_mfma_f32_16x16x16_bf16 a[112:115], v[132:133], v[104:105], a[112:115]
buffer_load_dwordx4 v211, s[4:7], s39 offen offset:3072 nt lds
v_mfma_f32_16x16x16_bf16 a[116:119], v[134:135], v[104:105], a[116:119]
ds_read_b128 v[132:135], v220 offset:24576
v_mfma_f32_16x16x16_bf16 a[120:123], v[136:137], v[104:105], a[120:123]
v_mfma_f32_16x16x16_bf16 a[124:127], v[138:139], v[104:105], a[124:127]
ds_read_b128 v[136:139], v217 offset:24704
v_mfma_f32_16x16x16_bf16 a[128:131], v[140:141], v[104:105], a[128:131]
v_mfma_f32_16x16x16_bf16 a[132:135], v[142:143], v[104:105], a[132:135]
ds_read_b128 v[140:143], v218 offset:24704
s_waitcnt lgkmcnt(4)
v_mfma_f32_16x16x16_bf16 a[136:139], v[144:145], v[104:105], a[136:139]
s_add_u32 m0, s33, 0x1000
s_nop 0
buffer_load_dwordx4 v212, s[4:7], s39 offen offset:0 nt lds
buffer_load_dwordx4 v213, s[4:7], s39 offen offset:1024 nt lds
v_mfma_f32_16x16x16_bf16 a[140:143], v[146:147], v[104:105], a[140:143]
v_mfma_f32_32x32x16_bf16 v[72:87], v[148:151], v[0:3], v[108:123]
ds_read_b128 v[144:147], v219 offset:24704
ds_read_b128 v[148:151], v220 offset:24704
v_mfma_f32_32x32x16_bf16 v[72:87], v[152:155], v[4:7], v[72:87]
ds_read_b128 v[152:155], v217 offset:24832
s_add_u32 s59, s52, 0x2000
buffer_load_dwordx4 v[204:207], v243, s[24:27], s59 offen offset:0 sc1
s_waitcnt lgkmcnt(3)
v_mfma_f32_32x32x16_bf16 v[72:87], v[128:131], v[8:11], v[72:87]
ds_read_b128 v[128:131], v218 offset:24832
v_mfma_f32_32x32x16_bf16 v[72:87], v[132:135], v[12:15], v[72:87]
ds_read_b128 v[132:135], v219 offset:24832
buffer_load_dwordx4 a[224:227], v243, s[24:27], s59 offen offset:1024 sc1
v_mfma_f32_32x32x16_bf16 v[72:87], v[136:139], v[16:19], v[72:87]
ds_read_b128 v[136:139], v220 offset:24832
v_mfma_f32_32x32x16_bf16 v[72:87], v[140:143], v[20:23], v[72:87]
ds_read_b64_tr_b16 v[140:141], v235 offset:43008
ds_read_b64_tr_b16 v[142:143], v235 offset:45568
s_waitcnt lgkmcnt(5)
v_mfma_f32_32x32x16_bf16 v[72:87], v[144:147], v[24:27], v[72:87]
ds_read_b64_tr_b16 v[144:145], v235 offset:43072
ds_read_b64_tr_b16 v[146:147], v235 offset:45632
buffer_load_dwordx4 a[228:231], v243, s[24:27], s59 offen offset:2048 sc1
v_mfma_f32_32x32x16_bf16 v[72:87], v[148:151], v[28:31], v[72:87]
ds_read_b64_tr_b16 v[148:149], v235 offset:43136
ds_read_b64_tr_b16 v[150:151], v235 offset:45696
v_mfma_f32_32x32x16_bf16 v[72:87], v[152:155], v[32:35], v[72:87]
ds_read_b128 v[152:155], v217 offset:36864
buffer_load_dwordx4 a[232:235], v243, s[24:27], s59 offen offset:3072 sc1
s_waitcnt lgkmcnt(6)
v_mfma_f32_32x32x16_bf16 v[72:87], v[128:131], v[36:39], v[72:87]
ds_read_b128 v[128:131], v218 offset:36864
v_mfma_f32_32x32x16_bf16 v[72:87], v[132:135], v[40:43], v[72:87]
ds_read_b128 v[132:135], v219 offset:36864
v_mfma_f32_32x32x16_bf16 v[72:87], v[136:139], v[44:47], v[72:87]
ds_read_b128 v[136:139], v220 offset:36864
s_add_u32 s59, s52, 0x1000
buffer_load_dwordx4 a[236:239], v244, s[24:27], s59 offen offset:0 sc1
s_waitcnt lgkmcnt(4)
s_waitcnt vmcnt(27)
v_mfma_f32_32x32x16_bf16 a[144:159], v[140:143], v[180:183], a[144:159]
ds_read_b128 v[140:143], v217 offset:36992
s_nop 2
v_max3_f32 v249, v72, v73, v74
v_max3_f32 v249, v249, v75, v76
v_max3_f32 v249, v249, v77, v78
v_max3_f32 v249, v249, v79, v80
v_max3_f32 v249, v249, v81, v82
v_mfma_f32_32x32x16_bf16 a[160:175], v[144:147], v[180:183], a[160:175]
ds_read_b128 v[144:147], v218 offset:36992
v_max3_f32 v249, v249, v83, v84
v_max3_f32 v249, v249, v85, v86
v_max_f32 v249, v249, v87
v_cmp_lt_f32 vcc, 0x41000000, v249
s_nop 0
s_cbranch_vccnz L_fb29
L_rt29:
v_mfma_f32_32x32x16_bf16 a[176:191], v[148:151], v[180:183], a[176:191]
ds_read_b128 v[148:151], v219 offset:36992
buffer_load_dwordx4 a[252:255], v244, s[24:27], s59 offen offset:1024 sc1
v_exp_f32 v72, v72
v_exp_f32 v73, v73
s_waitcnt lgkmcnt(2)
v_mfma_f32_32x32x16_bf16 v[88:103], v[152:155], v[0:3], v[108:123]
ds_read_b128 v[152:155], v220 offset:36992
v_add_f32 v246, v246, v72
v_add_f32 v247, v247, v73
v_cvt_pk_bf16_f32 v72, v72, v73
v_mfma_f32_32x32x16_bf16 v[88:103], v[128:131], v[4:7], v[88:103]
ds_read_b128 v[128:131], v217 offset:37120
s_add_u32 m0, s33, 0xc000
s_mov_b32 s39, 0x318000
buffer_load_dwordx4 v214, s[8:11], s39 offen offset:0 nt lds
v_mfma_f32_32x32x16_bf16 v[88:103], v[132:135], v[8:11], v[88:103]
ds_read_b128 v[132:135], v218 offset:37120
v_exp_f32 v74, v74
v_exp_f32 v75, v75
v_mfma_f32_32x32x16_bf16 v[88:103], v[136:139], v[12:15], v[88:103]
ds_read_b128 v[136:139], v219 offset:37120
v_add_f32 v246, v246, v74
v_add_f32 v247, v247, v75
v_cvt_pk_bf16_f32 v73, v74, v75
v_exp_f32 v76, v76
v_exp_f32 v77, v77
v_mfma_f32_32x32x16_bf16 v[88:103], v[140:143], v[16:19], v[88:103]
ds_read_b128 v[140:143], v220 offset:37120
buffer_load_dwordx4 v215, s[8:11], s39 offen offset:1024 nt lds
s_waitcnt lgkmcnt(2)
v_mfma_f32_32x32x16_bf16 v[88:103], v[144:147], v[20:23], v[88:103]
ds_read_b128 v[144:147], v221 offset:24576
v_add_f32 v246, v246, v76
v_add_f32 v247, v247, v77
v_cvt_pk_bf16_f32 v74, v76, v77
v_exp_f32 v78, v78
v_exp_f32 v79, v79
v_mfma_f32_32x32x16_bf16 v[88:103], v[148:151], v[24:27], v[88:103]
ds_read_b64_tr_b16 v[148:149], v237 offset:43008
ds_read_b64_tr_b16 v[150:151], v237 offset:48128
buffer_load_dwordx4 v216, s[8:11], s39 offen offset:2048 nt lds
v_mfma_f32_32x32x16_bf16 v[88:103], v[152:155], v[28:31], v[88:103]
ds_read_b128 v[152:155], v222 offset:24576
v_add_f32 v246, v246, v78
v_add_f32 v247, v247, v79
v_cvt_pk_bf16_f32 v75, v78, v79
v_exp_f32 v80, v80
v_exp_f32 v81, v81
v_mfma_f32_32x32x16_bf16 v[88:103], v[128:131], v[32:35], v[88:103]
ds_read_b64_tr_b16 v[128:129], v235 offset:43200
ds_read_b64_tr_b16 v[130:131], v235 offset:45760
v_mfma_f32_32x32x16_bf16 v[88:103], v[132:135], v[36:39], v[88:103]
ds_read_b128 v[132:135], v221 offset:24704
s_add_u32 m0, s33, 0xcc00
s_add_u32 s39, s39, 0xc00
buffer_load_dwordx4 v214, s[8:11], s39 offen offset:0 nt lds
s_waitcnt lgkmcnt(4)
v_mfma_f32_32x32x16_bf16 v[88:103], v[136:139], v[40:43], v[88:103]
ds_read_b64_tr_b16 v[136:137], v235 offset:43264
ds_read_b64_tr_b16 v[138:139], v235 offset:45824
v_add_f32 v246, v246, v80
v_add_f32 v247, v247, v81
v_cvt_pk_bf16_f32 v80, v80, v81
v_mfma_f32_32x32x16_bf16 v[88:103], v[140:143], v[44:47], v[88:103]
ds_read_b128 v[140:143], v222 offset:24704
buffer_load_dwordx4 v215, s[8:11], s39 offen offset:1024 nt lds
v_exp_f32 v82, v82
v_exp_f32 v83, v83
v_mfma_f32_16x16x32_bf16 v[104:107], v[144:147], v[48:51], v[124:127]
ds_read_b64_tr_b16 v[144:145], v235 offset:48128
ds_read_b64_tr_b16 v[146:147], v235 offset:50688
s_waitcnt vmcnt(29)
v_mfma_f32_16x16x32_bf16 a[240:243], v[148:151], v[196:199], a[240:243]
ds_read_b128 v[148:151], v221 offset:24832
s_waitcnt lgkmcnt(4)
v_mfma_f32_16x16x32_bf16 v[104:107], v[152:155], v[52:55], v[104:107]
ds_read_b64_tr_b16 v[152:153], v238 offset:43008
ds_read_b64_tr_b16 v[154:155], v238 offset:48128
v_mfma_f32_32x32x16_bf16 a[192:207], v[128:131], v[180:183], a[192:207]
ds_read_b128 v[128:131], v222 offset:24832
buffer_load_dwordx4 v216, s[8:11], s39 offen offset:2048 nt lds
v_add_f32 v246, v246, v82
v_add_f32 v247, v247, v83
v_cvt_pk_bf16_f32 v81, v82, v83
v_mfma_f32_16x16x32_bf16 v[104:107], v[132:135], v[56:59], v[104:107]
ds_read_b64_tr_b16 v[132:133], v235 offset:48192
ds_read_b64_tr_b16 v[134:135], v235 offset:50752
v_mfma_f32_32x32x16_bf16 a[208:223], v[136:139], v[180:183], a[208:223]
ds_read_b64_tr_b16 v[136:137], v235 offset:48256
ds_read_b64_tr_b16 v[138:139], v235 offset:50816
v_exp_f32 v84, v84
v_exp_f32 v85, v85
s_waitcnt lgkmcnt(5)
v_mfma_f32_16x16x32_bf16 v[104:107], v[140:143], v[60:63], v[104:107]
ds_read_b64_tr_b16 v[140:141], v235 offset:48320
ds_read_b64_tr_b16 v[142:143], v235 offset:50880
v_mfma_f32_32x32x16_bf16 a[144:159], v[144:147], v[184:187], a[144:159]
ds_read_b64_tr_b16 v[144:145], v239 offset:43008
ds_read_b64_tr_b16 v[146:147], v239 offset:48128
v_add_f32 v246, v246, v84
v_add_f32 v247, v247, v85
v_cvt_pk_bf16_f32 v82, v84, v85
v_mfma_f32_16x16x32_bf16 v[104:107], v[148:151], v[64:67], v[104:107]
ds_read_b64_tr_b16 v[148:149], v235 offset:48384
ds_read_b64_tr_b16 v[150:151], v235 offset:50944
v_mfma_f32_16x16x32_bf16 a[244:247], v[152:155], v[196:199], a[244:247]
ds_read_b64_tr_b16 v[152:153], v235 offset:53248
ds_read_b64_tr_b16 v[154:155], v235 offset:55808
s_waitcnt lgkmcnt(8)
v_mfma_f32_16x16x32_bf16 v[104:107], v[128:131], v[68:71], v[104:107]
ds_read_b64_tr_b16 v[128:129], v235 offset:53312
ds_read_b64_tr_b16 v[130:131], v235 offset:55872
v_mfma_f32_32x32x16_bf16 a[160:175], v[132:135], v[184:187], a[160:175]
ds_read_b64_tr_b16 v[132:133], v237 offset:53248
ds_read_b64_tr_b16 v[134:135], v237 offset:58368
v_exp_f32 v86, v86
v_exp_f32 v87, v87
v_mfma_f32_32x32x16_bf16 a[176:191], v[136:139], v[184:187], a[176:191]
ds_read_b64_tr_b16 v[136:137], v235 offset:53376
ds_read_b64_tr_b16 v[138:139], v235 offset:55936
v_add_f32 v246, v246, v86
v_add_f32 v247, v247, v87
v_cvt_pk_bf16_f32 v83, v86, v87
v_max3_f32 v249, v88, v89, v90
s_waitcnt lgkmcnt(6)
v_mfma_f32_32x32x16_bf16 a[192:207], v[140:143], v[184:187], a[192:207]
ds_read_b64_tr_b16 v[140:141], v235 offset:53440
ds_read_b64_tr_b16 v[142:143], v235 offset:56000
v_max3_f32 v249, v249, v91, v92
v_max3_f32 v249, v249, v93, v94
v_max3_f32 v249, v249, v95, v96
v_max3_f32 v249, v249, v97, v98
v_mfma_f32_16x16x32_bf16 a[248:251], v[144:147], v[196:199], a[248:251]
ds_read_b64_tr_b16 v[144:145], v235 offset:53504
ds_read_b64_tr_b16 v[146:147], v235 offset:56064
v_mfma_f32_32x32x16_bf16 a[208:223], v[148:151], v[184:187], a[208:223]
ds_read_b64_tr_b16 v[148:149], v238 offset:53248
ds_read_b64_tr_b16 v[150:151], v238 offset:58368
v_max3_f32 v249, v249, v99, v100
v_max3_f32 v249, v249, v101, v102
v_max_f32 v249, v249, v103
v_max3_f32 v252, v104, v105, v106
v_mfma_f32_32x32x16_bf16 a[144:159], v[152:155], v[188:191], a[144:159]
ds_read_b64_tr_b16 v[152:153], v235 offset:58368
ds_read_b64_tr_b16 v[154:155], v235 offset:60928
v_cmp_lt_f32 vcc, 0x41000000, v249
s_nop 0
s_cbranch_vccnz L_fb31
L_rt31:
v_exp_f32 v88, v88
v_exp_f32 v89, v89
s_waitcnt lgkmcnt(4)
v_mfma_f32_32x32x16_bf16 a[160:175], v[128:131], v[188:191], a[160:175]
ds_read_b64_tr_b16 v[128:129], v235 offset:58432
ds_read_b64_tr_b16 v[130:131], v235 offset:60992
v_max_f32 v252, v252, v107
s_waitcnt vmcnt(29)
v_mfma_f32_16x16x32_bf16 a[240:243], v[132:135], v[200:203], a[240:243]
ds_read_b64_tr_b16 v[132:133], v235 offset:58496
ds_read_b64_tr_b16 v[134:135], v235 offset:61056
v_mfma_f32_32x32x16_bf16 a[176:191], v[136:139], v[188:191], a[176:191]
ds_read_b64_tr_b16 v[136:137], v239 offset:53248
ds_read_b64_tr_b16 v[138:139], v239 offset:58368
v_add_f32 v246, v246, v88
v_add_f32 v247, v247, v89
v_cvt_pk_bf16_f32 v88, v88, v89
v_mfma_f32_32x32x16_bf16 a[192:207], v[140:143], v[188:191], a[192:207]
ds_read_b64_tr_b16 v[140:141], v235 offset:58560
ds_read_b64_tr_b16 v[142:143], v235 offset:61120
v_exp_f32 v90, v90
v_exp_f32 v91, v91
v_mfma_f32_32x32x16_bf16 a[208:223], v[144:147], v[188:191], a[208:223]
ds_read_b64_tr_b16 v[144:145], v235 offset:58624
ds_read_b64_tr_b16 v[146:147], v235 offset:61184
s_waitcnt vmcnt(23)
s_barrier
v_cmp_lt_f32 vcc, 0x41000000, v252
s_nop 0
s_cbranch_vccnz L_fb30
L_rt30:
s_waitcnt lgkmcnt(4)
v_mfma_f32_16x16x32_bf16 a[244:247], v[148:151], v[200:203], a[244:247]
ds_read_b64_tr_b16 v[148:149], v223 offset:24576
ds_read_b64_tr_b16 v[150:151], v223 offset:27648
v_mfma_f32_32x32x16_bf16 a[144:159], v[152:155], v[192:195], a[144:159]
ds_read_b64_tr_b16 v[152:153], v224 offset:24576
ds_read_b64_tr_b16 v[154:155], v224 offset:27648
v_add_f32 v246, v246, v90
v_add_f32 v247, v247, v91
v_cvt_pk_bf16_f32 v89, v90, v91
v_mfma_f32_32x32x16_bf16 a[160:175], v[128:131], v[192:195], a[160:175]
ds_read_b64_tr_b16 v[128:129], v223 offset:24704
ds_read_b64_tr_b16 v[130:131], v223 offset:27776
v_exp_f32 v92, v92
v_exp_f32 v93, v93
v_mfma_f32_32x32x16_bf16 a[176:191], v[132:135], v[192:195], a[176:191]
ds_read_b64_tr_b16 v[132:133], v224 offset:24704
ds_read_b64_tr_b16 v[134:135], v224 offset:27776
v_add_f32 v246, v246, v92
v_add_f32 v247, v247, v93
v_cvt_pk_bf16_f32 v90, v92, v93
v_mfma_f32_16x16x32_bf16 a[248:251], v[136:139], v[200:203], a[248:251]
ds_read_b64_tr_b16 v[136:137], v223 offset:24832
ds_read_b64_tr_b16 v[138:139], v223 offset:27904
s_waitcnt lgkmcnt(6)
v_mfma_f32_32x32x16_bf16 a[192:207], v[140:143], v[192:195], a[192:207]
ds_read_b64_tr_b16 v[140:141], v224 offset:24832
ds_read_b64_tr_b16 v[142:143], v224 offset:27904
v_exp_f32 v94, v94
v_exp_f32 v95, v95
v_mfma_f32_32x32x16_bf16 a[208:223], v[144:147], v[192:195], a[208:223]
ds_read_b64_tr_b16 v[144:145], v223 offset:30720
ds_read_b64_tr_b16 v[146:147], v223 offset:33792
v_add_f32 v246, v246, v94
v_add_f32 v247, v247, v95
v_cvt_pk_bf16_f32 v91, v94, v95
v_mfma_f32_32x32x16_bf16 a[0:15], v[148:151], v[72:75], a[0:15]
ds_read_b64_tr_b16 v[148:149], v224 offset:30720
ds_read_b64_tr_b16 v[150:151], v224 offset:33792
v_exp_f32 v96, v96
v_exp_f32 v97, v97
v_mfma_f32_32x32x16_bf16 a[16:31], v[152:155], v[72:75], a[16:31]
ds_read_b64_tr_b16 v[152:153], v223 offset:30848
ds_read_b64_tr_b16 v[154:155], v223 offset:33920
buffer_load_dword v253, off, s[28:31], 0 sc1
s_waitcnt lgkmcnt(6)
v_mfma_f32_32x32x16_bf16 a[32:47], v[128:131], v[72:75], a[32:47]
ds_read_b64_tr_b16 v[128:129], v224 offset:30848
ds_read_b64_tr_b16 v[130:131], v224 offset:33920
v_add_f32 v246, v246, v96
v_add_f32 v247, v247, v97
v_cvt_pk_bf16_f32 v96, v96, v97
v_mfma_f32_32x32x16_bf16 a[48:63], v[132:135], v[72:75], a[48:63]
ds_read_b64_tr_b16 v[132:133], v223 offset:30976
ds_read_b64_tr_b16 v[134:135], v223 offset:34048
v_exp_f32 v98, v98
v_exp_f32 v99, v99
v_mfma_f32_32x32x16_bf16 a[64:79], v[136:139], v[72:75], a[64:79]
ds_read_b64_tr_b16 v[136:137], v224 offset:30976
ds_read_b64_tr_b16 v[138:139], v224 offset:34048
s_add_u32 m0, s36, 0x1d400
s_add_u32 s38, s49, 0x0
buffer_load_dwordx4 v229, s[20:23], s38 offen offset:0 lds
v_mfma_f32_32x32x16_bf16 a[80:95], v[140:143], v[72:75], a[80:95]
ds_read_b64_tr_b16 v[140:141], v223 offset:36864
ds_read_b64_tr_b16 v[142:143], v223 offset:39936
v_add_f32 v246, v246, v98
v_add_f32 v247, v247, v99
v_cvt_pk_bf16_f32 v97, v98, v99
s_waitcnt lgkmcnt(4)
v_mfma_f32_32x32x16_bf16 a[0:15], v[144:147], v[80:83], a[0:15]
ds_read_b64_tr_b16 v[144:145], v224 offset:36864
ds_read_b64_tr_b16 v[146:147], v224 offset:39936
v_exp_f32 v100, v100
v_exp_f32 v101, v101
v_mfma_f32_32x32x16_bf16 a[16:31], v[148:151], v[80:83], a[16:31]
ds_read_b64_tr_b16 v[148:149], v223 offset:36992
ds_read_b64_tr_b16 v[150:151], v223 offset:40064
buffer_load_dwordx4 v230, s[20:23], s38 offen offset:1024 lds
v_mfma_f32_32x32x16_bf16 a[32:47], v[152:155], v[80:83], a[32:47]
ds_read_b64_tr_b16 v[152:153], v224 offset:36992
ds_read_b64_tr_b16 v[154:155], v224 offset:40064
v_add_f32 v246, v246, v100
v_add_f32 v247, v247, v101
v_cvt_pk_bf16_f32 v98, v100, v101
v_mfma_f32_32x32x16_bf16 a[48:63], v[128:131], v[80:83], a[48:63]
ds_read_b64_tr_b16 v[128:129], v223 offset:37120
ds_read_b64_tr_b16 v[130:131], v223 offset:40192
v_exp_f32 v102, v102
v_exp_f32 v103, v103
v_mfma_f32_32x32x16_bf16 a[64:79], v[132:135], v[80:83], a[64:79]
ds_read_b64_tr_b16 v[132:133], v224 offset:37120
ds_read_b64_tr_b16 v[134:135], v224 offset:40192
v_add_f32 v246, v246, v102
v_add_f32 v247, v247, v103
v_cvt_pk_bf16_f32 v99, v102, v103
s_waitcnt lgkmcnt(5)
v_mfma_f32_32x32x16_bf16 a[80:95], v[136:139], v[80:83], a[80:95]
ds_read_b64_tr_b16 v[136:137], v223 offset:43008
ds_read_b64_tr_b16 v[138:139], v223 offset:46080
buffer_load_dwordx4 v231, s[20:23], s38 offen offset:2048 lds
v_exp_f32 v104, v104
v_exp_f32 v105, v105
v_mfma_f32_32x32x16_bf16 a[0:15], v[140:143], v[88:91], a[0:15]
ds_read_b64_tr_b16 v[140:141], v224 offset:43008
ds_read_b64_tr_b16 v[142:143], v224 offset:46080
v_mfma_f32_32x32x16_bf16 a[16:31], v[144:147], v[88:91], a[16:31]
ds_read_b64_tr_b16 v[144:145], v223 offset:43136
ds_read_b64_tr_b16 v[146:147], v223 offset:46208
v_add_f32 v248, v248, v104
v_add_f32 v248, v248, v105
v_cvt_pk_bf16_f32 v104, v104, v105
v_mfma_f32_32x32x16_bf16 a[32:47], v[148:151], v[88:91], a[32:47]
ds_read_b64_tr_b16 v[148:149], v224 offset:43136
ds_read_b64_tr_b16 v[150:151], v224 offset:46208
buffer_load_dwordx4 v232, s[20:23], s38 offen offset:3072 lds
v_exp_f32 v106, v106
v_exp_f32 v107, v107
s_waitcnt lgkmcnt(6)
v_mfma_f32_32x32x16_bf16 a[48:63], v[152:155], v[88:91], a[48:63]
ds_read_b64_tr_b16 v[152:153], v223 offset:43264
ds_read_b64_tr_b16 v[154:155], v223 offset:46336
v_mfma_f32_32x32x16_bf16 a[64:79], v[128:131], v[88:91], a[64:79]
ds_read_b64_tr_b16 v[128:129], v224 offset:43264
ds_read_b64_tr_b16 v[130:131], v224 offset:46336
v_add_f32 v248, v248, v106
v_add_f32 v248, v248, v107
v_cvt_pk_bf16_f32 v105, v106, v107
v_mfma_f32_32x32x16_bf16 a[80:95], v[132:135], v[88:91], a[80:95]
ds_read_b64_tr_b16 v[132:133], v225 offset:24576
ds_read_b64_tr_b16 v[134:135], v226 offset:24576
s_add_u32 m0, s36, 0x1e400
s_nop 0
buffer_load_dwordx4 v233, s[20:23], s38 offen offset:0 lds
v_mfma_f32_32x32x16_bf16 a[0:15], v[136:139], v[96:99], a[0:15]
ds_read_b64_tr_b16 v[136:137], v227 offset:24576
ds_read_b64_tr_b16 v[138:139], v228 offset:24576
s_waitcnt lgkmcnt(6)
v_mfma_f32_32x32x16_bf16 a[16:31], v[140:143], v[96:99], a[16:31]
ds_read_b64_tr_b16 v[140:141], v225 offset:24704
ds_read_b64_tr_b16 v[142:143], v226 offset:24704
v_mfma_f32_32x32x16_bf16 a[32:47], v[144:147], v[96:99], a[32:47]
ds_read_b64_tr_b16 v[144:145], v227 offset:24704
ds_read_b64_tr_b16 v[146:147], v228 offset:24704
v_mfma_f32_32x32x16_bf16 a[48:63], v[148:151], v[96:99], a[48:63]
ds_read_b64_tr_b16 v[148:149], v225 offset:24832
ds_read_b64_tr_b16 v[150:151], v226 offset:24832
s_add_u32 m0, s33, 0x6000
s_mov_b32 s39, 0x31e000
buffer_load_dwordx4 v208, s[4:7], s39 offen offset:0 nt lds
v_mfma_f32_32x32x16_bf16 a[64:79], v[152:155], v[96:99], a[64:79]
ds_read_b64_tr_b16 v[152:153], v227 offset:24832
ds_read_b64_tr_b16 v[154:155], v228 offset:24832
s_waitcnt lgkmcnt(7)
v_mfma_f32_32x32x16_bf16 a[80:95], v[128:131], v[96:99], a[80:95]
s_waitcnt vmcnt(6)
v_readfirstlane_b32 s40, v253
s_nop 0
s_bfe_u32 s40, s40, 0x100000
s_cmp_lt_u32 s40, s57
s_cbranch_scc1 L_sp0
L_pr0:
s_barrier
v_mfma_f32_16x16x16_bf16 a[96:99], v[132:133], v[104:105], a[96:99]
ds_read_b128 v[128:131], v217 offset:0
v_mfma_f32_16x16x16_bf16 a[100:103], v[134:135], v[104:105], a[100:103]
ds_read_b128 v[132:135], v218 offset:0
v_mfma_f32_16x16x16_bf16 a[104:107], v[136:137], v[104:105], a[104:107]
buffer_load_dwordx4 v209, s[4:7], s39 offen offset:1024 nt lds
v_mfma_f32_16x16x16_bf16 a[108:111], v[138:139], v[104:105], a[108:111]
ds_read_b128 v[136:139], v219 offset:0
v_mfma_f32_16x16x16_bf16 a[112:115], v[140:141], v[104:105], a[112:115]
buffer_load_dwordx4 v210, s[4:7], s39 offen offset:2048 nt lds
s_waitcnt lgkmcnt(3)
v_mfma_f32_16x16x16_bf16 a[116:119], v[142:143], v[104:105], a[116:119]
ds_read_b128 v[140:143], v220 offset:0
v_mfma_f32_16x16x16_bf16 a[120:123], v[144:145], v[104:105], a[120:123]
v_mfma_f32_16x16x16_bf16 a[124:127], v[146:147], v[104:105], a[124:127]
ds_read_b128 v[144:147], v217 offset:128
v_mfma_f32_16x16x16_bf16 a[128:131], v[148:149], v[104:105], a[128:131]
buffer_load_dwordx4 v211, s[4:7], s39 offen offset:3072 nt lds
v_mfma_f32_16x16x16_bf16 a[132:135], v[150:151], v[104:105], a[132:135]
ds_read_b128 v[148:151], v218 offset:128
v_mfma_f32_16x16x16_bf16 a[136:139], v[152:153], v[104:105], a[136:139]
s_add_u32 m0, s33, 0x7000
s_nop 0
buffer_load_dwordx4 v212, s[4:7], s39 offen offset:0 nt lds
buffer_load_dwordx4 v213, s[4:7], s39 offen offset:1024 nt lds
v_mfma_f32_16x16x16_bf16 a[140:143], v[154:155], v[104:105], a[140:143]
s_waitcnt lgkmcnt(2)
v_mfma_f32_32x32x16_bf16 v[72:87], v[128:131], v[0:3], v[108:123]
ds_read_b128 v[152:155], v219 offset:128
ds_read_b128 v[128:131], v220 offset:128
v_mfma_f32_32x32x16_bf16 v[72:87], v[132:135], v[4:7], v[72:87]
ds_read_b128 v[132:135], v217 offset:256
s_add_u32 s59, s53, 0x0
buffer_load_dwordx4 v[156:159], v243, s[24:27], s59 offen offset:0 sc1
v_mfma_f32_32x32x16_bf16 v[72:87], v[136:139], v[8:11], v[72:87]
ds_read_b128 v[136:139], v218 offset:256
v_mfma_f32_32x32x16_bf16 v[72:87], v[140:143], v[12:15], v[72:87]
ds_read_b128 v[140:143], v219 offset:256
buffer_load_dwordx4 v[160:163], v243, s[24:27], s59 offen offset:1024 sc1
s_waitcnt lgkmcnt(5)
v_mfma_f32_32x32x16_bf16 v[72:87], v[144:147], v[16:19], v[72:87]
ds_read_b128 v[144:147], v220 offset:256
v_mfma_f32_32x32x16_bf16 v[72:87], v[148:151], v[20:23], v[72:87]
ds_read_b64_tr_b16 v[148:149], v235 offset:0
ds_read_b64_tr_b16 v[150:151], v235 offset:2560
s_waitcnt lgkmcnt(5)
v_mfma_f32_32x32x16_bf16 v[72:87], v[152:155], v[24:27], v[72:87]
ds_read_b64_tr_b16 v[152:153], v235 offset:64
ds_read_b64_tr_b16 v[154:155], v235 offset:2624
buffer_load_dwordx4 v[164:167], v243, s[24:27], s59 offen offset:2048 sc1
v_mfma_f32_32x32x16_bf16 v[72:87], v[128:131], v[28:31], v[72:87]
ds_read_b64_tr_b16 v[128:129], v235 offset:128
ds_read_b64_tr_b16 v[130:131], v235 offset:2688
v_mfma_f32_32x32x16_bf16 v[72:87], v[132:135], v[32:35], v[72:87]
ds_read_b128 v[132:135], v217 offset:12288
buffer_load_dwordx4 v[168:171], v243, s[24:27], s59 offen offset:3072 sc1
s_waitcnt lgkmcnt(6)
v_mfma_f32_32x32x16_bf16 v[72:87], v[136:139], v[36:39], v[72:87]
ds_read_b128 v[136:139], v218 offset:12288
v_mfma_f32_32x32x16_bf16 v[72:87], v[140:143], v[40:43], v[72:87]
ds_read_b128 v[140:143], v219 offset:12288
v_mfma_f32_32x32x16_bf16 v[72:87], v[144:147], v[44:47], v[72:87]
ds_read_b128 v[144:147], v220 offset:12288
s_add_u32 s59, s53, 0x0
buffer_load_dwordx4 v[172:175], v244, s[24:27], s59 offen offset:0 sc1
s_waitcnt lgkmcnt(4)
v_mfma_f32_32x32x16_bf16 a[144:159], v[148:151], v[204:207], a[144:159]
ds_read_b128 v[148:151], v217 offset:12416
s_nop 2
v_max3_f32 v249, v72, v73, v74
v_max3_f32 v249, v249, v75, v76
v_max3_f32 v249, v249, v77, v78
v_max3_f32 v249, v249, v79, v80
v_max3_f32 v249, v249, v81, v82
v_mfma_f32_32x32x16_bf16 a[160:175], v[152:155], v[204:207], a[160:175]
ds_read_b128 v[152:155], v218 offset:12416
v_max3_f32 v249, v249, v83, v84
v_max3_f32 v249, v249, v85, v86
v_max_f32 v249, v249, v87
v_cmp_lt_f32 vcc, 0x41000000, v249
s_nop 0
s_cbranch_vccnz L_fb32
L_rt32:
v_mfma_f32_32x32x16_bf16 a[176:191], v[128:131], v[204:207], a[176:191]
ds_read_b128 v[128:131], v219 offset:12416
buffer_load_dwordx4 v[176:179], v244, s[24:27], s59 offen offset:1024 sc1
v_exp_f32 v72, v72
v_exp_f32 v73, v73
s_waitcnt lgkmcnt(2)
v_mfma_f32_32x32x16_bf16 v[88:103], v[132:135], v[0:3], v[108:123]
ds_read_b128 v[132:135], v220 offset:12416
v_add_f32 v246, v246, v72
v_add_f32 v247, v247, v73
v_cvt_pk_bf16_f32 v72, v72, v73
v_mfma_f32_32x32x16_bf16 v[88:103], v[136:139], v[4:7], v[88:103]
ds_read_b128 v[136:139], v217 offset:12544
s_add_u32 m0, s33, 0x12000
s_mov_b32 s39, 0x31e000
buffer_load_dwordx4 v214, s[8:11], s39 offen offset:0 nt lds
v_mfma_f32_32x32x16_bf16 v[88:103], v[140:143], v[8:11], v[88:103]
ds_read_b128 v[140:143], v218 offset:12544
v_exp_f32 v74, v74
v_exp_f32 v75, v75
v_mfma_f32_32x32x16_bf16 v[88:103], v[144:147], v[12:15], v[88:103]
ds_read_b128 v[144:147], v219 offset:12544
v_add_f32 v246, v246, v74
v_add_f32 v247, v247, v75
v_cvt_pk_bf16_f32 v73, v74, v75
v_exp_f32 v76, v76
v_exp_f32 v77, v77
v_mfma_f32_32x32x16_bf16 v[88:103], v[148:151], v[16:19], v[88:103]
ds_read_b128 v[148:151], v220 offset:12544
buffer_load_dwordx4 v215, s[8:11], s39 offen offset:1024 nt lds
s_waitcnt lgkmcnt(2)
v_mfma_f32_32x32x16_bf16 v[88:103], v[152:155], v[20:23], v[88:103]
ds_read_b128 v[152:155], v221 offset:0
v_add_f32 v246, v246, v76
v_add_f32 v247, v247, v77
v_cvt_pk_bf16_f32 v74, v76, v77
v_exp_f32 v78, v78
v_exp_f32 v79, v79
v_mfma_f32_32x32x16_bf16 v[88:103], v[128:131], v[24:27], v[88:103]
ds_read_b64_tr_b16 v[128:129], v237 offset:0
ds_read_b64_tr_b16 v[130:131], v237 offset:5120
buffer_load_dwordx4 v216, s[8:11], s39 offen offset:2048 nt lds
v_mfma_f32_32x32x16_bf16 v[88:103], v[132:135], v[28:31], v[88:103]
ds_read_b128 v[132:135], v222 offset:0
v_add_f32 v246, v246, v78
v_add_f32 v247, v247, v79
v_cvt_pk_bf16_f32 v75, v78, v79
v_exp_f32 v80, v80
v_exp_f32 v81, v81
v_mfma_f32_32x32x16_bf16 v[88:103], v[136:139], v[32:35], v[88:103]
ds_read_b64_tr_b16 v[136:137], v235 offset:192
ds_read_b64_tr_b16 v[138:139], v235 offset:2752
v_mfma_f32_32x32x16_bf16 v[88:103], v[140:143], v[36:39], v[88:103]
ds_read_b128 v[140:143], v221 offset:128
s_add_u32 m0, s33, 0x12c00
s_add_u32 s39, s39, 0xc00
buffer_load_dwordx4 v214, s[8:11], s39 offen offset:0 nt lds
s_waitcnt lgkmcnt(4)
v_mfma_f32_32x32x16_bf16 v[88:103], v[144:147], v[40:43], v[88:103]
ds_read_b64_tr_b16 v[144:145], v235 offset:256
ds_read_b64_tr_b16 v[146:147], v235 offset:2816
v_add_f32 v246, v246, v80
v_add_f32 v247, v247, v81
v_cvt_pk_bf16_f32 v80, v80, v81
v_mfma_f32_32x32x16_bf16 v[88:103], v[148:151], v[44:47], v[88:103]
ds_read_b128 v[148:151], v222 offset:128
buffer_load_dwordx4 v215, s[8:11], s39 offen offset:1024 nt lds
v_exp_f32 v82, v82
v_exp_f32 v83, v83
v_mfma_f32_16x16x32_bf16 v[104:107], v[152:155], v[48:51], v[124:127]
ds_read_b64_tr_b16 v[152:153], v235 offset:5120
ds_read_b64_tr_b16 v[154:155], v235 offset:7680
v_mfma_f32_16x16x32_bf16 a[240:243], v[128:131], a[236:239], a[240:243]
ds_read_b128 v[128:131], v221 offset:256
s_waitcnt lgkmcnt(5)
v_mfma_f32_16x16x32_bf16 v[104:107], v[132:135], v[52:55], v[104:107]
ds_read_b64_tr_b16 v[132:133], v238 offset:0
ds_read_b64_tr_b16 v[134:135], v238 offset:5120
v_mfma_f32_32x32x16_bf16 a[192:207], v[136:139], v[204:207], a[192:207]
ds_read_b128 v[136:139], v222 offset:256
buffer_load_dwordx4 v216, s[8:11], s39 offen offset:2048 nt lds
v_add_f32 v246, v246, v82
v_add_f32 v247, v247, v83
v_cvt_pk_bf16_f32 v81, v82, v83
v_mfma_f32_16x16x32_bf16 v[104:107], v[140:143], v[56:59], v[104:107]
ds_read_b64_tr_b16 v[140:141], v235 offset:5184
ds_read_b64_tr_b16 v[142:143], v235 offset:7744
s_waitcnt lgkmcnt(6)
v_mfma_f32_32x32x16_bf16 a[208:223], v[144:147], v[204:207], a[208:223]
ds_read_b64_tr_b16 v[144:145], v235 offset:5248
ds_read_b64_tr_b16 v[146:147], v235 offset:7808
v_exp_f32 v84, v84
v_exp_f32 v85, v85
v_mfma_f32_16x16x32_bf16 v[104:107], v[148:151], v[60:63], v[104:107]
ds_read_b64_tr_b16 v[148:149], v235 offset:5312
ds_read_b64_tr_b16 v[150:151], v235 offset:7872
v_mfma_f32_32x32x16_bf16 a[144:159], v[152:155], a[224:227], a[144:159]
ds_read_b64_tr_b16 v[152:153], v239 offset:0
ds_read_b64_tr_b16 v[154:155], v239 offset:5120
v_add_f32 v246, v246, v84
v_add_f32 v247, v247, v85
v_cvt_pk_bf16_f32 v82, v84, v85
s_waitcnt lgkmcnt(6)
v_mfma_f32_16x16x32_bf16 v[104:107], v[128:131], v[64:67], v[104:107]
ds_read_b64_tr_b16 v[128:129], v235 offset:5376
ds_read_b64_tr_b16 v[130:131], v235 offset:7936
v_mfma_f32_16x16x32_bf16 a[244:247], v[132:135], a[236:239], a[244:247]
ds_read_b64_tr_b16 v[132:133], v235 offset:10240
ds_read_b64_tr_b16 v[134:135], v235 offset:12800
v_mfma_f32_16x16x32_bf16 v[104:107], v[136:139], v[68:71], v[104:107]
ds_read_b64_tr_b16 v[136:137], v235 offset:10304
ds_read_b64_tr_b16 v[138:139], v235 offset:12864
v_mfma_f32_32x32x16_bf16 a[160:175], v[140:143], a[224:227], a[160:175]
ds_read_b64_tr_b16 v[140:141], v237 offset:10240
ds_read_b64_tr_b16 v[142:143], v237 offset:15360
v_exp_f32 v86, v86
v_exp_f32 v87, v87
s_waitcnt lgkmcnt(8)
v_mfma_f32_32x32x16_bf16 a[176:191], v[144:147], a[224:227], a[176:191]
ds_read_b64_tr_b16 v[144:145], v235 offset:10368
ds_read_b64_tr_b16 v[146:147], v235 offset:12928
v_add_f32 v246, v246, v86
v_add_f32 v247, v247, v87
v_cvt_pk_bf16_f32 v83, v86, v87
v_max3_f32 v249, v88, v89, v90
v_mfma_f32_32x32x16_bf16 a[192:207], v[148:151], a[224:227], a[192:207]
ds_read_b64_tr_b16 v[148:149], v235 offset:10432
ds_read_b64_tr_b16 v[150:151], v235 offset:12992
v_max3_f32 v249, v249, v91, v92
v_max3_f32 v249, v249, v93, v94
v_max3_f32 v249, v249, v95, v96
v_max3_f32 v249, v249, v97, v98
v_mfma_f32_16x16x32_bf16 a[248:251], v[152:155], a[236:239], a[248:251]
ds_read_b64_tr_b16 v[152:153], v235 offset:10496
ds_read_b64_tr_b16 v[154:155], v235 offset:13056
s_waitcnt lgkmcnt(6)
v_mfma_f32_32x32x16_bf16 a[208:223], v[128:131], a[224:227], a[208:223]
ds_read_b64_tr_b16 v[128:129], v238 offset:10240
ds_read_b64_tr_b16 v[130:131], v238 offset:15360
v_max3_f32 v249, v249, v99, v100
v_max3_f32 v249, v249, v101, v102
v_max_f32 v249, v249, v103
v_max3_f32 v252, v104, v105, v106
v_mfma_f32_32x32x16_bf16 a[144:159], v[132:135], a[228:231], a[144:159]
ds_read_b64_tr_b16 v[132:133], v235 offset:15360
ds_read_b64_tr_b16 v[134:135], v235 offset:17920
v_cmp_lt_f32 vcc, 0x41000000, v249
s_nop 0
s_cbranch_vccnz L_fb34
L_rt34:
v_exp_f32 v88, v88
v_exp_f32 v89, v89
v_mfma_f32_32x32x16_bf16 a[160:175], v[136:139], a[228:231], a[160:175]
ds_read_b64_tr_b16 v[136:137], v235 offset:15424
ds_read_b64_tr_b16 v[138:139], v235 offset:17984
v_max_f32 v252, v252, v107
v_mfma_f32_16x16x32_bf16 a[240:243], v[140:143], a[252:255], a[240:243]
ds_read_b64_tr_b16 v[140:141], v235 offset:15488
ds_read_b64_tr_b16 v[142:143], v235 offset:18048
s_waitcnt lgkmcnt(6)
v_mfma_f32_32x32x16_bf16 a[176:191], v[144:147], a[228:231], a[176:191]
ds_read_b64_tr_b16 v[144:145], v239 offset:10240
ds_read_b64_tr_b16 v[146:147], v239 offset:15360
v_add_f32 v246, v246, v88
v_add_f32 v247, v247, v89
v_cvt_pk_bf16_f32 v88, v88, v89
v_mfma_f32_32x32x16_bf16 a[192:207], v[148:151], a[228:231], a[192:207]
ds_read_b64_tr_b16 v[148:149], v235 offset:15552
ds_read_b64_tr_b16 v[150:151], v235 offset:18112
v_exp_f32 v90, v90
v_exp_f32 v91, v91
v_mfma_f32_32x32x16_bf16 a[208:223], v[152:155], a[228:231], a[208:223]
ds_read_b64_tr_b16 v[152:153], v235 offset:15616
ds_read_b64_tr_b16 v[154:155], v235 offset:18176
s_barrier
v_cmp_lt_f32 vcc, 0x41000000, v252
s_nop 0
s_cbranch_vccnz L_fb33
L_rt33:
v_mfma_f32_16x16x32_bf16 a[244:247], v[128:131], a[252:255], a[244:247]
ds_read_b64_tr_b16 v[128:129], v223 offset:0
ds_read_b64_tr_b16 v[130:131], v223 offset:3072
s_waitcnt lgkmcnt(6)
v_mfma_f32_32x32x16_bf16 a[144:159], v[132:135], a[232:235], a[144:159]
ds_read_b64_tr_b16 v[132:133], v224 offset:0
ds_read_b64_tr_b16 v[134:135], v224 offset:3072
v_add_f32 v246, v246, v90
v_add_f32 v247, v247, v91
v_cvt_pk_bf16_f32 v89, v90, v91
v_mfma_f32_32x32x16_bf16 a[160:175], v[136:139], a[232:235], a[160:175]
ds_read_b64_tr_b16 v[136:137], v223 offset:128
ds_read_b64_tr_b16 v[138:139], v223 offset:3200
v_exp_f32 v92, v92
v_exp_f32 v93, v93
v_mfma_f32_32x32x16_bf16 a[176:191], v[140:143], a[232:235], a[176:191]
ds_read_b64_tr_b16 v[140:141], v224 offset:128
ds_read_b64_tr_b16 v[142:143], v224 offset:3200
v_add_f32 v246, v246, v92
v_add_f32 v247, v247, v93
v_cvt_pk_bf16_f32 v90, v92, v93
v_mfma_f32_16x16x32_bf16 a[248:251], v[144:147], a[252:255], a[248:251]
ds_read_b64_tr_b16 v[144:145], v223 offset:256
ds_read_b64_tr_b16 v[146:147], v223 offset:3328
s_waitcnt lgkmcnt(6)
v_mfma_f32_32x32x16_bf16 a[192:207], v[148:151], a[232:235], a[192:207]
ds_read_b64_tr_b16 v[148:149], v224 offset:256
ds_read_b64_tr_b16 v[150:151], v224 offset:3328
v_exp_f32 v94, v94
v_exp_f32 v95, v95
v_mfma_f32_32x32x16_bf16 a[208:223], v[152:155], a[232:235], a[208:223]
ds_read_b64_tr_b16 v[152:153], v223 offset:6144
ds_read_b64_tr_b16 v[154:155], v223 offset:9216
v_add_f32 v246, v246, v94
v_add_f32 v247, v247, v95
v_cvt_pk_bf16_f32 v91, v94, v95
v_mfma_f32_32x32x16_bf16 a[0:15], v[128:131], v[72:75], a[0:15]
ds_read_b64_tr_b16 v[128:129], v224 offset:6144
ds_read_b64_tr_b16 v[130:131], v224 offset:9216
v_exp_f32 v96, v96
v_exp_f32 v97, v97
v_mfma_f32_32x32x16_bf16 a[16:31], v[132:135], v[72:75], a[16:31]
ds_read_b64_tr_b16 v[132:133], v223 offset:6272
ds_read_b64_tr_b16 v[134:135], v223 offset:9344
s_add_u32 m0, s36, 0x22800
s_add_u32 s38, s49, 0x14000
buffer_load_dwordx4 v229, s[20:23], s38 offen offset:0 lds
s_waitcnt lgkmcnt(4)
v_mfma_f32_32x32x16_bf16 a[32:47], v[136:139], v[72:75], a[32:47]
ds_read_b64_tr_b16 v[136:137], v224 offset:6272
ds_read_b64_tr_b16 v[138:139], v224 offset:9344
v_add_f32 v246, v246, v96
v_add_f32 v247, v247, v97
v_cvt_pk_bf16_f32 v96, v96, v97
v_mfma_f32_32x32x16_bf16 a[48:63], v[140:143], v[72:75], a[48:63]
ds_read_b64_tr_b16 v[140:141], v223 offset:6400
ds_read_b64_tr_b16 v[142:143], v223 offset:9472
v_exp_f32 v98, v98
v_exp_f32 v99, v99
v_mfma_f32_32x32x16_bf16 a[64:79], v[144:147], v[72:75], a[64:79]
ds_read_b64_tr_b16 v[144:145], v224 offset:6400
ds_read_b64_tr_b16 v[146:147], v224 offset:9472
buffer_load_dwordx4 v230, s[20:23], s38 offen offset:1024 lds
v_mfma_f32_32x32x16_bf16 a[80:95], v[148:151], v[72:75], a[80:95]
ds_read_b64_tr_b16 v[148:149], v223 offset:12288
ds_read_b64_tr_b16 v[150:151], v223 offset:15360
v_add_f32 v246, v246, v98
v_add_f32 v247, v247, v99
v_cvt_pk_bf16_f32 v97, v98, v99
v_mfma_f32_32x32x16_bf16 a[0:15], v[152:155], v[80:83], a[0:15]
ds_read_b64_tr_b16 v[152:153], v224 offset:12288
ds_read_b64_tr_b16 v[154:155], v224 offset:15360
v_exp_f32 v100, v100
v_exp_f32 v101, v101
s_waitcnt lgkmcnt(6)
v_mfma_f32_32x32x16_bf16 a[16:31], v[128:131], v[80:83], a[16:31]
ds_read_b64_tr_b16 v[128:129], v223 offset:12416
ds_read_b64_tr_b16 v[130:131], v223 offset:15488
v_add_f32 v246, v246, v100
v_add_f32 v247, v247, v101
v_cvt_pk_bf16_f32 v98, v100, v101
v_mfma_f32_32x32x16_bf16 a[32:47], v[132:135], v[80:83], a[32:47]
ds_read_b64_tr_b16 v[132:133], v224 offset:12416
ds_read_b64_tr_b16 v[134:135], v224 offset:15488
buffer_load_dwordx4 v231, s[20:23], s38 offen offset:2048 lds
v_exp_f32 v102, v102
v_exp_f32 v103, v103
v_mfma_f32_32x32x16_bf16 a[48:63], v[136:139], v[80:83], a[48:63]
ds_read_b64_tr_b16 v[136:137], v223 offset:12544
ds_read_b64_tr_b16 v[138:139], v223 offset:15616
v_mfma_f32_32x32x16_bf16 a[64:79], v[140:143], v[80:83], a[64:79]
ds_read_b64_tr_b16 v[140:141], v224 offset:12544
ds_read_b64_tr_b16 v[142:143], v224 offset:15616
v_add_f32 v246, v246, v102
v_add_f32 v247, v247, v103
v_cvt_pk_bf16_f32 v99, v102, v103
s_waitcnt lgkmcnt(6)
v_mfma_f32_32x32x16_bf16 a[80:95], v[144:147], v[80:83], a[80:95]
ds_read_b64_tr_b16 v[144:145], v223 offset:18432
ds_read_b64_tr_b16 v[146:147], v223 offset:21504
buffer_load_dwordx4 v232, s[20:23], s38 offen offset:3072 lds
v_exp_f32 v104, v104
v_exp_f32 v105, v105
v_mfma_f32_32x32x16_bf16 a[0:15], v[148:151], v[88:91], a[0:15]
ds_read_b64_tr_b16 v[148:149], v224 offset:18432
ds_read_b64_tr_b16 v[150:151], v224 offset:21504
v_mfma_f32_32x32x16_bf16 a[16:31], v[152:155], v[88:91], a[16:31]
ds_read_b64_tr_b16 v[152:153], v223 offset:18560
ds_read_b64_tr_b16 v[154:155], v223 offset:21632
v_add_f32 v248, v248, v104
v_add_f32 v248, v248, v105
v_cvt_pk_bf16_f32 v104, v104, v105
v_mfma_f32_32x32x16_bf16 a[32:47], v[128:131], v[88:91], a[32:47]
ds_read_b64_tr_b16 v[128:129], v224 offset:18560
ds_read_b64_tr_b16 v[130:131], v224 offset:21632
v_exp_f32 v106, v106
v_exp_f32 v107, v107
s_waitcnt lgkmcnt(6)
v_mfma_f32_32x32x16_bf16 a[48:63], v[132:135], v[88:91], a[48:63]
ds_read_b64_tr_b16 v[132:133], v223 offset:18688
ds_read_b64_tr_b16 v[134:135], v223 offset:21760
s_add_u32 m0, s36, 0x23800
s_nop 0
buffer_load_dwordx4 v233, s[20:23], s38 offen offset:0 lds
v_mfma_f32_32x32x16_bf16 a[64:79], v[136:139], v[88:91], a[64:79]
ds_read_b64_tr_b16 v[136:137], v224 offset:18688
ds_read_b64_tr_b16 v[138:139], v224 offset:21760
v_add_f32 v248, v248, v106
v_add_f32 v248, v248, v107
v_cvt_pk_bf16_f32 v105, v106, v107
v_mfma_f32_32x32x16_bf16 a[80:95], v[140:143], v[88:91], a[80:95]
ds_read_b64_tr_b16 v[140:141], v225 offset:0
ds_read_b64_tr_b16 v[142:143], v226 offset:0
v_mfma_f32_32x32x16_bf16 a[0:15], v[144:147], v[96:99], a[0:15]
ds_read_b64_tr_b16 v[144:145], v227 offset:0
ds_read_b64_tr_b16 v[146:147], v228 offset:0
s_waitcnt lgkmcnt(6)
v_mfma_f32_32x32x16_bf16 a[16:31], v[148:151], v[96:99], a[16:31]
ds_read_b64_tr_b16 v[148:149], v225 offset:128
ds_read_b64_tr_b16 v[150:151], v226 offset:128
s_add_u32 m0, s33, 0x0
s_mov_b32 s39, 0x324000
buffer_load_dwordx4 v208, s[4:7], s39 offen offset:0 nt lds
v_mfma_f32_32x32x16_bf16 a[32:47], v[152:155], v[96:99], a[32:47]
ds_read_b64_tr_b16 v[152:153], v227 offset:128
ds_read_b64_tr_b16 v[154:155], v228 offset:128
v_mfma_f32_32x32x16_bf16 a[48:63], v[128:131], v[96:99], a[48:63]
ds_read_b64_tr_b16 v[128:129], v225 offset:256
ds_read_b64_tr_b16 v[130:131], v226 offset:256
v_mfma_f32_32x32x16_bf16 a[64:79], v[132:135], v[96:99], a[64:79]
ds_read_b64_tr_b16 v[132:133], v227 offset:256
ds_read_b64_tr_b16 v[134:135], v228 offset:256
buffer_load_dwordx4 v209, s[4:7], s39 offen offset:1024 nt lds
s_waitcnt lgkmcnt(6)
v_mfma_f32_32x32x16_bf16 a[80:95], v[136:139], v[96:99], a[80:95]
s_waitcnt vmcnt(19)
s_barrier
ds_read_b128 v[136:139], v217 offset:24576
v_mfma_f32_16x16x16_bf16 a[96:99], v[140:141], v[104:105], a[96:99]
v_mfma_f32_16x16x16_bf16 a[100:103], v[142:143], v[104:105], a[100:103]
ds_read_b128 v[140:143], v218 offset:24576
v_mfma_f32_16x16x16_bf16 a[104:107], v[144:145], v[104:105], a[104:107]
buffer_load_dwordx4 v210, s[4:7], s39 offen offset:2048 nt lds
v_mfma_f32_16x16x16_bf16 a[108:111], v[146:147], v[104:105], a[108:111]
ds_read_b128 v[144:147], v219 offset:24576
v_mfma_f32_16x16x16_bf16 a[112:115], v[148:149], v[104:105], a[112:115]
v_mfma_f32_16x16x16_bf16 a[116:119], v[150:151], v[104:105], a[116:119]
ds_read_b128 v[148:151], v220 offset:24576
s_waitcnt lgkmcnt(4)
v_mfma_f32_16x16x16_bf16 a[120:123], v[152:153], v[104:105], a[120:123]
buffer_load_dwordx4 v211, s[4:7], s39 offen offset:3072 nt lds
v_mfma_f32_16x16x16_bf16 a[124:127], v[154:155], v[104:105], a[124:127]
ds_read_b128 v[152:155], v217 offset:24704
v_mfma_f32_16x16x16_bf16 a[128:131], v[128:129], v[104:105], a[128:131]
v_mfma_f32_16x16x16_bf16 a[132:135], v[130:131], v[104:105], a[132:135]
ds_read_b128 v[128:131], v218 offset:24704
v_mfma_f32_16x16x16_bf16 a[136:139], v[132:133], v[104:105], a[136:139]
s_add_u32 m0, s33, 0x1000
s_nop 0
buffer_load_dwordx4 v212, s[4:7], s39 offen offset:0 nt lds
buffer_load_dwordx4 v213, s[4:7], s39 offen offset:1024 nt lds
v_mfma_f32_16x16x16_bf16 a[140:143], v[134:135], v[104:105], a[140:143]
s_waitcnt lgkmcnt(2)
v_mfma_f32_32x32x16_bf16 v[72:87], v[136:139], v[0:3], v[108:123]
ds_read_b128 v[132:135], v219 offset:24704
ds_read_b128 v[136:139], v220 offset:24704
v_mfma_f32_32x32x16_bf16 v[72:87], v[140:143], v[4:7], v[72:87]
ds_read_b128 v[140:143], v217 offset:24832
s_add_u32 s59, s53, 0x1000
buffer_load_dwordx4 v[180:183], v243, s[24:27], s59 offen offset:0 sc1
v_mfma_f32_32x32x16_bf16 v[72:87], v[144:147], v[8:11], v[72:87]
ds_read_b128 v[144:147], v218 offset:24832
v_mfma_f32_32x32x16_bf16 v[72:87], v[148:151], v[12:15], v[72:87]
ds_read_b128 v[148:151], v219 offset:24832
buffer_load_dwordx4 v[184:187], v243, s[24:27], s59 offen offset:1024 sc1
s_waitcnt lgkmcnt(5)
v_mfma_f32_32x32x16_bf16 v[72:87], v[152:155], v[16:19], v[72:87]
ds_read_b128 v[152:155], v220 offset:24832
v_mfma_f32_32x32x16_bf16 v[72:87], v[128:131], v[20:23], v[72:87]
ds_read_b64_tr_b16 v[128:129], v235 offset:21504
ds_read_b64_tr_b16 v[130:131], v235 offset:24064
s_waitcnt lgkmcnt(5)
v_mfma_f32_32x32x16_bf16 v[72:87], v[132:135], v[24:27], v[72:87]
ds_read_b64_tr_b16 v[132:133], v235 offset:21568
ds_read_b64_tr_b16 v[134:135], v235 offset:24128
buffer_load_dwordx4 v[188:191], v243, s[24:27], s59 offen offset:2048 sc1
v_mfma_f32_32x32x16_bf16 v[72:87], v[136:139], v[28:31], v[72:87]
ds_read_b64_tr_b16 v[136:137], v235 offset:21632
ds_read_b64_tr_b16 v[138:139], v235 offset:24192
v_mfma_f32_32x32x16_bf16 v[72:87], v[140:143], v[32:35], v[72:87]
ds_read_b128 v[140:143], v217 offset:36864
buffer_load_dwordx4 v[192:195], v243, s[24:27], s59 offen offset:3072 sc1
s_waitcnt lgkmcnt(6)
v_mfma_f32_32x32x16_bf16 v[72:87], v[144:147], v[36:39], v[72:87]
ds_read_b128 v[144:147], v218 offset:36864
v_mfma_f32_32x32x16_bf16 v[72:87], v[148:151], v[40:43], v[72:87]
ds_read_b128 v[148:151], v219 offset:36864
v_mfma_f32_32x32x16_bf16 v[72:87], v[152:155], v[44:47], v[72:87]
ds_read_b128 v[152:155], v220 offset:36864
s_add_u32 s59, s53, 0x800
buffer_load_dwordx4 v[196:199], v244, s[24:27], s59 offen offset:0 sc1
s_waitcnt lgkmcnt(4)
s_waitcnt vmcnt(27)
v_mfma_f32_32x32x16_bf16 a[144:159], v[128:131], v[156:159], a[144:159]
ds_read_b128 v[128:131], v217 offset:36992
s_nop 2
v_max3_f32 v249, v72, v73, v74
v_max3_f32 v249, v249, v75, v76
v_max3_f32 v249, v249, v77, v78
v_max3_f32 v249, v249, v79, v80
v_max3_f32 v249, v249, v81, v82
v_mfma_f32_32x32x16_bf16 a[160:175], v[132:135], v[156:159], a[160:175]
ds_read_b128 v[132:135], v218 offset:36992
v_max3_f32 v249, v249, v83, v84
v_max3_f32 v249, v249, v85, v86
v_max_f32 v249, v249, v87
v_cmp_lt_f32 vcc, 0x41000000, v249
s_nop 0
s_cbranch_vccnz L_fb35
L_rt35:
v_mfma_f32_32x32x16_bf16 a[176:191], v[136:139], v[156:159], a[176:191]
ds_read_b128 v[136:139], v219 offset:36992
buffer_load_dwordx4 v[200:203], v244, s[24:27], s59 offen offset:1024 sc1
v_exp_f32 v72, v72
v_exp_f32 v73, v73
s_waitcnt lgkmcnt(2)
v_mfma_f32_32x32x16_bf16 v[88:103], v[140:143], v[0:3], v[108:123]
ds_read_b128 v[140:143], v220 offset:36992
v_add_f32 v246, v246, v72
v_add_f32 v247, v247, v73
v_cvt_pk_bf16_f32 v72, v72, v73
v_mfma_f32_32x32x16_bf16 v[88:103], v[144:147], v[4:7], v[88:103]
ds_read_b128 v[144:147], v217 offset:37120
s_add_u32 m0, s33, 0xc000
s_mov_b32 s39, 0x324000
buffer_load_dwordx4 v214, s[8:11], s39 offen offset:0 nt lds
v_mfma_f32_32x32x16_bf16 v[88:103], v[148:151], v[8:11], v[88:103]
ds_read_b128 v[148:151], v218 offset:37120
v_exp_f32 v74, v74
v_exp_f32 v75, v75
v_mfma_f32_32x32x16_bf16 v[88:103], v[152:155], v[12:15], v[88:103]
ds_read_b128 v[152:155], v219 offset:37120
v_add_f32 v246, v246, v74
v_add_f32 v247, v247, v75
v_cvt_pk_bf16_f32 v73, v74, v75
v_exp_f32 v76, v76
v_exp_f32 v77, v77
v_mfma_f32_32x32x16_bf16 v[88:103], v[128:131], v[16:19], v[88:103]
ds_read_b128 v[128:131], v220 offset:37120
buffer_load_dwordx4 v215, s[8:11], s39 offen offset:1024 nt lds
s_waitcnt lgkmcnt(2)
v_mfma_f32_32x32x16_bf16 v[88:103], v[132:135], v[20:23], v[88:103]
ds_read_b128 v[132:135], v221 offset:24576
v_add_f32 v246, v246, v76
v_add_f32 v247, v247, v77
v_cvt_pk_bf16_f32 v74, v76, v77
v_exp_f32 v78, v78
v_exp_f32 v79, v79
v_mfma_f32_32x32x16_bf16 v[88:103], v[136:139], v[24:27], v[88:103]
ds_read_b64_tr_b16 v[136:137], v237 offset:21504
ds_read_b64_tr_b16 v[138:139], v237 offset:26624
buffer_load_dwordx4 v216, s[8:11], s39 offen offset:2048 nt lds
v_mfma_f32_32x32x16_bf16 v[88:103], v[140:143], v[28:31], v[88:103]
ds_read_b128 v[140:143], v222 offset:24576
v_add_f32 v246, v246, v78
v_add_f32 v247, v247, v79
v_cvt_pk_bf16_f32 v75, v78, v79
v_exp_f32 v80, v80
v_exp_f32 v81, v81
v_mfma_f32_32x32x16_bf16 v[88:103], v[144:147], v[32:35], v[88:103]
ds_read_b64_tr_b16 v[144:145], v235 offset:21696
ds_read_b64_tr_b16 v[146:147], v235 offset:24256
v_mfma_f32_32x32x16_bf16 v[88:103], v[148:151], v[36:39], v[88:103]
ds_read_b128 v[148:151], v221 offset:24704
s_add_u32 m0, s33, 0xcc00
s_add_u32 s39, s39, 0xc00
buffer_load_dwordx4 v214, s[8:11], s39 offen offset:0 nt lds
s_waitcnt lgkmcnt(4)
v_mfma_f32_32x32x16_bf16 v[88:103], v[152:155], v[40:43], v[88:103]
ds_read_b64_tr_b16 v[152:153], v235 offset:21760
ds_read_b64_tr_b16 v[154:155], v235 offset:24320
v_add_f32 v246, v246, v80
v_add_f32 v247, v247, v81
v_cvt_pk_bf16_f32 v80, v80, v81
v_mfma_f32_32x32x16_bf16 v[88:103], v[128:131], v[44:47], v[88:103]
ds_read_b128 v[128:131], v222 offset:24704
buffer_load_dwordx4 v215, s[8:11], s39 offen offset:1024 nt lds
v_exp_f32 v82, v82
v_exp_f32 v83, v83
v_mfma_f32_16x16x32_bf16 v[104:107], v[132:135], v[48:51], v[124:127]
ds_read_b64_tr_b16 v[132:133], v235 offset:26624
ds_read_b64_tr_b16 v[134:135], v235 offset:29184
s_waitcnt vmcnt(29)
v_mfma_f32_16x16x32_bf16 a[240:243], v[136:139], v[172:175], a[240:243]
ds_read_b128 v[136:139], v221 offset:24832
s_waitcnt lgkmcnt(4)
v_mfma_f32_16x16x32_bf16 v[104:107], v[140:143], v[52:55], v[104:107]
ds_read_b64_tr_b16 v[140:141], v238 offset:21504
ds_read_b64_tr_b16 v[142:143], v238 offset:26624
v_mfma_f32_32x32x16_bf16 a[192:207], v[144:147], v[156:159], a[192:207]
ds_read_b128 v[144:147], v222 offset:24832
buffer_load_dwordx4 v216, s[8:11], s39 offen offset:2048 nt lds
v_add_f32 v246, v246, v82
v_add_f32 v247, v247, v83
v_cvt_pk_bf16_f32 v81, v82, v83
v_mfma_f32_16x16x32_bf16 v[104:107], v[148:151], v[56:59], v[104:107]
ds_read_b64_tr_b16 v[148:149], v235 offset:26688
ds_read_b64_tr_b16 v[150:151], v235 offset:29248
v_mfma_f32_32x32x16_bf16 a[208:223], v[152:155], v[156:159], a[208:223]
ds_read_b64_tr_b16 v[152:153], v235 offset:26752
ds_read_b64_tr_b16 v[154:155], v235 offset:29312
v_exp_f32 v84, v84
v_exp_f32 v85, v85
s_waitcnt lgkmcnt(5)
v_mfma_f32_16x16x32_bf16 v[104:107], v[128:131], v[60:63], v[104:107]
ds_read_b64_tr_b16 v[128:129], v235 offset:26816
ds_read_b64_tr_b16 v[130:131], v235 offset:29376
v_mfma_f32_32x32x16_bf16 a[144:159], v[132:135], v[160:163], a[144:159]
ds_read_b64_tr_b16 v[132:133], v239 offset:21504
ds_read_b64_tr_b16 v[134:135], v239 offset:26624
v_add_f32 v246, v246, v84
v_add_f32 v247, v247, v85
v_cvt_pk_bf16_f32 v82, v84, v85
v_mfma_f32_16x16x32_bf16 v[104:107], v[136:139], v[64:67], v[104:107]
ds_read_b64_tr_b16 v[136:137], v235 offset:26880
ds_read_b64_tr_b16 v[138:139], v235 offset:29440
v_mfma_f32_16x16x32_bf16 a[244:247], v[140:143], v[172:175], a[244:247]
ds_read_b64_tr_b16 v[140:141], v235 offset:31744
ds_read_b64_tr_b16 v[142:143], v235 offset:34304
s_waitcnt lgkmcnt(8)
v_mfma_f32_16x16x32_bf16 v[104:107], v[144:147], v[68:71], v[104:107]
ds_read_b64_tr_b16 v[144:145], v235 offset:31808
ds_read_b64_tr_b16 v[146:147], v235 offset:34368
v_mfma_f32_32x32x16_bf16 a[160:175], v[148:151], v[160:163], a[160:175]
ds_read_b64_tr_b16 v[148:149], v237 offset:31744
ds_read_b64_tr_b16 v[150:151], v237 offset:36864
v_exp_f32 v86, v86
v_exp_f32 v87, v87
v_mfma_f32_32x32x16_bf16 a[176:191], v[152:155], v[160:163], a[176:191]
ds_read_b64_tr_b16 v[152:153], v235 offset:31872
ds_read_b64_tr_b16 v[154:155], v235 offset:34432
v_add_f32 v246, v246, v86
v_add_f32 v247, v247, v87
v_cvt_pk_bf16_f32 v83, v86, v87
v_max3_f32 v249, v88, v89, v90
s_waitcnt lgkmcnt(6)
v_mfma_f32_32x32x16_bf16 a[192:207], v[128:131], v[160:163], a[192:207]
ds_read_b64_tr_b16 v[128:129], v235 offset:31936
ds_read_b64_tr_b16 v[130:131], v235 offset:34496
v_max3_f32 v249, v249, v91, v92
v_max3_f32 v249, v249, v93, v94
v_max3_f32 v249, v249, v95, v96
v_max3_f32 v249, v249, v97, v98
v_mfma_f32_16x16x32_bf16 a[248:251], v[132:135], v[172:175], a[248:251]
ds_read_b64_tr_b16 v[132:133], v235 offset:32000
ds_read_b64_tr_b16 v[134:135], v235 offset:34560
v_mfma_f32_32x32x16_bf16 a[208:223], v[136:139], v[160:163], a[208:223]
ds_read_b64_tr_b16 v[136:137], v238 offset:31744
ds_read_b64_tr_b16 v[138:139], v238 offset:36864
v_max3_f32 v249, v249, v99, v100
v_max3_f32 v249, v249, v101, v102
v_max_f32 v249, v249, v103
v_max3_f32 v252, v104, v105, v106
v_mfma_f32_32x32x16_bf16 a[144:159], v[140:143], v[164:167], a[144:159]
ds_read_b64_tr_b16 v[140:141], v235 offset:36864
ds_read_b64_tr_b16 v[142:143], v235 offset:39424
v_cmp_lt_f32 vcc, 0x41000000, v249
s_nop 0
s_cbranch_vccnz L_fb37
L_rt37:
v_exp_f32 v88, v88
v_exp_f32 v89, v89
s_waitcnt lgkmcnt(4)
v_mfma_f32_32x32x16_bf16 a[160:175], v[144:147], v[164:167], a[160:175]
ds_read_b64_tr_b16 v[144:145], v235 offset:36928
ds_read_b64_tr_b16 v[146:147], v235 offset:39488
v_max_f32 v252, v252, v107
s_waitcnt vmcnt(29)
v_mfma_f32_16x16x32_bf16 a[240:243], v[148:151], v[176:179], a[240:243]
ds_read_b64_tr_b16 v[148:149], v235 offset:36992
ds_read_b64_tr_b16 v[150:151], v235 offset:39552
v_mfma_f32_32x32x16_bf16 a[176:191], v[152:155], v[164:167], a[176:191]
ds_read_b64_tr_b16 v[152:153], v239 offset:31744
ds_read_b64_tr_b16 v[154:155], v239 offset:36864
v_add_f32 v246, v246, v88
v_add_f32 v247, v247, v89
v_cvt_pk_bf16_f32 v88, v88, v89
v_mfma_f32_32x32x16_bf16 a[192:207], v[128:131], v[164:167], a[192:207]
ds_read_b64_tr_b16 v[128:129], v235 offset:37056
ds_read_b64_tr_b16 v[130:131], v235 offset:39616
v_exp_f32 v90, v90
v_exp_f32 v91, v91
v_mfma_f32_32x32x16_bf16 a[208:223], v[132:135], v[164:167], a[208:223]
ds_read_b64_tr_b16 v[132:133], v235 offset:37120
ds_read_b64_tr_b16 v[134:135], v235 offset:39680
s_waitcnt vmcnt(23)
s_barrier
v_cmp_lt_f32 vcc, 0x41000000, v252
s_nop 0
s_cbranch_vccnz L_fb36
L_rt36:
s_waitcnt lgkmcnt(4)
v_mfma_f32_16x16x32_bf16 a[244:247], v[136:139], v[176:179], a[244:247]
ds_read_b64_tr_b16 v[136:137], v223 offset:24576
ds_read_b64_tr_b16 v[138:139], v223 offset:27648
v_mfma_f32_32x32x16_bf16 a[144:159], v[140:143], v[168:171], a[144:159]
ds_read_b64_tr_b16 v[140:141], v224 offset:24576
ds_read_b64_tr_b16 v[142:143], v224 offset:27648
v_add_f32 v246, v246, v90
v_add_f32 v247, v247, v91
v_cvt_pk_bf16_f32 v89, v90, v91
v_mfma_f32_32x32x16_bf16 a[160:175], v[144:147], v[168:171], a[160:175]
ds_read_b64_tr_b16 v[144:145], v223 offset:24704
ds_read_b64_tr_b16 v[146:147], v223 offset:27776
v_exp_f32 v92, v92
v_exp_f32 v93, v93
v_mfma_f32_32x32x16_bf16 a[176:191], v[148:151], v[168:171], a[176:191]
ds_read_b64_tr_b16 v[148:149], v224 offset:24704
ds_read_b64_tr_b16 v[150:151], v224 offset:27776
v_add_f32 v246, v246, v92
v_add_f32 v247, v247, v93
v_cvt_pk_bf16_f32 v90, v92, v93
v_mfma_f32_16x16x32_bf16 a[248:251], v[152:155], v[176:179], a[248:251]
ds_read_b64_tr_b16 v[152:153], v223 offset:24832
ds_read_b64_tr_b16 v[154:155], v223 offset:27904
s_waitcnt lgkmcnt(6)
v_mfma_f32_32x32x16_bf16 a[192:207], v[128:131], v[168:171], a[192:207]
ds_read_b64_tr_b16 v[128:129], v224 offset:24832
ds_read_b64_tr_b16 v[130:131], v224 offset:27904
v_exp_f32 v94, v94
v_exp_f32 v95, v95
v_mfma_f32_32x32x16_bf16 a[208:223], v[132:135], v[168:171], a[208:223]
ds_read_b64_tr_b16 v[132:133], v223 offset:30720
ds_read_b64_tr_b16 v[134:135], v223 offset:33792
v_add_f32 v246, v246, v94
v_add_f32 v247, v247, v95
v_cvt_pk_bf16_f32 v91, v94, v95
v_mfma_f32_32x32x16_bf16 a[0:15], v[136:139], v[72:75], a[0:15]
ds_read_b64_tr_b16 v[136:137], v224 offset:30720
ds_read_b64_tr_b16 v[138:139], v224 offset:33792
v_exp_f32 v96, v96
v_exp_f32 v97, v97
v_mfma_f32_32x32x16_bf16 a[16:31], v[140:143], v[72:75], a[16:31]
ds_read_b64_tr_b16 v[140:141], v223 offset:30848
ds_read_b64_tr_b16 v[142:143], v223 offset:33920
s_add_u32 m0, s36, 0x18000
s_add_u32 s38, s49, 0x28000
buffer_load_dwordx4 v229, s[20:23], s38 offen offset:0 lds
s_waitcnt lgkmcnt(4)
v_mfma_f32_32x32x16_bf16 a[32:47], v[144:147], v[72:75], a[32:47]
ds_read_b64_tr_b16 v[144:145], v224 offset:30848
ds_read_b64_tr_b16 v[146:147], v224 offset:33920
v_add_f32 v246, v246, v96
v_add_f32 v247, v247, v97
v_cvt_pk_bf16_f32 v96, v96, v97
v_mfma_f32_32x32x16_bf16 a[48:63], v[148:151], v[72:75], a[48:63]
ds_read_b64_tr_b16 v[148:149], v223 offset:30976
ds_read_b64_tr_b16 v[150:151], v223 offset:34048
v_exp_f32 v98, v98
v_exp_f32 v99, v99
v_mfma_f32_32x32x16_bf16 a[64:79], v[152:155], v[72:75], a[64:79]
ds_read_b64_tr_b16 v[152:153], v224 offset:30976
ds_read_b64_tr_b16 v[154:155], v224 offset:34048
buffer_load_dwordx4 v230, s[20:23], s38 offen offset:1024 lds
v_mfma_f32_32x32x16_bf16 a[80:95], v[128:131], v[72:75], a[80:95]
ds_read_b64_tr_b16 v[128:129], v223 offset:36864
ds_read_b64_tr_b16 v[130:131], v223 offset:39936
v_add_f32 v246, v246, v98
v_add_f32 v247, v247, v99
v_cvt_pk_bf16_f32 v97, v98, v99
v_mfma_f32_32x32x16_bf16 a[0:15], v[132:135], v[80:83], a[0:15]
ds_read_b64_tr_b16 v[132:133], v224 offset:36864
ds_read_b64_tr_b16 v[134:135], v224 offset:39936
v_exp_f32 v100, v100
v_exp_f32 v101, v101
s_waitcnt lgkmcnt(6)
v_mfma_f32_32x32x16_bf16 a[16:31], v[136:139], v[80:83], a[16:31]
ds_read_b64_tr_b16 v[136:137], v223 offset:36992
ds_read_b64_tr_b16 v[138:139], v223 offset:40064
v_add_f32 v246, v246, v100
v_add_f32 v247, v247, v101
v_cvt_pk_bf16_f32 v98, v100, v101
v_mfma_f32_32x32x16_bf16 a[32:47], v[140:143], v[80:83], a[32:47]
ds_read_b64_tr_b16 v[140:141], v224 offset:36992
ds_read_b64_tr_b16 v[142:143], v224 offset:40064
buffer_load_dwordx4 v231, s[20:23], s38 offen offset:2048 lds
v_exp_f32 v102, v102
v_exp_f32 v103, v103
v_mfma_f32_32x32x16_bf16 a[48:63], v[144:147], v[80:83], a[48:63]
ds_read_b64_tr_b16 v[144:145], v223 offset:37120
ds_read_b64_tr_b16 v[146:147], v223 offset:40192
v_mfma_f32_32x32x16_bf16 a[64:79], v[148:151], v[80:83], a[64:79]
ds_read_b64_tr_b16 v[148:149], v224 offset:37120
ds_read_b64_tr_b16 v[150:151], v224 offset:40192
v_add_f32 v246, v246, v102
v_add_f32 v247, v247, v103
v_cvt_pk_bf16_f32 v99, v102, v103
s_waitcnt lgkmcnt(6)
v_mfma_f32_32x32x16_bf16 a[80:95], v[152:155], v[80:83], a[80:95]
ds_read_b64_tr_b16 v[152:153], v223 offset:43008
ds_read_b64_tr_b16 v[154:155], v223 offset:46080
buffer_load_dwordx4 v232, s[20:23], s38 offen offset:3072 lds
v_exp_f32 v104, v104
v_exp_f32 v105, v105
v_mfma_f32_32x32x16_bf16 a[0:15], v[128:131], v[88:91], a[0:15]
ds_read_b64_tr_b16 v[128:129], v224 offset:43008
ds_read_b64_tr_b16 v[130:131], v224 offset:46080
v_mfma_f32_32x32x16_bf16 a[16:31], v[132:135], v[88:91], a[16:31]
ds_read_b64_tr_b16 v[132:133], v223 offset:43136
ds_read_b64_tr_b16 v[134:135], v223 offset:46208
v_add_f32 v248, v248, v104
v_add_f32 v248, v248, v105
v_cvt_pk_bf16_f32 v104, v104, v105
v_mfma_f32_32x32x16_bf16 a[32:47], v[136:139], v[88:91], a[32:47]
ds_read_b64_tr_b16 v[136:137], v224 offset:43136
ds_read_b64_tr_b16 v[138:139], v224 offset:46208
v_exp_f32 v106, v106
v_exp_f32 v107, v107
s_waitcnt lgkmcnt(6)
v_mfma_f32_32x32x16_bf16 a[48:63], v[140:143], v[88:91], a[48:63]
ds_read_b64_tr_b16 v[140:141], v223 offset:43264
ds_read_b64_tr_b16 v[142:143], v223 offset:46336
s_add_u32 m0, s36, 0x19000
s_nop 0
buffer_load_dwordx4 v233, s[20:23], s38 offen offset:0 lds
v_mfma_f32_32x32x16_bf16 a[64:79], v[144:147], v[88:91], a[64:79]
ds_read_b64_tr_b16 v[144:145], v224 offset:43264
ds_read_b64_tr_b16 v[146:147], v224 offset:46336
v_add_f32 v248, v248, v106
v_add_f32 v248, v248, v107
v_cvt_pk_bf16_f32 v105, v106, v107
v_mfma_f32_32x32x16_bf16 a[80:95], v[148:151], v[88:91], a[80:95]
ds_read_b64_tr_b16 v[148:149], v225 offset:24576
ds_read_b64_tr_b16 v[150:151], v226 offset:24576
v_mfma_f32_32x32x16_bf16 a[0:15], v[152:155], v[96:99], a[0:15]
ds_read_b64_tr_b16 v[152:153], v227 offset:24576
ds_read_b64_tr_b16 v[154:155], v228 offset:24576
s_waitcnt lgkmcnt(6)
v_mfma_f32_32x32x16_bf16 a[16:31], v[128:131], v[96:99], a[16:31]
ds_read_b64_tr_b16 v[128:129], v225 offset:24704
ds_read_b64_tr_b16 v[130:131], v226 offset:24704
s_add_u32 m0, s33, 0x6000
s_mov_b32 s39, 0x32a000
buffer_load_dwordx4 v208, s[4:7], s39 offen offset:0 nt lds
v_mfma_f32_32x32x16_bf16 a[32:47], v[132:135], v[96:99], a[32:47]
ds_read_b64_tr_b16 v[132:133], v227 offset:24704
ds_read_b64_tr_b16 v[134:135], v228 offset:24704
v_mfma_f32_32x32x16_bf16 a[48:63], v[136:139], v[96:99], a[48:63]
ds_read_b64_tr_b16 v[136:137], v225 offset:24832
ds_read_b64_tr_b16 v[138:139], v226 offset:24832
v_mfma_f32_32x32x16_bf16 a[64:79], v[140:143], v[96:99], a[64:79]
ds_read_b64_tr_b16 v[140:141], v227 offset:24832
ds_read_b64_tr_b16 v[142:143], v228 offset:24832
buffer_load_dwordx4 v209, s[4:7], s39 offen offset:1024 nt lds
s_waitcnt lgkmcnt(6)
v_mfma_f32_32x32x16_bf16 a[80:95], v[144:147], v[96:99], a[80:95]
s_waitcnt vmcnt(19)
s_barrier
ds_read_b128 v[144:147], v217 offset:0
v_mfma_f32_16x16x16_bf16 a[96:99], v[148:149], v[104:105], a[96:99]
v_mfma_f32_16x16x16_bf16 a[100:103], v[150:151], v[104:105], a[100:103]
ds_read_b128 v[148:151], v218 offset:0
v_mfma_f32_16x16x16_bf16 a[104:107], v[152:153], v[104:105], a[104:107]
buffer_load_dwordx4 v210, s[4:7], s39 offen offset:2048 nt lds
v_mfma_f32_16x16x16_bf16 a[108:111], v[154:155], v[104:105], a[108:111]
ds_read_b128 v[152:155], v219 offset:0
v_mfma_f32_16x16x16_bf16 a[112:115], v[128:129], v[104:105], a[112:115]
v_mfma_f32_16x16x16_bf16 a[116:119], v[130:131], v[104:105], a[116:119]
ds_read_b128 v[128:131], v220 offset:0
s_waitcnt lgkmcnt(4)
v_mfma_f32_16x16x16_bf16 a[120:123], v[132:133], v[104:105], a[120:123]
buffer_load_dwordx4 v211, s[4:7], s39 offen offset:3072 nt lds
v_mfma_f32_16x16x16_bf16 a[124:127], v[134:135], v[104:105], a[124:127]
ds_read_b128 v[132:135], v217 offset:128
v_mfma_f32_16x16x16_bf16 a[128:131], v[136:137], v[104:105], a[128:131]
v_mfma_f32_16x16x16_bf16 a[132:135], v[138:139], v[104:105], a[132:135]
ds_read_b128 v[136:139], v218 offset:128
v_mfma_f32_16x16x16_bf16 a[136:139], v[140:141], v[104:105], a[136:139]
s_add_u32 m0, s33, 0x7000
s_nop 0
buffer_load_dwordx4 v212, s[4:7], s39 offen offset:0 nt lds
buffer_load_dwordx4 v213, s[4:7], s39 offen offset:1024 nt lds
v_mfma_f32_16x16x16_bf16 a[140:143], v[142:143], v[104:105], a[140:143]
s_waitcnt lgkmcnt(2)
v_mfma_f32_32x32x16_bf16 v[72:87], v[144:147], v[0:3], v[108:123]
ds_read_b128 v[140:143], v219 offset:128
ds_read_b128 v[144:147], v220 offset:128
v_mfma_f32_32x32x16_bf16 v[72:87], v[148:151], v[4:7], v[72:87]
ds_read_b128 v[148:151], v217 offset:256
s_add_u32 s59, s53, 0x2000
buffer_load_dwordx4 v[204:207], v243, s[24:27], s59 offen offset:0 sc1
v_mfma_f32_32x32x16_bf16 v[72:87], v[152:155], v[8:11], v[72:87]
ds_read_b128 v[152:155], v218 offset:256
v_mfma_f32_32x32x16_bf16 v[72:87], v[128:131], v[12:15], v[72:87]
ds_read_b128 v[128:131], v219 offset:256
buffer_load_dwordx4 a[224:227], v243, s[24:27], s59 offen offset:1024 sc1
s_waitcnt lgkmcnt(5)
v_mfma_f32_32x32x16_bf16 v[72:87], v[132:135], v[16:19], v[72:87]
ds_read_b128 v[132:135], v220 offset:256
v_mfma_f32_32x32x16_bf16 v[72:87], v[136:139], v[20:23], v[72:87]
ds_read_b64_tr_b16 v[136:137], v235 offset:43008
ds_read_b64_tr_b16 v[138:139], v235 offset:45568
s_waitcnt lgkmcnt(5)
v_mfma_f32_32x32x16_bf16 v[72:87], v[140:143], v[24:27], v[72:87]
ds_read_b64_tr_b16 v[140:141], v235 offset:43072
ds_read_b64_tr_b16 v[142:143], v235 offset:45632
buffer_load_dwordx4 a[228:231], v243, s[24:27], s59 offen offset:2048 sc1
v_mfma_f32_32x32x16_bf16 v[72:87], v[144:147], v[28:31], v[72:87]
ds_read_b64_tr_b16 v[144:145], v235 offset:43136
ds_read_b64_tr_b16 v[146:147], v235 offset:45696
v_mfma_f32_32x32x16_bf16 v[72:87], v[148:151], v[32:35], v[72:87]
ds_read_b128 v[148:151], v217 offset:12288
buffer_load_dwordx4 a[232:235], v243, s[24:27], s59 offen offset:3072 sc1
s_waitcnt lgkmcnt(6)
v_mfma_f32_32x32x16_bf16 v[72:87], v[152:155], v[36:39], v[72:87]
ds_read_b128 v[152:155], v218 offset:12288
v_mfma_f32_32x32x16_bf16 v[72:87], v[128:131], v[40:43], v[72:87]
ds_read_b128 v[128:131], v219 offset:12288
v_mfma_f32_32x32x16_bf16 v[72:87], v[132:135], v[44:47], v[72:87]
ds_read_b128 v[132:135], v220 offset:12288
s_add_u32 s59, s53, 0x1000
buffer_load_dwordx4 a[236:239], v244, s[24:27], s59 offen offset:0 sc1
s_waitcnt lgkmcnt(4)
s_waitcnt vmcnt(27)
v_mfma_f32_32x32x16_bf16 a[144:159], v[136:139], v[180:183], a[144:159]
ds_read_b128 v[136:139], v217 offset:12416
s_nop 2
v_max3_f32 v249, v72, v73, v74
v_max3_f32 v249, v249, v75, v76
v_max3_f32 v249, v249, v77, v78
v_max3_f32 v249, v249, v79, v80
v_max3_f32 v249, v249, v81, v82
v_mfma_f32_32x32x16_bf16 a[160:175], v[140:143], v[180:183], a[160:175]
ds_read_b128 v[140:143], v218 offset:12416
v_max3_f32 v249, v249, v83, v84
v_max3_f32 v249, v249, v85, v86
v_max_f32 v249, v249, v87
v_cmp_lt_f32 vcc, 0x41000000, v249
s_nop 0
s_cbranch_vccnz L_fb38
L_rt38:
v_mfma_f32_32x32x16_bf16 a[176:191], v[144:147], v[180:183], a[176:191]
ds_read_b128 v[144:147], v219 offset:12416
buffer_load_dwordx4 a[252:255], v244, s[24:27], s59 offen offset:1024 sc1
v_exp_f32 v72, v72
v_exp_f32 v73, v73
s_waitcnt lgkmcnt(2)
v_mfma_f32_32x32x16_bf16 v[88:103], v[148:151], v[0:3], v[108:123]
ds_read_b128 v[148:151], v220 offset:12416
v_add_f32 v246, v246, v72
v_add_f32 v247, v247, v73
v_cvt_pk_bf16_f32 v72, v72, v73
v_mfma_f32_32x32x16_bf16 v[88:103], v[152:155], v[4:7], v[88:103]
ds_read_b128 v[152:155], v217 offset:12544
s_add_u32 m0, s33, 0x12000
s_mov_b32 s39, 0x32a000
buffer_load_dwordx4 v214, s[8:11], s39 offen offset:0 nt lds
v_mfma_f32_32x32x16_bf16 v[88:103], v[128:131], v[8:11], v[88:103]
ds_read_b128 v[128:131], v218 offset:12544
v_exp_f32 v74, v74
v_exp_f32 v75, v75
v_mfma_f32_32x32x16_bf16 v[88:103], v[132:135], v[12:15], v[88:103]
ds_read_b128 v[132:135], v219 offset:12544
v_add_f32 v246, v246, v74
v_add_f32 v247, v247, v75
v_cvt_pk_bf16_f32 v73, v74, v75
v_exp_f32 v76, v76
v_exp_f32 v77, v77
v_mfma_f32_32x32x16_bf16 v[88:103], v[136:139], v[16:19], v[88:103]
ds_read_b128 v[136:139], v220 offset:12544
buffer_load_dwordx4 v215, s[8:11], s39 offen offset:1024 nt lds
s_waitcnt lgkmcnt(2)
v_mfma_f32_32x32x16_bf16 v[88:103], v[140:143], v[20:23], v[88:103]
ds_read_b128 v[140:143], v221 offset:0
v_add_f32 v246, v246, v76
v_add_f32 v247, v247, v77
v_cvt_pk_bf16_f32 v74, v76, v77
v_exp_f32 v78, v78
v_exp_f32 v79, v79
v_mfma_f32_32x32x16_bf16 v[88:103], v[144:147], v[24:27], v[88:103]
ds_read_b64_tr_b16 v[144:145], v237 offset:43008
ds_read_b64_tr_b16 v[146:147], v237 offset:48128
buffer_load_dwordx4 v216, s[8:11], s39 offen offset:2048 nt lds
v_mfma_f32_32x32x16_bf16 v[88:103], v[148:151], v[28:31], v[88:103]
ds_read_b128 v[148:151], v222 offset:0
v_add_f32 v246, v246, v78
v_add_f32 v247, v247, v79
v_cvt_pk_bf16_f32 v75, v78, v79
v_exp_f32 v80, v80
v_exp_f32 v81, v81
v_mfma_f32_32x32x16_bf16 v[88:103], v[152:155], v[32:35], v[88:103]
ds_read_b64_tr_b16 v[152:153], v235 offset:43200
ds_read_b64_tr_b16 v[154:155], v235 offset:45760
v_mfma_f32_32x32x16_bf16 v[88:103], v[128:131], v[36:39], v[88:103]
ds_read_b128 v[128:131], v221 offset:128
s_add_u32 m0, s33, 0x12c00
s_add_u32 s39, s39, 0xc00
buffer_load_dwordx4 v214, s[8:11], s39 offen offset:0 nt lds
s_waitcnt lgkmcnt(4)
v_mfma_f32_32x32x16_bf16 v[88:103], v[132:135], v[40:43], v[88:103]
ds_read_b64_tr_b16 v[132:133], v235 offset:43264
ds_read_b64_tr_b16 v[134:135], v235 offset:45824
v_add_f32 v246, v246, v80
v_add_f32 v247, v247, v81
v_cvt_pk_bf16_f32 v80, v80, v81
v_mfma_f32_32x32x16_bf16 v[88:103], v[136:139], v[44:47], v[88:103]
ds_read_b128 v[136:139], v222 offset:128
buffer_load_dwordx4 v215, s[8:11], s39 offen offset:1024 nt lds
v_exp_f32 v82, v82
v_exp_f32 v83, v83
v_mfma_f32_16x16x32_bf16 v[104:107], v[140:143], v[48:51], v[124:127]
ds_read_b64_tr_b16 v[140:141], v235 offset:48128
ds_read_b64_tr_b16 v[142:143], v235 offset:50688
s_waitcnt vmcnt(29)
v_mfma_f32_16x16x32_bf16 a[240:243], v[144:147], v[196:199], a[240:243]
ds_read_b128 v[144:147], v221 offset:256
s_waitcnt lgkmcnt(4)
v_mfma_f32_16x16x32_bf16 v[104:107], v[148:151], v[52:55], v[104:107]
ds_read_b64_tr_b16 v[148:149], v238 offset:43008
ds_read_b64_tr_b16 v[150:151], v238 offset:48128
v_mfma_f32_32x32x16_bf16 a[192:207], v[152:155], v[180:183], a[192:207]
ds_read_b128 v[152:155], v222 offset:256
buffer_load_dwordx4 v216, s[8:11], s39 offen offset:2048 nt lds
v_add_f32 v246, v246, v82
v_add_f32 v247, v247, v83
v_cvt_pk_bf16_f32 v81, v82, v83
v_mfma_f32_16x16x32_bf16 v[104:107], v[128:131], v[56:59], v[104:107]
ds_read_b64_tr_b16 v[128:129], v235 offset:48192
ds_read_b64_tr_b16 v[130:131], v235 offset:50752
v_mfma_f32_32x32x16_bf16 a[208:223], v[132:135], v[180:183], a[208:223]
ds_read_b64_tr_b16 v[132:133], v235 offset:48256
ds_read_b64_tr_b16 v[134:135], v235 offset:50816
v_exp_f32 v84, v84
v_exp_f32 v85, v85
s_waitcnt lgkmcnt(5)
v_mfma_f32_16x16x32_bf16 v[104:107], v[136:139], v[60:63], v[104:107]
ds_read_b64_tr_b16 v[136:137], v235 offset:48320
ds_read_b64_tr_b16 v[138:139], v235 offset:50880
v_mfma_f32_32x32x16_bf16 a[144:159], v[140:143], v[184:187], a[144:159]
ds_read_b64_tr_b16 v[140:141], v239 offset:43008
ds_read_b64_tr_b16 v[142:143], v239 offset:48128
v_add_f32 v246, v246, v84
v_add_f32 v247, v247, v85
v_cvt_pk_bf16_f32 v82, v84, v85
v_mfma_f32_16x16x32_bf16 v[104:107], v[144:147], v[64:67], v[104:107]
ds_read_b64_tr_b16 v[144:145], v235 offset:48384
ds_read_b64_tr_b16 v[146:147], v235 offset:50944
v_mfma_f32_16x16x32_bf16 a[244:247], v[148:151], v[196:199], a[244:247]
ds_read_b64_tr_b16 v[148:149], v235 offset:53248
ds_read_b64_tr_b16 v[150:151], v235 offset:55808
s_waitcnt lgkmcnt(8)
v_mfma_f32_16x16x32_bf16 v[104:107], v[152:155], v[68:71], v[104:107]
ds_read_b64_tr_b16 v[152:153], v235 offset:53312
ds_read_b64_tr_b16 v[154:155], v235 offset:55872
v_mfma_f32_32x32x16_bf16 a[160:175], v[128:131], v[184:187], a[160:175]
ds_read_b64_tr_b16 v[128:129], v237 offset:53248
ds_read_b64_tr_b16 v[130:131], v237 offset:58368
v_exp_f32 v86, v86
v_exp_f32 v87, v87
v_mfma_f32_32x32x16_bf16 a[176:191], v[132:135], v[184:187], a[176:191]
ds_read_b64_tr_b16 v[132:133], v235 offset:53376
ds_read_b64_tr_b16 v[134:135], v235 offset:55936
v_add_f32 v246, v246, v86
v_add_f32 v247, v247, v87
v_cvt_pk_bf16_f32 v83, v86, v87
v_max3_f32 v249, v88, v89, v90
s_waitcnt lgkmcnt(6)
v_mfma_f32_32x32x16_bf16 a[192:207], v[136:139], v[184:187], a[192:207]
ds_read_b64_tr_b16 v[136:137], v235 offset:53440
ds_read_b64_tr_b16 v[138:139], v235 offset:56000
v_max3_f32 v249, v249, v91, v92
v_max3_f32 v249, v249, v93, v94
v_max3_f32 v249, v249, v95, v96
v_max3_f32 v249, v249, v97, v98
v_mfma_f32_16x16x32_bf16 a[248:251], v[140:143], v[196:199], a[248:251]
ds_read_b64_tr_b16 v[140:141], v235 offset:53504
ds_read_b64_tr_b16 v[142:143], v235 offset:56064
v_mfma_f32_32x32x16_bf16 a[208:223], v[144:147], v[184:187], a[208:223]
ds_read_b64_tr_b16 v[144:145], v238 offset:53248
ds_read_b64_tr_b16 v[146:147], v238 offset:58368
v_max3_f32 v249, v249, v99, v100
v_max3_f32 v249, v249, v101, v102
v_max_f32 v249, v249, v103
v_max3_f32 v252, v104, v105, v106
v_mfma_f32_32x32x16_bf16 a[144:159], v[148:151], v[188:191], a[144:159]
ds_read_b64_tr_b16 v[148:149], v235 offset:58368
ds_read_b64_tr_b16 v[150:151], v235 offset:60928
v_cmp_lt_f32 vcc, 0x41000000, v249
s_nop 0
s_cbranch_vccnz L_fb40
L_rt40:
v_exp_f32 v88, v88
v_exp_f32 v89, v89
s_waitcnt lgkmcnt(4)
v_mfma_f32_32x32x16_bf16 a[160:175], v[152:155], v[188:191], a[160:175]
ds_read_b64_tr_b16 v[152:153], v235 offset:58432
ds_read_b64_tr_b16 v[154:155], v235 offset:60992
v_max_f32 v252, v252, v107
s_waitcnt vmcnt(29)
v_mfma_f32_16x16x32_bf16 a[240:243], v[128:131], v[200:203], a[240:243]
ds_read_b64_tr_b16 v[128:129], v235 offset:58496
ds_read_b64_tr_b16 v[130:131], v235 offset:61056
v_mfma_f32_32x32x16_bf16 a[176:191], v[132:135], v[188:191], a[176:191]
ds_read_b64_tr_b16 v[132:133], v239 offset:53248
ds_read_b64_tr_b16 v[134:135], v239 offset:58368
v_add_f32 v246, v246, v88
v_add_f32 v247, v247, v89
v_cvt_pk_bf16_f32 v88, v88, v89
v_mfma_f32_32x32x16_bf16 a[192:207], v[136:139], v[188:191], a[192:207]
ds_read_b64_tr_b16 v[136:137], v235 offset:58560
ds_read_b64_tr_b16 v[138:139], v235 offset:61120
v_exp_f32 v90, v90
v_exp_f32 v91, v91
v_mfma_f32_32x32x16_bf16 a[208:223], v[140:143], v[188:191], a[208:223]
ds_read_b64_tr_b16 v[140:141], v235 offset:58624
ds_read_b64_tr_b16 v[142:143], v235 offset:61184
s_waitcnt vmcnt(23)
s_barrier
v_cmp_lt_f32 vcc, 0x41000000, v252
s_nop 0
s_cbranch_vccnz L_fb39
L_rt39:
s_waitcnt lgkmcnt(4)
v_mfma_f32_16x16x32_bf16 a[244:247], v[144:147], v[200:203], a[244:247]
ds_read_b64_tr_b16 v[144:145], v223 offset:0
ds_read_b64_tr_b16 v[146:147], v223 offset:3072
v_mfma_f32_32x32x16_bf16 a[144:159], v[148:151], v[192:195], a[144:159]
ds_read_b64_tr_b16 v[148:149], v224 offset:0
ds_read_b64_tr_b16 v[150:151], v224 offset:3072
v_add_f32 v246, v246, v90
v_add_f32 v247, v247, v91
v_cvt_pk_bf16_f32 v89, v90, v91
v_mfma_f32_32x32x16_bf16 a[160:175], v[152:155], v[192:195], a[160:175]
ds_read_b64_tr_b16 v[152:153], v223 offset:128
ds_read_b64_tr_b16 v[154:155], v223 offset:3200
v_exp_f32 v92, v92
v_exp_f32 v93, v93
v_mfma_f32_32x32x16_bf16 a[176:191], v[128:131], v[192:195], a[176:191]
ds_read_b64_tr_b16 v[128:129], v224 offset:128
ds_read_b64_tr_b16 v[130:131], v224 offset:3200
v_add_f32 v246, v246, v92
v_add_f32 v247, v247, v93
v_cvt_pk_bf16_f32 v90, v92, v93
v_mfma_f32_16x16x32_bf16 a[248:251], v[132:135], v[200:203], a[248:251]
ds_read_b64_tr_b16 v[132:133], v223 offset:256
ds_read_b64_tr_b16 v[134:135], v223 offset:3328
s_waitcnt lgkmcnt(6)
v_mfma_f32_32x32x16_bf16 a[192:207], v[136:139], v[192:195], a[192:207]
ds_read_b64_tr_b16 v[136:137], v224 offset:256
ds_read_b64_tr_b16 v[138:139], v224 offset:3328
v_exp_f32 v94, v94
v_exp_f32 v95, v95
v_mfma_f32_32x32x16_bf16 a[208:223], v[140:143], v[192:195], a[208:223]
ds_read_b64_tr_b16 v[140:141], v223 offset:6144
ds_read_b64_tr_b16 v[142:143], v223 offset:9216
v_add_f32 v246, v246, v94
v_add_f32 v247, v247, v95
v_cvt_pk_bf16_f32 v91, v94, v95
v_mfma_f32_32x32x16_bf16 a[0:15], v[144:147], v[72:75], a[0:15]
ds_read_b64_tr_b16 v[144:145], v224 offset:6144
ds_read_b64_tr_b16 v[146:147], v224 offset:9216
v_exp_f32 v96, v96
v_exp_f32 v97, v97
v_mfma_f32_32x32x16_bf16 a[16:31], v[148:151], v[72:75], a[16:31]
ds_read_b64_tr_b16 v[148:149], v223 offset:6272
ds_read_b64_tr_b16 v[150:151], v223 offset:9344
s_add_u32 s59, s54, 0x0
buffer_load_dwordx4 v[156:159], v243, s[24:27], s59 offen offset:0 sc1
s_waitcnt lgkmcnt(5)
v_mfma_f32_32x32x16_bf16 a[32:47], v[152:155], v[72:75], a[32:47]
ds_read_b64_tr_b16 v[152:153], v224 offset:6272
ds_read_b64_tr_b16 v[154:155], v224 offset:9344
v_add_f32 v246, v246, v96
v_add_f32 v247, v247, v97
v_cvt_pk_bf16_f32 v96, v96, v97
v_mfma_f32_32x32x16_bf16 a[48:63], v[128:131], v[72:75], a[48:63]
ds_read_b64_tr_b16 v[128:129], v223 offset:6400
ds_read_b64_tr_b16 v[130:131], v223 offset:9472
buffer_load_dwordx4 v[160:163], v243, s[24:27], s59 offen offset:1024 sc1
v_exp_f32 v98, v98
v_exp_f32 v99, v99
v_mfma_f32_32x32x16_bf16 a[64:79], v[132:135], v[72:75], a[64:79]
ds_read_b64_tr_b16 v[132:133], v224 offset:6400
ds_read_b64_tr_b16 v[134:135], v224 offset:9472
v_mfma_f32_32x32x16_bf16 a[80:95], v[136:139], v[72:75], a[80:95]
ds_read_b64_tr_b16 v[136:137], v223 offset:12288
ds_read_b64_tr_b16 v[138:139], v223 offset:15360
v_add_f32 v246, v246, v98
v_add_f32 v247, v247, v99
v_cvt_pk_bf16_f32 v97, v98, v99
s_waitcnt lgkmcnt(6)
v_mfma_f32_32x32x16_bf16 a[0:15], v[140:143], v[80:83], a[0:15]
ds_read_b64_tr_b16 v[140:141], v224 offset:12288
ds_read_b64_tr_b16 v[142:143], v224 offset:15360
buffer_load_dwordx4 v[164:167], v243, s[24:27], s59 offen offset:2048 sc1
v_exp_f32 v100, v100
v_exp_f32 v101, v101
v_mfma_f32_32x32x16_bf16 a[16:31], v[144:147], v[80:83], a[16:31]
ds_read_b64_tr_b16 v[144:145], v223 offset:12416
ds_read_b64_tr_b16 v[146:147], v223 offset:15488
v_mfma_f32_32x32x16_bf16 a[32:47], v[148:151], v[80:83], a[32:47]
ds_read_b64_tr_b16 v[148:149], v224 offset:12416
ds_read_b64_tr_b16 v[150:151], v224 offset:15488
buffer_load_dwordx4 v[168:171], v243, s[24:27], s59 offen offset:3072 sc1
v_mfma_f32_32x32x16_bf16 a[48:63], v[152:155], v[80:83], a[48:63]
ds_read_b64_tr_b16 v[152:153], v223 offset:12544
ds_read_b64_tr_b16 v[154:155], v223 offset:15616
v_add_f32 v246, v246, v100
v_add_f32 v247, v247, v101
v_cvt_pk_bf16_f32 v98, v100, v101
s_waitcnt lgkmcnt(6)
v_mfma_f32_32x32x16_bf16 a[64:79], v[128:131], v[80:83], a[64:79]
ds_read_b64_tr_b16 v[128:129], v224 offset:12544
ds_read_b64_tr_b16 v[130:131], v224 offset:15616
v_exp_f32 v102, v102
v_exp_f32 v103, v103
v_mfma_f32_32x32x16_bf16 a[80:95], v[132:135], v[80:83], a[80:95]
ds_read_b64_tr_b16 v[132:133], v223 offset:18432
ds_read_b64_tr_b16 v[134:135], v223 offset:21504
s_add_u32 s59, s54, 0x0
buffer_load_dwordx4 v[172:175], v244, s[24:27], s59 offen offset:0 sc1
v_mfma_f32_32x32x16_bf16 a[0:15], v[136:139], v[88:91], a[0:15]
ds_read_b64_tr_b16 v[136:137], v224 offset:18432
ds_read_b64_tr_b16 v[138:139], v224 offset:21504
v_add_f32 v246, v246, v102
v_add_f32 v247, v247, v103
v_cvt_pk_bf16_f32 v99, v102, v103
v_mfma_f32_32x32x16_bf16 a[16:31], v[140:143], v[88:91], a[16:31]
ds_read_b64_tr_b16 v[140:141], v223 offset:18560
ds_read_b64_tr_b16 v[142:143], v223 offset:21632
buffer_load_dwordx4 v[176:179], v244, s[24:27], s59 offen offset:1024 sc1
v_exp_f32 v104, v104
v_exp_f32 v105, v105
s_waitcnt lgkmcnt(4)
v_mfma_f32_32x32x16_bf16 a[32:47], v[144:147], v[88:91], a[32:47]
ds_read_b64_tr_b16 v[144:145], v224 offset:18560
ds_read_b64_tr_b16 v[146:147], v224 offset:21632
v_mfma_f32_32x32x16_bf16 a[48:63], v[148:151], v[88:91], a[48:63]
ds_read_b64_tr_b16 v[148:149], v223 offset:18688
ds_read_b64_tr_b16 v[150:151], v223 offset:21760
v_add_f32 v248, v248, v104
v_add_f32 v248, v248, v105
v_cvt_pk_bf16_f32 v104, v104, v105
v_mfma_f32_32x32x16_bf16 a[64:79], v[152:155], v[88:91], a[64:79]
ds_read_b64_tr_b16 v[152:153], v224 offset:18688
ds_read_b64_tr_b16 v[154:155], v224 offset:21760
s_add_u32 m0, s36, 0x1d400
s_add_u32 s38, s50, 0x0
buffer_load_dwordx4 v229, s[20:23], s38 offen offset:0 lds
v_mfma_f32_32x32x16_bf16 a[80:95], v[128:131], v[88:91], a[80:95]
ds_read_b64_tr_b16 v[128:129], v225 offset:0
ds_read_b64_tr_b16 v[130:131], v226 offset:0
v_exp_f32 v106, v106
v_exp_f32 v107, v107
v_mfma_f32_32x32x16_bf16 a[0:15], v[132:135], v[96:99], a[0:15]
ds_read_b64_tr_b16 v[132:133], v227 offset:0
ds_read_b64_tr_b16 v[134:135], v228 offset:0
buffer_load_dwordx4 v230, s[20:23], s38 offen offset:1024 lds
s_waitcnt lgkmcnt(5)
v_mfma_f32_32x32x16_bf16 a[16:31], v[136:139], v[96:99], a[16:31]
ds_read_b64_tr_b16 v[136:137], v225 offset:128
ds_read_b64_tr_b16 v[138:139], v226 offset:128
v_add_f32 v248, v248, v106
v_add_f32 v248, v248, v107
v_cvt_pk_bf16_f32 v105, v106, v107
v_mfma_f32_32x32x16_bf16 a[32:47], v[140:143], v[96:99], a[32:47]
ds_read_b64_tr_b16 v[140:141], v227 offset:128
ds_read_b64_tr_b16 v[142:143], v228 offset:128
v_mfma_f32_32x32x16_bf16 a[48:63], v[144:147], v[96:99], a[48:63]
ds_read_b64_tr_b16 v[144:145], v225 offset:256
ds_read_b64_tr_b16 v[146:147], v226 offset:256
buffer_load_dwordx4 v231, s[20:23], s38 offen offset:2048 lds
v_mfma_f32_32x32x16_bf16 a[64:79], v[148:151], v[96:99], a[64:79]
ds_read_b64_tr_b16 v[148:149], v227 offset:256
ds_read_b64_tr_b16 v[150:151], v228 offset:256
s_waitcnt lgkmcnt(6)
v_mfma_f32_32x32x16_bf16 a[80:95], v[152:155], v[96:99], a[80:95]
s_waitcnt vmcnt(21)
s_barrier
ds_read_b128 v[152:155], v217 offset:24576
buffer_load_dwordx4 v232, s[20:23], s38 offen offset:3072 lds
v_mfma_f32_16x16x16_bf16 a[96:99], v[128:129], v[104:105], a[96:99]
v_mfma_f32_16x16x16_bf16 a[100:103], v[130:131], v[104:105], a[100:103]
ds_read_b128 v[128:131], v218 offset:24576
v_mfma_f32_16x16x16_bf16 a[104:107], v[132:133], v[104:105], a[104:107]
v_mfma_f32_16x16x16_bf16 a[108:111], v[134:135], v[104:105], a[108:111]
ds_read_b128 v[132:135], v219 offset:24576
v_mfma_f32_16x16x16_bf16 a[112:115], v[136:137], v[104:105], a[112:115]
s_add_u32 m0, s36, 0x1e400
s_nop 0
buffer_load_dwordx4 v233, s[20:23], s38 offen offset:0 lds
v_mfma_f32_16x16x16_bf16 a[116:119], v[138:139], v[104:105], a[116:119]
ds_read_b128 v[136:139], v220 offset:24576
s_waitcnt lgkmcnt(3)
v_mfma_f32_16x16x16_bf16 a[120:123], v[140:141], v[104:105], a[120:123]
s_add_u32 m0, s36, 0x1000
s_add_u32 s38, s48, 0x3c0000
buffer_load_dwordx4 v229, s[20:23], s38 offen offset:0 lds
v_mfma_f32_16x16x16_bf16 a[124:127], v[142:143], v[104:105], a[124:127]
v_mfma_f32_16x16x16_bf16 a[128:131], v[144:145], v[104:105], a[128:131]
ds_read_b128 v[140:143], v217 offset:24704
v_mfma_f32_16x16x16_bf16 a[132:135], v[146:147], v[104:105], a[132:135]
ds_read_b128 v[144:147], v218 offset:24704
buffer_load_dwordx4 v230, s[20:23], s38 offen offset:1024 lds
v_mfma_f32_16x16x16_bf16 a[136:139], v[148:149], v[104:105], a[136:139]
buffer_load_dwordx4 v231, s[20:23], s38 offen offset:2048 lds
buffer_load_dwordx4 v232, s[20:23], s38 offen offset:3072 lds
s_add_u32 m0, s36, 0x2000
s_nop 0
buffer_load_dwordx4 v233, s[20:23], s38 offen offset:0 lds
v_mfma_f32_16x16x16_bf16 a[140:143], v[150:151], v[104:105], a[140:143]
v_mfma_f32_32x32x16_bf16 v[72:87], v[152:155], v[0:3], v[108:123]
ds_read_b128 v[148:151], v219 offset:24704
ds_read_b128 v[152:155], v220 offset:24704
s_waitcnt lgkmcnt(3)
v_mfma_f32_32x32x16_bf16 v[72:87], v[128:131], v[4:7], v[72:87]
ds_read_b128 v[128:131], v217 offset:24832
s_add_u32 s59, s54, 0x1000
buffer_load_dwordx4 v[180:183], v243, s[24:27], s59 offen offset:0 sc1
v_mfma_f32_32x32x16_bf16 v[72:87], v[132:135], v[8:11], v[72:87]
ds_read_b128 v[132:135], v218 offset:24832
buffer_load_dwordx4 v[184:187], v243, s[24:27], s59 offen offset:1024 sc1
v_mfma_f32_32x32x16_bf16 v[72:87], v[136:139], v[12:15], v[72:87]
ds_read_b128 v[136:139], v219 offset:24832
v_mfma_f32_32x32x16_bf16 v[72:87], v[140:143], v[16:19], v[72:87]
ds_read_b128 v[140:143], v220 offset:24832
buffer_load_dwordx4 v[188:191], v243, s[24:27], s59 offen offset:2048 sc1
s_waitcnt lgkmcnt(4)
v_mfma_f32_32x32x16_bf16 v[72:87], v[144:147], v[20:23], v[72:87]
ds_read_b64_tr_b16 v[144:145], v235 offset:0
ds_read_b64_tr_b16 v[146:147], v235 offset:2560
v_mfma_f32_32x32x16_bf16 v[72:87], v[148:151], v[24:27], v[72:87]
ds_read_b64_tr_b16 v[148:149], v235 offset:64
ds_read_b64_tr_b16 v[150:151], v235 offset:2624
buffer_load_dwordx4 v[192:195], v243, s[24:27], s59 offen offset:3072 sc1
v_mfma_f32_32x32x16_bf16 v[72:87], v[152:155], v[28:31], v[72:87]
ds_read_b64_tr_b16 v[152:153], v235 offset:128
ds_read_b64_tr_b16 v[154:155], v235 offset:2688
s_waitcnt lgkmcnt(6)
v_mfma_f32_32x32x16_bf16 v[72:87], v[128:131], v[32:35], v[72:87]
ds_read_b128 v[128:131], v217 offset:36864
s_add_u32 s59, s54, 0x800
buffer_load_dwordx4 v[196:199], v244, s[24:27], s59 offen offset:0 sc1
v_mfma_f32_32x32x16_bf16 v[72:87], v[132:135], v[36:39], v[72:87]
ds_read_b128 v[132:135], v218 offset:36864
v_mfma_f32_32x32x16_bf16 v[72:87], v[136:139], v[40:43], v[72:87]
ds_read_b128 v[136:139], v219 offset:36864
buffer_load_dwordx4 v[200:203], v244, s[24:27], s59 offen offset:1024 sc1
v_mfma_f32_32x32x16_bf16 v[72:87], v[140:143], v[44:47], v[72:87]
ds_read_b128 v[140:143], v220 offset:36864
s_waitcnt lgkmcnt(4)
s_waitcnt vmcnt(33)
v_mfma_f32_32x32x16_bf16 a[144:159], v[144:147], v[204:207], a[144:159]
ds_read_b128 v[144:147], v217 offset:36992
s_add_u32 m0, s36, 0x22800
s_add_u32 s38, s50, 0x14000
buffer_load_dwordx4 v229, s[20:23], s38 offen offset:0 lds
v_max3_f32 v249, v72, v73, v74
v_mfma_f32_32x32x16_bf16 a[160:175], v[148:151], v[204:207], a[160:175]
ds_read_b128 v[148:151], v218 offset:36992
v_max3_f32 v249, v249, v75, v76
v_max3_f32 v249, v249, v77, v78
v_max3_f32 v249, v249, v79, v80
v_max3_f32 v249, v249, v81, v82
v_max3_f32 v249, v249, v83, v84
v_mfma_f32_32x32x16_bf16 a[176:191], v[152:155], v[204:207], a[176:191]
ds_read_b128 v[152:155], v219 offset:36992
v_max3_f32 v249, v249, v85, v86
v_max_f32 v249, v249, v87
v_cmp_lt_f32 vcc, 0x41000000, v249
s_nop 0
s_cbranch_vccnz L_fb41
L_rt41:
s_waitcnt lgkmcnt(2)
v_mfma_f32_32x32x16_bf16 v[88:103], v[128:131], v[0:3], v[108:123]
ds_read_b128 v[128:131], v220 offset:36992
buffer_load_dwordx4 v230, s[20:23], s38 offen offset:1024 lds
v_exp_f32 v72, v72
v_exp_f32 v73, v73
v_mfma_f32_32x32x16_bf16 v[88:103], v[132:135], v[4:7], v[88:103]
ds_read_b128 v[132:135], v217 offset:37120
buffer_load_dwordx4 v231, s[20:23], s38 offen offset:2048 lds
v_mfma_f32_32x32x16_bf16 v[88:103], v[136:139], v[8:11], v[88:103]
ds_read_b128 v[136:139], v218 offset:37120
v_add_f32 v246, v246, v72
v_add_f32 v247, v247, v73
v_cvt_pk_bf16_f32 v72, v72, v73
v_exp_f32 v74, v74
v_exp_f32 v75, v75
v_mfma_f32_32x32x16_bf16 v[88:103], v[140:143], v[12:15], v[88:103]
ds_read_b128 v[140:143], v219 offset:37120
buffer_load_dwordx4 v232, s[20:23], s38 offen offset:3072 lds
v_mfma_f32_32x32x16_bf16 v[88:103], v[144:147], v[16:19], v[88:103]
ds_read_b128 v[144:147], v220 offset:37120
v_add_f32 v246, v246, v74
v_add_f32 v247, v247, v75
v_cvt_pk_bf16_f32 v73, v74, v75
v_exp_f32 v76, v76
v_exp_f32 v77, v77
s_waitcnt lgkmcnt(2)
v_mfma_f32_32x32x16_bf16 v[88:103], v[148:151], v[20:23], v[88:103]
ds_read_b128 v[148:151], v221 offset:24576
s_add_u32 m0, s36, 0x23800
s_nop 0
buffer_load_dwordx4 v233, s[20:23], s38 offen offset:0 lds
v_mfma_f32_32x32x16_bf16 v[88:103], v[152:155], v[24:27], v[88:103]
ds_read_b64_tr_b16 v[152:153], v237 offset:0
ds_read_b64_tr_b16 v[154:155], v237 offset:5120
v_add_f32 v246, v246, v76
v_add_f32 v247, v247, v77
v_cvt_pk_bf16_f32 v74, v76, v77
v_mfma_f32_32x32x16_bf16 v[88:103], v[128:131], v[28:31], v[88:103]
ds_read_b128 v[128:131], v222 offset:24576
s_add_u32 m0, s36, 0xc000
s_add_u32 s38, s48, 0x3d4000
buffer_load_dwordx4 v229, s[20:23], s38 offen offset:0 lds
v_mfma_f32_32x32x16_bf16 v[88:103], v[132:135], v[32:35], v[88:103]
ds_read_b64_tr_b16 v[132:133], v235 offset:192
ds_read_b64_tr_b16 v[134:135], v235 offset:2752
v_exp_f32 v78, v78
v_exp_f32 v79, v79
v_mfma_f32_32x32x16_bf16 v[88:103], v[136:139], v[36:39], v[88:103]
ds_read_b128 v[136:139], v221 offset:24704
buffer_load_dwordx4 v230, s[20:23], s38 offen offset:1024 lds
v_add_f32 v246, v246, v78
v_add_f32 v247, v247, v79
v_cvt_pk_bf16_f32 v75, v78, v79
s_waitcnt lgkmcnt(3)
v_mfma_f32_32x32x16_bf16 v[88:103], v[140:143], v[40:43], v[88:103]
ds_read_b64_tr_b16 v[140:141], v235 offset:256
ds_read_b64_tr_b16 v[142:143], v235 offset:2816
v_exp_f32 v80, v80
v_exp_f32 v81, v81
v_mfma_f32_32x32x16_bf16 v[88:103], v[144:147], v[44:47], v[88:103]
ds_read_b128 v[144:147], v222 offset:24704
buffer_load_dwordx4 v231, s[20:23], s38 offen offset:2048 lds
v_add_f32 v246, v246, v80
v_add_f32 v247, v247, v81
v_cvt_pk_bf16_f32 v80, v80, v81
v_mfma_f32_16x16x32_bf16 v[104:107], v[148:151], v[48:51], v[124:127]
ds_read_b64_tr_b16 v[148:149], v235 offset:5120
ds_read_b64_tr_b16 v[150:151], v235 offset:7680
s_waitcnt vmcnt(37)
v_mfma_f32_16x16x32_bf16 a[240:243], v[152:155], a[236:239], a[240:243]
ds_read_b128 v[152:155], v221 offset:24832
v_mfma_f32_16x16x32_bf16 v[104:107], v[128:131], v[52:55], v[104:107]
ds_read_b64_tr_b16 v[128:129], v238 offset:0
ds_read_b64_tr_b16 v[130:131], v238 offset:5120
s_waitcnt lgkmcnt(6)
v_mfma_f32_32x32x16_bf16 a[192:207], v[132:135], v[204:207], a[192:207]
ds_read_b128 v[132:135], v222 offset:24832
buffer_load_dwordx4 v232, s[20:23], s38 offen offset:3072 lds
s_add_u32 m0, s36, 0xd000
s_nop 0
buffer_load_dwordx4 v233, s[20:23], s38 offen offset:0 lds
v_mfma_f32_16x16x32_bf16 v[104:107], v[136:139], v[56:59], v[104:107]
ds_read_b64_tr_b16 v[136:137], v235 offset:5184
ds_read_b64_tr_b16 v[138:139], v235 offset:7744
v_mfma_f32_32x32x16_bf16 a[208:223], v[140:143], v[204:207], a[208:223]
ds_read_b64_tr_b16 v[140:141], v235 offset:5248
ds_read_b64_tr_b16 v[142:143], v235 offset:7808
v_exp_f32 v82, v82
v_exp_f32 v83, v83
s_waitcnt lgkmcnt(5)
v_mfma_f32_16x16x32_bf16 v[104:107], v[144:147], v[60:63], v[104:107]
ds_read_b64_tr_b16 v[144:145], v235 offset:5312
ds_read_b64_tr_b16 v[146:147], v235 offset:7872
v_mfma_f32_32x32x16_bf16 a[144:159], v[148:151], a[224:227], a[144:159]
ds_read_b64_tr_b16 v[148:149], v239 offset:0
ds_read_b64_tr_b16 v[150:151], v239 offset:5120
v_add_f32 v246, v246, v82
v_add_f32 v247, v247, v83
v_cvt_pk_bf16_f32 v81, v82, v83
v_mfma_f32_16x16x32_bf16 v[104:107], v[152:155], v[64:67], v[104:107]
ds_read_b64_tr_b16 v[152:153], v235 offset:5376
ds_read_b64_tr_b16 v[154:155], v235 offset:7936
v_mfma_f32_16x16x32_bf16 a[244:247], v[128:131], a[236:239], a[244:247]
ds_read_b64_tr_b16 v[128:129], v235 offset:10240
ds_read_b64_tr_b16 v[130:131], v235 offset:12800
s_waitcnt lgkmcnt(8)
v_mfma_f32_16x16x32_bf16 v[104:107], v[132:135], v[68:71], v[104:107]
ds_read_b64_tr_b16 v[132:133], v235 offset:10304
ds_read_b64_tr_b16 v[134:135], v235 offset:12864
v_mfma_f32_32x32x16_bf16 a[160:175], v[136:139], a[224:227], a[160:175]
ds_read_b64_tr_b16 v[136:137], v237 offset:10240
ds_read_b64_tr_b16 v[138:139], v237 offset:15360
v_exp_f32 v84, v84
v_exp_f32 v85, v85
v_mfma_f32_32x32x16_bf16 a[176:191], v[140:143], a[224:227], a[176:191]
ds_read_b64_tr_b16 v[140:141], v235 offset:10368
ds_read_b64_tr_b16 v[142:143], v235 offset:12928
v_add_f32 v246, v246, v84
v_add_f32 v247, v247, v85
v_cvt_pk_bf16_f32 v82, v84, v85
v_max3_f32 v252, v104, v105, v106
s_waitcnt lgkmcnt(6)
v_mfma_f32_32x32x16_bf16 a[192:207], v[144:147], a[224:227], a[192:207]
ds_read_b64_tr_b16 v[144:145], v235 offset:10432
ds_read_b64_tr_b16 v[146:147], v235 offset:12992
v_exp_f32 v86, v86
v_exp_f32 v87, v87
v_mfma_f32_16x16x32_bf16 a[248:251], v[148:151], a[236:239], a[248:251]
ds_read_b64_tr_b16 v[148:149], v235 offset:10496
ds_read_b64_tr_b16 v[150:151], v235 offset:13056
v_mfma_f32_32x32x16_bf16 a[208:223], v[152:155], a[224:227], a[208:223]
ds_read_b64_tr_b16 v[152:153], v238 offset:10240
ds_read_b64_tr_b16 v[154:155], v238 offset:15360
v_add_f32 v246, v246, v86
v_add_f32 v247, v247, v87
v_cvt_pk_bf16_f32 v83, v86, v87
v_max3_f32 v249, v88, v89, v90
v_mfma_f32_32x32x16_bf16 a[144:159], v[128:131], a[228:231], a[144:159]
ds_read_b64_tr_b16 v[128:129], v235 offset:15360
ds_read_b64_tr_b16 v[130:131], v235 offset:17920
v_max3_f32 v249, v249, v91, v92
v_max3_f32 v249, v249, v93, v94
v_max3_f32 v249, v249, v95, v96
v_max3_f32 v249, v249, v97, v98
s_waitcnt lgkmcnt(6)
v_mfma_f32_32x32x16_bf16 a[160:175], v[132:135], a[228:231], a[160:175]
ds_read_b64_tr_b16 v[132:133], v235 offset:15424
ds_read_b64_tr_b16 v[134:135], v235 offset:17984
v_max3_f32 v249, v249, v99, v100
v_max3_f32 v249, v249, v101, v102
v_max_f32 v249, v249, v103
v_max_f32 v252, v252, v107
s_waitcnt vmcnt(38)
v_mfma_f32_16x16x32_bf16 a[240:243], v[136:139], a[252:255], a[240:243]
ds_read_b64_tr_b16 v[136:137], v235 offset:15488
ds_read_b64_tr_b16 v[138:139], v235 offset:18048
v_mfma_f32_32x32x16_bf16 a[176:191], v[140:143], a[228:231], a[176:191]
ds_read_b64_tr_b16 v[140:141], v239 offset:10240
ds_read_b64_tr_b16 v[142:143], v239 offset:15360
v_cmp_lt_f32 vcc, 0x41000000, v249
s_nop 0
s_cbranch_vccnz L_fb43
L_rt43:
v_cmp_lt_f32 vcc, 0x41000000, v252
s_nop 0
s_cbranch_vccnz L_fb42
L_rt42:
v_mfma_f32_32x32x16_bf16 a[192:207], v[144:147], a[228:231], a[192:207]
ds_read_b64_tr_b16 v[144:145], v235 offset:15552
ds_read_b64_tr_b16 v[146:147], v235 offset:18112
v_exp_f32 v104, v104
v_exp_f32 v105, v105
s_waitcnt lgkmcnt(5)
v_mfma_f32_32x32x16_bf16 a[208:223], v[148:151], a[228:231], a[208:223]
ds_read_b64_tr_b16 v[148:149], v235 offset:15616
ds_read_b64_tr_b16 v[150:151], v235 offset:18176
s_waitcnt vmcnt(32)
s_barrier
v_mfma_f32_16x16x32_bf16 a[244:247], v[152:155], a[252:255], a[244:247]
ds_read_b64_tr_b16 v[152:153], v223 offset:24576
ds_read_b64_tr_b16 v[154:155], v223 offset:27648
v_mfma_f32_32x32x16_bf16 a[144:159], v[128:131], a[232:235], a[144:159]
ds_read_b64_tr_b16 v[128:129], v224 offset:24576
ds_read_b64_tr_b16 v[130:131], v224 offset:27648
v_add_f32 v248, v248, v104
v_add_f32 v248, v248, v105
v_cvt_pk_bf16_f32 v104, v104, v105
v_mfma_f32_32x32x16_bf16 a[160:175], v[132:135], a[232:235], a[160:175]
ds_read_b64_tr_b16 v[132:133], v223 offset:24704
ds_read_b64_tr_b16 v[134:135], v223 offset:27776
v_exp_f32 v106, v106
v_exp_f32 v107, v107
s_waitcnt lgkmcnt(6)
v_mfma_f32_32x32x16_bf16 a[176:191], v[136:139], a[232:235], a[176:191]
ds_read_b64_tr_b16 v[136:137], v224 offset:24704
ds_read_b64_tr_b16 v[138:139], v224 offset:27776
v_add_f32 v248, v248, v106
v_add_f32 v248, v248, v107
v_cvt_pk_bf16_f32 v105, v106, v107
v_mfma_f32_16x16x32_bf16 a[248:251], v[140:143], a[252:255], a[248:251]
ds_read_b64_tr_b16 v[140:141], v223 offset:24832
ds_read_b64_tr_b16 v[142:143], v223 offset:27904
v_mfma_f32_32x32x16_bf16 a[192:207], v[144:147], a[232:235], a[192:207]
ds_read_b64_tr_b16 v[144:145], v224 offset:24832
ds_read_b64_tr_b16 v[146:147], v224 offset:27904
v_exp_f32 v88, v88
v_exp_f32 v89, v89
v_mfma_f32_32x32x16_bf16 a[208:223], v[148:151], a[232:235], a[208:223]
ds_read_b64_tr_b16 v[148:149], v223 offset:30720
ds_read_b64_tr_b16 v[150:151], v223 offset:33792
v_add_f32 v246, v246, v88
v_add_f32 v247, v247, v89
v_cvt_pk_bf16_f32 v88, v88, v89
s_waitcnt lgkmcnt(6)
v_mfma_f32_32x32x16_bf16 a[0:15], v[152:155], v[72:75], a[0:15]
ds_read_b64_tr_b16 v[152:153], v224 offset:30720
ds_read_b64_tr_b16 v[154:155], v224 offset:33792
v_exp_f32 v90, v90
v_exp_f32 v91, v91
v_mfma_f32_32x32x16_bf16 a[16:31], v[128:131], v[72:75], a[16:31]
ds_read_b64_tr_b16 v[128:129], v223 offset:30848
ds_read_b64_tr_b16 v[130:131], v223 offset:33920
s_add_u32 s59, s54, 0x2000
buffer_load_dwordx4 v[204:207], v243, s[24:27], s59 offen offset:0 sc1
v_mfma_f32_32x32x16_bf16 a[32:47], v[132:135], v[72:75], a[32:47]
ds_read_b64_tr_b16 v[132:133], v224 offset:30848
ds_read_b64_tr_b16 v[134:135], v224 offset:33920
v_add_f32 v246, v246, v90
v_add_f32 v247, v247, v91
v_cvt_pk_bf16_f32 v89, v90, v91
v_mfma_f32_32x32x16_bf16 a[48:63], v[136:139], v[72:75], a[48:63]
ds_read_b64_tr_b16 v[136:137], v223 offset:30976
ds_read_b64_tr_b16 v[138:139], v223 offset:34048
buffer_load_dwordx4 a[224:227], v243, s[24:27], s59 offen offset:1024 sc1
v_exp_f32 v92, v92
v_exp_f32 v93, v93
s_waitcnt lgkmcnt(4)
v_mfma_f32_32x32x16_bf16 a[64:79], v[140:143], v[72:75], a[64:79]
ds_read_b64_tr_b16 v[140:141], v224 offset:30976
ds_read_b64_tr_b16 v[142:143], v224 offset:34048
v_mfma_f32_32x32x16_bf16 a[80:95], v[144:147], v[72:75], a[80:95]
ds_read_b64_tr_b16 v[144:145], v225 offset:24576
ds_read_b64_tr_b16 v[146:147], v226 offset:24576
v_add_f32 v246, v246, v92
v_add_f32 v247, v247, v93
v_cvt_pk_bf16_f32 v90, v92, v93
v_mfma_f32_32x32x16_bf16 a[0:15], v[148:151], v[80:83], a[0:15]
ds_read_b64_tr_b16 v[148:149], v227 offset:24576
ds_read_b64_tr_b16 v[150:151], v228 offset:24576
buffer_load_dwordx4 a[228:231], v243, s[24:27], s59 offen offset:2048 sc1
v_exp_f32 v94, v94
v_exp_f32 v95, v95
v_mfma_f32_32x32x16_bf16 a[16:31], v[152:155], v[80:83], a[16:31]
ds_read_b64_tr_b16 v[152:153], v225 offset:24704
ds_read_b64_tr_b16 v[154:155], v226 offset:24704
v_mfma_f32_32x32x16_bf16 a[32:47], v[128:131], v[80:83], a[32:47]
ds_read_b64_tr_b16 v[128:129], v227 offset:24704
ds_read_b64_tr_b16 v[130:131], v228 offset:24704
buffer_load_dwordx4 a[232:235], v243, s[24:27], s59 offen offset:3072 sc1
s_waitcnt lgkmcnt(6)
v_mfma_f32_32x32x16_bf16 a[48:63], v[132:135], v[80:83], a[48:63]
ds_read_b64_tr_b16 v[132:133], v225 offset:24832
ds_read_b64_tr_b16 v[134:135], v226 offset:24832
v_add_f32 v246, v246, v94
v_add_f32 v247, v247, v95
v_cvt_pk_bf16_f32 v91, v94, v95
v_mfma_f32_32x32x16_bf16 a[64:79], v[136:139], v[80:83], a[64:79]
ds_read_b64_tr_b16 v[136:137], v227 offset:24832
ds_read_b64_tr_b16 v[138:139], v228 offset:24832
v_exp_f32 v96, v96
v_exp_f32 v97, v97
v_mfma_f32_32x32x16_bf16 a[80:95], v[140:143], v[80:83], a[80:95]
ds_read_b64_tr_b16 v[140:141], v223 offset:36864
ds_read_b64_tr_b16 v[142:143], v223 offset:39936
s_add_u32 s59, s54, 0x1000
buffer_load_dwordx4 a[236:239], v244, s[24:27], s59 offen offset:0 sc1
v_mfma_f32_16x16x16_bf16 a[96:99], v[144:145], v[104:105], a[96:99]
v_mfma_f32_16x16x16_bf16 a[100:103], v[146:147], v[104:105], a[100:103]
ds_read_b64_tr_b16 v[144:145], v223 offset:43008
ds_read_b64_tr_b16 v[146:147], v223 offset:46080
s_waitcnt lgkmcnt(6)
v_mfma_f32_16x16x16_bf16 a[104:107], v[148:149], v[104:105], a[104:107]
buffer_load_dwordx4 a[252:255], v244, s[24:27], s59 offen offset:1024 sc1
v_mfma_f32_16x16x16_bf16 a[108:111], v[150:151], v[104:105], a[108:111]
ds_read_b64_tr_b16 v[148:149], v224 offset:36864
ds_read_b64_tr_b16 v[150:151], v224 offset:39936
v_mfma_f32_16x16x16_bf16 a[112:115], v[152:153], v[104:105], a[112:115]
s_add_u32 m0, s36, 0x18000
s_add_u32 s38, s50, 0x28000
buffer_load_dwordx4 v229, s[20:23], s38 offen offset:0 lds
v_mfma_f32_16x16x16_bf16 a[116:119], v[154:155], v[104:105], a[116:119]
v_mfma_f32_16x16x16_bf16 a[120:123], v[128:129], v[104:105], a[120:123]
ds_read_b64_tr_b16 v[152:153], v224 offset:43008
ds_read_b64_tr_b16 v[154:155], v224 offset:46080
v_mfma_f32_16x16x16_bf16 a[124:127], v[130:131], v[104:105], a[124:127]
ds_read_b64_tr_b16 v[128:129], v223 offset:36992
ds_read_b64_tr_b16 v[130:131], v223 offset:40064
v_mfma_f32_16x16x16_bf16 a[128:131], v[132:133], v[104:105], a[128:131]
buffer_load_dwordx4 v230, s[20:23], s38 offen offset:1024 lds
v_mfma_f32_16x16x16_bf16 a[132:135], v[134:135], v[104:105], a[132:135]
ds_read_b64_tr_b16 v[132:133], v223 offset:43136
ds_read_b64_tr_b16 v[134:135], v223 offset:46208
s_waitcnt lgkmcnt(6)
v_mfma_f32_16x16x16_bf16 a[136:139], v[136:137], v[104:105], a[136:139]
buffer_load_dwordx4 v231, s[20:23], s38 offen offset:2048 lds
v_mfma_f32_16x16x16_bf16 a[140:143], v[138:139], v[104:105], a[140:143]
ds_read_b64_tr_b16 v[136:137], v224 offset:36992
ds_read_b64_tr_b16 v[138:139], v224 offset:40064
v_mfma_f32_32x32x16_bf16 a[0:15], v[140:143], v[88:91], a[0:15]
ds_read_b64_tr_b16 v[140:141], v224 offset:43136
ds_read_b64_tr_b16 v[142:143], v224 offset:46208
v_add_f32 v246, v246, v96
v_add_f32 v247, v247, v97
v_cvt_pk_bf16_f32 v96, v96, v97
v_exp_f32 v98, v98
v_exp_f32 v99, v99
v_add_f32 v246, v246, v98
v_add_f32 v247, v247, v99
v_cvt_pk_bf16_f32 v97, v98, v99
v_exp_f32 v100, v100
v_exp_f32 v101, v101
v_add_f32 v246, v246, v100
v_add_f32 v247, v247, v101
v_cvt_pk_bf16_f32 v98, v100, v101
v_exp_f32 v102, v102
v_exp_f32 v103, v103
v_add_f32 v246, v246, v102
v_add_f32 v247, v247, v103
v_cvt_pk_bf16_f32 v99, v102, v103
s_nop 1
v_mfma_f32_32x32x16_bf16 a[0:15], v[144:147], v[96:99], a[0:15]
buffer_load_dwordx4 v232, s[20:23], s38 offen offset:3072 lds
v_mfma_f32_32x32x16_bf16 a[16:31], v[148:151], v[88:91], a[16:31]
ds_read_b64_tr_b16 v[144:145], v223 offset:37120
ds_read_b64_tr_b16 v[146:147], v223 offset:40192
ds_read_b64_tr_b16 v[148:149], v223 offset:43264
ds_read_b64_tr_b16 v[150:151], v223 offset:46336
s_waitcnt lgkmcnt(4)
v_mfma_f32_32x32x16_bf16 a[16:31], v[152:155], v[96:99], a[16:31]
ds_read_b64_tr_b16 v[152:153], v224 offset:37120
ds_read_b64_tr_b16 v[154:155], v224 offset:40192
s_add_u32 m0, s36, 0x19000
s_nop 0
buffer_load_dwordx4 v233, s[20:23], s38 offen offset:0 lds
v_mfma_f32_32x32x16_bf16 a[32:47], v[128:131], v[88:91], a[32:47]
ds_read_b64_tr_b16 v[128:129], v224 offset:43264
ds_read_b64_tr_b16 v[130:131], v224 offset:46336
s_add_u32 m0, s36, 0x6000
s_add_u32 s38, s48, 0x3e8000
buffer_load_dwordx4 v229, s[20:23], s38 offen offset:0 lds
v_mfma_f32_32x32x16_bf16 a[32:47], v[132:135], v[96:99], a[32:47]
v_add_f32 v246, v246, v247
v_mov_b32 v250, v246
s_nop 0
s_nop 0
v_permlane32_swap_b32 v246, v250
v_add_f32 v246, v246, v250
v_rcp_f32 v246, v246
v_mfma_f32_32x32x16_bf16 a[48:63], v[136:139], v[88:91], a[48:63]
v_mov_b32 v255, v248
s_nop 0
s_nop 0
v_permlane32_swap_b32 v248, v255
v_add_f32 v248, v248, v255
v_mov_b32 v255, v248
s_nop 0
s_nop 0
v_permlane16_swap_b32 v248, v255
v_add_f32 v248, v248, v255
v_mfma_f32_32x32x16_bf16 a[48:63], v[140:143], v[96:99], a[48:63]
buffer_load_dwordx4 v230, s[20:23], s38 offen offset:1024 lds
s_waitcnt lgkmcnt(0)
v_mfma_f32_32x32x16_bf16 a[64:79], v[144:147], v[88:91], a[64:79]
v_bfe_u32 v254, v244, 4, 4
v_lshlrev_b32 v254, 3, v254
v_add_u32 v254, 0x27c00, v254
s_lshl_b32 s40, s32, 7
v_add_u32 v255, s40, v254
v_mov_b32 v125, v248
v_mfma_f32_32x32x16_bf16 a[64:79], v[148:151], v[96:99], a[64:79]
buffer_load_dwordx4 v231, s[20:23], s38 offen offset:2048 lds
ds_write_b64 v255, v[124:125]
v_mfma_f32_32x32x16_bf16 a[80:95], v[152:155], v[88:91], a[80:95]
s_waitcnt vmcnt(35)
s_waitcnt lgkmcnt(0)
s_barrier
ds_read_b64_tr_b16 v[132:133], v235 offset:21504
ds_read_b64_tr_b16 v[134:135], v235 offset:24064
ds_read_b64_tr_b16 v[136:137], v235 offset:21568
ds_read_b64_tr_b16 v[138:139], v235 offset:24128
ds_read_b64_tr_b16 v[140:141], v235 offset:21632
ds_read_b64_tr_b16 v[142:143], v235 offset:24192
buffer_load_dwordx4 v232, s[20:23], s38 offen offset:3072 lds
s_add_u32 m0, s36, 0x7000
s_nop 0
buffer_load_dwordx4 v233, s[20:23], s38 offen offset:0 lds
v_mfma_f32_32x32x16_bf16 a[80:95], v[128:131], v[96:99], a[80:95]
ds_read_b64_tr_b16 v[144:145], v237 offset:21504
ds_read_b64_tr_b16 v[146:147], v237 offset:26624
s_waitcnt lgkmcnt(6)
v_mfma_f32_32x32x16_bf16 a[144:159], v[132:135], v[156:159], a[144:159]
ds_read_b64_tr_b16 v[148:149], v235 offset:21696
ds_read_b64_tr_b16 v[150:151], v235 offset:24256
ds_read_b64_tr_b16 v[152:153], v235 offset:21760
ds_read_b64_tr_b16 v[154:155], v235 offset:24320
s_waitcnt lgkmcnt(8)
v_mfma_f32_32x32x16_bf16 a[160:175], v[136:139], v[156:159], a[160:175]
ds_read_b64_tr_b16 v[128:129], v235 offset:26624
ds_read_b64_tr_b16 v[130:131], v235 offset:29184
ds_read_b64_tr_b16 v[132:133], v238 offset:21504
ds_read_b64_tr_b16 v[134:135], v238 offset:26624
ds_read_b64_tr_b16 v[136:137], v235 offset:26688
ds_read_b64_tr_b16 v[138:139], v235 offset:29248
s_waitcnt lgkmcnt(12)
v_mfma_f32_32x32x16_bf16 a[176:191], v[140:143], v[156:159], a[176:191]
ds_read_b64_tr_b16 v[140:141], v235 offset:26752
ds_read_b64_tr_b16 v[142:143], v235 offset:29312
ds_read_b64 v[48:49], v254 offset:0
ds_read_b64 v[50:51], v254 offset:128
ds_read_b64 v[52:53], v254 offset:256
ds_read_b64 v[54:55], v254 offset:384
s_waitcnt lgkmcnt(13)
v_mfma_f32_16x16x32_bf16 a[240:243], v[144:147], v[172:175], a[240:243]
ds_read_b64_tr_b16 v[144:145], v235 offset:26816
ds_read_b64_tr_b16 v[146:147], v235 offset:29376
v_mfma_f32_32x32x16_bf16 a[192:207], v[148:151], v[156:159], a[192:207]
ds_read_b64_tr_b16 v[148:149], v239 offset:21504
ds_read_b64_tr_b16 v[150:151], v239 offset:26624
s_waitcnt lgkmcnt(5)
v_min3_f32 v255, v48, v50, v52
s_waitcnt lgkmcnt(4)
v_min_f32 v255, v255, v54
v_sub_f32 v48, v255, v48
v_sub_f32 v50, v255, v50
v_sub_f32 v52, v255, v52
v_sub_f32 v54, v255, v54
v_sub_f32 v255, v255, v124
v_mfma_f32_32x32x16_bf16 a[208:223], v[152:155], v[156:159], a[208:223]
ds_read_b64_tr_b16 v[152:153], v235 offset:26880
ds_read_b64_tr_b16 v[154:155], v235 offset:29440
v_mfma_f32_32x32x16_bf16 a[144:159], v[128:131], v[160:163], a[144:159]
ds_read_b64_tr_b16 v[128:129], v235 offset:31744
ds_read_b64_tr_b16 v[130:131], v235 offset:34304
v_exp_f32 v48, v48
v_exp_f32 v50, v50
v_exp_f32 v52, v52
v_exp_f32 v54, v54
v_exp_f32 v255, v255
v_mfma_f32_16x16x32_bf16 a[244:247], v[132:135], v[172:175], a[244:247]
v_mfma_f32_32x32x16_bf16 a[160:175], v[136:139], v[160:163], a[160:175]
ds_read_b64_tr_b16 v[132:133], v235 offset:31808
ds_read_b64_tr_b16 v[134:135], v235 offset:34368
v_mfma_f32_32x32x16_bf16 a[176:191], v[140:143], v[160:163], a[176:191]
ds_read_b64_tr_b16 v[136:137], v237 offset:31744
ds_read_b64_tr_b16 v[138:139], v237 offset:36864
ds_read_b64_tr_b16 v[140:141], v235 offset:31872
ds_read_b64_tr_b16 v[142:143], v235 offset:34432
v_mul_f32 v248, v48, v49
v_fmac_f32 v248, v50, v51
v_fmac_f32 v248, v52, v53
v_fmac_f32 v248, v54, v55
v_rcp_f32 v248, v248
v_lshrrev_b32 v254, 1, v244
v_mul_f32 v248, v248, v255
v_add_u32 v254, 0xc000, v254
v_add_u32 v255, s33, v254
v_add_u32 v250, s61, v254
v_add_u32 v254, s60, v254
s_waitcnt lgkmcnt(6)
v_mfma_f32_32x32x16_bf16 a[192:207], v[144:147], v[160:163], a[192:207]
v_mfma_f32_16x16x32_bf16 a[248:251], v[148:151], v[172:175], a[248:251]
ds_read_b64_tr_b16 v[144:145], v235 offset:31936
ds_read_b64_tr_b16 v[146:147], v235 offset:34496
v_mfma_f32_32x32x16_bf16 a[208:223], v[152:155], v[160:163], a[208:223]
ds_read_b64_tr_b16 v[148:149], v235 offset:32000
ds_read_b64_tr_b16 v[150:151], v235 offset:34560
ds_read_b64_tr_b16 v[152:153], v238 offset:31744
ds_read_b64_tr_b16 v[154:155], v238 offset:36864
v_accvgpr_read_b32 v88, a96
v_accvgpr_read_b32 v89, a97
v_accvgpr_read_b32 v90, a98
v_accvgpr_read_b32 v91, a99
v_mfma_f32_32x32x16_bf16 a[144:159], v[128:131], v[164:167], a[144:159]
ds_read_b64_tr_b16 v[128:129], v235 offset:36864
ds_read_b64_tr_b16 v[130:131], v235 offset:39424
v_pk_mul_f32 v[88:89], v[88:89], v[248:249] op_sel_hi:[1,0]
v_pk_mul_f32 v[90:91], v[90:91], v[248:249] op_sel_hi:[1,0]
s_waitcnt lgkmcnt(8)
v_mfma_f32_32x32x16_bf16 a[160:175], v[132:135], v[164:167], a[160:175]
ds_read_b64_tr_b16 v[132:133], v235 offset:36928
ds_read_b64_tr_b16 v[134:135], v235 offset:39488
v_cvt_pk_bf16_f32 v88, v88, v89
v_cvt_pk_bf16_f32 v89, v90, v91
ds_write_b64 v255, v[88:89] offset:0
v_mfma_f32_16x16x32_bf16 a[240:243], v[136:139], v[176:179], a[240:243]
ds_read_b64_tr_b16 v[136:137], v235 offset:36992
ds_read_b64_tr_b16 v[138:139], v235 offset:39552
v_mfma_f32_32x32x16_bf16 a[176:191], v[140:143], v[164:167], a[176:191]
ds_read_b64_tr_b16 v[140:141], v239 offset:31744
ds_read_b64_tr_b16 v[142:143], v239 offset:36864
v_accvgpr_read_b32 v96, a100
v_accvgpr_read_b32 v97, a101
v_accvgpr_read_b32 v98, a102
v_accvgpr_read_b32 v99, a103
s_waitcnt lgkmcnt(7)
v_mfma_f32_32x32x16_bf16 a[192:207], v[144:147], v[164:167], a[192:207]
ds_read_b64_tr_b16 v[144:145], v235 offset:37056
ds_read_b64_tr_b16 v[146:147], v235 offset:39616
v_pk_mul_f32 v[96:97], v[96:97], v[248:249] op_sel_hi:[1,0]
v_pk_mul_f32 v[98:99], v[98:99], v[248:249] op_sel_hi:[1,0]
v_cvt_pk_bf16_f32 v96, v96, v97
v_cvt_pk_bf16_f32 v97, v98, v99
v_mfma_f32_32x32x16_bf16 a[208:223], v[148:151], v[164:167], a[208:223]
ds_read_b64_tr_b16 v[148:149], v235 offset:37120
ds_read_b64_tr_b16 v[150:151], v235 offset:39680
s_waitcnt lgkmcnt(6)
ds_write_b64 v255, v[96:97] offset:512
v_accvgpr_read_b32 v72, a104
v_accvgpr_read_b32 v73, a105
v_accvgpr_read_b32 v74, a106
v_accvgpr_read_b32 v75, a107
v_mfma_f32_16x16x32_bf16 a[244:247], v[152:155], v[176:179], a[244:247]
v_mfma_f32_32x32x16_bf16 a[144:159], v[128:131], v[168:171], a[144:159]
v_pk_mul_f32 v[72:73], v[72:73], v[248:249] op_sel_hi:[1,0]
v_pk_mul_f32 v[74:75], v[74:75], v[248:249] op_sel_hi:[1,0]
v_cvt_pk_bf16_f32 v72, v72, v73
v_cvt_pk_bf16_f32 v73, v74, v75
s_waitcnt lgkmcnt(0)
ds_write_b64 v255, v[72:73] offset:1024
v_mfma_f32_32x32x16_bf16 a[160:175], v[132:135], v[168:171], a[160:175]
v_accvgpr_read_b32 v80, a108
v_accvgpr_read_b32 v81, a109
v_accvgpr_read_b32 v82, a110
v_accvgpr_read_b32 v83, a111
v_pk_mul_f32 v[80:81], v[80:81], v[248:249] op_sel_hi:[1,0]
v_pk_mul_f32 v[82:83], v[82:83], v[248:249] op_sel_hi:[1,0]
v_mfma_f32_32x32x16_bf16 a[176:191], v[136:139], v[168:171], a[176:191]
v_cvt_pk_bf16_f32 v80, v80, v81
v_cvt_pk_bf16_f32 v81, v82, v83
s_waitcnt lgkmcnt(0)
ds_write_b64 v255, v[80:81] offset:1536
v_accvgpr_read_b32 v88, a112
v_accvgpr_read_b32 v89, a113
v_accvgpr_read_b32 v90, a114
v_accvgpr_read_b32 v91, a115
v_mfma_f32_16x16x32_bf16 a[248:251], v[140:143], v[176:179], a[248:251]
v_mfma_f32_32x32x16_bf16 a[192:207], v[144:147], v[168:171], a[192:207]
v_pk_mul_f32 v[88:89], v[88:89], v[248:249] op_sel_hi:[1,0]
v_pk_mul_f32 v[90:91], v[90:91], v[248:249] op_sel_hi:[1,0]
v_cvt_pk_bf16_f32 v88, v88, v89
v_cvt_pk_bf16_f32 v89, v90, v91
s_waitcnt lgkmcnt(0)
ds_write_b64 v255, v[88:89] offset:2048
v_mfma_f32_32x32x16_bf16 a[208:223], v[148:151], v[168:171], a[208:223]
v_accvgpr_read_b32 v96, a116
v_accvgpr_read_b32 v97, a117
v_accvgpr_read_b32 v98, a118
v_accvgpr_read_b32 v99, a119
v_pk_mul_f32 v[96:97], v[96:97], v[248:249] op_sel_hi:[1,0]
v_pk_mul_f32 v[98:99], v[98:99], v[248:249] op_sel_hi:[1,0]
v_cvt_pk_bf16_f32 v96, v96, v97
v_cvt_pk_bf16_f32 v97, v98, v99
s_waitcnt lgkmcnt(0)
ds_write_b64 v255, v[96:97] offset:2560
v_accvgpr_read_b32 v72, a120
v_accvgpr_read_b32 v73, a121
v_accvgpr_read_b32 v74, a122
v_accvgpr_read_b32 v75, a123
v_pk_mul_f32 v[72:73], v[72:73], v[248:249] op_sel_hi:[1,0]
v_pk_mul_f32 v[74:75], v[74:75], v[248:249] op_sel_hi:[1,0]
v_cvt_pk_bf16_f32 v72, v72, v73
v_cvt_pk_bf16_f32 v73, v74, v75
s_waitcnt lgkmcnt(0)
ds_write_b64 v255, v[72:73] offset:3072
v_accvgpr_read_b32 v80, a124
v_accvgpr_read_b32 v81, a125
v_accvgpr_read_b32 v82, a126
v_accvgpr_read_b32 v83, a127
v_pk_mul_f32 v[80:81], v[80:81], v[248:249] op_sel_hi:[1,0]
v_pk_mul_f32 v[82:83], v[82:83], v[248:249] op_sel_hi:[1,0]
v_cvt_pk_bf16_f32 v80, v80, v81
v_cvt_pk_bf16_f32 v81, v82, v83
s_waitcnt lgkmcnt(0)
ds_write_b64 v255, v[80:81] offset:3584
v_accvgpr_read_b32 v88, a128
v_accvgpr_read_b32 v89, a129
v_accvgpr_read_b32 v90, a130
v_accvgpr_read_b32 v91, a131
v_pk_mul_f32 v[88:89], v[88:89], v[248:249] op_sel_hi:[1,0]
v_pk_mul_f32 v[90:91], v[90:91], v[248:249] op_sel_hi:[1,0]
v_cvt_pk_bf16_f32 v88, v88, v89
v_cvt_pk_bf16_f32 v89, v90, v91
s_waitcnt lgkmcnt(0)
ds_write_b64 v255, v[88:89] offset:4096
v_accvgpr_read_b32 v96, a132
v_accvgpr_read_b32 v97, a133
v_accvgpr_read_b32 v98, a134
v_accvgpr_read_b32 v99, a135
v_pk_mul_f32 v[96:97], v[96:97], v[248:249] op_sel_hi:[1,0]
v_pk_mul_f32 v[98:99], v[98:99], v[248:249] op_sel_hi:[1,0]
v_cvt_pk_bf16_f32 v96, v96, v97
v_cvt_pk_bf16_f32 v97, v98, v99
s_waitcnt lgkmcnt(0)
ds_write_b64 v255, v[96:97] offset:4608
v_accvgpr_read_b32 v72, a136
v_accvgpr_read_b32 v73, a137
v_accvgpr_read_b32 v74, a138
v_accvgpr_read_b32 v75, a139
v_pk_mul_f32 v[72:73], v[72:73], v[248:249] op_sel_hi:[1,0]
v_pk_mul_f32 v[74:75], v[74:75], v[248:249] op_sel_hi:[1,0]
v_cvt_pk_bf16_f32 v72, v72, v73
v_cvt_pk_bf16_f32 v73, v74, v75
s_waitcnt lgkmcnt(0)
ds_write_b64 v255, v[72:73] offset:5120
v_accvgpr_read_b32 v80, a140
v_accvgpr_read_b32 v81, a141
v_accvgpr_read_b32 v82, a142
v_accvgpr_read_b32 v83, a143
v_pk_mul_f32 v[80:81], v[80:81], v[248:249] op_sel_hi:[1,0]
v_pk_mul_f32 v[82:83], v[82:83], v[248:249] op_sel_hi:[1,0]
v_cvt_pk_bf16_f32 v80, v80, v81
v_cvt_pk_bf16_f32 v81, v82, v83
s_waitcnt lgkmcnt(0)
ds_write_b64 v255, v[80:81] offset:5632
s_waitcnt vmcnt(21)
s_waitcnt lgkmcnt(0)
s_barrier
ds_read_b64_tr_b16 v[152:153], v235 offset:43008
ds_read_b64_tr_b16 v[154:155], v235 offset:45568
ds_read_b64_tr_b16 v[128:129], v235 offset:43072
ds_read_b64_tr_b16 v[130:131], v235 offset:45632
ds_read_b64_tr_b16 v[132:133], v235 offset:43136
ds_read_b64_tr_b16 v[134:135], v235 offset:45696
ds_read_b64_tr_b16 v[136:137], v237 offset:43008
ds_read_b64_tr_b16 v[138:139], v237 offset:48128
s_waitcnt lgkmcnt(6)
v_mfma_f32_32x32x16_bf16 a[144:159], v[152:155], v[180:183], a[144:159]
ds_read_b64_tr_b16 v[140:141], v235 offset:43200
ds_read_b64_tr_b16 v[142:143], v235 offset:45760
s_waitcnt lgkmcnt(6)
v_mfma_f32_32x32x16_bf16 a[160:175], v[128:131], v[180:183], a[160:175]
ds_read_b64_tr_b16 v[144:145], v235 offset:43264
ds_read_b64_tr_b16 v[146:147], v235 offset:45824
ds_read_b64_tr_b16 v[148:149], v235 offset:48128
ds_read_b64_tr_b16 v[150:151], v235 offset:50688
v_accvgpr_read_b32 v88, a0
v_accvgpr_read_b32 v89, a1
v_accvgpr_read_b32 v90, a2
v_accvgpr_read_b32 v91, a3
v_accvgpr_read_b32 v92, a4
v_accvgpr_read_b32 v93, a5
v_accvgpr_read_b32 v94, a6
v_accvgpr_read_b32 v95, a7
v_pk_mul_f32 v[88:89], v[88:89], v[246:247] op_sel_hi:[1,0]
v_pk_mul_f32 v[90:91], v[90:91], v[246:247] op_sel_hi:[1,0]
v_pk_mul_f32 v[92:93], v[92:93], v[246:247] op_sel_hi:[1,0]
v_pk_mul_f32 v[94:95], v[94:95], v[246:247] op_sel_hi:[1,0]
v_cvt_pk_bf16_f32 v0, v88, v89
v_cvt_pk_bf16_f32 v1, v90, v91
v_cvt_pk_bf16_f32 v2, v92, v93
v_cvt_pk_bf16_f32 v3, v94, v95
s_waitcnt lgkmcnt(4)
v_mfma_f32_32x32x16_bf16 a[176:191], v[132:135], v[180:183], a[176:191]
v_mfma_f32_16x16x32_bf16 a[240:243], v[136:139], v[196:199], a[240:243]
ds_read_b64_tr_b16 v[152:153], v238 offset:43008
ds_read_b64_tr_b16 v[154:155], v238 offset:48128
s_add_u32 s59, s55, 0x0
buffer_load_dwordx4 v[156:159], v243, s[24:27], s59 offen offset:0 sc1
v_accvgpr_read_b32 v96, a8
v_accvgpr_read_b32 v97, a9
v_accvgpr_read_b32 v98, a10
v_accvgpr_read_b32 v99, a11
v_accvgpr_read_b32 v100, a12
v_accvgpr_read_b32 v101, a13
v_accvgpr_read_b32 v102, a14
v_accvgpr_read_b32 v103, a15
v_pk_mul_f32 v[96:97], v[96:97], v[246:247] op_sel_hi:[1,0]
v_pk_mul_f32 v[98:99], v[98:99], v[246:247] op_sel_hi:[1,0]
v_pk_mul_f32 v[100:101], v[100:101], v[246:247] op_sel_hi:[1,0]
v_pk_mul_f32 v[102:103], v[102:103], v[246:247] op_sel_hi:[1,0]
v_cvt_pk_bf16_f32 v4, v96, v97
v_cvt_pk_bf16_f32 v5, v98, v99
v_cvt_pk_bf16_f32 v6, v100, v101
v_cvt_pk_bf16_f32 v7, v102, v103
v_mfma_f32_32x32x16_bf16 a[192:207], v[140:143], v[180:183], a[192:207]
ds_read_b64_tr_b16 v[128:129], v235 offset:48192
ds_read_b64_tr_b16 v[130:131], v235 offset:50752
buffer_load_dwordx4 v[160:163], v243, s[24:27], s59 offen offset:1024 sc1
s_waitcnt lgkmcnt(2)
v_mfma_f32_32x32x16_bf16 a[208:223], v[144:147], v[180:183], a[208:223]
ds_read_b64_tr_b16 v[132:133], v235 offset:48256
ds_read_b64_tr_b16 v[134:135], v235 offset:50816
buffer_load_dwordx4 v[164:167], v243, s[24:27], s59 offen offset:2048 sc1
v_mfma_f32_32x32x16_bf16 a[144:159], v[148:151], v[184:187], a[144:159]
ds_read_b64_tr_b16 v[136:137], v235 offset:48320
ds_read_b64_tr_b16 v[138:139], v235 offset:50880
ds_read_b64_tr_b16 v[140:141], v239 offset:43008
ds_read_b64_tr_b16 v[142:143], v239 offset:48128
s_add_u32 s41, s52, 0xd8000
buffer_store_dwordx4 v[0:3], v243, s[24:27], s41 offen offset:0 sc1
v_mfma_f32_16x16x32_bf16 a[244:247], v[152:155], v[196:199], a[244:247]
buffer_load_dwordx4 v[168:171], v243, s[24:27], s59 offen offset:3072 sc1
s_waitcnt lgkmcnt(6)
v_mfma_f32_32x32x16_bf16 a[160:175], v[128:131], v[184:187], a[160:175]
ds_read_b64_tr_b16 v[144:145], v235 offset:48384
ds_read_b64_tr_b16 v[146:147], v235 offset:50944
ds_read_b64_tr_b16 v[148:149], v235 offset:53248
ds_read_b64_tr_b16 v[150:151], v235 offset:55808
s_add_u32 s59, s55, 0x0
buffer_load_dwordx4 v[172:175], v244, s[24:27], s59 offen offset:0 sc1
s_waitcnt lgkmcnt(8)
v_mfma_f32_32x32x16_bf16 a[176:191], v[132:135], v[184:187], a[176:191]
ds_read_b64_tr_b16 v[152:153], v235 offset:53312
ds_read_b64_tr_b16 v[154:155], v235 offset:55872
buffer_load_dwordx4 v[176:179], v244, s[24:27], s59 offen offset:1024 sc1
s_waitcnt lgkmcnt(6)
v_mfma_f32_32x32x16_bf16 a[192:207], v[136:139], v[184:187], a[192:207]
ds_read_b64_tr_b16 v[128:129], v237 offset:53248
ds_read_b64_tr_b16 v[130:131], v237 offset:58368
ds_read_b64_tr_b16 v[132:133], v235 offset:53376
ds_read_b64_tr_b16 v[134:135], v235 offset:55936
s_add_u32 s41, s52, 0xd8000
buffer_store_dwordx4 v[4:7], v243, s[24:27], s41 offen offset:1024 sc1
v_mfma_f32_16x16x32_bf16 a[248:251], v[140:143], v[196:199], a[248:251]
s_add_u32 m0, s36, 0x1d400
s_add_u32 s38, s51, 0x0
buffer_load_dwordx4 v229, s[20:23], s38 offen offset:0 lds
s_waitcnt lgkmcnt(6)
v_mfma_f32_32x32x16_bf16 a[208:223], v[144:147], v[184:187], a[208:223]
ds_read_b64_tr_b16 v[136:137], v235 offset:53440
ds_read_b64_tr_b16 v[138:139], v235 offset:56000
buffer_load_dwordx4 v230, s[20:23], s38 offen offset:1024 lds
v_mfma_f32_32x32x16_bf16 a[144:159], v[148:151], v[188:191], a[144:159]
ds_read_b64_tr_b16 v[140:141], v235 offset:53504
ds_read_b64_tr_b16 v[142:143], v235 offset:56064
ds_read_b64_tr_b16 v[144:145], v238 offset:53248
ds_read_b64_tr_b16 v[146:147], v238 offset:58368
buffer_load_dwordx4 v231, s[20:23], s38 offen offset:2048 lds
s_waitcnt lgkmcnt(6)
v_mfma_f32_32x32x16_bf16 a[160:175], v[152:155], v[188:191], a[160:175]
ds_read_b64_tr_b16 v[148:149], v235 offset:58368
ds_read_b64_tr_b16 v[150:151], v235 offset:60928
ds_read_b64_tr_b16 v[152:153], v235 offset:58432
ds_read_b64_tr_b16 v[154:155], v235 offset:60992
v_mfma_f32_16x16x32_bf16 a[240:243], v[128:131], v[200:203], a[240:243]
ds_read_b64_tr_b16 v[128:129], v235 offset:58496
ds_read_b64_tr_b16 v[130:131], v235 offset:61056
buffer_load_dwordx4 v232, s[20:23], s38 offen offset:3072 lds
v_mfma_f32_32x32x16_bf16 a[176:191], v[132:135], v[188:191], a[176:191]
ds_read_b64_tr_b16 v[132:133], v239 offset:53248
ds_read_b64_tr_b16 v[134:135], v239 offset:58368
s_add_u32 m0, s36, 0x1e400
s_nop 0
buffer_load_dwordx4 v233, s[20:23], s38 offen offset:0 lds
s_waitcnt lgkmcnt(8)
v_mfma_f32_32x32x16_bf16 a[192:207], v[136:139], v[188:191], a[192:207]
ds_read_b64_tr_b16 v[136:137], v235 offset:58560
ds_read_b64_tr_b16 v[138:139], v235 offset:61120
v_subrev_u32 v217, 0x17000, v235
v_subrev_u32 v218, 0x17000, v237
v_subrev_u32 v219, 0x17000, v238
v_subrev_u32 v220, 0x17000, v239
v_subrev_u32 v251, 0x1000, v244
v_mfma_f32_32x32x16_bf16 a[208:223], v[140:143], v[188:191], a[208:223]
ds_read_b64_tr_b16 v[140:141], v235 offset:58624
ds_read_b64_tr_b16 v[142:143], v235 offset:61184
v_mfma_f32_16x16x32_bf16 a[244:247], v[144:147], v[200:203], a[244:247]
ds_read_b64 v[48:49], v254 offset:0
ds_read_b64 v[50:51], v254 offset:6144
ds_read_b64 v[52:53], v254 offset:12288
ds_read_b64 v[54:55], v254 offset:18432
s_waitcnt lgkmcnt(3)
v_lshlrev_b32 v56, 16, v48
v_and_b32 v57, 0xffff0000, v48
v_lshlrev_b32 v58, 16, v49
v_and_b32 v59, 0xffff0000, v49
s_waitcnt lgkmcnt(2)
v_lshlrev_b32 v60, 16, v50
v_and_b32 v61, 0xffff0000, v50
v_add_f32 v56, v56, v60
v_add_f32 v57, v57, v61
v_lshlrev_b32 v60, 16, v51
v_and_b32 v61, 0xffff0000, v51
v_add_f32 v58, v58, v60
v_add_f32 v59, v59, v61
s_waitcnt lgkmcnt(1)
v_lshlrev_b32 v60, 16, v52
v_and_b32 v61, 0xffff0000, v52
v_add_f32 v56, v56, v60
v_add_f32 v57, v57, v61
v_lshlrev_b32 v60, 16, v53
v_and_b32 v61, 0xffff0000, v53
v_add_f32 v58, v58, v60
v_add_f32 v59, v59, v61
s_waitcnt lgkmcnt(0)
v_lshlrev_b32 v60, 16, v54
v_and_b32 v61, 0xffff0000, v54
v_add_f32 v56, v56, v60
v_add_f32 v57, v57, v61
v_lshlrev_b32 v60, 16, v55
v_and_b32 v61, 0xffff0000, v55
v_add_f32 v58, v58, v60
v_add_f32 v59, v59, v61
v_cvt_pk_bf16_f32 v64, v56, v57
v_cvt_pk_bf16_f32 v65, v58, v59
ds_read_b64 v[48:49], v254 offset:512
ds_read_b64 v[50:51], v254 offset:6656
ds_read_b64 v[52:53], v254 offset:12800
ds_read_b64 v[54:55], v254 offset:18944
s_waitcnt lgkmcnt(3)
v_lshlrev_b32 v56, 16, v48
v_and_b32 v57, 0xffff0000, v48
v_lshlrev_b32 v58, 16, v49
v_and_b32 v59, 0xffff0000, v49
s_waitcnt lgkmcnt(2)
v_lshlrev_b32 v60, 16, v50
v_and_b32 v61, 0xffff0000, v50
v_add_f32 v56, v56, v60
v_add_f32 v57, v57, v61
v_lshlrev_b32 v60, 16, v51
v_and_b32 v61, 0xffff0000, v51
v_add_f32 v58, v58, v60
v_add_f32 v59, v59, v61
s_waitcnt lgkmcnt(1)
v_lshlrev_b32 v60, 16, v52
v_and_b32 v61, 0xffff0000, v52
v_add_f32 v56, v56, v60
v_add_f32 v57, v57, v61
v_lshlrev_b32 v60, 16, v53
v_and_b32 v61, 0xffff0000, v53
v_add_f32 v58, v58, v60
v_add_f32 v59, v59, v61
s_waitcnt lgkmcnt(0)
v_lshlrev_b32 v60, 16, v54
v_and_b32 v61, 0xffff0000, v54
v_add_f32 v56, v56, v60
v_add_f32 v57, v57, v61
v_lshlrev_b32 v60, 16, v55
v_and_b32 v61, 0xffff0000, v55
v_add_f32 v58, v58, v60
v_add_f32 v59, v59, v61
v_cvt_pk_bf16_f32 v66, v56, v57
v_cvt_pk_bf16_f32 v67, v58, v59
v_add_u32 v255, s60, v251
ds_write_b128 v255, v[64:67] offset:0
ds_read_b64 v[48:49], v250 offset:0
ds_read_b64 v[50:51], v250 offset:6144
ds_read_b64 v[52:53], v250 offset:12288
ds_read_b64 v[54:55], v250 offset:18432
s_waitcnt lgkmcnt(3)
v_lshlrev_b32 v56, 16, v48
v_and_b32 v57, 0xffff0000, v48
v_lshlrev_b32 v58, 16, v49
v_and_b32 v59, 0xffff0000, v49
s_waitcnt lgkmcnt(2)
v_lshlrev_b32 v60, 16, v50
v_and_b32 v61, 0xffff0000, v50
v_add_f32 v56, v56, v60
v_add_f32 v57, v57, v61
v_lshlrev_b32 v60, 16, v51
v_and_b32 v61, 0xffff0000, v51
v_add_f32 v58, v58, v60
v_add_f32 v59, v59, v61
s_waitcnt lgkmcnt(1)
v_lshlrev_b32 v60, 16, v52
v_and_b32 v61, 0xffff0000, v52
v_add_f32 v56, v56, v60
v_add_f32 v57, v57, v61
v_lshlrev_b32 v60, 16, v53
v_and_b32 v61, 0xffff0000, v53
v_add_f32 v58, v58, v60
v_add_f32 v59, v59, v61
s_waitcnt lgkmcnt(0)
v_lshlrev_b32 v60, 16, v54
v_and_b32 v61, 0xffff0000, v54
v_add_f32 v56, v56, v60
v_add_f32 v57, v57, v61
v_lshlrev_b32 v60, 16, v55
v_and_b32 v61, 0xffff0000, v55
v_add_f32 v58, v58, v60
v_add_f32 v59, v59, v61
v_cvt_pk_bf16_f32 v68, v56, v57
v_cvt_pk_bf16_f32 v69, v58, v59
ds_read_b64 v[48:49], v250 offset:512
ds_read_b64 v[50:51], v250 offset:6656
ds_read_b64 v[52:53], v250 offset:12800
ds_read_b64 v[54:55], v250 offset:18944
v_mfma_f32_32x32x16_bf16 a[144:159], v[148:151], v[192:195], a[144:159]
v_mfma_f32_32x32x16_bf16 a[160:175], v[152:155], v[192:195], a[160:175]
s_waitcnt lgkmcnt(3)
v_lshlrev_b32 v56, 16, v48
v_and_b32 v57, 0xffff0000, v48
v_lshlrev_b32 v58, 16, v49
v_and_b32 v59, 0xffff0000, v49
s_waitcnt lgkmcnt(2)
v_lshlrev_b32 v60, 16, v50
v_and_b32 v61, 0xffff0000, v50
v_add_f32 v56, v56, v60
v_add_f32 v57, v57, v61
v_lshlrev_b32 v60, 16, v51
v_and_b32 v61, 0xffff0000, v51
v_add_f32 v58, v58, v60
v_add_f32 v59, v59, v61
s_waitcnt lgkmcnt(1)
v_lshlrev_b32 v60, 16, v52
v_and_b32 v61, 0xffff0000, v52
v_add_f32 v56, v56, v60
v_add_f32 v57, v57, v61
v_lshlrev_b32 v60, 16, v53
v_and_b32 v61, 0xffff0000, v53
v_add_f32 v58, v58, v60
v_add_f32 v59, v59, v61
s_waitcnt lgkmcnt(0)
v_lshlrev_b32 v60, 16, v54
v_and_b32 v61, 0xffff0000, v54
v_add_f32 v56, v56, v60
v_add_f32 v57, v57, v61
v_lshlrev_b32 v60, 16, v55
v_and_b32 v61, 0xffff0000, v55
v_add_f32 v58, v58, v60
v_add_f32 v59, v59, v61
v_mfma_f32_32x32x16_bf16 a[176:191], v[128:131], v[192:195], a[176:191]
v_mfma_f32_16x16x32_bf16 a[248:251], v[132:135], v[200:203], a[248:251]
v_cvt_pk_bf16_f32 v70, v56, v57
v_cvt_pk_bf16_f32 v71, v58, v59
v_mfma_f32_32x32x16_bf16 a[192:207], v[136:139], v[192:195], a[192:207]
v_add_u32 v255, s61, v251
ds_write_b128 v255, v[68:71] offset:20480
s_add_u32 s40, s52, s60
s_add_u32 s40, s40, 0xd8000
buffer_store_dwordx4 v[64:67], v244, s[24:27], s40 offen sc1
s_add_u32 s40, s52, s61
s_add_u32 s40, s40, 0xd8000
s_mov_b32 exec_lo, s62
s_mov_b32 exec_hi, s62
s_waitcnt lgkmcnt(0)
buffer_store_dwordx4 v[68:71], v244, s[24:27], s40 offen sc1
s_mov_b64 exec, -1
v_mfma_f32_32x32x16_bf16 a[208:223], v[140:143], v[192:195], a[208:223]
s_waitcnt vmcnt(20)
s_waitcnt lgkmcnt(0)
s_barrier
ds_read_b64_tr_b16 v[144:145], v235 offset:0
ds_read_b64_tr_b16 v[146:147], v235 offset:2560
ds_read_b64_tr_b16 v[148:149], v235 offset:64
ds_read_b64_tr_b16 v[150:151], v235 offset:2624
ds_read_b64_tr_b16 v[152:153], v235 offset:128
ds_read_b64_tr_b16 v[154:155], v235 offset:2688
ds_read_b64_tr_b16 v[128:129], v237 offset:0
ds_read_b64_tr_b16 v[130:131], v237 offset:5120
s_waitcnt lgkmcnt(6)
v_mfma_f32_32x32x16_bf16 a[144:159], v[144:147], v[204:207], a[144:159]
ds_read_b64_tr_b16 v[132:133], v235 offset:192
ds_read_b64_tr_b16 v[134:135], v235 offset:2752
s_waitcnt lgkmcnt(6)
v_mfma_f32_32x32x16_bf16 a[160:175], v[148:151], v[204:207], a[160:175]
ds_read_b64_tr_b16 v[136:137], v235 offset:256
ds_read_b64_tr_b16 v[138:139], v235 offset:2816
ds_read_b64_tr_b16 v[140:141], v235 offset:5120
ds_read_b64_tr_b16 v[142:143], v235 offset:7680
v_accvgpr_read_b32 v72, a16
v_accvgpr_read_b32 v73, a17
v_accvgpr_read_b32 v74, a18
v_accvgpr_read_b32 v75, a19
v_accvgpr_read_b32 v76, a20
v_accvgpr_read_b32 v77, a21
v_accvgpr_read_b32 v78, a22
v_accvgpr_read_b32 v79, a23
v_pk_mul_f32 v[72:73], v[72:73], v[246:247] op_sel_hi:[1,0]
v_pk_mul_f32 v[74:75], v[74:75], v[246:247] op_sel_hi:[1,0]
v_pk_mul_f32 v[76:77], v[76:77], v[246:247] op_sel_hi:[1,0]
v_pk_mul_f32 v[78:79], v[78:79], v[246:247] op_sel_hi:[1,0]
v_cvt_pk_bf16_f32 v8, v72, v73
v_cvt_pk_bf16_f32 v9, v74, v75
v_cvt_pk_bf16_f32 v10, v76, v77
v_cvt_pk_bf16_f32 v11, v78, v79
s_waitcnt lgkmcnt(4)
v_mfma_f32_32x32x16_bf16 a[176:191], v[152:155], v[204:207], a[176:191]
v_mfma_f32_16x16x32_bf16 a[240:243], v[128:131], a[236:239], a[240:243]
ds_read_b64_tr_b16 v[144:145], v238 offset:0
ds_read_b64_tr_b16 v[146:147], v238 offset:5120
s_add_u32 s59, s55, 0x1000
buffer_load_dwordx4 v[180:183], v243, s[24:27], s59 offen offset:0 sc1
buffer_load_dwordx4 v[184:187], v243, s[24:27], s59 offen offset:1024 sc1
buffer_load_dwordx4 v[188:191], v243, s[24:27], s59 offen offset:2048 sc1
v_accvgpr_read_b32 v80, a24
v_accvgpr_read_b32 v81, a25
v_accvgpr_read_b32 v82, a26
v_accvgpr_read_b32 v83, a27
v_accvgpr_read_b32 v84, a28
v_accvgpr_read_b32 v85, a29
v_accvgpr_read_b32 v86, a30
v_accvgpr_read_b32 v87, a31
v_pk_mul_f32 v[80:81], v[80:81], v[246:247] op_sel_hi:[1,0]
v_pk_mul_f32 v[82:83], v[82:83], v[246:247] op_sel_hi:[1,0]
v_pk_mul_f32 v[84:85], v[84:85], v[246:247] op_sel_hi:[1,0]
v_pk_mul_f32 v[86:87], v[86:87], v[246:247] op_sel_hi:[1,0]
v_cvt_pk_bf16_f32 v12, v80, v81
v_cvt_pk_bf16_f32 v13, v82, v83
v_cvt_pk_bf16_f32 v14, v84, v85
v_cvt_pk_bf16_f32 v15, v86, v87
v_mfma_f32_32x32x16_bf16 a[192:207], v[132:135], v[204:207], a[192:207]
ds_read_b64_tr_b16 v[148:149], v235 offset:5184
ds_read_b64_tr_b16 v[150:151], v235 offset:7744
buffer_load_dwordx4 v[192:195], v243, s[24:27], s59 offen offset:3072 sc1
s_add_u32 s59, s55, 0x800
buffer_load_dwordx4 v[196:199], v244, s[24:27], s59 offen offset:0 sc1
s_waitcnt lgkmcnt(2)
v_mfma_f32_32x32x16_bf16 a[208:223], v[136:139], v[204:207], a[208:223]
ds_read_b64_tr_b16 v[152:153], v235 offset:5248
ds_read_b64_tr_b16 v[154:155], v235 offset:7808
buffer_load_dwordx4 v[200:203], v244, s[24:27], s59 offen offset:1024 sc1
s_add_u32 m0, s36, 0x22800
s_add_u32 s38, s51, 0x14000
buffer_load_dwordx4 v229, s[20:23], s38 offen offset:0 lds
v_mfma_f32_32x32x16_bf16 a[144:159], v[140:143], a[224:227], a[144:159]
ds_read_b64_tr_b16 v[128:129], v235 offset:5312
ds_read_b64_tr_b16 v[130:131], v235 offset:7872
buffer_load_dwordx4 v230, s[20:23], s38 offen offset:1024 lds
buffer_load_dwordx4 v231, s[20:23], s38 offen offset:2048 lds
v_accvgpr_read_b32 v88, a32
v_accvgpr_read_b32 v89, a33
v_accvgpr_read_b32 v90, a34
v_accvgpr_read_b32 v91, a35
v_accvgpr_read_b32 v92, a36
v_accvgpr_read_b32 v93, a37
v_accvgpr_read_b32 v94, a38
v_accvgpr_read_b32 v95, a39
v_pk_mul_f32 v[88:89], v[88:89], v[246:247] op_sel_hi:[1,0]
v_pk_mul_f32 v[90:91], v[90:91], v[246:247] op_sel_hi:[1,0]
v_pk_mul_f32 v[92:93], v[92:93], v[246:247] op_sel_hi:[1,0]
v_pk_mul_f32 v[94:95], v[94:95], v[246:247] op_sel_hi:[1,0]
v_cvt_pk_bf16_f32 v16, v88, v89
v_cvt_pk_bf16_f32 v17, v90, v91
v_cvt_pk_bf16_f32 v18, v92, v93
v_cvt_pk_bf16_f32 v19, v94, v95
v_mfma_f32_16x16x32_bf16 a[244:247], v[144:147], a[236:239], a[244:247]
ds_read_b64_tr_b16 v[132:133], v239 offset:0
ds_read_b64_tr_b16 v[134:135], v239 offset:5120
buffer_load_dwordx4 v232, s[20:23], s38 offen offset:3072 lds
s_add_u32 m0, s36, 0x23800
s_nop 0
buffer_load_dwordx4 v233, s[20:23], s38 offen offset:0 lds
s_waitcnt lgkmcnt(2)
v_mfma_f32_32x32x16_bf16 a[160:175], v[148:151], a[224:227], a[160:175]
ds_read_b64_tr_b16 v[136:137], v235 offset:5376
ds_read_b64_tr_b16 v[138:139], v235 offset:7936
v_accvgpr_read_b32 v96, a40
v_accvgpr_read_b32 v97, a41
v_accvgpr_read_b32 v98, a42
v_accvgpr_read_b32 v99, a43
v_accvgpr_read_b32 v100, a44
v_accvgpr_read_b32 v101, a45
v_accvgpr_read_b32 v102, a46
v_accvgpr_read_b32 v103, a47
v_pk_mul_f32 v[96:97], v[96:97], v[246:247] op_sel_hi:[1,0]
v_pk_mul_f32 v[98:99], v[98:99], v[246:247] op_sel_hi:[1,0]
v_pk_mul_f32 v[100:101], v[100:101], v[246:247] op_sel_hi:[1,0]
v_pk_mul_f32 v[102:103], v[102:103], v[246:247] op_sel_hi:[1,0]
v_cvt_pk_bf16_f32 v20, v96, v97
v_cvt_pk_bf16_f32 v21, v98, v99
v_cvt_pk_bf16_f32 v22, v100, v101
v_cvt_pk_bf16_f32 v23, v102, v103
s_add_u32 s41, s52, 0xd8000
buffer_store_dwordx4 v[8:11], v243, s[24:27], s41 offen offset:2048 sc1
v_mfma_f32_32x32x16_bf16 a[176:191], v[152:155], a[224:227], a[176:191]
ds_read_b64_tr_b16 v[140:141], v235 offset:10240
ds_read_b64_tr_b16 v[142:143], v235 offset:12800
v_mfma_f32_32x32x16_bf16 a[192:207], v[128:131], a[224:227], a[192:207]
ds_read_b64_tr_b16 v[144:145], v235 offset:10304
ds_read_b64_tr_b16 v[146:147], v235 offset:12864
ds_read_b64_tr_b16 v[148:149], v237 offset:10240
ds_read_b64_tr_b16 v[150:151], v237 offset:15360
s_waitcnt lgkmcnt(6)
v_mfma_f32_16x16x32_bf16 a[248:251], v[132:135], a[236:239], a[248:251]
ds_read_b64_tr_b16 v[152:153], v235 offset:10368
ds_read_b64_tr_b16 v[154:155], v235 offset:12928
v_accvgpr_read_b32 v72, a48
v_accvgpr_read_b32 v73, a49
v_accvgpr_read_b32 v74, a50
v_accvgpr_read_b32 v75, a51
v_accvgpr_read_b32 v76, a52
v_accvgpr_read_b32 v77, a53
v_accvgpr_read_b32 v78, a54
v_accvgpr_read_b32 v79, a55
v_pk_mul_f32 v[72:73], v[72:73], v[246:247] op_sel_hi:[1,0]
v_pk_mul_f32 v[74:75], v[74:75], v[246:247] op_sel_hi:[1,0]
v_pk_mul_f32 v[76:77], v[76:77], v[246:247] op_sel_hi:[1,0]
v_pk_mul_f32 v[78:79], v[78:79], v[246:247] op_sel_hi:[1,0]
v_cvt_pk_bf16_f32 v24, v72, v73
v_cvt_pk_bf16_f32 v25, v74, v75
v_cvt_pk_bf16_f32 v26, v76, v77
v_cvt_pk_bf16_f32 v27, v78, v79
v_mfma_f32_32x32x16_bf16 a[208:223], v[136:139], a[224:227], a[208:223]
s_add_u32 s41, s52, 0xd8000
buffer_store_dwordx4 v[12:15], v243, s[24:27], s41 offen offset:3072 sc1
s_waitcnt lgkmcnt(0)
v_mfma_f32_32x32x16_bf16 a[144:159], v[140:143], a[228:231], a[144:159]
ds_read_b64_tr_b16 v[128:129], v235 offset:10432
ds_read_b64_tr_b16 v[130:131], v235 offset:12992
ds_read_b64_tr_b16 v[132:133], v235 offset:10496
ds_read_b64_tr_b16 v[134:135], v235 offset:13056
v_accvgpr_read_b32 v80, a56
v_accvgpr_read_b32 v81, a57
v_accvgpr_read_b32 v82, a58
v_accvgpr_read_b32 v83, a59
v_accvgpr_read_b32 v84, a60
v_accvgpr_read_b32 v85, a61
v_accvgpr_read_b32 v86, a62
v_accvgpr_read_b32 v87, a63
v_pk_mul_f32 v[80:81], v[80:81], v[246:247] op_sel_hi:[1,0]
v_pk_mul_f32 v[82:83], v[82:83], v[246:247] op_sel_hi:[1,0]
v_pk_mul_f32 v[84:85], v[84:85], v[246:247] op_sel_hi:[1,0]
v_pk_mul_f32 v[86:87], v[86:87], v[246:247] op_sel_hi:[1,0]
v_cvt_pk_bf16_f32 v28, v80, v81
v_cvt_pk_bf16_f32 v29, v82, v83
v_cvt_pk_bf16_f32 v30, v84, v85
v_cvt_pk_bf16_f32 v31, v86, v87
v_mfma_f32_32x32x16_bf16 a[160:175], v[144:147], a[228:231], a[160:175]
v_mfma_f32_16x16x32_bf16 a[240:243], v[148:151], a[252:255], a[240:243]
ds_read_b64_tr_b16 v[136:137], v238 offset:10240
ds_read_b64_tr_b16 v[138:139], v238 offset:15360
v_accvgpr_read_b32 v88, a64
v_accvgpr_read_b32 v89, a65
v_accvgpr_read_b32 v90, a66
v_accvgpr_read_b32 v91, a67
v_accvgpr_read_b32 v92, a68
v_accvgpr_read_b32 v93, a69
v_accvgpr_read_b32 v94, a70
v_accvgpr_read_b32 v95, a71
v_pk_mul_f32 v[88:89], v[88:89], v[246:247] op_sel_hi:[1,0]
v_pk_mul_f32 v[90:91], v[90:91], v[246:247] op_sel_hi:[1,0]
v_pk_mul_f32 v[92:93], v[92:93], v[246:247] op_sel_hi:[1,0]
v_pk_mul_f32 v[94:95], v[94:95], v[246:247] op_sel_hi:[1,0]
v_cvt_pk_bf16_f32 v32, v88, v89
v_cvt_pk_bf16_f32 v33, v90, v91
v_cvt_pk_bf16_f32 v34, v92, v93
v_cvt_pk_bf16_f32 v35, v94, v95
v_mfma_f32_32x32x16_bf16 a[176:191], v[152:155], a[228:231], a[176:191]
ds_read_b64_tr_b16 v[140:141], v235 offset:15360
ds_read_b64_tr_b16 v[142:143], v235 offset:17920
s_add_u32 s41, s52, 0xd9000
buffer_store_dwordx4 v[16:19], v243, s[24:27], s41 offen offset:0 sc1
s_waitcnt lgkmcnt(2)
v_mfma_f32_32x32x16_bf16 a[192:207], v[128:131], a[228:231], a[192:207]
ds_read_b64_tr_b16 v[144:145], v235 offset:15424
ds_read_b64_tr_b16 v[146:147], v235 offset:17984
v_mfma_f32_32x32x16_bf16 a[208:223], v[132:135], a[228:231], a[208:223]
ds_read_b64_tr_b16 v[148:149], v235 offset:15488
ds_read_b64_tr_b16 v[150:151], v235 offset:18048
ds_read_b64_tr_b16 v[152:153], v239 offset:10240
ds_read_b64_tr_b16 v[154:155], v239 offset:15360
ds_read_b64_tr_b16 v[128:129], v235 offset:15552
ds_read_b64_tr_b16 v[130:131], v235 offset:18112
v_accvgpr_read_b32 v96, a72
v_accvgpr_read_b32 v97, a73
v_accvgpr_read_b32 v98, a74
v_accvgpr_read_b32 v99, a75
v_accvgpr_read_b32 v100, a76
v_accvgpr_read_b32 v101, a77
v_accvgpr_read_b32 v102, a78
v_accvgpr_read_b32 v103, a79
v_pk_mul_f32 v[96:97], v[96:97], v[246:247] op_sel_hi:[1,0]
v_pk_mul_f32 v[98:99], v[98:99], v[246:247] op_sel_hi:[1,0]
v_pk_mul_f32 v[100:101], v[100:101], v[246:247] op_sel_hi:[1,0]
v_pk_mul_f32 v[102:103], v[102:103], v[246:247] op_sel_hi:[1,0]
v_cvt_pk_bf16_f32 v36, v96, v97
v_cvt_pk_bf16_f32 v37, v98, v99
v_cvt_pk_bf16_f32 v38, v100, v101
v_cvt_pk_bf16_f32 v39, v102, v103
v_mfma_f32_16x16x32_bf16 a[244:247], v[136:139], a[252:255], a[244:247]
s_waitcnt lgkmcnt(5)
v_mfma_f32_32x32x16_bf16 a[144:159], v[140:143], a[232:235], a[144:159]
ds_read_b64_tr_b16 v[132:133], v235 offset:15616
ds_read_b64_tr_b16 v[134:135], v235 offset:18176
v_accvgpr_read_b32 v72, a80
v_accvgpr_read_b32 v73, a81
v_accvgpr_read_b32 v74, a82
v_accvgpr_read_b32 v75, a83
v_accvgpr_read_b32 v76, a84
v_accvgpr_read_b32 v77, a85
v_accvgpr_read_b32 v78, a86
v_accvgpr_read_b32 v79, a87
v_pk_mul_f32 v[72:73], v[72:73], v[246:247] op_sel_hi:[1,0]
v_pk_mul_f32 v[74:75], v[74:75], v[246:247] op_sel_hi:[1,0]
v_pk_mul_f32 v[76:77], v[76:77], v[246:247] op_sel_hi:[1,0]
v_pk_mul_f32 v[78:79], v[78:79], v[246:247] op_sel_hi:[1,0]
v_cvt_pk_bf16_f32 v40, v72, v73
v_cvt_pk_bf16_f32 v41, v74, v75
v_cvt_pk_bf16_f32 v42, v76, v77
v_cvt_pk_bf16_f32 v43, v78, v79
s_add_u32 s41, s52, 0xd9000
buffer_store_dwordx4 v[20:23], v243, s[24:27], s41 offen offset:1024 sc1
v_mfma_f32_32x32x16_bf16 a[160:175], v[144:147], a[232:235], a[160:175]
s_waitcnt lgkmcnt(0)
v_mfma_f32_32x32x16_bf16 a[176:191], v[148:151], a[232:235], a[176:191]
s_barrier
ds_read_b64_tr_b16 v[136:137], v217 offset:0
ds_read_b64_tr_b16 v[138:139], v217 offset:2560
ds_read_b64_tr_b16 v[140:141], v217 offset:64
ds_read_b64_tr_b16 v[142:143], v217 offset:2624
v_mfma_f32_16x16x32_bf16 a[248:251], v[152:155], a[252:255], a[248:251]
ds_read_b64_tr_b16 v[144:145], v217 offset:128
ds_read_b64_tr_b16 v[146:147], v217 offset:2688
v_accvgpr_read_b32 v80, a88
v_accvgpr_read_b32 v81, a89
v_accvgpr_read_b32 v82, a90
v_accvgpr_read_b32 v83, a91
v_accvgpr_read_b32 v84, a92
v_accvgpr_read_b32 v85, a93
v_accvgpr_read_b32 v86, a94
v_accvgpr_read_b32 v87, a95
v_pk_mul_f32 v[80:81], v[80:81], v[246:247] op_sel_hi:[1,0]
v_pk_mul_f32 v[82:83], v[82:83], v[246:247] op_sel_hi:[1,0]
v_pk_mul_f32 v[84:85], v[84:85], v[246:247] op_sel_hi:[1,0]
v_pk_mul_f32 v[86:87], v[86:87], v[246:247] op_sel_hi:[1,0]
v_cvt_pk_bf16_f32 v44, v80, v81
v_cvt_pk_bf16_f32 v45, v82, v83
v_cvt_pk_bf16_f32 v46, v84, v85
v_cvt_pk_bf16_f32 v47, v86, v87
ds_read_b128 v[48:51], v251 offset:0
ds_read_b128 v[52:55], v251 offset:1024
ds_read_b128 v[56:59], v251 offset:2048
ds_read_b128 v[60:63], v251 offset:3072
ds_read_b128 v[64:67], v251 offset:24576
ds_read_b128 v[68:71], v251 offset:25600
v_mfma_f32_32x32x16_bf16 a[192:207], v[128:131], a[232:235], a[192:207]
s_add_u32 s41, s52, 0xd9000
buffer_store_dwordx4 v[24:27], v243, s[24:27], s41 offen offset:2048 sc1
v_mfma_f32_32x32x16_bf16 a[208:223], v[132:135], a[232:235], a[208:223]
ds_read_b64_tr_b16 v[148:149], v218 offset:0
ds_read_b64_tr_b16 v[150:151], v218 offset:5120
ds_read_b64_tr_b16 v[152:153], v217 offset:192
ds_read_b64_tr_b16 v[154:155], v217 offset:2752
s_waitcnt lgkmcnt(10)
v_mfma_f32_32x32x16_bf16 a[144:159], v[136:139], v[0:3], a[144:159]
ds_read_b64_tr_b16 v[128:129], v217 offset:256
ds_read_b64_tr_b16 v[130:131], v217 offset:2816
ds_read_b64_tr_b16 v[132:133], v217 offset:5120
ds_read_b64_tr_b16 v[134:135], v217 offset:7680
ds_read_b64_tr_b16 v[136:137], v219 offset:0
ds_read_b64_tr_b16 v[138:139], v219 offset:5120
v_mfma_f32_32x32x16_bf16 a[160:175], v[140:143], v[0:3], a[160:175]
ds_read_b64_tr_b16 v[140:141], v217 offset:5184
ds_read_b64_tr_b16 v[142:143], v217 offset:7744
s_add_u32 s41, s52, 0xd9000
buffer_store_dwordx4 v[28:31], v243, s[24:27], s41 offen offset:3072 sc1
v_mfma_f32_32x32x16_bf16 a[176:191], v[144:147], v[0:3], a[176:191]
ds_read_b64_tr_b16 v[144:145], v217 offset:5248
ds_read_b64_tr_b16 v[146:147], v217 offset:7808
s_add_u32 s59, s55, 0x2000
buffer_load_dwordx4 v[204:207], v243, s[24:27], s59 offen offset:0 sc1
s_waitcnt lgkmcnt(9)
v_mfma_f32_16x16x32_bf16 a[240:243], v[148:151], v[48:51], a[240:243]
ds_read_b64_tr_b16 v[148:149], v217 offset:5312
ds_read_b64_tr_b16 v[150:151], v217 offset:7872
v_mfma_f32_32x32x16_bf16 a[192:207], v[152:155], v[0:3], a[192:207]
ds_read_b64_tr_b16 v[152:153], v220 offset:0
ds_read_b64_tr_b16 v[154:155], v220 offset:5120
buffer_load_dwordx4 a[224:227], v243, s[24:27], s59 offen offset:1024 sc1
buffer_load_dwordx4 a[228:231], v243, s[24:27], s59 offen offset:2048 sc1
s_waitcnt lgkmcnt(6)
v_mfma_f32_32x32x16_bf16 a[208:223], v[128:131], v[0:3], a[208:223]
ds_read_b64_tr_b16 v[128:129], v217 offset:5376
ds_read_b64_tr_b16 v[130:131], v217 offset:7936
s_add_u32 s41, s52, 0xda000
buffer_store_dwordx4 v[32:35], v243, s[24:27], s41 offen offset:0 sc1
v_mfma_f32_32x32x16_bf16 a[144:159], v[132:135], v[4:7], a[144:159]
ds_read_b64_tr_b16 v[132:133], v217 offset:10240
ds_read_b64_tr_b16 v[134:135], v217 offset:12800
buffer_load_dwordx4 a[232:235], v243, s[24:27], s59 offen offset:3072 sc1
v_mfma_f32_16x16x32_bf16 a[244:247], v[136:139], v[48:51], a[244:247]
ds_read_b64_tr_b16 v[136:137], v217 offset:10304
ds_read_b64_tr_b16 v[138:139], v217 offset:12864
v_mfma_f32_32x32x16_bf16 a[160:175], v[140:143], v[4:7], a[160:175]
ds_read_b64_tr_b16 v[140:141], v218 offset:10240
ds_read_b64_tr_b16 v[142:143], v218 offset:15360
s_add_u32 s59, s55, 0x1000
buffer_load_dwordx4 a[236:239], v244, s[24:27], s59 offen offset:0 sc1
s_waitcnt lgkmcnt(6)
v_mfma_f32_32x32x16_bf16 a[176:191], v[144:147], v[4:7], a[176:191]
ds_read_b64_tr_b16 v[144:145], v217 offset:10368
ds_read_b64_tr_b16 v[146:147], v217 offset:12928
buffer_load_dwordx4 a[252:255], v244, s[24:27], s59 offen offset:1024 sc1
v_mfma_f32_32x32x16_bf16 a[192:207], v[148:151], v[4:7], a[192:207]
ds_read_b64_tr_b16 v[148:149], v217 offset:10432
ds_read_b64_tr_b16 v[150:151], v217 offset:12992
s_add_u32 s41, s52, 0xda000
buffer_store_dwordx4 v[36:39], v243, s[24:27], s41 offen offset:1024 sc1
v_mfma_f32_16x16x32_bf16 a[248:251], v[152:155], v[48:51], a[248:251]
ds_read_b64_tr_b16 v[152:153], v217 offset:10496
ds_read_b64_tr_b16 v[154:155], v217 offset:13056
s_add_u32 m0, s36, 0x18000
s_add_u32 s38, s51, 0x28000
buffer_load_dwordx4 v229, s[20:23], s38 offen offset:0 lds
v_mfma_f32_32x32x16_bf16 a[208:223], v[128:131], v[4:7], a[208:223]
ds_read_b64_tr_b16 v[128:129], v219 offset:10240
ds_read_b64_tr_b16 v[130:131], v219 offset:15360
buffer_load_dwordx4 v230, s[20:23], s38 offen offset:1024 lds
s_waitcnt lgkmcnt(6)
v_mfma_f32_32x32x16_bf16 a[144:159], v[132:135], v[8:11], a[144:159]
ds_read_b64_tr_b16 v[132:133], v217 offset:15360
ds_read_b64_tr_b16 v[134:135], v217 offset:17920
buffer_load_dwordx4 v231, s[20:23], s38 offen offset:2048 lds
v_mfma_f32_32x32x16_bf16 a[160:175], v[136:139], v[8:11], a[160:175]
ds_read_b64_tr_b16 v[136:137], v217 offset:15424
ds_read_b64_tr_b16 v[138:139], v217 offset:17984
s_add_u32 s41, s52, 0xda000
buffer_store_dwordx4 v[40:43], v243, s[24:27], s41 offen offset:2048 sc1
v_mfma_f32_16x16x32_bf16 a[240:243], v[140:143], v[52:55], a[240:243]
ds_read_b64_tr_b16 v[140:141], v217 offset:15488
ds_read_b64_tr_b16 v[142:143], v217 offset:18048
buffer_load_dwordx4 v232, s[20:23], s38 offen offset:3072 lds
v_mfma_f32_32x32x16_bf16 a[176:191], v[144:147], v[8:11], a[176:191]
ds_read_b64_tr_b16 v[144:145], v220 offset:10240
ds_read_b64_tr_b16 v[146:147], v220 offset:15360
s_add_u32 m0, s36, 0x19000
s_nop 0
buffer_load_dwordx4 v233, s[20:23], s38 offen offset:0 lds
s_waitcnt lgkmcnt(6)
v_mfma_f32_32x32x16_bf16 a[192:207], v[148:151], v[8:11], a[192:207]
ds_read_b64_tr_b16 v[148:149], v217 offset:15552
ds_read_b64_tr_b16 v[150:151], v217 offset:18112
s_add_u32 s41, s52, 0xda000
buffer_store_dwordx4 v[44:47], v243, s[24:27], s41 offen offset:3072 sc1
v_mfma_f32_32x32x16_bf16 a[208:223], v[152:155], v[8:11], a[208:223]
ds_read_b64_tr_b16 v[152:153], v217 offset:15616
ds_read_b64_tr_b16 v[154:155], v217 offset:18176
s_barrier
v_mfma_f32_16x16x32_bf16 a[244:247], v[128:131], v[52:55], a[244:247]
ds_read_b64_tr_b16 v[128:129], v217 offset:45056
ds_read_b64_tr_b16 v[130:131], v217 offset:47616
v_mfma_f32_32x32x16_bf16 a[144:159], v[132:135], v[12:15], a[144:159]
ds_read_b64_tr_b16 v[132:133], v217 offset:45120
ds_read_b64_tr_b16 v[134:135], v217 offset:47680
s_waitcnt lgkmcnt(8)
v_mfma_f32_32x32x16_bf16 a[160:175], v[136:139], v[12:15], a[160:175]
ds_read_b64_tr_b16 v[136:137], v217 offset:45184
ds_read_b64_tr_b16 v[138:139], v217 offset:47744
v_mfma_f32_32x32x16_bf16 a[176:191], v[140:143], v[12:15], a[176:191]
ds_read_b64_tr_b16 v[140:141], v218 offset:45056
ds_read_b64_tr_b16 v[142:143], v218 offset:50176
v_mfma_f32_16x16x32_bf16 a[248:251], v[144:147], v[52:55], a[248:251]
ds_read_b64_tr_b16 v[144:145], v217 offset:45248
ds_read_b64_tr_b16 v[146:147], v217 offset:47808
s_waitcnt lgkmcnt(8)
v_mfma_f32_32x32x16_bf16 a[192:207], v[148:151], v[12:15], a[192:207]
ds_read_b64_tr_b16 v[148:149], v217 offset:45312
ds_read_b64_tr_b16 v[150:151], v217 offset:47872
v_mfma_f32_32x32x16_bf16 a[208:223], v[152:155], v[12:15], a[208:223]
ds_read_b64_tr_b16 v[152:153], v217 offset:50176
ds_read_b64_tr_b16 v[154:155], v217 offset:52736
v_mfma_f32_32x32x16_bf16 a[144:159], v[128:131], v[16:19], a[144:159]
ds_read_b64_tr_b16 v[128:129], v219 offset:45056
ds_read_b64_tr_b16 v[130:131], v219 offset:50176
s_waitcnt lgkmcnt(8)
v_mfma_f32_32x32x16_bf16 a[160:175], v[132:135], v[16:19], a[160:175]
ds_read_b64_tr_b16 v[132:133], v217 offset:50240
ds_read_b64_tr_b16 v[134:135], v217 offset:52800
s_add_u32 m0, s36, 0x1000
s_add_u32 s38, s78, 0x3c0000
buffer_load_dwordx4 v229, s[20:23], s38 offen offset:0 lds
v_mfma_f32_32x32x16_bf16 a[176:191], v[136:139], v[16:19], a[176:191]
ds_read_b64_tr_b16 v[136:137], v217 offset:50304
ds_read_b64_tr_b16 v[138:139], v217 offset:52864
v_mfma_f32_16x16x32_bf16 a[240:243], v[140:143], v[56:59], a[240:243]
ds_read_b64_tr_b16 v[140:141], v217 offset:50368
ds_read_b64_tr_b16 v[142:143], v217 offset:52928
s_waitcnt lgkmcnt(8)
v_mfma_f32_32x32x16_bf16 a[192:207], v[144:147], v[16:19], a[192:207]
ds_read_b64_tr_b16 v[144:145], v220 offset:45056
ds_read_b64_tr_b16 v[146:147], v220 offset:50176
buffer_load_dwordx4 v230, s[20:23], s38 offen offset:1024 lds
v_mfma_f32_32x32x16_bf16 a[208:223], v[148:151], v[16:19], a[208:223]
ds_read_b64_tr_b16 v[148:149], v217 offset:50432
ds_read_b64_tr_b16 v[150:151], v217 offset:52992
v_mfma_f32_32x32x16_bf16 a[144:159], v[152:155], v[20:23], a[144:159]
ds_read_b64_tr_b16 v[152:153], v217 offset:55296
ds_read_b64_tr_b16 v[154:155], v217 offset:57856
s_waitcnt lgkmcnt(8)
v_mfma_f32_16x16x32_bf16 a[244:247], v[128:131], v[56:59], a[244:247]
ds_read_b64_tr_b16 v[128:129], v217 offset:55360
ds_read_b64_tr_b16 v[130:131], v217 offset:57920
v_mfma_f32_32x32x16_bf16 a[160:175], v[132:135], v[20:23], a[160:175]
ds_read_b64_tr_b16 v[132:133], v218 offset:55296
ds_read_b64_tr_b16 v[134:135], v218 offset:60416
buffer_load_dwordx4 v231, s[20:23], s38 offen offset:2048 lds
v_mfma_f32_32x32x16_bf16 a[176:191], v[136:139], v[20:23], a[176:191]
ds_read_b64_tr_b16 v[136:137], v217 offset:55424
ds_read_b64_tr_b16 v[138:139], v217 offset:57984
s_waitcnt lgkmcnt(8)
v_mfma_f32_32x32x16_bf16 a[192:207], v[140:143], v[20:23], a[192:207]
ds_read_b64_tr_b16 v[140:141], v217 offset:55488
ds_read_b64_tr_b16 v[142:143], v217 offset:58048
buffer_load_dwordx4 v232, s[20:23], s38 offen offset:3072 lds
v_mfma_f32_16x16x32_bf16 a[248:251], v[144:147], v[56:59], a[248:251]
ds_read_b64_tr_b16 v[144:145], v217 offset:55552
ds_read_b64_tr_b16 v[146:147], v217 offset:58112
v_mfma_f32_32x32x16_bf16 a[208:223], v[148:151], v[20:23], a[208:223]
ds_read_b64_tr_b16 v[148:149], v219 offset:55296
ds_read_b64_tr_b16 v[150:151], v219 offset:60416
s_waitcnt lgkmcnt(8)
v_mfma_f32_32x32x16_bf16 a[144:159], v[152:155], v[24:27], a[144:159]
ds_read_b64_tr_b16 v[152:153], v217 offset:60416
ds_read_b64_tr_b16 v[154:155], v217 offset:62976
s_add_u32 m0, s36, 0x2000
s_nop 0
buffer_load_dwordx4 v233, s[20:23], s38 offen offset:0 lds
v_mfma_f32_32x32x16_bf16 a[160:175], v[128:131], v[24:27], a[160:175]
ds_read_b64_tr_b16 v[128:129], v217 offset:60480
ds_read_b64_tr_b16 v[130:131], v217 offset:63040
v_mfma_f32_16x16x32_bf16 a[240:243], v[132:135], v[60:63], a[240:243]
ds_read_b64_tr_b16 v[132:133], v217 offset:60544
ds_read_b64_tr_b16 v[134:135], v217 offset:63104
s_waitcnt lgkmcnt(8)
v_mfma_f32_32x32x16_bf16 a[176:191], v[136:139], v[24:27], a[176:191]
ds_read_b64_tr_b16 v[136:137], v220 offset:55296
ds_read_b64_tr_b16 v[138:139], v220 offset:60416
v_mfma_f32_32x32x16_bf16 a[192:207], v[140:143], v[24:27], a[192:207]
ds_read_b64_tr_b16 v[140:141], v217 offset:60608
ds_read_b64_tr_b16 v[142:143], v217 offset:63168
v_mfma_f32_32x32x16_bf16 a[208:223], v[144:147], v[24:27], a[208:223]
ds_read_b64_tr_b16 v[144:145], v217 offset:60672
ds_read_b64_tr_b16 v[146:147], v217 offset:63232
s_waitcnt vmcnt(5)
s_barrier
s_waitcnt lgkmcnt(8)
v_mfma_f32_16x16x32_bf16 a[244:247], v[148:151], v[60:63], a[244:247]
ds_read_b64_tr_b16 v[148:149], v217 offset:20480
ds_read_b64_tr_b16 v[150:151], v217 offset:23040
v_mfma_f32_32x32x16_bf16 a[144:159], v[152:155], v[28:31], a[144:159]
ds_read_b64_tr_b16 v[152:153], v217 offset:20544
ds_read_b64_tr_b16 v[154:155], v217 offset:23104
v_mfma_f32_32x32x16_bf16 a[160:175], v[128:131], v[28:31], a[160:175]
ds_read_b64_tr_b16 v[128:129], v217 offset:20608
ds_read_b64_tr_b16 v[130:131], v217 offset:23168
s_waitcnt lgkmcnt(8)
v_mfma_f32_32x32x16_bf16 a[176:191], v[132:135], v[28:31], a[176:191]
ds_read_b64_tr_b16 v[132:133], v218 offset:20480
ds_read_b64_tr_b16 v[134:135], v218 offset:25600
v_mfma_f32_16x16x32_bf16 a[248:251], v[136:139], v[60:63], a[248:251]
ds_read_b64_tr_b16 v[136:137], v217 offset:20672
ds_read_b64_tr_b16 v[138:139], v217 offset:23232
v_mfma_f32_32x32x16_bf16 a[192:207], v[140:143], v[28:31], a[192:207]
ds_read_b64_tr_b16 v[140:141], v217 offset:20736
ds_read_b64_tr_b16 v[142:143], v217 offset:23296
s_waitcnt lgkmcnt(8)
v_mfma_f32_32x32x16_bf16 a[208:223], v[144:147], v[28:31], a[208:223]
ds_read_b64_tr_b16 v[144:145], v217 offset:25600
ds_read_b64_tr_b16 v[146:147], v217 offset:28160
v_mfma_f32_32x32x16_bf16 a[144:159], v[148:151], v[32:35], a[144:159]
ds_read_b64_tr_b16 v[148:149], v219 offset:20480
ds_read_b64_tr_b16 v[150:151], v219 offset:25600
v_mfma_f32_32x32x16_bf16 a[160:175], v[152:155], v[32:35], a[160:175]
ds_read_b64_tr_b16 v[152:153], v217 offset:25664
ds_read_b64_tr_b16 v[154:155], v217 offset:28224
v_mov_b32 v253, 0x10000
s_mov_b64 exec, s[44:45]
buffer_atomic_add v253, off, s[28:31], 0 sc1
s_mov_b64 exec, -1
s_waitcnt lgkmcnt(6)
v_mfma_f32_32x32x16_bf16 a[176:191], v[128:131], v[32:35], a[176:191]
ds_read_b64_tr_b16 v[128:129], v217 offset:25728
ds_read_b64_tr_b16 v[130:131], v217 offset:28288
v_mfma_f32_16x16x32_bf16 a[240:243], v[132:135], v[64:67], a[240:243]
ds_read_b64_tr_b16 v[132:133], v217 offset:25792
ds_read_b64_tr_b16 v[134:135], v217 offset:28352
v_mfma_f32_32x32x16_bf16 a[192:207], v[136:139], v[32:35], a[192:207]
ds_read_b64_tr_b16 v[136:137], v220 offset:20480
ds_read_b64_tr_b16 v[138:139], v220 offset:25600
s_add_u32 m0, s36, 0xc000
s_add_u32 s38, s79, 0x3c0000
buffer_load_dwordx4 v229, s[20:23], s38 offen offset:0 lds
v_mfma_f32_32x32x16_bf16 a[208:223], v[140:143], v[32:35], a[208:223]
ds_read_b64_tr_b16 v[140:141], v217 offset:25856
ds_read_b64_tr_b16 v[142:143], v217 offset:28416
s_waitcnt lgkmcnt(8)
v_mfma_f32_32x32x16_bf16 a[144:159], v[144:147], v[36:39], a[144:159]
ds_read_b64_tr_b16 v[144:145], v217 offset:30720
ds_read_b64_tr_b16 v[146:147], v217 offset:33280
buffer_load_dwordx4 v230, s[20:23], s38 offen offset:1024 lds
v_mfma_f32_16x16x32_bf16 a[244:247], v[148:151], v[64:67], a[244:247]
ds_read_b64_tr_b16 v[148:149], v217 offset:30784
ds_read_b64_tr_b16 v[150:151], v217 offset:33344
v_mfma_f32_32x32x16_bf16 a[160:175], v[152:155], v[36:39], a[160:175]
ds_read_b64_tr_b16 v[152:153], v218 offset:30720
ds_read_b64_tr_b16 v[154:155], v218 offset:35840
buffer_load_dwordx4 v231, s[20:23], s38 offen offset:2048 lds
s_waitcnt lgkmcnt(8)
v_mfma_f32_32x32x16_bf16 a[176:191], v[128:131], v[36:39], a[176:191]
ds_read_b64_tr_b16 v[128:129], v217 offset:30848
ds_read_b64_tr_b16 v[130:131], v217 offset:33408
v_mfma_f32_32x32x16_bf16 a[192:207], v[132:135], v[36:39], a[192:207]
ds_read_b64_tr_b16 v[132:133], v217 offset:30912
ds_read_b64_tr_b16 v[134:135], v217 offset:33472
v_mfma_f32_16x16x32_bf16 a[248:251], v[136:139], v[64:67], a[248:251]
ds_read_b64_tr_b16 v[136:137], v217 offset:30976
ds_read_b64_tr_b16 v[138:139], v217 offset:33536
s_waitcnt lgkmcnt(8)
v_mfma_f32_32x32x16_bf16 a[208:223], v[140:143], v[36:39], a[208:223]
ds_read_b64_tr_b16 v[140:141], v219 offset:30720
ds_read_b64_tr_b16 v[142:143], v219 offset:35840
buffer_load_dwordx4 v232, s[20:23], s38 offen offset:3072 lds
v_mfma_f32_32x32x16_bf16 a[144:159], v[144:147], v[40:43], a[144:159]
ds_read_b64_tr_b16 v[144:145], v217 offset:35840
ds_read_b64_tr_b16 v[146:147], v217 offset:38400
s_add_u32 m0, s36, 0xd000
s_nop 0
buffer_load_dwordx4 v233, s[20:23], s38 offen offset:0 lds
v_mfma_f32_32x32x16_bf16 a[160:175], v[148:151], v[40:43], a[160:175]
ds_read_b64_tr_b16 v[148:149], v217 offset:35904
ds_read_b64_tr_b16 v[150:151], v217 offset:38464
s_waitcnt lgkmcnt(6)
v_mfma_f32_16x16x32_bf16 a[240:243], v[152:155], v[68:71], a[240:243]
ds_read_b64_tr_b16 v[152:153], v217 offset:35968
ds_read_b64_tr_b16 v[154:155], v217 offset:38528
v_mfma_f32_32x32x16_bf16 a[176:191], v[128:131], v[40:43], a[176:191]
ds_read_b64_tr_b16 v[128:129], v220 offset:30720
ds_read_b64_tr_b16 v[130:131], v220 offset:35840
v_mfma_f32_32x32x16_bf16 a[192:207], v[132:135], v[40:43], a[192:207]
ds_read_b64_tr_b16 v[132:133], v217 offset:36032
ds_read_b64_tr_b16 v[134:135], v217 offset:38592
v_mfma_f32_32x32x16_bf16 a[208:223], v[136:139], v[40:43], a[208:223]
ds_read_b64_tr_b16 v[136:137], v217 offset:36096
ds_read_b64_tr_b16 v[138:139], v217 offset:38656
s_barrier
s_waitcnt lgkmcnt(8)
v_mfma_f32_16x16x32_bf16 a[244:247], v[140:143], v[68:71], a[244:247]
ds_read_b64_tr_b16 v[140:141], v235 offset:21504
ds_read_b64_tr_b16 v[142:143], v235 offset:24064
v_mfma_f32_32x32x16_bf16 a[144:159], v[144:147], v[44:47], a[144:159]
ds_read_b64_tr_b16 v[144:145], v235 offset:21568
ds_read_b64_tr_b16 v[146:147], v235 offset:24128
v_mfma_f32_32x32x16_bf16 a[160:175], v[148:151], v[44:47], a[160:175]
ds_read_b64_tr_b16 v[148:149], v235 offset:21632
ds_read_b64_tr_b16 v[150:151], v235 offset:24192
s_waitcnt lgkmcnt(8)
v_mfma_f32_32x32x16_bf16 a[176:191], v[152:155], v[44:47], a[176:191]
ds_read_b64_tr_b16 v[152:153], v237 offset:21504
ds_read_b64_tr_b16 v[154:155], v237 offset:26624
v_mfma_f32_16x16x32_bf16 a[248:251], v[128:131], v[68:71], a[248:251]
ds_read_b64_tr_b16 v[128:129], v235 offset:21696
ds_read_b64_tr_b16 v[130:131], v235 offset:24256
v_mfma_f32_32x32x16_bf16 a[192:207], v[132:135], v[44:47], a[192:207]
ds_read_b64_tr_b16 v[132:133], v235 offset:21760
ds_read_b64_tr_b16 v[134:135], v235 offset:24320
s_waitcnt lgkmcnt(8)
v_mfma_f32_32x32x16_bf16 a[208:223], v[136:139], v[44:47], a[208:223]
ds_read_b64_tr_b16 v[136:137], v235 offset:26624
ds_read_b64_tr_b16 v[138:139], v235 offset:29184
v_mfma_f32_32x32x16_bf16 a[144:159], v[140:143], v[156:159], a[144:159]
ds_read_b64_tr_b16 v[140:141], v238 offset:21504
ds_read_b64_tr_b16 v[142:143], v238 offset:26624
v_mfma_f32_32x32x16_bf16 a[160:175], v[144:147], v[156:159], a[160:175]
ds_read_b64_tr_b16 v[144:145], v235 offset:26688
ds_read_b64_tr_b16 v[146:147], v235 offset:29248
s_add_u32 m0, s36, 0x6000
s_add_u32 s38, s80, 0x3c0000
buffer_load_dwordx4 v229, s[20:23], s38 offen offset:0 lds
s_waitcnt lgkmcnt(6)
v_mfma_f32_32x32x16_bf16 a[176:191], v[148:151], v[156:159], a[176:191]
ds_read_b64_tr_b16 v[148:149], v235 offset:26752
ds_read_b64_tr_b16 v[150:151], v235 offset:29312
v_mfma_f32_16x16x32_bf16 a[240:243], v[152:155], v[172:175], a[240:243]
ds_read_b64_tr_b16 v[152:153], v235 offset:26816
ds_read_b64_tr_b16 v[154:155], v235 offset:29376
v_mfma_f32_32x32x16_bf16 a[192:207], v[128:131], v[156:159], a[192:207]
ds_read_b64_tr_b16 v[128:129], v239 offset:21504
ds_read_b64_tr_b16 v[130:131], v239 offset:26624
buffer_load_dwordx4 v230, s[20:23], s38 offen offset:1024 lds
v_mfma_f32_32x32x16_bf16 a[208:223], v[132:135], v[156:159], a[208:223]
ds_read_b64_tr_b16 v[132:133], v235 offset:26880
ds_read_b64_tr_b16 v[134:135], v235 offset:29440
s_waitcnt lgkmcnt(8)
v_mfma_f32_32x32x16_bf16 a[144:159], v[136:139], v[160:163], a[144:159]
ds_read_b64_tr_b16 v[136:137], v235 offset:31744
ds_read_b64_tr_b16 v[138:139], v235 offset:34304
v_mfma_f32_16x16x32_bf16 a[244:247], v[140:143], v[172:175], a[244:247]
ds_read_b64_tr_b16 v[140:141], v235 offset:31808
ds_read_b64_tr_b16 v[142:143], v235 offset:34368
v_mfma_f32_32x32x16_bf16 a[160:175], v[144:147], v[160:163], a[160:175]
ds_read_b64_tr_b16 v[144:145], v237 offset:31744
ds_read_b64_tr_b16 v[146:147], v237 offset:36864
buffer_load_dwordx4 v231, s[20:23], s38 offen offset:2048 lds
s_waitcnt lgkmcnt(8)
v_mfma_f32_32x32x16_bf16 a[176:191], v[148:151], v[160:163], a[176:191]
ds_read_b64_tr_b16 v[148:149], v235 offset:31872
ds_read_b64_tr_b16 v[150:151], v235 offset:34432
v_mfma_f32_32x32x16_bf16 a[192:207], v[152:155], v[160:163], a[192:207]
ds_read_b64_tr_b16 v[152:153], v235 offset:31936
ds_read_b64_tr_b16 v[154:155], v235 offset:34496
buffer_load_dwordx4 v232, s[20:23], s38 offen offset:3072 lds
v_mfma_f32_16x16x32_bf16 a[248:251], v[128:131], v[172:175], a[248:251]
ds_read_b64_tr_b16 v[128:129], v235 offset:32000
ds_read_b64_tr_b16 v[130:131], v235 offset:34560
s_waitcnt lgkmcnt(8)
v_mfma_f32_32x32x16_bf16 a[208:223], v[132:135], v[160:163], a[208:223]
ds_read_b64_tr_b16 v[132:133], v238 offset:31744
ds_read_b64_tr_b16 v[134:135], v238 offset:36864
v_mfma_f32_32x32x16_bf16 a[144:159], v[136:139], v[164:167], a[144:159]
ds_read_b64_tr_b16 v[136:137], v235 offset:36864
ds_read_b64_tr_b16 v[138:139], v235 offset:39424
s_add_u32 m0, s36, 0x7000
s_nop 0
buffer_load_dwordx4 v233, s[20:23], s38 offen offset:0 lds
v_mfma_f32_32x32x16_bf16 a[160:175], v[140:143], v[164:167], a[160:175]
ds_read_b64_tr_b16 v[140:141], v235 offset:36928
ds_read_b64_tr_b16 v[142:143], v235 offset:39488
s_waitcnt lgkmcnt(6)
v_mfma_f32_16x16x32_bf16 a[240:243], v[144:147], v[176:179], a[240:243]
ds_read_b64_tr_b16 v[144:145], v235 offset:36992
ds_read_b64_tr_b16 v[146:147], v235 offset:39552
v_mfma_f32_32x32x16_bf16 a[176:191], v[148:151], v[164:167], a[176:191]
ds_read_b64_tr_b16 v[148:149], v239 offset:31744
ds_read_b64_tr_b16 v[150:151], v239 offset:36864
v_mfma_f32_32x32x16_bf16 a[192:207], v[152:155], v[164:167], a[192:207]
ds_read_b64_tr_b16 v[152:153], v235 offset:37056
ds_read_b64_tr_b16 v[154:155], v235 offset:39616
v_mfma_f32_32x32x16_bf16 a[208:223], v[128:131], v[164:167], a[208:223]
ds_read_b64_tr_b16 v[128:129], v235 offset:37120
ds_read_b64_tr_b16 v[130:131], v235 offset:39680
s_barrier
s_waitcnt lgkmcnt(8)
v_mfma_f32_16x16x32_bf16 a[244:247], v[132:135], v[176:179], a[244:247]
ds_read_b64_tr_b16 v[132:133], v235 offset:43008
ds_read_b64_tr_b16 v[134:135], v235 offset:45568
v_mfma_f32_32x32x16_bf16 a[144:159], v[136:139], v[168:171], a[144:159]
ds_read_b64_tr_b16 v[136:137], v235 offset:43072
ds_read_b64_tr_b16 v[138:139], v235 offset:45632
v_mfma_f32_32x32x16_bf16 a[160:175], v[140:143], v[168:171], a[160:175]
ds_read_b64_tr_b16 v[140:141], v235 offset:43136
ds_read_b64_tr_b16 v[142:143], v235 offset:45696
s_waitcnt lgkmcnt(8)
v_mfma_f32_32x32x16_bf16 a[176:191], v[144:147], v[168:171], a[176:191]
ds_read_b64_tr_b16 v[144:145], v237 offset:43008
ds_read_b64_tr_b16 v[146:147], v237 offset:48128
v_mfma_f32_16x16x32_bf16 a[248:251], v[148:151], v[176:179], a[248:251]
ds_read_b64_tr_b16 v[148:149], v235 offset:43200
ds_read_b64_tr_b16 v[150:151], v235 offset:45760
v_mfma_f32_32x32x16_bf16 a[192:207], v[152:155], v[168:171], a[192:207]
ds_read_b64_tr_b16 v[152:153], v235 offset:43264
ds_read_b64_tr_b16 v[154:155], v235 offset:45824
s_waitcnt lgkmcnt(8)
v_mfma_f32_32x32x16_bf16 a[208:223], v[128:131], v[168:171], a[208:223]
ds_read_b64_tr_b16 v[128:129], v235 offset:48128
ds_read_b64_tr_b16 v[130:131], v235 offset:50688
v_mfma_f32_32x32x16_bf16 a[144:159], v[132:135], v[180:183], a[144:159]
ds_read_b64_tr_b16 v[132:133], v238 offset:43008
ds_read_b64_tr_b16 v[134:135], v238 offset:48128
v_mfma_f32_32x32x16_bf16 a[160:175], v[136:139], v[180:183], a[160:175]
ds_read_b64_tr_b16 v[136:137], v235 offset:48192
ds_read_b64_tr_b16 v[138:139], v235 offset:50752
buffer_load_dword v253, off, s[28:31], 0 sc1
s_waitcnt lgkmcnt(8)
v_mfma_f32_32x32x16_bf16 a[176:191], v[140:143], v[180:183], a[176:191]
ds_read_b64_tr_b16 v[140:141], v235 offset:48256
ds_read_b64_tr_b16 v[142:143], v235 offset:50816
v_mfma_f32_16x16x32_bf16 a[240:243], v[144:147], v[196:199], a[240:243]
ds_read_b64_tr_b16 v[144:145], v235 offset:48320
ds_read_b64_tr_b16 v[146:147], v235 offset:50880
v_mfma_f32_32x32x16_bf16 a[192:207], v[148:151], v[180:183], a[192:207]
ds_read_b64_tr_b16 v[148:149], v239 offset:43008
ds_read_b64_tr_b16 v[150:151], v239 offset:48128
s_add_u32 m0, s36, 0x1d400
s_add_u32 s38, s81, 0x3c0000
buffer_load_dwordx4 v229, s[20:23], s38 offen offset:0 lds
s_waitcnt lgkmcnt(6)
v_mfma_f32_32x32x16_bf16 a[208:223], v[152:155], v[180:183], a[208:223]
ds_read_b64_tr_b16 v[152:153], v235 offset:48384
ds_read_b64_tr_b16 v[154:155], v235 offset:50944
v_mfma_f32_32x32x16_bf16 a[144:159], v[128:131], v[184:187], a[144:159]
ds_read_b64_tr_b16 v[128:129], v235 offset:53248
ds_read_b64_tr_b16 v[130:131], v235 offset:55808
buffer_load_dwordx4 v230, s[20:23], s38 offen offset:1024 lds
v_mfma_f32_16x16x32_bf16 a[244:247], v[132:135], v[196:199], a[244:247]
ds_read_b64_tr_b16 v[132:133], v235 offset:53312
ds_read_b64_tr_b16 v[134:135], v235 offset:55872
v_mfma_f32_32x32x16_bf16 a[160:175], v[136:139], v[184:187], a[160:175]
ds_read_b64_tr_b16 v[136:137], v237 offset:53248
ds_read_b64_tr_b16 v[138:139], v237 offset:58368
buffer_load_dwordx4 v231, s[20:23], s38 offen offset:2048 lds
s_waitcnt lgkmcnt(8)
v_mfma_f32_32x32x16_bf16 a[176:191], v[140:143], v[184:187], a[176:191]
ds_read_b64_tr_b16 v[140:141], v235 offset:53376
ds_read_b64_tr_b16 v[142:143], v235 offset:55936
v_mfma_f32_32x32x16_bf16 a[192:207], v[144:147], v[184:187], a[192:207]
ds_read_b64_tr_b16 v[144:145], v235 offset:53440
ds_read_b64_tr_b16 v[146:147], v235 offset:56000
v_mfma_f32_16x16x32_bf16 a[248:251], v[148:151], v[196:199], a[248:251]
ds_read_b64_tr_b16 v[148:149], v235 offset:53504
ds_read_b64_tr_b16 v[150:151], v235 offset:56064
s_waitcnt lgkmcnt(8)
v_mfma_f32_32x32x16_bf16 a[208:223], v[152:155], v[184:187], a[208:223]
ds_read_b64_tr_b16 v[152:153], v238 offset:53248
ds_read_b64_tr_b16 v[154:155], v238 offset:58368
buffer_load_dwordx4 v232, s[20:23], s38 offen offset:3072 lds
v_mfma_f32_32x32x16_bf16 a[144:159], v[128:131], v[188:191], a[144:159]
ds_read_b64_tr_b16 v[128:129], v235 offset:58368
ds_read_b64_tr_b16 v[130:131], v235 offset:60928
s_add_u32 m0, s36, 0x1e400
s_nop 0
buffer_load_dwordx4 v233, s[20:23], s38 offen offset:0 lds
v_mfma_f32_32x32x16_bf16 a[160:175], v[132:135], v[188:191], a[160:175]
ds_read_b64_tr_b16 v[132:133], v235 offset:58432
ds_read_b64_tr_b16 v[134:135], v235 offset:60992
s_waitcnt lgkmcnt(6)
v_mfma_f32_16x16x32_bf16 a[240:243], v[136:139], v[200:203], a[240:243]
ds_read_b64_tr_b16 v[136:137], v235 offset:58496
ds_read_b64_tr_b16 v[138:139], v235 offset:61056
v_mfma_f32_32x32x16_bf16 a[176:191], v[140:143], v[188:191], a[176:191]
ds_read_b64_tr_b16 v[140:141], v239 offset:53248
ds_read_b64_tr_b16 v[142:143], v239 offset:58368
v_mfma_f32_32x32x16_bf16 a[192:207], v[144:147], v[188:191], a[192:207]
ds_read_b64_tr_b16 v[144:145], v235 offset:58560
ds_read_b64_tr_b16 v[146:147], v235 offset:61120
v_mfma_f32_32x32x16_bf16 a[208:223], v[148:151], v[188:191], a[208:223]
ds_read_b64_tr_b16 v[148:149], v235 offset:58624
ds_read_b64_tr_b16 v[150:151], v235 offset:61184
s_waitcnt vmcnt(5)
v_readfirstlane_b32 s40, v253
s_nop 0
s_bfe_u32 s40, s40, 0x100010
s_cmp_lt_u32 s40, s57
s_cbranch_scc1 L_sp1
L_pr1:
s_barrier
s_waitcnt lgkmcnt(6)
v_mfma_f32_16x16x32_bf16 a[244:247], v[152:155], v[200:203], a[244:247]
v_mfma_f32_32x32x16_bf16 a[144:159], v[128:131], v[192:195], a[144:159]
ds_read_b64_tr_b16 v[152:153], v235 offset:0
ds_read_b64_tr_b16 v[154:155], v235 offset:2560
ds_read_b64_tr_b16 v[128:129], v235 offset:64
ds_read_b64_tr_b16 v[130:131], v235 offset:2624
v_mfma_f32_32x32x16_bf16 a[160:175], v[132:135], v[192:195], a[160:175]
ds_read_b64_tr_b16 v[132:133], v235 offset:128
ds_read_b64_tr_b16 v[134:135], v235 offset:2688
v_mfma_f32_32x32x16_bf16 a[176:191], v[136:139], v[192:195], a[176:191]
ds_read_b64_tr_b16 v[136:137], v237 offset:0
ds_read_b64_tr_b16 v[138:139], v237 offset:5120
s_waitcnt lgkmcnt(8)
v_mfma_f32_16x16x32_bf16 a[248:251], v[140:143], v[200:203], a[248:251]
ds_read_b64_tr_b16 v[140:141], v235 offset:192
ds_read_b64_tr_b16 v[142:143], v235 offset:2752
v_mfma_f32_32x32x16_bf16 a[192:207], v[144:147], v[192:195], a[192:207]
ds_read_b64_tr_b16 v[144:145], v235 offset:256
ds_read_b64_tr_b16 v[146:147], v235 offset:2816
v_mfma_f32_32x32x16_bf16 a[208:223], v[148:151], v[192:195], a[208:223]
ds_read_b64_tr_b16 v[148:149], v235 offset:5120
ds_read_b64_tr_b16 v[150:151], v235 offset:7680
s_waitcnt lgkmcnt(8)
v_mfma_f32_32x32x16_bf16 a[144:159], v[152:155], v[204:207], a[144:159]
ds_read_b64_tr_b16 v[152:153], v238 offset:0
ds_read_b64_tr_b16 v[154:155], v238 offset:5120
v_mfma_f32_32x32x16_bf16 a[160:175], v[128:131], v[204:207], a[160:175]
ds_read_b64_tr_b16 v[128:129], v235 offset:5184
ds_read_b64_tr_b16 v[130:131], v235 offset:7744
s_lshl_b32 s40, s32, 10
s_and_b32 s40, s40, 0x400
s_add_u32 m0, s40, 0x12000
s_add_u32 s40, s40, s87
s_sub_u32 s40, s40, s75
s_add_u32 s40, s40, 0xd8000
buffer_load_dwordx4 v244, s[24:27], s40 offen sc1 lds
v_mfma_f32_32x32x16_bf16 a[176:191], v[132:135], v[204:207], a[176:191]
ds_read_b64_tr_b16 v[132:133], v235 offset:5248
ds_read_b64_tr_b16 v[134:135], v235 offset:7808
s_waitcnt lgkmcnt(6)
v_mfma_f32_16x16x32_bf16 a[240:243], v[136:139], a[236:239], a[240:243]
ds_read_b64_tr_b16 v[136:137], v235 offset:5312
ds_read_b64_tr_b16 v[138:139], v235 offset:7872
s_add_u32 s59, s87, 0xd8000
buffer_load_dwordx4 a[0:3], v243, s[24:27], s59 offen offset:0 sc1
v_mfma_f32_32x32x16_bf16 a[192:207], v[140:143], v[204:207], a[192:207]
ds_read_b64_tr_b16 v[140:141], v239 offset:0
ds_read_b64_tr_b16 v[142:143], v239 offset:5120
buffer_load_dwordx4 a[4:7], v243, s[24:27], s59 offen offset:1024 sc1
v_mfma_f32_32x32x16_bf16 a[208:223], v[144:147], v[204:207], a[208:223]
ds_read_b64_tr_b16 v[144:145], v235 offset:5376
ds_read_b64_tr_b16 v[146:147], v235 offset:7936
buffer_load_dwordx4 a[8:11], v243, s[24:27], s59 offen offset:2048 sc1
v_mfma_f32_32x32x16_bf16 a[144:159], v[148:151], a[224:227], a[144:159]
ds_read_b64_tr_b16 v[148:149], v235 offset:10240
ds_read_b64_tr_b16 v[150:151], v235 offset:12800
buffer_load_dwordx4 a[12:15], v243, s[24:27], s59 offen offset:3072 sc1
s_lshl_b32 s40, s32, 10
s_and_b32 s40, s40, 0x400
s_add_u32 m0, s40, 0x12800
s_add_u32 s40, s40, s88
s_sub_u32 s40, s40, s76
s_add_u32 s40, s40, 0xd8000
buffer_load_dwordx4 v244, s[24:27], s40 offen sc1 lds
s_waitcnt lgkmcnt(4)
v_mfma_f32_16x16x32_bf16 a[244:247], v[152:155], a[236:239], a[244:247]
s_add_u32 s59, s88, 0xd8000
buffer_load_dwordx4 a[16:19], v243, s[24:27], s59 offen offset:0 sc1
v_mfma_f32_32x32x16_bf16 a[160:175], v[128:131], a[224:227], a[160:175]
buffer_load_dwordx4 a[20:23], v243, s[24:27], s59 offen offset:1024 sc1
v_mfma_f32_32x32x16_bf16 a[176:191], v[132:135], a[224:227], a[176:191]
ds_read_b64_tr_b16 v[152:153], v235 offset:10304
ds_read_b64_tr_b16 v[154:155], v235 offset:12864
ds_read_b64_tr_b16 v[128:129], v237 offset:10240
ds_read_b64_tr_b16 v[130:131], v237 offset:15360
buffer_load_dwordx4 a[24:27], v243, s[24:27], s59 offen offset:2048 sc1
buffer_load_dwordx4 a[28:31], v243, s[24:27], s59 offen offset:3072 sc1
v_mfma_f32_32x32x16_bf16 a[192:207], v[136:139], a[224:227], a[192:207]
ds_read_b64_tr_b16 v[132:133], v235 offset:10368
ds_read_b64_tr_b16 v[134:135], v235 offset:12928
s_lshl_b32 s40, s32, 10
s_and_b32 s40, s40, 0x400
s_add_u32 m0, s40, 0x13000
s_add_u32 s40, s40, s89
s_sub_u32 s40, s40, s77
s_add_u32 s40, s40, 0xd8000
buffer_load_dwordx4 v244, s[24:27], s40 offen sc1 lds
v_mfma_f32_16x16x32_bf16 a[248:251], v[140:143], a[236:239], a[248:251]
s_add_u32 s59, s89, 0xd8000
buffer_load_dwordx4 a[32:35], v243, s[24:27], s59 offen offset:0 sc1
s_waitcnt lgkmcnt(2)
v_mfma_f32_32x32x16_bf16 a[208:223], v[144:147], a[224:227], a[208:223]
buffer_load_dwordx4 a[36:39], v243, s[24:27], s59 offen offset:1024 sc1
buffer_load_dwordx4 a[40:43], v243, s[24:27], s59 offen offset:2048 sc1
v_mfma_f32_32x32x16_bf16 a[144:159], v[148:151], a[228:231], a[144:159]
ds_read_b64_tr_b16 v[136:137], v235 offset:10432
ds_read_b64_tr_b16 v[138:139], v235 offset:12992
buffer_load_dwordx4 a[44:47], v243, s[24:27], s59 offen offset:3072 sc1
v_mfma_f32_32x32x16_bf16 a[160:175], v[152:155], a[228:231], a[160:175]
ds_read_b64_tr_b16 v[140:141], v235 offset:10496
ds_read_b64_tr_b16 v[142:143], v235 offset:13056
ds_read_b64_tr_b16 v[144:145], v238 offset:10240
ds_read_b64_tr_b16 v[146:147], v238 offset:15360
s_add_u32 m0, s36, 0x22800
s_add_u32 s38, s82, 0x3c0000
buffer_load_dwordx4 v229, s[20:23], s38 offen offset:0 lds
v_mfma_f32_16x16x32_bf16 a[240:243], v[128:131], a[252:255], a[240:243]
buffer_load_dwordx4 v230, s[20:23], s38 offen offset:1024 lds
buffer_load_dwordx4 v231, s[20:23], s38 offen offset:2048 lds
s_waitcnt lgkmcnt(6)
v_mfma_f32_32x32x16_bf16 a[176:191], v[132:135], a[228:231], a[176:191]
ds_read_b64_tr_b16 v[148:149], v235 offset:15360
ds_read_b64_tr_b16 v[150:151], v235 offset:17920
buffer_load_dwordx4 v232, s[20:23], s38 offen offset:3072 lds
s_waitcnt lgkmcnt(6)
v_mfma_f32_32x32x16_bf16 a[192:207], v[136:139], a[228:231], a[192:207]
ds_read_b64_tr_b16 v[152:153], v235 offset:15424
ds_read_b64_tr_b16 v[154:155], v235 offset:17984
s_add_u32 m0, s36, 0x23800
s_nop 0
buffer_load_dwordx4 v233, s[20:23], s38 offen offset:0 lds
s_waitcnt lgkmcnt(4)
v_mfma_f32_32x32x16_bf16 a[208:223], v[140:143], a[228:231], a[208:223]
ds_read_b64_tr_b16 v[128:129], v235 offset:15488
ds_read_b64_tr_b16 v[130:131], v235 offset:18048
ds_read_b64_tr_b16 v[132:133], v239 offset:10240
ds_read_b64_tr_b16 v[134:135], v239 offset:15360
v_mfma_f32_16x16x32_bf16 a[244:247], v[144:147], a[252:255], a[244:247]
ds_read_b64_tr_b16 v[136:137], v235 offset:15552
ds_read_b64_tr_b16 v[138:139], v235 offset:18112
s_waitcnt lgkmcnt(8)
v_mfma_f32_32x32x16_bf16 a[144:159], v[148:151], a[232:235], a[144:159]
ds_read_b64_tr_b16 v[140:141], v235 offset:15616
ds_read_b64_tr_b16 v[142:143], v235 offset:18176
s_waitcnt vmcnt(19)
s_barrier
ds_read_b64_tr_b16 v[144:145], v217 offset:0
ds_read_b64_tr_b16 v[146:147], v217 offset:2560
s_waitcnt lgkmcnt(10)
v_mfma_f32_32x32x16_bf16 a[160:175], v[152:155], a[232:235], a[160:175]
ds_read_b64_tr_b16 v[148:149], v217 offset:64
ds_read_b64_tr_b16 v[150:151], v217 offset:2624
ds_read_b64_tr_b16 v[152:153], v217 offset:128
ds_read_b64_tr_b16 v[154:155], v217 offset:2688
s_waitcnt lgkmcnt(10)
v_mfma_f32_32x32x16_bf16 a[176:191], v[128:131], a[232:235], a[176:191]
ds_read_b64_tr_b16 v[128:129], v218 offset:0
ds_read_b64_tr_b16 v[130:131], v218 offset:5120
ds_read_b128 v[156:159], v244 offset:24576
v_mfma_f32_16x16x32_bf16 a[248:251], v[132:135], a[252:255], a[248:251]
ds_read_b64_tr_b16 v[132:133], v217 offset:192
ds_read_b64_tr_b16 v[134:135], v217 offset:2752
s_waitcnt lgkmcnt(11)
v_mfma_f32_32x32x16_bf16 a[192:207], v[136:139], a[232:235], a[192:207]
ds_read_b64_tr_b16 v[136:137], v217 offset:256
ds_read_b64_tr_b16 v[138:139], v217 offset:2816
v_mfma_f32_32x32x16_bf16 a[208:223], v[140:143], a[232:235], a[208:223]
ds_read_b64_tr_b16 v[140:141], v217 offset:5120
ds_read_b64_tr_b16 v[142:143], v217 offset:7680
s_waitcnt lgkmcnt(9)
s_waitcnt vmcnt(18)
v_mfma_f32_32x32x16_bf16 a[144:159], v[144:147], a[0:3], a[144:159]
ds_read_b64_tr_b16 v[144:145], v219 offset:0
ds_read_b64_tr_b16 v[146:147], v219 offset:5120
v_mfma_f32_32x32x16_bf16 a[160:175], v[148:151], a[0:3], a[160:175]
ds_read_b64_tr_b16 v[148:149], v217 offset:5184
ds_read_b64_tr_b16 v[150:151], v217 offset:7744
s_lshl_b32 s40, s32, 10
s_and_b32 s40, s40, 0x400
s_add_u32 m0, s40, 0x13800
s_add_u32 s40, s40, s90
s_sub_u32 s40, s40, s75
s_add_u32 s40, s40, 0xd8000
buffer_load_dwordx4 v244, s[24:27], s40 offen sc1 lds
v_mfma_f32_32x32x16_bf16 a[176:191], v[152:155], a[0:3], a[176:191]
ds_read_b64_tr_b16 v[152:153], v217 offset:5248
ds_read_b64_tr_b16 v[154:155], v217 offset:7808
s_waitcnt lgkmcnt(6)
v_mfma_f32_16x16x32_bf16 a[240:243], v[128:131], v[156:159], a[240:243]
ds_read_b64_tr_b16 v[128:129], v217 offset:5312
ds_read_b64_tr_b16 v[130:131], v217 offset:7872
v_mfma_f32_32x32x16_bf16 a[192:207], v[132:135], a[0:3], a[192:207]
ds_read_b64_tr_b16 v[132:133], v220 offset:0
ds_read_b64_tr_b16 v[134:135], v220 offset:5120
s_add_u32 s59, s90, 0xd8000
buffer_load_dwordx4 a[48:51], v243, s[24:27], s59 offen offset:0 sc1
v_mfma_f32_32x32x16_bf16 a[208:223], v[136:139], a[0:3], a[208:223]
ds_read_b64_tr_b16 v[136:137], v217 offset:5376
ds_read_b64_tr_b16 v[138:139], v217 offset:7936
buffer_load_dwordx4 a[52:55], v243, s[24:27], s59 offen offset:1024 sc1
buffer_load_dwordx4 a[56:59], v243, s[24:27], s59 offen offset:2048 sc1
s_waitcnt vmcnt(21)
v_mfma_f32_32x32x16_bf16 a[144:159], v[140:143], a[4:7], a[144:159]
ds_read_b64_tr_b16 v[140:141], v217 offset:10240
ds_read_b64_tr_b16 v[142:143], v217 offset:12800
buffer_load_dwordx4 a[60:63], v243, s[24:27], s59 offen offset:3072 sc1
s_lshl_b32 s40, s32, 10
s_and_b32 s40, s40, 0x400
s_add_u32 m0, s40, 0x14000
s_add_u32 s40, s40, s91
s_sub_u32 s40, s40, s76
s_add_u32 s40, s40, 0xd8000
buffer_load_dwordx4 v244, s[24:27], s40 offen sc1 lds
s_waitcnt lgkmcnt(4)
v_mfma_f32_16x16x32_bf16 a[244:247], v[144:147], v[156:159], a[244:247]
v_mfma_f32_32x32x16_bf16 a[160:175], v[148:151], a[4:7], a[160:175]
ds_read_b64_tr_b16 v[144:145], v217 offset:10304
ds_read_b64_tr_b16 v[146:147], v217 offset:12864
v_mfma_f32_32x32x16_bf16 a[176:191], v[152:155], a[4:7], a[176:191]
ds_read_b64_tr_b16 v[148:149], v218 offset:10240
ds_read_b64_tr_b16 v[150:151], v218 offset:15360
ds_read_b128 v[160:163], v244 offset:25600
ds_read_b64_tr_b16 v[152:153], v217 offset:10368
ds_read_b64_tr_b16 v[154:155], v217 offset:12928
s_add_u32 s59, s91, 0xd8000
buffer_load_dwordx4 a[64:67], v243, s[24:27], s59 offen offset:0 sc1
v_mfma_f32_32x32x16_bf16 a[192:207], v[128:131], a[4:7], a[192:207]
ds_read_b64_tr_b16 v[128:129], v217 offset:10432
ds_read_b64_tr_b16 v[130:131], v217 offset:12992
buffer_load_dwordx4 a[68:71], v243, s[24:27], s59 offen offset:1024 sc1
v_mfma_f32_16x16x32_bf16 a[248:251], v[132:135], v[156:159], a[248:251]
ds_read_b64_tr_b16 v[132:133], v217 offset:10496
ds_read_b64_tr_b16 v[134:135], v217 offset:13056
buffer_load_dwordx4 a[72:75], v243, s[24:27], s59 offen offset:2048 sc1
s_waitcnt lgkmcnt(9)
v_mfma_f32_32x32x16_bf16 a[208:223], v[136:139], a[4:7], a[208:223]
ds_read_b64_tr_b16 v[136:137], v219 offset:10240
ds_read_b64_tr_b16 v[138:139], v219 offset:15360
buffer_load_dwordx4 a[76:79], v243, s[24:27], s59 offen offset:3072 sc1
s_waitcnt vmcnt(26)
v_mfma_f32_32x32x16_bf16 a[144:159], v[140:143], a[8:11], a[144:159]
ds_read_b64_tr_b16 v[140:141], v217 offset:15360
ds_read_b64_tr_b16 v[142:143], v217 offset:17920
s_add_u32 m0, s36, 0x18000
s_add_u32 s38, s83, 0x3c0000
buffer_load_dwordx4 v229, s[20:23], s38 offen offset:0 lds
v_mfma_f32_32x32x16_bf16 a[160:175], v[144:147], a[8:11], a[160:175]
ds_read_b64_tr_b16 v[144:145], v217 offset:15424
ds_read_b64_tr_b16 v[146:147], v217 offset:17984
buffer_load_dwordx4 v230, s[20:23], s38 offen offset:1024 lds
buffer_load_dwordx4 v231, s[20:23], s38 offen offset:2048 lds
s_waitcnt lgkmcnt(4)
v_mfma_f32_16x16x32_bf16 a[240:243], v[148:151], v[160:163], a[240:243]
ds_read_b64_tr_b16 v[148:149], v217 offset:15488
ds_read_b64_tr_b16 v[150:151], v217 offset:18048
v_mfma_f32_32x32x16_bf16 a[176:191], v[152:155], a[8:11], a[176:191]
ds_read_b64_tr_b16 v[152:153], v220 offset:10240
ds_read_b64_tr_b16 v[154:155], v220 offset:15360
buffer_load_dwordx4 v232, s[20:23], s38 offen offset:3072 lds
v_mfma_f32_32x32x16_bf16 a[192:207], v[128:131], a[8:11], a[192:207]
ds_read_b64_tr_b16 v[128:129], v217 offset:15552
ds_read_b64_tr_b16 v[130:131], v217 offset:18112
s_add_u32 m0, s36, 0x19000
s_nop 0
buffer_load_dwordx4 v233, s[20:23], s38 offen offset:0 lds
v_mfma_f32_32x32x16_bf16 a[208:223], v[132:135], a[8:11], a[208:223]
ds_read_b64_tr_b16 v[132:133], v217 offset:15616
ds_read_b64_tr_b16 v[134:135], v217 offset:18176
s_waitcnt vmcnt(29)
s_barrier
v_mfma_f32_16x16x32_bf16 a[244:247], v[136:139], v[160:163], a[244:247]
ds_read_b64_tr_b16 v[136:137], v217 offset:45056
ds_read_b64_tr_b16 v[138:139], v217 offset:47616
s_waitcnt lgkmcnt(6)
v_mfma_f32_32x32x16_bf16 a[144:159], v[140:143], a[12:15], a[144:159]
ds_read_b64_tr_b16 v[140:141], v217 offset:45120
ds_read_b64_tr_b16 v[142:143], v217 offset:47680
v_mfma_f32_32x32x16_bf16 a[160:175], v[144:147], a[12:15], a[160:175]
ds_read_b64_tr_b16 v[144:145], v217 offset:45184
ds_read_b64_tr_b16 v[146:147], v217 offset:47744
v_mfma_f32_32x32x16_bf16 a[176:191], v[148:151], a[12:15], a[176:191]
ds_read_b64_tr_b16 v[148:149], v218 offset:45056
ds_read_b64_tr_b16 v[150:151], v218 offset:50176
ds_read_b128 v[164:167], v244 offset:26624
v_mfma_f32_16x16x32_bf16 a[248:251], v[152:155], v[160:163], a[248:251]
ds_read_b64_tr_b16 v[152:153], v217 offset:45248
ds_read_b64_tr_b16 v[154:155], v217 offset:47808
s_waitcnt lgkmcnt(9)
v_mfma_f32_32x32x16_bf16 a[192:207], v[128:131], a[12:15], a[192:207]
ds_read_b64_tr_b16 v[128:129], v217 offset:45312
ds_read_b64_tr_b16 v[130:131], v217 offset:47872
v_mfma_f32_32x32x16_bf16 a[208:223], v[132:135], a[12:15], a[208:223]
ds_read_b64_tr_b16 v[132:133], v217 offset:50176
ds_read_b64_tr_b16 v[134:135], v217 offset:52736
s_waitcnt vmcnt(28)
v_mfma_f32_32x32x16_bf16 a[144:159], v[136:139], a[16:19], a[144:159]
ds_read_b64_tr_b16 v[136:137], v219 offset:45056
ds_read_b64_tr_b16 v[138:139], v219 offset:50176
s_waitcnt lgkmcnt(8)
v_mfma_f32_32x32x16_bf16 a[160:175], v[140:143], a[16:19], a[160:175]
ds_read_b64_tr_b16 v[140:141], v217 offset:50240
ds_read_b64_tr_b16 v[142:143], v217 offset:52800
s_lshl_b32 s40, s32, 10
s_and_b32 s40, s40, 0x400
s_add_u32 m0, s40, 0x14800
s_add_u32 s40, s40, s92
s_sub_u32 s40, s40, s77
s_add_u32 s40, s40, 0xd8000
buffer_load_dwordx4 v244, s[24:27], s40 offen sc1 lds
v_mfma_f32_32x32x16_bf16 a[176:191], v[144:147], a[16:19], a[176:191]
ds_read_b64_tr_b16 v[144:145], v217 offset:50304
ds_read_b64_tr_b16 v[146:147], v217 offset:52864
v_mfma_f32_16x16x32_bf16 a[240:243], v[148:151], v[164:167], a[240:243]
ds_read_b64_tr_b16 v[148:149], v217 offset:50368
ds_read_b64_tr_b16 v[150:151], v217 offset:52928
s_waitcnt lgkmcnt(6)
v_mfma_f32_32x32x16_bf16 a[192:207], v[152:155], a[16:19], a[192:207]
ds_read_b64_tr_b16 v[152:153], v220 offset:45056
ds_read_b64_tr_b16 v[154:155], v220 offset:50176
s_add_u32 s59, s92, 0xd8000
buffer_load_dwordx4 a[80:83], v243, s[24:27], s59 offen offset:0 sc1
v_mfma_f32_32x32x16_bf16 a[208:223], v[128:131], a[16:19], a[208:223]
ds_read_b64_tr_b16 v[128:129], v217 offset:50432
ds_read_b64_tr_b16 v[130:131], v217 offset:52992
buffer_load_dwordx4 a[84:87], v243, s[24:27], s59 offen offset:1024 sc1
buffer_load_dwordx4 a[88:91], v243, s[24:27], s59 offen offset:2048 sc1
s_waitcnt vmcnt(31)
v_mfma_f32_32x32x16_bf16 a[144:159], v[132:135], a[20:23], a[144:159]
ds_read_b64_tr_b16 v[132:133], v217 offset:55296
ds_read_b64_tr_b16 v[134:135], v217 offset:57856
buffer_load_dwordx4 a[92:95], v243, s[24:27], s59 offen offset:3072 sc1
s_lshl_b32 s40, s32, 10
s_and_b32 s40, s40, 0x400
s_add_u32 m0, s40, 0x15000
s_add_u32 s40, s40, s93
s_sub_u32 s40, s40, s75
s_add_u32 s40, s40, 0xd8000
buffer_load_dwordx4 v244, s[24:27], s40 offen sc1 lds
v_mfma_f32_16x16x32_bf16 a[244:247], v[136:139], v[164:167], a[244:247]
s_waitcnt lgkmcnt(2)
v_mfma_f32_32x32x16_bf16 a[160:175], v[140:143], a[20:23], a[160:175]
ds_read_b64_tr_b16 v[136:137], v217 offset:55360
ds_read_b64_tr_b16 v[138:139], v217 offset:57920
v_mfma_f32_32x32x16_bf16 a[176:191], v[144:147], a[20:23], a[176:191]
ds_read_b64_tr_b16 v[140:141], v218 offset:55296
ds_read_b64_tr_b16 v[142:143], v218 offset:60416
ds_read_b128 v[168:171], v244 offset:27648
ds_read_b64_tr_b16 v[144:145], v217 offset:55424
ds_read_b64_tr_b16 v[146:147], v217 offset:57984
s_add_u32 s59, s93, 0xd8000
buffer_load_dwordx4 a[96:99], v243, s[24:27], s59 offen offset:0 sc1
v_mfma_f32_32x32x16_bf16 a[192:207], v[148:151], a[20:23], a[192:207]
ds_read_b64_tr_b16 v[148:149], v217 offset:55488
ds_read_b64_tr_b16 v[150:151], v217 offset:58048
buffer_load_dwordx4 a[100:103], v243, s[24:27], s59 offen offset:1024 sc1
v_mfma_f32_16x16x32_bf16 a[248:251], v[152:155], v[164:167], a[248:251]
ds_read_b64_tr_b16 v[152:153], v217 offset:55552
ds_read_b64_tr_b16 v[154:155], v217 offset:58112
buffer_load_dwordx4 a[104:107], v243, s[24:27], s59 offen offset:2048 sc1
v_mfma_f32_32x32x16_bf16 a[208:223], v[128:131], a[20:23], a[208:223]
ds_read_b64_tr_b16 v[128:129], v219 offset:55296
ds_read_b64_tr_b16 v[130:131], v219 offset:60416
buffer_load_dwordx4 a[108:111], v243, s[24:27], s59 offen offset:3072 sc1
s_waitcnt lgkmcnt(6)
s_waitcnt vmcnt(36)
v_mfma_f32_32x32x16_bf16 a[144:159], v[132:135], a[24:27], a[144:159]
ds_read_b64_tr_b16 v[132:133], v217 offset:60416
ds_read_b64_tr_b16 v[134:135], v217 offset:62976
s_add_u32 m0, s36, 0x1000
s_add_u32 s38, s84, 0x3c0000
buffer_load_dwordx4 v229, s[20:23], s38 offen offset:0 lds
v_mfma_f32_32x32x16_bf16 a[160:175], v[136:139], a[24:27], a[160:175]
ds_read_b64_tr_b16 v[136:137], v217 offset:60480
ds_read_b64_tr_b16 v[138:139], v217 offset:63040
buffer_load_dwordx4 v230, s[20:23], s38 offen offset:1024 lds
buffer_load_dwordx4 v231, s[20:23], s38 offen offset:2048 lds
v_mfma_f32_16x16x32_bf16 a[240:243], v[140:143], v[168:171], a[240:243]
ds_read_b64_tr_b16 v[140:141], v217 offset:60544
ds_read_b64_tr_b16 v[142:143], v217 offset:63104
v_mfma_f32_32x32x16_bf16 a[176:191], v[144:147], a[24:27], a[176:191]
ds_read_b64_tr_b16 v[144:145], v220 offset:55296
ds_read_b64_tr_b16 v[146:147], v220 offset:60416
buffer_load_dwordx4 v232, s[20:23], s38 offen offset:3072 lds
s_waitcnt lgkmcnt(6)
v_mfma_f32_32x32x16_bf16 a[192:207], v[148:151], a[24:27], a[192:207]
ds_read_b64_tr_b16 v[148:149], v217 offset:60608
ds_read_b64_tr_b16 v[150:151], v217 offset:63168
s_add_u32 m0, s36, 0x2000
s_nop 0
buffer_load_dwordx4 v233, s[20:23], s38 offen offset:0 lds
v_mfma_f32_32x32x16_bf16 a[208:223], v[152:155], a[24:27], a[208:223]
ds_read_b64_tr_b16 v[152:153], v217 offset:60672
ds_read_b64_tr_b16 v[154:155], v217 offset:63232
s_waitcnt vmcnt(39)
s_barrier
v_mfma_f32_16x16x32_bf16 a[244:247], v[128:131], v[168:171], a[244:247]
ds_read_b64_tr_b16 v[128:129], v217 offset:20480
ds_read_b64_tr_b16 v[130:131], v217 offset:23040
v_mfma_f32_32x32x16_bf16 a[144:159], v[132:135], a[28:31], a[144:159]
ds_read_b64_tr_b16 v[132:133], v217 offset:20544
ds_read_b64_tr_b16 v[134:135], v217 offset:23104
s_waitcnt lgkmcnt(7)
v_mfma_f32_32x32x16_bf16 a[160:175], v[136:139], a[28:31], a[160:175]
ds_read_b64_tr_b16 v[136:137], v217 offset:20608
ds_read_b64_tr_b16 v[138:139], v217 offset:23168
v_mfma_f32_32x32x16_bf16 a[176:191], v[140:143], a[28:31], a[176:191]
ds_read_b64_tr_b16 v[140:141], v218 offset:20480
ds_read_b64_tr_b16 v[142:143], v218 offset:25600
ds_read_b128 v[156:159], v244 offset:28672
v_mfma_f32_16x16x32_bf16 a[248:251], v[144:147], v[168:171], a[248:251]
ds_read_b64_tr_b16 v[144:145], v217 offset:20672
ds_read_b64_tr_b16 v[146:147], v217 offset:23232
s_waitcnt lgkmcnt(9)
v_mfma_f32_32x32x16_bf16 a[192:207], v[148:151], a[28:31], a[192:207]
ds_read_b64_tr_b16 v[148:149], v217 offset:20736
ds_read_b64_tr_b16 v[150:151], v217 offset:23296
v_mfma_f32_32x32x16_bf16 a[208:223], v[152:155], a[28:31], a[208:223]
ds_read_b64_tr_b16 v[152:153], v217 offset:25600
ds_read_b64_tr_b16 v[154:155], v217 offset:28160
s_waitcnt vmcnt(38)
v_mfma_f32_32x32x16_bf16 a[144:159], v[128:131], a[32:35], a[144:159]
ds_read_b64_tr_b16 v[128:129], v219 offset:20480
ds_read_b64_tr_b16 v[130:131], v219 offset:25600
s_waitcnt lgkmcnt(8)
v_mfma_f32_32x32x16_bf16 a[160:175], v[132:135], a[32:35], a[160:175]
ds_read_b64_tr_b16 v[132:133], v217 offset:25664
ds_read_b64_tr_b16 v[134:135], v217 offset:28224
s_lshl_b32 s40, s32, 10
s_and_b32 s40, s40, 0x400
s_add_u32 m0, s40, 0x15800
s_add_u32 s40, s40, s94
s_sub_u32 s40, s40, s76
s_add_u32 s40, s40, 0xd8000
buffer_load_dwordx4 v244, s[24:27], s40 offen sc1 lds
v_mfma_f32_32x32x16_bf16 a[176:191], v[136:139], a[32:35], a[176:191]
ds_read_b64_tr_b16 v[136:137], v217 offset:25728
ds_read_b64_tr_b16 v[138:139], v217 offset:28288
v_mfma_f32_16x16x32_bf16 a[240:243], v[140:143], v[156:159], a[240:243]
ds_read_b64_tr_b16 v[140:141], v217 offset:25792
ds_read_b64_tr_b16 v[142:143], v217 offset:28352
s_waitcnt lgkmcnt(6)
v_mfma_f32_32x32x16_bf16 a[192:207], v[144:147], a[32:35], a[192:207]
ds_read_b64_tr_b16 v[144:145], v220 offset:20480
ds_read_b64_tr_b16 v[146:147], v220 offset:25600
s_add_u32 s59, s94, 0xd8000
buffer_load_dwordx4 a[112:115], v243, s[24:27], s59 offen offset:0 sc1
v_mfma_f32_32x32x16_bf16 a[208:223], v[148:151], a[32:35], a[208:223]
ds_read_b64_tr_b16 v[148:149], v217 offset:25856
ds_read_b64_tr_b16 v[150:151], v217 offset:28416
buffer_load_dwordx4 a[116:119], v243, s[24:27], s59 offen offset:1024 sc1
buffer_load_dwordx4 a[120:123], v243, s[24:27], s59 offen offset:2048 sc1
s_waitcnt vmcnt(41)
v_mfma_f32_32x32x16_bf16 a[144:159], v[152:155], a[36:39], a[144:159]
ds_read_b64_tr_b16 v[152:153], v217 offset:30720
ds_read_b64_tr_b16 v[154:155], v217 offset:33280
buffer_load_dwordx4 a[124:127], v243, s[24:27], s59 offen offset:3072 sc1
s_lshl_b32 s40, s32, 10
s_and_b32 s40, s40, 0x400
s_add_u32 m0, s40, 0x16000
s_add_u32 s40, s40, s95
s_sub_u32 s40, s40, s77
s_add_u32 s40, s40, 0xd8000
buffer_load_dwordx4 v244, s[24:27], s40 offen sc1 lds
v_mfma_f32_16x16x32_bf16 a[244:247], v[128:131], v[156:159], a[244:247]
s_waitcnt lgkmcnt(2)
v_mfma_f32_32x32x16_bf16 a[160:175], v[132:135], a[36:39], a[160:175]
ds_read_b64_tr_b16 v[128:129], v217 offset:30784
ds_read_b64_tr_b16 v[130:131], v217 offset:33344
v_mfma_f32_32x32x16_bf16 a[176:191], v[136:139], a[36:39], a[176:191]
ds_read_b64_tr_b16 v[132:133], v218 offset:30720
ds_read_b64_tr_b16 v[134:135], v218 offset:35840
ds_read_b128 v[160:163], v244 offset:29696
ds_read_b64_tr_b16 v[136:137], v217 offset:30848
ds_read_b64_tr_b16 v[138:139], v217 offset:33408
s_add_u32 s59, s95, 0xd8000
buffer_load_dwordx4 a[128:131], v243, s[24:27], s59 offen offset:0 sc1
v_mfma_f32_32x32x16_bf16 a[192:207], v[140:143], a[36:39], a[192:207]
ds_read_b64_tr_b16 v[140:141], v217 offset:30912
ds_read_b64_tr_b16 v[142:143], v217 offset:33472
buffer_load_dwordx4 a[132:135], v243, s[24:27], s59 offen offset:1024 sc1
v_mfma_f32_16x16x32_bf16 a[248:251], v[144:147], v[156:159], a[248:251]
ds_read_b64_tr_b16 v[144:145], v217 offset:30976
ds_read_b64_tr_b16 v[146:147], v217 offset:33536
buffer_load_dwordx4 a[136:139], v243, s[24:27], s59 offen offset:2048 sc1
v_mfma_f32_32x32x16_bf16 a[208:223], v[148:151], a[36:39], a[208:223]
ds_read_b64_tr_b16 v[148:149], v219 offset:30720
ds_read_b64_tr_b16 v[150:151], v219 offset:35840
buffer_load_dwordx4 a[140:143], v243, s[24:27], s59 offen offset:3072 sc1
s_waitcnt lgkmcnt(6)
s_waitcnt vmcnt(46)
v_mfma_f32_32x32x16_bf16 a[144:159], v[152:155], a[40:43], a[144:159]
ds_read_b64_tr_b16 v[152:153], v217 offset:35840
ds_read_b64_tr_b16 v[154:155], v217 offset:38400
s_add_u32 m0, s36, 0xc000
s_add_u32 s38, s85, 0x3c0000
buffer_load_dwordx4 v229, s[20:23], s38 offen offset:0 lds
v_mfma_f32_32x32x16_bf16 a[160:175], v[128:131], a[40:43], a[160:175]
ds_read_b64_tr_b16 v[128:129], v217 offset:35904
ds_read_b64_tr_b16 v[130:131], v217 offset:38464
buffer_load_dwordx4 v230, s[20:23], s38 offen offset:1024 lds
buffer_load_dwordx4 v231, s[20:23], s38 offen offset:2048 lds
v_mfma_f32_16x16x32_bf16 a[240:243], v[132:135], v[160:163], a[240:243]
ds_read_b64_tr_b16 v[132:133], v217 offset:35968
ds_read_b64_tr_b16 v[134:135], v217 offset:38528
v_mfma_f32_32x32x16_bf16 a[176:191], v[136:139], a[40:43], a[176:191]
ds_read_b64_tr_b16 v[136:137], v220 offset:30720
ds_read_b64_tr_b16 v[138:139], v220 offset:35840
buffer_load_dwordx4 v232, s[20:23], s38 offen offset:3072 lds
s_waitcnt lgkmcnt(6)
v_mfma_f32_32x32x16_bf16 a[192:207], v[140:143], a[40:43], a[192:207]
ds_read_b64_tr_b16 v[140:141], v217 offset:36032
ds_read_b64_tr_b16 v[142:143], v217 offset:38592
s_add_u32 m0, s36, 0xd000
s_nop 0
buffer_load_dwordx4 v233, s[20:23], s38 offen offset:0 lds
v_mfma_f32_32x32x16_bf16 a[208:223], v[144:147], a[40:43], a[208:223]
ds_read_b64_tr_b16 v[144:145], v217 offset:36096
ds_read_b64_tr_b16 v[146:147], v217 offset:38656
s_waitcnt vmcnt(44)
s_barrier
v_mfma_f32_16x16x32_bf16 a[244:247], v[148:151], v[160:163], a[244:247]
ds_read_b64_tr_b16 v[148:149], v235 offset:21504
ds_read_b64_tr_b16 v[150:151], v235 offset:24064
v_mfma_f32_32x32x16_bf16 a[144:159], v[152:155], a[44:47], a[144:159]
ds_read_b64_tr_b16 v[152:153], v235 offset:21568
ds_read_b64_tr_b16 v[154:155], v235 offset:24128
s_waitcnt lgkmcnt(7)
v_mfma_f32_32x32x16_bf16 a[160:175], v[128:131], a[44:47], a[160:175]
ds_read_b64_tr_b16 v[128:129], v235 offset:21632
ds_read_b64_tr_b16 v[130:131], v235 offset:24192
v_mfma_f32_32x32x16_bf16 a[176:191], v[132:135], a[44:47], a[176:191]
ds_read_b64_tr_b16 v[132:133], v237 offset:21504
ds_read_b64_tr_b16 v[134:135], v237 offset:26624
ds_read_b128 v[164:167], v244 offset:30720
v_mfma_f32_16x16x32_bf16 a[248:251], v[136:139], v[160:163], a[248:251]
ds_read_b64_tr_b16 v[136:137], v235 offset:21696
ds_read_b64_tr_b16 v[138:139], v235 offset:24256
s_waitcnt lgkmcnt(9)
v_mfma_f32_32x32x16_bf16 a[192:207], v[140:143], a[44:47], a[192:207]
ds_read_b64_tr_b16 v[140:141], v235 offset:21760
ds_read_b64_tr_b16 v[142:143], v235 offset:24320
v_mfma_f32_32x32x16_bf16 a[208:223], v[144:147], a[44:47], a[208:223]
ds_read_b64_tr_b16 v[144:145], v235 offset:26624
ds_read_b64_tr_b16 v[146:147], v235 offset:29184
s_waitcnt vmcnt(43)
v_mfma_f32_32x32x16_bf16 a[144:159], v[148:151], a[48:51], a[144:159]
ds_read_b64_tr_b16 v[148:149], v238 offset:21504
ds_read_b64_tr_b16 v[150:151], v238 offset:26624
s_waitcnt lgkmcnt(8)
v_mfma_f32_32x32x16_bf16 a[160:175], v[152:155], a[48:51], a[160:175]
ds_read_b64_tr_b16 v[152:153], v235 offset:26688
ds_read_b64_tr_b16 v[154:155], v235 offset:29248
s_add_u32 m0, s36, 0x6000
s_add_u32 s38, s86, 0x3c0000
buffer_load_dwordx4 v229, s[20:23], s38 offen offset:0 lds
v_mfma_f32_32x32x16_bf16 a[176:191], v[128:131], a[48:51], a[176:191]
ds_read_b64_tr_b16 v[128:129], v235 offset:26752
ds_read_b64_tr_b16 v[130:131], v235 offset:29312
v_mfma_f32_16x16x32_bf16 a[240:243], v[132:135], v[164:167], a[240:243]
ds_read_b64_tr_b16 v[132:133], v235 offset:26816
ds_read_b64_tr_b16 v[134:135], v235 offset:29376
s_waitcnt lgkmcnt(8)
v_mfma_f32_32x32x16_bf16 a[192:207], v[136:139], a[48:51], a[192:207]
ds_read_b64_tr_b16 v[136:137], v239 offset:21504
ds_read_b64_tr_b16 v[138:139], v239 offset:26624
buffer_load_dwordx4 v230, s[20:23], s38 offen offset:1024 lds
v_mfma_f32_32x32x16_bf16 a[208:223], v[140:143], a[48:51], a[208:223]
ds_read_b64_tr_b16 v[140:141], v235 offset:26880
ds_read_b64_tr_b16 v[142:143], v235 offset:29440
s_waitcnt vmcnt(44)
v_mfma_f32_32x32x16_bf16 a[144:159], v[144:147], a[52:55], a[144:159]
ds_read_b64_tr_b16 v[144:145], v235 offset:31744
ds_read_b64_tr_b16 v[146:147], v235 offset:34304
s_waitcnt lgkmcnt(7)
v_mfma_f32_16x16x32_bf16 a[244:247], v[148:151], v[164:167], a[244:247]
ds_read_b64_tr_b16 v[148:149], v235 offset:31808
ds_read_b64_tr_b16 v[150:151], v235 offset:34368
v_mfma_f32_32x32x16_bf16 a[160:175], v[152:155], a[52:55], a[160:175]
ds_read_b64_tr_b16 v[152:153], v237 offset:31744
ds_read_b64_tr_b16 v[154:155], v237 offset:36864
ds_read_b128 v[168:171], v244 offset:31744
buffer_load_dwordx4 v231, s[20:23], s38 offen offset:2048 lds
v_mfma_f32_32x32x16_bf16 a[176:191], v[128:131], a[52:55], a[176:191]
ds_read_b64_tr_b16 v[128:129], v235 offset:31872
ds_read_b64_tr_b16 v[130:131], v235 offset:34432
s_waitcnt lgkmcnt(9)
v_mfma_f32_32x32x16_bf16 a[192:207], v[132:135], a[52:55], a[192:207]
ds_read_b64_tr_b16 v[132:133], v235 offset:31936
ds_read_b64_tr_b16 v[134:135], v235 offset:34496
buffer_load_dwordx4 v232, s[20:23], s38 offen offset:3072 lds
v_mfma_f32_16x16x32_bf16 a[248:251], v[136:139], v[164:167], a[248:251]
ds_read_b64_tr_b16 v[136:137], v235 offset:32000
ds_read_b64_tr_b16 v[138:139], v235 offset:34560
v_mfma_f32_32x32x16_bf16 a[208:223], v[140:143], a[52:55], a[208:223]
ds_read_b64_tr_b16 v[140:141], v238 offset:31744
ds_read_b64_tr_b16 v[142:143], v238 offset:36864
s_waitcnt lgkmcnt(8)
s_waitcnt vmcnt(45)
v_mfma_f32_32x32x16_bf16 a[144:159], v[144:147], a[56:59], a[144:159]
ds_read_b64_tr_b16 v[144:145], v235 offset:36864
ds_read_b64_tr_b16 v[146:147], v235 offset:39424
s_add_u32 m0, s36, 0x7000
s_nop 0
buffer_load_dwordx4 v233, s[20:23], s38 offen offset:0 lds
v_mfma_f32_32x32x16_bf16 a[160:175], v[148:151], a[56:59], a[160:175]
ds_read_b64_tr_b16 v[148:149], v235 offset:36928
ds_read_b64_tr_b16 v[150:151], v235 offset:39488
v_mfma_f32_16x16x32_bf16 a[240:243], v[152:155], v[168:171], a[240:243]
ds_read_b64_tr_b16 v[152:153], v235 offset:36992
ds_read_b64_tr_b16 v[154:155], v235 offset:39552
s_waitcnt lgkmcnt(7)
v_mfma_f32_32x32x16_bf16 a[176:191], v[128:131], a[56:59], a[176:191]
ds_read_b64_tr_b16 v[128:129], v239 offset:31744
ds_read_b64_tr_b16 v[130:131], v239 offset:36864
v_mfma_f32_32x32x16_bf16 a[192:207], v[132:135], a[56:59], a[192:207]
ds_read_b64_tr_b16 v[132:133], v235 offset:37056
ds_read_b64_tr_b16 v[134:135], v235 offset:39616
v_mfma_f32_32x32x16_bf16 a[208:223], v[136:139], a[56:59], a[208:223]
ds_read_b64_tr_b16 v[136:137], v235 offset:37120
ds_read_b64_tr_b16 v[138:139], v235 offset:39680
s_waitcnt vmcnt(44)
s_barrier
s_waitcnt lgkmcnt(8)
v_mfma_f32_16x16x32_bf16 a[244:247], v[140:143], v[168:171], a[244:247]
ds_read_b64_tr_b16 v[140:141], v235 offset:43008
ds_read_b64_tr_b16 v[142:143], v235 offset:45568
v_mfma_f32_32x32x16_bf16 a[144:159], v[144:147], a[60:63], a[144:159]
ds_read_b64_tr_b16 v[144:145], v235 offset:43072
ds_read_b64_tr_b16 v[146:147], v235 offset:45632
v_mfma_f32_32x32x16_bf16 a[160:175], v[148:151], a[60:63], a[160:175]
ds_read_b64_tr_b16 v[148:149], v235 offset:43136
ds_read_b64_tr_b16 v[150:151], v235 offset:45696
s_waitcnt lgkmcnt(8)
v_mfma_f32_32x32x16_bf16 a[176:191], v[152:155], a[60:63], a[176:191]
ds_read_b64_tr_b16 v[152:153], v237 offset:43008
ds_read_b64_tr_b16 v[154:155], v237 offset:48128
ds_read_b128 v[156:159], v244 offset:32768
v_mfma_f32_16x16x32_bf16 a[248:251], v[128:131], v[168:171], a[248:251]
ds_read_b64_tr_b16 v[128:129], v235 offset:43200
ds_read_b64_tr_b16 v[130:131], v235 offset:45760
v_mfma_f32_32x32x16_bf16 a[192:207], v[132:135], a[60:63], a[192:207]
ds_read_b64_tr_b16 v[132:133], v235 offset:43264
ds_read_b64_tr_b16 v[134:135], v235 offset:45824
s_waitcnt lgkmcnt(9)
v_mfma_f32_32x32x16_bf16 a[208:223], v[136:139], a[60:63], a[208:223]
ds_read_b64_tr_b16 v[136:137], v235 offset:48128
ds_read_b64_tr_b16 v[138:139], v235 offset:50688
s_waitcnt vmcnt(43)
v_mfma_f32_32x32x16_bf16 a[144:159], v[140:143], a[64:67], a[144:159]
ds_read_b64_tr_b16 v[140:141], v238 offset:43008
ds_read_b64_tr_b16 v[142:143], v238 offset:48128
v_mfma_f32_32x32x16_bf16 a[160:175], v[144:147], a[64:67], a[160:175]
ds_read_b64_tr_b16 v[144:145], v235 offset:48192
ds_read_b64_tr_b16 v[146:147], v235 offset:50752
s_waitcnt lgkmcnt(8)
v_mfma_f32_32x32x16_bf16 a[176:191], v[148:151], a[64:67], a[176:191]
ds_read_b64_tr_b16 v[148:149], v235 offset:48256
ds_read_b64_tr_b16 v[150:151], v235 offset:50816
v_mfma_f32_16x16x32_bf16 a[240:243], v[152:155], v[156:159], a[240:243]
ds_read_b64_tr_b16 v[152:153], v235 offset:48320
ds_read_b64_tr_b16 v[154:155], v235 offset:50880
v_mfma_f32_32x32x16_bf16 a[192:207], v[128:131], a[64:67], a[192:207]
ds_read_b64_tr_b16 v[128:129], v239 offset:43008
ds_read_b64_tr_b16 v[130:131], v239 offset:48128
s_waitcnt lgkmcnt(8)
v_mfma_f32_32x32x16_bf16 a[208:223], v[132:135], a[64:67], a[208:223]
ds_read_b64_tr_b16 v[132:133], v235 offset:48384
ds_read_b64_tr_b16 v[134:135], v235 offset:50944
s_waitcnt vmcnt(42)
v_mfma_f32_32x32x16_bf16 a[144:159], v[136:139], a[68:71], a[144:159]
ds_read_b64_tr_b16 v[136:137], v235 offset:53248
ds_read_b64_tr_b16 v[138:139], v235 offset:55808
v_mfma_f32_16x16x32_bf16 a[244:247], v[140:143], v[156:159], a[244:247]
ds_read_b64_tr_b16 v[140:141], v235 offset:53312
ds_read_b64_tr_b16 v[142:143], v235 offset:55872
s_waitcnt lgkmcnt(8)
v_mfma_f32_32x32x16_bf16 a[160:175], v[144:147], a[68:71], a[160:175]
ds_read_b64_tr_b16 v[144:145], v237 offset:53248
ds_read_b64_tr_b16 v[146:147], v237 offset:58368
ds_read_b128 v[160:163], v244 offset:33792
v_mfma_f32_32x32x16_bf16 a[176:191], v[148:151], a[68:71], a[176:191]
ds_read_b64_tr_b16 v[148:149], v235 offset:53376
ds_read_b64_tr_b16 v[150:151], v235 offset:55936
v_mfma_f32_32x32x16_bf16 a[192:207], v[152:155], a[68:71], a[192:207]
ds_read_b64_tr_b16 v[152:153], v235 offset:53440
ds_read_b64_tr_b16 v[154:155], v235 offset:56000
s_waitcnt lgkmcnt(9)
v_mfma_f32_16x16x32_bf16 a[248:251], v[128:131], v[156:159], a[248:251]
ds_read_b64_tr_b16 v[128:129], v235 offset:53504
ds_read_b64_tr_b16 v[130:131], v235 offset:56064
v_mfma_f32_32x32x16_bf16 a[208:223], v[132:135], a[68:71], a[208:223]
ds_read_b64_tr_b16 v[132:133], v238 offset:53248
ds_read_b64_tr_b16 v[134:135], v238 offset:58368
s_waitcnt vmcnt(41)
v_mfma_f32_32x32x16_bf16 a[144:159], v[136:139], a[72:75], a[144:159]
ds_read_b64_tr_b16 v[136:137], v235 offset:58368
ds_read_b64_tr_b16 v[138:139], v235 offset:60928
s_waitcnt lgkmcnt(8)
v_mfma_f32_32x32x16_bf16 a[160:175], v[140:143], a[72:75], a[160:175]
ds_read_b64_tr_b16 v[140:141], v235 offset:58432
ds_read_b64_tr_b16 v[142:143], v235 offset:60992
v_mfma_f32_16x16x32_bf16 a[240:243], v[144:147], v[160:163], a[240:243]
ds_read_b64_tr_b16 v[144:145], v235 offset:58496
ds_read_b64_tr_b16 v[146:147], v235 offset:61056
v_mfma_f32_32x32x16_bf16 a[176:191], v[148:151], a[72:75], a[176:191]
ds_read_b64_tr_b16 v[148:149], v239 offset:53248
ds_read_b64_tr_b16 v[150:151], v239 offset:58368
s_waitcnt lgkmcnt(8)
v_mfma_f32_32x32x16_bf16 a[192:207], v[152:155], a[72:75], a[192:207]
ds_read_b64_tr_b16 v[152:153], v235 offset:58560
ds_read_b64_tr_b16 v[154:155], v235 offset:61120
v_mfma_f32_32x32x16_bf16 a[208:223], v[128:131], a[72:75], a[208:223]
ds_read_b64_tr_b16 v[128:129], v235 offset:58624
ds_read_b64_tr_b16 v[130:131], v235 offset:61184
s_waitcnt vmcnt(34)
s_barrier
v_mfma_f32_16x16x32_bf16 a[244:247], v[132:135], v[160:163], a[244:247]
ds_read_b64_tr_b16 v[132:133], v235 offset:0
ds_read_b64_tr_b16 v[134:135], v235 offset:2560
s_waitcnt lgkmcnt(8)
v_mfma_f32_32x32x16_bf16 a[144:159], v[136:139], a[76:79], a[144:159]
ds_read_b64_tr_b16 v[136:137], v235 offset:64
ds_read_b64_tr_b16 v[138:139], v235 offset:2624
v_mfma_f32_32x32x16_bf16 a[160:175], v[140:143], a[76:79], a[160:175]
ds_read_b64_tr_b16 v[140:141], v235 offset:128
ds_read_b64_tr_b16 v[142:143], v235 offset:2688
v_mfma_f32_32x32x16_bf16 a[176:191], v[144:147], a[76:79], a[176:191]
ds_read_b64_tr_b16 v[144:145], v237 offset:0
ds_read_b64_tr_b16 v[146:147], v237 offset:5120
ds_read_b128 v[164:167], v244 offset:34816
s_waitcnt lgkmcnt(9)
v_mfma_f32_16x16x32_bf16 a[248:251], v[148:151], v[160:163], a[248:251]
ds_read_b64_tr_b16 v[148:149], v235 offset:192
ds_read_b64_tr_b16 v[150:151], v235 offset:2752
v_mfma_f32_32x32x16_bf16 a[192:207], v[152:155], a[76:79], a[192:207]
ds_read_b64_tr_b16 v[152:153], v235 offset:256
ds_read_b64_tr_b16 v[154:155], v235 offset:2816
v_mfma_f32_32x32x16_bf16 a[208:223], v[128:131], a[76:79], a[208:223]
ds_read_b64_tr_b16 v[128:129], v235 offset:5120
ds_read_b64_tr_b16 v[130:131], v235 offset:7680
s_waitcnt lgkmcnt(9)
s_waitcnt vmcnt(33)
v_mfma_f32_32x32x16_bf16 a[144:159], v[132:135], a[80:83], a[144:159]
ds_read_b64_tr_b16 v[132:133], v238 offset:0
ds_read_b64_tr_b16 v[134:135], v238 offset:5120
v_mfma_f32_32x32x16_bf16 a[160:175], v[136:139], a[80:83], a[160:175]
ds_read_b64_tr_b16 v[136:137], v235 offset:5184
ds_read_b64_tr_b16 v[138:139], v235 offset:7744
v_mfma_f32_32x32x16_bf16 a[176:191], v[140:143], a[80:83], a[176:191]
ds_read_b64_tr_b16 v[140:141], v235 offset:5248
ds_read_b64_tr_b16 v[142:143], v235 offset:7808
s_waitcnt lgkmcnt(8)
v_mfma_f32_16x16x32_bf16 a[240:243], v[144:147], v[164:167], a[240:243]
ds_read_b64_tr_b16 v[144:145], v235 offset:5312
ds_read_b64_tr_b16 v[146:147], v235 offset:7872
v_mfma_f32_32x32x16_bf16 a[192:207], v[148:151], a[80:83], a[192:207]
ds_read_b64_tr_b16 v[148:149], v239 offset:0
ds_read_b64_tr_b16 v[150:151], v239 offset:5120
v_mfma_f32_32x32x16_bf16 a[208:223], v[152:155], a[80:83], a[208:223]
ds_read_b64_tr_b16 v[152:153], v235 offset:5376
ds_read_b64_tr_b16 v[154:155], v235 offset:7936
s_waitcnt lgkmcnt(8)
s_waitcnt vmcnt(32)
v_mfma_f32_32x32x16_bf16 a[144:159], v[128:131], a[84:87], a[144:159]
ds_read_b64_tr_b16 v[128:129], v235 offset:10240
ds_read_b64_tr_b16 v[130:131], v235 offset:12800
v_mfma_f32_16x16x32_bf16 a[244:247], v[132:135], v[164:167], a[244:247]
ds_read_b64_tr_b16 v[132:133], v235 offset:10304
ds_read_b64_tr_b16 v[134:135], v235 offset:12864
v_mfma_f32_32x32x16_bf16 a[160:175], v[136:139], a[84:87], a[160:175]
ds_read_b64_tr_b16 v[136:137], v237 offset:10240
ds_read_b64_tr_b16 v[138:139], v237 offset:15360
ds_read_b128 v[168:171], v244 offset:35840
s_waitcnt lgkmcnt(9)
v_mfma_f32_32x32x16_bf16 a[176:191], v[140:143], a[84:87], a[176:191]
ds_read_b64_tr_b16 v[140:141], v235 offset:10368
ds_read_b64_tr_b16 v[142:143], v235 offset:12928
v_mfma_f32_32x32x16_bf16 a[192:207], v[144:147], a[84:87], a[192:207]
ds_read_b64_tr_b16 v[144:145], v235 offset:10432
ds_read_b64_tr_b16 v[146:147], v235 offset:12992
v_mfma_f32_16x16x32_bf16 a[248:251], v[148:151], v[164:167], a[248:251]
ds_read_b64_tr_b16 v[148:149], v235 offset:10496
ds_read_b64_tr_b16 v[150:151], v235 offset:13056
s_waitcnt lgkmcnt(9)
v_mfma_f32_32x32x16_bf16 a[208:223], v[152:155], a[84:87], a[208:223]
ds_read_b64_tr_b16 v[152:153], v238 offset:10240
ds_read_b64_tr_b16 v[154:155], v238 offset:15360
s_waitcnt vmcnt(31)
v_mfma_f32_32x32x16_bf16 a[144:159], v[128:131], a[88:91], a[144:159]
ds_read_b64_tr_b16 v[128:129], v235 offset:15360
ds_read_b64_tr_b16 v[130:131], v235 offset:17920
v_mfma_f32_32x32x16_bf16 a[160:175], v[132:135], a[88:91], a[160:175]
ds_read_b64_tr_b16 v[132:133], v235 offset:15424
ds_read_b64_tr_b16 v[134:135], v235 offset:17984
s_waitcnt lgkmcnt(8)
v_mfma_f32_16x16x32_bf16 a[240:243], v[136:139], v[168:171], a[240:243]
ds_read_b64_tr_b16 v[136:137], v235 offset:15488
ds_read_b64_tr_b16 v[138:139], v235 offset:18048
v_mfma_f32_32x32x16_bf16 a[176:191], v[140:143], a[88:91], a[176:191]
ds_read_b64_tr_b16 v[140:141], v239 offset:10240
ds_read_b64_tr_b16 v[142:143], v239 offset:15360
v_mfma_f32_32x32x16_bf16 a[192:207], v[144:147], a[88:91], a[192:207]
ds_read_b64_tr_b16 v[144:145], v235 offset:15552
ds_read_b64_tr_b16 v[146:147], v235 offset:18112
s_waitcnt lgkmcnt(8)
v_mfma_f32_32x32x16_bf16 a[208:223], v[148:151], a[88:91], a[208:223]
ds_read_b64_tr_b16 v[148:149], v235 offset:15616
ds_read_b64_tr_b16 v[150:151], v235 offset:18176
s_waitcnt vmcnt(0)
s_barrier
v_mfma_f32_16x16x32_bf16 a[244:247], v[152:155], v[168:171], a[244:247]
ds_read_b64_tr_b16 v[152:153], v217 offset:0
ds_read_b64_tr_b16 v[154:155], v217 offset:2560
v_mfma_f32_32x32x16_bf16 a[144:159], v[128:131], a[92:95], a[144:159]
ds_read_b64_tr_b16 v[128:129], v218 offset:0
ds_read_b64_tr_b16 v[130:131], v218 offset:5120
ds_read_b128 v[156:159], v244 offset:36864
s_waitcnt lgkmcnt(9)
v_mfma_f32_32x32x16_bf16 a[160:175], v[132:135], a[92:95], a[160:175]
ds_read_b64_tr_b16 v[132:133], v217 offset:5120
ds_read_b64_tr_b16 v[134:135], v217 offset:7680
v_mfma_f32_32x32x16_bf16 a[176:191], v[136:139], a[92:95], a[176:191]
ds_read_b64_tr_b16 v[136:137], v219 offset:0
ds_read_b64_tr_b16 v[138:139], v219 offset:5120
v_mfma_f32_16x16x32_bf16 a[248:251], v[140:143], v[168:171], a[248:251]
ds_read_b64_tr_b16 v[140:141], v217 offset:10240
ds_read_b64_tr_b16 v[142:143], v217 offset:12800
s_waitcnt lgkmcnt(9)
v_mfma_f32_32x32x16_bf16 a[192:207], v[144:147], a[92:95], a[192:207]
ds_read_b64_tr_b16 v[144:145], v220 offset:0
ds_read_b64_tr_b16 v[146:147], v220 offset:5120
v_mfma_f32_32x32x16_bf16 a[208:223], v[148:151], a[92:95], a[208:223]
ds_read_b64_tr_b16 v[148:149], v217 offset:15360
ds_read_b64_tr_b16 v[150:151], v217 offset:17920
v_mfma_f32_32x32x16_bf16 a[144:159], v[152:155], a[96:99], a[144:159]
ds_read_b64_tr_b16 v[152:153], v218 offset:10240
ds_read_b64_tr_b16 v[154:155], v218 offset:15360
ds_read_b128 v[160:163], v244 offset:37888
s_lshl_b32 s40, s32, 11
s_mul_i32 s41, s32, 12288
v_subrev_u32 v254, s40, v243
v_subrev_u32 v255, s41, v243
v_lshrrev_b32 v255, 1, v255
s_lshl_b32 s40, s32, 9
s_add_u32 s60, s58, s40
s_and_b32 s40, s40, 0x200
s_add_u32 s62, s58, s40
s_waitcnt lgkmcnt(6)
v_mfma_f32_16x16x32_bf16 a[240:243], v[128:131], v[156:159], a[240:243]
v_mfma_f32_32x32x16_bf16 a[144:159], v[132:135], a[100:103], a[144:159]
ds_read_b64_tr_b16 v[128:129], v217 offset:45056
ds_read_b64_tr_b16 v[130:131], v217 offset:47616
v_mfma_f32_16x16x32_bf16 a[244:247], v[136:139], v[156:159], a[244:247]
ds_read_b64_tr_b16 v[132:133], v219 offset:10240
ds_read_b64_tr_b16 v[134:135], v219 offset:15360
v_mfma_f32_32x32x16_bf16 a[144:159], v[140:143], a[104:107], a[144:159]
ds_read_b64_tr_b16 v[136:137], v217 offset:50176
ds_read_b64_tr_b16 v[138:139], v217 offset:52736
ds_read_b64_tr_b16 v[140:141], v220 offset:10240
ds_read_b64_tr_b16 v[142:143], v220 offset:15360
s_waitcnt lgkmcnt(8)
v_mfma_f32_16x16x32_bf16 a[248:251], v[144:147], v[156:159], a[248:251]
ds_read_b64_tr_b16 v[144:145], v217 offset:55296
ds_read_b64_tr_b16 v[146:147], v217 offset:57856
v_mfma_f32_32x32x16_bf16 a[144:159], v[148:151], a[108:111], a[144:159]
ds_read_b64_tr_b16 v[148:149], v218 offset:45056
ds_read_b64_tr_b16 v[150:151], v218 offset:50176
ds_read_b128 v[164:167], v244 offset:38912
v_mfma_f32_16x16x32_bf16 a[240:243], v[152:155], v[160:163], a[240:243]
ds_read_b64_tr_b16 v[152:153], v217 offset:60416
ds_read_b64_tr_b16 v[154:155], v217 offset:62976
s_waitcnt lgkmcnt(11)
v_mfma_f32_32x32x16_bf16 a[144:159], v[128:131], a[112:115], a[144:159]
ds_read_b64_tr_b16 v[128:129], v219 offset:45056
ds_read_b64_tr_b16 v[130:131], v219 offset:50176
v_mfma_f32_16x16x32_bf16 a[244:247], v[132:135], v[160:163], a[244:247]
ds_read_b64_tr_b16 v[132:133], v217 offset:20480
ds_read_b64_tr_b16 v[134:135], v217 offset:23040
s_waitcnt lgkmcnt(9)
v_mfma_f32_32x32x16_bf16 a[144:159], v[136:139], a[116:119], a[144:159]
ds_read_b64_tr_b16 v[136:137], v220 offset:45056
ds_read_b64_tr_b16 v[138:139], v220 offset:50176
v_mfma_f32_16x16x32_bf16 a[248:251], v[140:143], v[160:163], a[248:251]
ds_read_b64_tr_b16 v[140:141], v217 offset:25600
ds_read_b64_tr_b16 v[142:143], v217 offset:28160
v_mfma_f32_32x32x16_bf16 a[144:159], v[144:147], a[120:123], a[144:159]
ds_read_b64_tr_b16 v[144:145], v218 offset:55296
ds_read_b64_tr_b16 v[146:147], v218 offset:60416
ds_read_b128 v[168:171], v244 offset:39936
s_waitcnt lgkmcnt(9)
v_mfma_f32_16x16x32_bf16 a[240:243], v[148:151], v[164:167], a[240:243]
ds_read_b64_tr_b16 v[148:149], v217 offset:30720
ds_read_b64_tr_b16 v[150:151], v217 offset:33280
v_mfma_f32_32x32x16_bf16 a[144:159], v[152:155], a[124:127], a[144:159]
ds_read_b64_tr_b16 v[152:153], v219 offset:55296
ds_read_b64_tr_b16 v[154:155], v219 offset:60416
v_mfma_f32_16x16x32_bf16 a[244:247], v[128:131], v[164:167], a[244:247]
ds_read_b64_tr_b16 v[128:129], v217 offset:35840
ds_read_b64_tr_b16 v[130:131], v217 offset:38400
s_waitcnt lgkmcnt(9)
v_mfma_f32_32x32x16_bf16 a[144:159], v[132:135], a[128:131], a[144:159]
ds_read_b64_tr_b16 v[132:133], v220 offset:55296
ds_read_b64_tr_b16 v[134:135], v220 offset:60416
v_mfma_f32_16x16x32_bf16 a[248:251], v[136:139], v[164:167], a[248:251]
ds_read_b64_tr_b16 v[136:137], v217 offset:64
ds_read_b64_tr_b16 v[138:139], v217 offset:2624
v_mfma_f32_32x32x16_bf16 a[144:159], v[140:143], a[132:135], a[144:159]
ds_read_b64_tr_b16 v[140:141], v218 offset:20480
ds_read_b64_tr_b16 v[142:143], v218 offset:25600
ds_read_b128 v[156:159], v244 offset:40960
s_waitcnt lgkmcnt(9)
v_mfma_f32_16x16x32_bf16 a[240:243], v[144:147], v[168:171], a[240:243]
ds_read_b64_tr_b16 v[144:145], v217 offset:5184
ds_read_b64_tr_b16 v[146:147], v217 offset:7744
v_mfma_f32_32x32x16_bf16 a[144:159], v[148:151], a[136:139], a[144:159]
ds_read_b64_tr_b16 v[148:149], v219 offset:20480
ds_read_b64_tr_b16 v[150:151], v219 offset:25600
v_mfma_f32_16x16x32_bf16 a[244:247], v[152:155], v[168:171], a[244:247]
ds_read_b64_tr_b16 v[152:153], v217 offset:10304
ds_read_b64_tr_b16 v[154:155], v217 offset:12864
s_waitcnt lgkmcnt(9)
v_mfma_f32_32x32x16_bf16 a[144:159], v[128:131], a[140:143], a[144:159]
ds_read_b64_tr_b16 v[128:129], v220 offset:20480
ds_read_b64_tr_b16 v[130:131], v220 offset:25600
v_mfma_f32_16x16x32_bf16 a[248:251], v[132:135], v[168:171], a[248:251]
ds_read_b64_tr_b16 v[132:133], v217 offset:15424
ds_read_b64_tr_b16 v[134:135], v217 offset:17984
v_mfma_f32_32x32x16_bf16 a[160:175], v[136:139], a[96:99], a[160:175]
ds_read_b64_tr_b16 v[136:137], v218 offset:30720
ds_read_b64_tr_b16 v[138:139], v218 offset:35840
ds_read_b128 v[160:163], v244 offset:41984
v_accvgpr_read_b32 v88, a144
v_accvgpr_read_b32 v89, a145
v_accvgpr_read_b32 v90, a146
v_accvgpr_read_b32 v91, a147
s_waitcnt lgkmcnt(8)
v_mfma_f32_16x16x32_bf16 a[240:243], v[140:143], v[156:159], a[240:243]
ds_read_b64_tr_b16 v[140:141], v217 offset:45120
ds_read_b64_tr_b16 v[142:143], v217 offset:47680
v_mfma_f32_32x32x16_bf16 a[160:175], v[144:147], a[100:103], a[160:175]
ds_read_b64_tr_b16 v[144:145], v219 offset:30720
ds_read_b64_tr_b16 v[146:147], v219 offset:35840
v_accvgpr_read_b32 v92, a148
v_accvgpr_read_b32 v93, a149
v_accvgpr_read_b32 v94, a150
v_accvgpr_read_b32 v95, a151
v_mfma_f32_16x16x32_bf16 a[244:247], v[148:151], v[156:159], a[244:247]
ds_read_b64_tr_b16 v[148:149], v217 offset:50240
ds_read_b64_tr_b16 v[150:151], v217 offset:52800
s_waitcnt lgkmcnt(6)
v_mfma_f32_32x32x16_bf16 a[160:175], v[152:155], a[104:107], a[160:175]
ds_read_b64_tr_b16 v[152:153], v220 offset:30720
ds_read_b64_tr_b16 v[154:155], v220 offset:35840
v_cvt_pk_bf16_f32 v88, v88, v89
v_cvt_pk_bf16_f32 v89, v90, v91
v_cvt_pk_bf16_f32 v90, v92, v93
v_cvt_pk_bf16_f32 v91, v94, v95
v_mfma_f32_16x16x32_bf16 a[248:251], v[128:131], v[156:159], a[248:251]
ds_read_b64_tr_b16 v[128:129], v217 offset:55360
ds_read_b64_tr_b16 v[130:131], v217 offset:57920
v_mfma_f32_32x32x16_bf16 a[160:175], v[132:135], a[108:111], a[160:175]
ds_read_b64_tr_b16 v[132:133], v217 offset:60480
ds_read_b64_tr_b16 v[134:135], v217 offset:63040
s_add_u32 s40, s58, 0x0
buffer_store_dwordx4 v[88:91], v254, s[24:27], s40 offen offset:0 sc1
v_mfma_f32_16x16x32_bf16 a[240:243], v[136:139], v[160:163], a[240:243]
ds_read_b64_tr_b16 v[136:137], v217 offset:20544
ds_read_b64_tr_b16 v[138:139], v217 offset:23104
s_waitcnt lgkmcnt(7)
v_mfma_f32_32x32x16_bf16 a[160:175], v[140:143], a[112:115], a[160:175]
ds_read_b64_tr_b16 v[140:141], v217 offset:25664
ds_read_b64_tr_b16 v[142:143], v217 offset:28224
v_accvgpr_read_b32 v96, a152
v_accvgpr_read_b32 v97, a153
v_accvgpr_read_b32 v98, a154
v_accvgpr_read_b32 v99, a155
v_mfma_f32_16x16x32_bf16 a[244:247], v[144:147], v[160:163], a[244:247]
ds_read_b64_tr_b16 v[144:145], v217 offset:30784
ds_read_b64_tr_b16 v[146:147], v217 offset:33344
v_mfma_f32_32x32x16_bf16 a[160:175], v[148:151], a[116:119], a[160:175]
ds_read_b64_tr_b16 v[148:149], v217 offset:35904
ds_read_b64_tr_b16 v[150:151], v217 offset:38464
v_accvgpr_read_b32 v100, a156
v_accvgpr_read_b32 v101, a157
v_accvgpr_read_b32 v102, a158
v_accvgpr_read_b32 v103, a159
s_waitcnt lgkmcnt(6)
v_mfma_f32_16x16x32_bf16 a[248:251], v[152:155], v[160:163], a[248:251]
ds_read_b64_tr_b16 v[152:153], v217 offset:128
ds_read_b64_tr_b16 v[154:155], v217 offset:2688
v_mfma_f32_32x32x16_bf16 a[160:175], v[128:131], a[120:123], a[160:175]
ds_read_b64_tr_b16 v[128:129], v217 offset:5248
ds_read_b64_tr_b16 v[130:131], v217 offset:7808
v_cvt_pk_bf16_f32 v96, v96, v97
v_cvt_pk_bf16_f32 v97, v98, v99
v_cvt_pk_bf16_f32 v98, v100, v101
v_cvt_pk_bf16_f32 v99, v102, v103
v_mfma_f32_32x32x16_bf16 a[160:175], v[132:135], a[124:127], a[160:175]
ds_read_b64_tr_b16 v[132:133], v217 offset:10368
ds_read_b64_tr_b16 v[134:135], v217 offset:12928
s_add_u32 s40, s58, 0x0
buffer_store_dwordx4 v[96:99], v254, s[24:27], s40 offen offset:1024 sc1
v_mfma_f32_32x32x16_bf16 a[160:175], v[136:139], a[128:131], a[160:175]
ds_read_b64_tr_b16 v[136:137], v217 offset:15488
ds_read_b64_tr_b16 v[138:139], v217 offset:18048
v_accvgpr_read_b32 v72, a240
v_accvgpr_read_b32 v73, a241
v_accvgpr_read_b32 v74, a242
v_accvgpr_read_b32 v75, a243
s_waitcnt lgkmcnt(4)
v_mfma_f32_32x32x16_bf16 a[160:175], v[140:143], a[132:135], a[160:175]
ds_read_b64_tr_b16 v[140:141], v217 offset:45184
ds_read_b64_tr_b16 v[142:143], v217 offset:47744
v_cvt_pk_bf16_f32 v72, v72, v73
v_cvt_pk_bf16_f32 v73, v74, v75
v_mfma_f32_32x32x16_bf16 a[160:175], v[144:147], a[136:139], a[160:175]
ds_read_b64_tr_b16 v[144:145], v217 offset:50304
ds_read_b64_tr_b16 v[146:147], v217 offset:52864
s_add_u32 s40, s60, 0xa000
buffer_store_dwordx2 v[72:73], v255, s[24:27], s40 offen sc1
v_mfma_f32_32x32x16_bf16 a[160:175], v[148:151], a[140:143], a[160:175]
ds_read_b64_tr_b16 v[148:149], v217 offset:55424
ds_read_b64_tr_b16 v[150:151], v217 offset:57984
v_accvgpr_read_b32 v80, a244
v_accvgpr_read_b32 v81, a245
v_accvgpr_read_b32 v82, a246
v_accvgpr_read_b32 v83, a247
v_mfma_f32_32x32x16_bf16 a[176:191], v[152:155], a[96:99], a[176:191]
ds_read_b64_tr_b16 v[152:153], v217 offset:60544
ds_read_b64_tr_b16 v[154:155], v217 offset:63104
v_cvt_pk_bf16_f32 v80, v80, v81
v_cvt_pk_bf16_f32 v81, v82, v83
v_mfma_f32_32x32x16_bf16 a[176:191], v[128:131], a[100:103], a[176:191]
ds_read_b64_tr_b16 v[128:129], v217 offset:20608
ds_read_b64_tr_b16 v[130:131], v217 offset:23168
s_add_u32 s40, s60, 0xa800
buffer_store_dwordx2 v[80:81], v255, s[24:27], s40 offen sc1
s_waitcnt lgkmcnt(6)
v_mfma_f32_32x32x16_bf16 a[176:191], v[132:135], a[104:107], a[176:191]
ds_read_b64_tr_b16 v[132:133], v217 offset:25728
ds_read_b64_tr_b16 v[134:135], v217 offset:28288
v_accvgpr_read_b32 v88, a248
v_accvgpr_read_b32 v89, a249
v_accvgpr_read_b32 v90, a250
v_accvgpr_read_b32 v91, a251
v_mfma_f32_32x32x16_bf16 a[176:191], v[136:139], a[108:111], a[176:191]
ds_read_b64_tr_b16 v[136:137], v217 offset:30848
ds_read_b64_tr_b16 v[138:139], v217 offset:33408
v_cvt_pk_bf16_f32 v88, v88, v89
v_cvt_pk_bf16_f32 v89, v90, v91
v_mfma_f32_32x32x16_bf16 a[176:191], v[140:143], a[112:115], a[176:191]
ds_read_b64_tr_b16 v[140:141], v217 offset:35968
ds_read_b64_tr_b16 v[142:143], v217 offset:38528
s_add_u32 s40, s62, 0xb000
buffer_store_dwordx2 v[88:89], v255, s[24:27], s40 offen sc1
v_mfma_f32_32x32x16_bf16 a[176:191], v[144:147], a[116:119], a[176:191]
ds_read_b64_tr_b16 v[144:145], v217 offset:192
ds_read_b64_tr_b16 v[146:147], v217 offset:2752
v_accvgpr_read_b32 v96, a160
v_accvgpr_read_b32 v97, a161
v_accvgpr_read_b32 v98, a162
v_accvgpr_read_b32 v99, a163
s_waitcnt lgkmcnt(6)
v_mfma_f32_32x32x16_bf16 a[176:191], v[148:151], a[120:123], a[176:191]
ds_read_b64_tr_b16 v[148:149], v217 offset:5312
ds_read_b64_tr_b16 v[150:151], v217 offset:7872
v_accvgpr_read_b32 v100, a164
v_accvgpr_read_b32 v101, a165
v_accvgpr_read_b32 v102, a166
v_accvgpr_read_b32 v103, a167
v_mfma_f32_32x32x16_bf16 a[176:191], v[152:155], a[124:127], a[176:191]
ds_read_b64_tr_b16 v[152:153], v217 offset:10432
ds_read_b64_tr_b16 v[154:155], v217 offset:12992
v_cvt_pk_bf16_f32 v96, v96, v97
v_cvt_pk_bf16_f32 v97, v98, v99
v_cvt_pk_bf16_f32 v98, v100, v101
v_cvt_pk_bf16_f32 v99, v102, v103
v_mfma_f32_32x32x16_bf16 a[176:191], v[128:131], a[128:131], a[176:191]
ds_read_b64_tr_b16 v[128:129], v217 offset:15552
ds_read_b64_tr_b16 v[130:131], v217 offset:18112
s_add_u32 s40, s58, 0x0
buffer_store_dwordx4 v[96:99], v254, s[24:27], s40 offen offset:2048 sc1
v_mfma_f32_32x32x16_bf16 a[176:191], v[132:135], a[132:135], a[176:191]
ds_read_b64_tr_b16 v[132:133], v217 offset:45248
ds_read_b64_tr_b16 v[134:135], v217 offset:47808
v_accvgpr_read_b32 v72, a168
v_accvgpr_read_b32 v73, a169
v_accvgpr_read_b32 v74, a170
v_accvgpr_read_b32 v75, a171
s_waitcnt lgkmcnt(4)
v_mfma_f32_32x32x16_bf16 a[176:191], v[136:139], a[136:139], a[176:191]
ds_read_b64_tr_b16 v[136:137], v217 offset:50368
ds_read_b64_tr_b16 v[138:139], v217 offset:52928
v_accvgpr_read_b32 v76, a172
v_accvgpr_read_b32 v77, a173
v_accvgpr_read_b32 v78, a174
v_accvgpr_read_b32 v79, a175
v_mfma_f32_32x32x16_bf16 a[176:191], v[140:143], a[140:143], a[176:191]
ds_read_b64_tr_b16 v[140:141], v217 offset:55488
ds_read_b64_tr_b16 v[142:143], v217 offset:58048
v_cvt_pk_bf16_f32 v72, v72, v73
v_cvt_pk_bf16_f32 v73, v74, v75
v_cvt_pk_bf16_f32 v74, v76, v77
v_cvt_pk_bf16_f32 v75, v78, v79
v_mfma_f32_32x32x16_bf16 a[192:207], v[144:147], a[96:99], a[192:207]
ds_read_b64_tr_b16 v[144:145], v217 offset:60608
ds_read_b64_tr_b16 v[146:147], v217 offset:63168
s_add_u32 s40, s58, 0x0
buffer_store_dwordx4 v[72:75], v254, s[24:27], s40 offen offset:3072 sc1
v_mfma_f32_32x32x16_bf16 a[192:207], v[148:151], a[100:103], a[192:207]
ds_read_b64_tr_b16 v[148:149], v217 offset:20672
ds_read_b64_tr_b16 v[150:151], v217 offset:23232
v_accvgpr_read_b32 v80, a176
v_accvgpr_read_b32 v81, a177
v_accvgpr_read_b32 v82, a178
v_accvgpr_read_b32 v83, a179
v_mfma_f32_32x32x16_bf16 a[192:207], v[152:155], a[104:107], a[192:207]
ds_read_b64_tr_b16 v[152:153], v217 offset:25792
ds_read_b64_tr_b16 v[154:155], v217 offset:28352
v_accvgpr_read_b32 v84, a180
v_accvgpr_read_b32 v85, a181
v_accvgpr_read_b32 v86, a182
v_accvgpr_read_b32 v87, a183
s_waitcnt lgkmcnt(4)
v_mfma_f32_32x32x16_bf16 a[192:207], v[128:131], a[108:111], a[192:207]
ds_read_b64_tr_b16 v[128:129], v217 offset:30912
ds_read_b64_tr_b16 v[130:131], v217 offset:33472
v_cvt_pk_bf16_f32 v80, v80, v81
v_cvt_pk_bf16_f32 v81, v82, v83
v_cvt_pk_bf16_f32 v82, v84, v85
v_cvt_pk_bf16_f32 v83, v86, v87
v_mfma_f32_32x32x16_bf16 a[192:207], v[132:135], a[112:115], a[192:207]
ds_read_b64_tr_b16 v[132:133], v217 offset:36032
ds_read_b64_tr_b16 v[134:135], v217 offset:38592
s_add_u32 s40, s58, 0x1000
buffer_store_dwordx4 v[80:83], v254, s[24:27], s40 offen offset:0 sc1
v_mfma_f32_32x32x16_bf16 a[192:207], v[136:139], a[116:119], a[192:207]
ds_read_b64_tr_b16 v[136:137], v217 offset:256
ds_read_b64_tr_b16 v[138:139], v217 offset:2816
v_accvgpr_read_b32 v88, a184
v_accvgpr_read_b32 v89, a185
v_accvgpr_read_b32 v90, a186
v_accvgpr_read_b32 v91, a187
v_mfma_f32_32x32x16_bf16 a[192:207], v[140:143], a[120:123], a[192:207]
ds_read_b64_tr_b16 v[140:141], v217 offset:5376
ds_read_b64_tr_b16 v[142:143], v217 offset:7936
v_accvgpr_read_b32 v92, a188
v_accvgpr_read_b32 v93, a189
v_accvgpr_read_b32 v94, a190
v_accvgpr_read_b32 v95, a191
v_mfma_f32_32x32x16_bf16 a[192:207], v[144:147], a[124:127], a[192:207]
ds_read_b64_tr_b16 v[144:145], v217 offset:10496
ds_read_b64_tr_b16 v[146:147], v217 offset:13056
v_cvt_pk_bf16_f32 v88, v88, v89
v_cvt_pk_bf16_f32 v89, v90, v91
v_cvt_pk_bf16_f32 v90, v92, v93
v_cvt_pk_bf16_f32 v91, v94, v95
s_waitcnt lgkmcnt(4)
v_mfma_f32_32x32x16_bf16 a[192:207], v[148:151], a[128:131], a[192:207]
ds_read_b64_tr_b16 v[148:149], v217 offset:15616
ds_read_b64_tr_b16 v[150:151], v217 offset:18176
s_add_u32 s40, s58, 0x1000
buffer_store_dwordx4 v[88:91], v254, s[24:27], s40 offen offset:1024 sc1
v_mfma_f32_32x32x16_bf16 a[192:207], v[152:155], a[132:135], a[192:207]
ds_read_b64_tr_b16 v[152:153], v217 offset:45312
ds_read_b64_tr_b16 v[154:155], v217 offset:47872
v_mfma_f32_32x32x16_bf16 a[192:207], v[128:131], a[136:139], a[192:207]
ds_read_b64_tr_b16 v[128:129], v217 offset:50432
ds_read_b64_tr_b16 v[130:131], v217 offset:52992
v_mfma_f32_32x32x16_bf16 a[192:207], v[132:135], a[140:143], a[192:207]
ds_read_b64_tr_b16 v[132:133], v217 offset:55552
ds_read_b64_tr_b16 v[134:135], v217 offset:58112
v_mfma_f32_32x32x16_bf16 a[208:223], v[136:139], a[96:99], a[208:223]
ds_read_b64_tr_b16 v[136:137], v217 offset:60672
ds_read_b64_tr_b16 v[138:139], v217 offset:63232
s_nop 1
v_accvgpr_read_b32 v96, a192
v_accvgpr_read_b32 v97, a193
v_accvgpr_read_b32 v98, a194
v_accvgpr_read_b32 v99, a195
s_waitcnt lgkmcnt(6)
v_mfma_f32_32x32x16_bf16 a[208:223], v[140:143], a[100:103], a[208:223]
ds_read_b64_tr_b16 v[140:141], v217 offset:20736
ds_read_b64_tr_b16 v[142:143], v217 offset:23296
v_accvgpr_read_b32 v100, a196
v_accvgpr_read_b32 v101, a197
v_accvgpr_read_b32 v102, a198
v_accvgpr_read_b32 v103, a199
v_mfma_f32_32x32x16_bf16 a[208:223], v[144:147], a[104:107], a[208:223]
ds_read_b64_tr_b16 v[144:145], v217 offset:25856
ds_read_b64_tr_b16 v[146:147], v217 offset:28416
v_cvt_pk_bf16_f32 v96, v96, v97
v_cvt_pk_bf16_f32 v97, v98, v99
v_cvt_pk_bf16_f32 v98, v100, v101
v_cvt_pk_bf16_f32 v99, v102, v103
v_mfma_f32_32x32x16_bf16 a[208:223], v[148:151], a[108:111], a[208:223]
ds_read_b64_tr_b16 v[148:149], v217 offset:30976
ds_read_b64_tr_b16 v[150:151], v217 offset:33536
s_add_u32 s40, s58, 0x1000
buffer_store_dwordx4 v[96:99], v254, s[24:27], s40 offen offset:2048 sc1
v_mfma_f32_32x32x16_bf16 a[208:223], v[152:155], a[112:115], a[208:223]
ds_read_b64_tr_b16 v[152:153], v217 offset:36096
ds_read_b64_tr_b16 v[154:155], v217 offset:38656
v_accvgpr_read_b32 v72, a200
v_accvgpr_read_b32 v73, a201
v_accvgpr_read_b32 v74, a202
v_accvgpr_read_b32 v75, a203
s_waitcnt lgkmcnt(4)
v_mfma_f32_32x32x16_bf16 a[208:223], v[128:131], a[116:119], a[208:223]
v_accvgpr_read_b32 v76, a204
v_accvgpr_read_b32 v77, a205
v_accvgpr_read_b32 v78, a206
v_accvgpr_read_b32 v79, a207
v_cvt_pk_bf16_f32 v72, v72, v73
v_cvt_pk_bf16_f32 v73, v74, v75
v_cvt_pk_bf16_f32 v74, v76, v77
v_cvt_pk_bf16_f32 v75, v78, v79
v_mfma_f32_32x32x16_bf16 a[208:223], v[132:135], a[120:123], a[208:223]
s_add_u32 s40, s58, 0x1000
buffer_store_dwordx4 v[72:75], v254, s[24:27], s40 offen offset:3072 sc1
v_mfma_f32_32x32x16_bf16 a[208:223], v[136:139], a[124:127], a[208:223]
v_mfma_f32_32x32x16_bf16 a[208:223], v[140:143], a[128:131], a[208:223]
v_mfma_f32_32x32x16_bf16 a[208:223], v[144:147], a[132:135], a[208:223]
s_waitcnt lgkmcnt(0)
v_mfma_f32_32x32x16_bf16 a[208:223], v[148:151], a[136:139], a[208:223]
v_mfma_f32_32x32x16_bf16 a[208:223], v[152:155], a[140:143], a[208:223]
s_nop 11
v_accvgpr_read_b32 v80, a208
v_accvgpr_read_b32 v81, a209
v_accvgpr_read_b32 v82, a210
v_accvgpr_read_b32 v83, a211
v_accvgpr_read_b32 v84, a212
v_accvgpr_read_b32 v85, a213
v_accvgpr_read_b32 v86, a214
v_accvgpr_read_b32 v87, a215
v_cvt_pk_bf16_f32 v80, v80, v81
v_cvt_pk_bf16_f32 v81, v82, v83
v_cvt_pk_bf16_f32 v82, v84, v85
v_cvt_pk_bf16_f32 v83, v86, v87
s_add_u32 s40, s58, 0x2000
buffer_store_dwordx4 v[80:83], v254, s[24:27], s40 offen offset:0 sc1
v_accvgpr_read_b32 v88, a216
v_accvgpr_read_b32 v89, a217
v_accvgpr_read_b32 v90, a218
v_accvgpr_read_b32 v91, a219
v_accvgpr_read_b32 v92, a220
v_accvgpr_read_b32 v93, a221
v_accvgpr_read_b32 v94, a222
v_accvgpr_read_b32 v95, a223
v_cvt_pk_bf16_f32 v88, v88, v89
v_cvt_pk_bf16_f32 v89, v90, v91
v_cvt_pk_bf16_f32 v90, v92, v93
v_cvt_pk_bf16_f32 v91, v94, v95
s_add_u32 s40, s58, 0x2000
buffer_store_dwordx4 v[88:91], v254, s[24:27], s40 offen offset:1024 sc1
L_end:
s_endpgm
L_fb0:
s_call_b64 s[46:47], L_FB
s_branch L_rt0
L_fb1:
s_call_b64 s[46:47], L_FA
s_branch L_rt1
L_fb2:
s_call_b64 s[46:47], L_FX
s_branch L_rt2
L_fb3:
s_call_b64 s[46:47], L_FB
s_branch L_rt3
L_fb4:
s_call_b64 s[46:47], L_FA
s_branch L_rt4
L_fb5:
s_call_b64 s[46:47], L_FX
s_branch L_rt5
L_fb6:
s_call_b64 s[46:47], L_FB
s_branch L_rt6
L_fb7:
s_call_b64 s[46:47], L_FA
s_branch L_rt7
L_fb8:
s_call_b64 s[46:47], L_FX
s_branch L_rt8
L_fb9:
s_call_b64 s[46:47], L_FB
s_branch L_rt9
L_fb10:
s_call_b64 s[46:47], L_FA
s_branch L_rt10
L_fb11:
s_call_b64 s[46:47], L_FX
s_branch L_rt11
L_fb12:
s_call_b64 s[46:47], L_FB
s_branch L_rt12
L_fb13:
s_call_b64 s[46:47], L_FA
s_branch L_rt13
L_fb14:
s_call_b64 s[46:47], L_FX
s_branch L_rt14
L_fb15:
s_call_b64 s[46:47], L_FB
s_branch L_rt15
L_fb16:
s_call_b64 s[46:47], L_FA
s_branch L_rt16
L_fb17:
s_call_b64 s[46:47], L_FX
s_branch L_rt17
L_fb18:
s_call_b64 s[46:47], L_FB
s_branch L_rt18
L_fb19:
s_call_b64 s[46:47], L_FA
s_branch L_rt19
L_fb20:
s_call_b64 s[46:47], L_FX
s_branch L_rt20
L_fb21:
s_call_b64 s[46:47], L_FB
s_branch L_rt21
L_fb22:
s_call_b64 s[46:47], L_FB
s_branch L_rt22
L_fb23:
s_call_b64 s[46:47], L_FA
s_branch L_rt23
L_fb24:
s_call_b64 s[46:47], L_FX
s_branch L_rt24
L_fb25:
s_call_b64 s[46:47], L_FB
s_branch L_rt25
L_fb26:
s_call_b64 s[46:47], L_FA
s_branch L_rt26
L_fb27:
s_call_b64 s[46:47], L_FX
s_branch L_rt27
L_fb28:
s_call_b64 s[46:47], L_FB
s_branch L_rt28
L_fb29:
s_call_b64 s[46:47], L_FA
s_branch L_rt29
L_fb30:
s_call_b64 s[46:47], L_FX
s_branch L_rt30
L_fb31:
s_call_b64 s[46:47], L_FB
s_branch L_rt31
L_fb32:
s_call_b64 s[46:47], L_FA
s_branch L_rt32
L_fb33:
s_call_b64 s[46:47], L_FX
s_branch L_rt33
L_fb34:
s_call_b64 s[46:47], L_FB
s_branch L_rt34
L_fb35:
s_call_b64 s[46:47], L_FA
s_branch L_rt35
L_fb36:
s_call_b64 s[46:47], L_FX
s_branch L_rt36
L_fb37:
s_call_b64 s[46:47], L_FB
s_branch L_rt37
L_fb38:
s_call_b64 s[46:47], L_FA
s_branch L_rt38
L_fb39:
s_call_b64 s[46:47], L_FX
s_branch L_rt39
L_fb40:
s_call_b64 s[46:47], L_FB
s_branch L_rt40
L_fb41:
s_call_b64 s[46:47], L_FA
s_branch L_rt41
L_fb42:
s_call_b64 s[46:47], L_FX
s_branch L_rt42
L_fb43:
s_call_b64 s[46:47], L_FB
s_branch L_rt43
L_FA:
s_nop 15
s_nop 15
v_mov_b32 v250, v249
s_nop 0
s_nop 0
v_permlane32_swap_b32 v249, v250
v_max_f32 v249, v249, v250
v_max_f32 v249, 0, v249
v_sub_f32 v72, v72, v249
v_sub_f32 v73, v73, v249
v_sub_f32 v74, v74, v249
v_sub_f32 v75, v75, v249
v_sub_f32 v76, v76, v249
v_sub_f32 v77, v77, v249
v_sub_f32 v78, v78, v249
v_sub_f32 v79, v79, v249
v_sub_f32 v80, v80, v249
v_sub_f32 v81, v81, v249
v_sub_f32 v82, v82, v249
v_sub_f32 v83, v83, v249
v_sub_f32 v84, v84, v249
v_sub_f32 v85, v85, v249
v_sub_f32 v86, v86, v249
v_sub_f32 v87, v87, v249
v_sub_f32 v108, v108, v249
v_sub_f32 v109, v109, v249
v_sub_f32 v110, v110, v249
v_sub_f32 v111, v111, v249
v_sub_f32 v112, v112, v249
v_sub_f32 v113, v113, v249
v_sub_f32 v114, v114, v249
v_sub_f32 v115, v115, v249
v_sub_f32 v116, v116, v249
v_sub_f32 v117, v117, v249
v_sub_f32 v118, v118, v249
v_sub_f32 v119, v119, v249
v_sub_f32 v120, v120, v249
v_sub_f32 v121, v121, v249
v_sub_f32 v122, v122, v249
v_sub_f32 v123, v123, v249
v_exp_f32 v249, -v249
s_nop 1
v_mul_f32 v246, v246, v249
v_mul_f32 v247, v247, v249
v_accvgpr_read_b32 v250, a0
v_mul_f32 v250, v250, v249
v_accvgpr_write_b32 a0, v250
v_accvgpr_read_b32 v250, a1
v_mul_f32 v250, v250, v249
v_accvgpr_write_b32 a1, v250
v_accvgpr_read_b32 v250, a2
v_mul_f32 v250, v250, v249
v_accvgpr_write_b32 a2, v250
v_accvgpr_read_b32 v250, a3
v_mul_f32 v250, v250, v249
v_accvgpr_write_b32 a3, v250
v_accvgpr_read_b32 v250, a4
v_mul_f32 v250, v250, v249
v_accvgpr_write_b32 a4, v250
v_accvgpr_read_b32 v250, a5
v_mul_f32 v250, v250, v249
v_accvgpr_write_b32 a5, v250
v_accvgpr_read_b32 v250, a6
v_mul_f32 v250, v250, v249
v_accvgpr_write_b32 a6, v250
v_accvgpr_read_b32 v250, a7
v_mul_f32 v250, v250, v249
v_accvgpr_write_b32 a7, v250
v_accvgpr_read_b32 v250, a8
v_mul_f32 v250, v250, v249
v_accvgpr_write_b32 a8, v250
v_accvgpr_read_b32 v250, a9
v_mul_f32 v250, v250, v249
v_accvgpr_write_b32 a9, v250
v_accvgpr_read_b32 v250, a10
v_mul_f32 v250, v250, v249
v_accvgpr_write_b32 a10, v250
v_accvgpr_read_b32 v250, a11
v_mul_f32 v250, v250, v249
v_accvgpr_write_b32 a11, v250
v_accvgpr_read_b32 v250, a12
v_mul_f32 v250, v250, v249
v_accvgpr_write_b32 a12, v250
v_accvgpr_read_b32 v250, a13
v_mul_f32 v250, v250, v249
v_accvgpr_write_b32 a13, v250
v_accvgpr_read_b32 v250, a14
v_mul_f32 v250, v250, v249
v_accvgpr_write_b32 a14, v250
v_accvgpr_read_b32 v250, a15
v_mul_f32 v250, v250, v249
v_accvgpr_write_b32 a15, v250
v_accvgpr_read_b32 v250, a16
v_mul_f32 v250, v250, v249
v_accvgpr_write_b32 a16, v250
v_accvgpr_read_b32 v250, a17
v_mul_f32 v250, v250, v249
v_accvgpr_write_b32 a17, v250
v_accvgpr_read_b32 v250, a18
v_mul_f32 v250, v250, v249
v_accvgpr_write_b32 a18, v250
v_accvgpr_read_b32 v250, a19
v_mul_f32 v250, v250, v249
v_accvgpr_write_b32 a19, v250
v_accvgpr_read_b32 v250, a20
v_mul_f32 v250, v250, v249
v_accvgpr_write_b32 a20, v250
v_accvgpr_read_b32 v250, a21
v_mul_f32 v250, v250, v249
v_accvgpr_write_b32 a21, v250
v_accvgpr_read_b32 v250, a22
v_mul_f32 v250, v250, v249
v_accvgpr_write_b32 a22, v250
v_accvgpr_read_b32 v250, a23
v_mul_f32 v250, v250, v249
v_accvgpr_write_b32 a23, v250
v_accvgpr_read_b32 v250, a24
v_mul_f32 v250, v250, v249
v_accvgpr_write_b32 a24, v250
v_accvgpr_read_b32 v250, a25
v_mul_f32 v250, v250, v249
v_accvgpr_write_b32 a25, v250
v_accvgpr_read_b32 v250, a26
v_mul_f32 v250, v250, v249
v_accvgpr_write_b32 a26, v250
v_accvgpr_read_b32 v250, a27
v_mul_f32 v250, v250, v249
v_accvgpr_write_b32 a27, v250
v_accvgpr_read_b32 v250, a28
v_mul_f32 v250, v250, v249
v_accvgpr_write_b32 a28, v250
v_accvgpr_read_b32 v250, a29
v_mul_f32 v250, v250, v249
v_accvgpr_write_b32 a29, v250
v_accvgpr_read_b32 v250, a30
v_mul_f32 v250, v250, v249
v_accvgpr_write_b32 a30, v250
v_accvgpr_read_b32 v250, a31
v_mul_f32 v250, v250, v249
v_accvgpr_write_b32 a31, v250
v_accvgpr_read_b32 v250, a32
v_mul_f32 v250, v250, v249
v_accvgpr_write_b32 a32, v250
v_accvgpr_read_b32 v250, a33
v_mul_f32 v250, v250, v249
v_accvgpr_write_b32 a33, v250
v_accvgpr_read_b32 v250, a34
v_mul_f32 v250, v250, v249
v_accvgpr_write_b32 a34, v250
v_accvgpr_read_b32 v250, a35
v_mul_f32 v250, v250, v249
v_accvgpr_write_b32 a35, v250
v_accvgpr_read_b32 v250, a36
v_mul_f32 v250, v250, v249
v_accvgpr_write_b32 a36, v250
v_accvgpr_read_b32 v250, a37
v_mul_f32 v250, v250, v249
v_accvgpr_write_b32 a37, v250
v_accvgpr_read_b32 v250, a38
v_mul_f32 v250, v250, v249
v_accvgpr_write_b32 a38, v250
v_accvgpr_read_b32 v250, a39
v_mul_f32 v250, v250, v249
v_accvgpr_write_b32 a39, v250
v_accvgpr_read_b32 v250, a40
v_mul_f32 v250, v250, v249
v_accvgpr_write_b32 a40, v250
v_accvgpr_read_b32 v250, a41
v_mul_f32 v250, v250, v249
v_accvgpr_write_b32 a41, v250
v_accvgpr_read_b32 v250, a42
v_mul_f32 v250, v250, v249
v_accvgpr_write_b32 a42, v250
v_accvgpr_read_b32 v250, a43
v_mul_f32 v250, v250, v249
v_accvgpr_write_b32 a43, v250
v_accvgpr_read_b32 v250, a44
v_mul_f32 v250, v250, v249
v_accvgpr_write_b32 a44, v250
v_accvgpr_read_b32 v250, a45
v_mul_f32 v250, v250, v249
v_accvgpr_write_b32 a45, v250
v_accvgpr_read_b32 v250, a46
v_mul_f32 v250, v250, v249
v_accvgpr_write_b32 a46, v250
v_accvgpr_read_b32 v250, a47
v_mul_f32 v250, v250, v249
v_accvgpr_write_b32 a47, v250
v_accvgpr_read_b32 v250, a48
v_mul_f32 v250, v250, v249
v_accvgpr_write_b32 a48, v250
v_accvgpr_read_b32 v250, a49
v_mul_f32 v250, v250, v249
v_accvgpr_write_b32 a49, v250
v_accvgpr_read_b32 v250, a50
v_mul_f32 v250, v250, v249
v_accvgpr_write_b32 a50, v250
v_accvgpr_read_b32 v250, a51
v_mul_f32 v250, v250, v249
v_accvgpr_write_b32 a51, v250
v_accvgpr_read_b32 v250, a52
v_mul_f32 v250, v250, v249
v_accvgpr_write_b32 a52, v250
v_accvgpr_read_b32 v250, a53
v_mul_f32 v250, v250, v249
v_accvgpr_write_b32 a53, v250
v_accvgpr_read_b32 v250, a54
v_mul_f32 v250, v250, v249
v_accvgpr_write_b32 a54, v250
v_accvgpr_read_b32 v250, a55
v_mul_f32 v250, v250, v249
v_accvgpr_write_b32 a55, v250
v_accvgpr_read_b32 v250, a56
v_mul_f32 v250, v250, v249
v_accvgpr_write_b32 a56, v250
v_accvgpr_read_b32 v250, a57
v_mul_f32 v250, v250, v249
v_accvgpr_write_b32 a57, v250
v_accvgpr_read_b32 v250, a58
v_mul_f32 v250, v250, v249
v_accvgpr_write_b32 a58, v250
v_accvgpr_read_b32 v250, a59
v_mul_f32 v250, v250, v249
v_accvgpr_write_b32 a59, v250
v_accvgpr_read_b32 v250, a60
v_mul_f32 v250, v250, v249
v_accvgpr_write_b32 a60, v250
v_accvgpr_read_b32 v250, a61
v_mul_f32 v250, v250, v249
v_accvgpr_write_b32 a61, v250
v_accvgpr_read_b32 v250, a62
v_mul_f32 v250, v250, v249
v_accvgpr_write_b32 a62, v250
v_accvgpr_read_b32 v250, a63
v_mul_f32 v250, v250, v249
v_accvgpr_write_b32 a63, v250
v_accvgpr_read_b32 v250, a64
v_mul_f32 v250, v250, v249
v_accvgpr_write_b32 a64, v250
v_accvgpr_read_b32 v250, a65
v_mul_f32 v250, v250, v249
v_accvgpr_write_b32 a65, v250
v_accvgpr_read_b32 v250, a66
v_mul_f32 v250, v250, v249
v_accvgpr_write_b32 a66, v250
v_accvgpr_read_b32 v250, a67
v_mul_f32 v250, v250, v249
v_accvgpr_write_b32 a67, v250
v_accvgpr_read_b32 v250, a68
v_mul_f32 v250, v250, v249
v_accvgpr_write_b32 a68, v250
v_accvgpr_read_b32 v250, a69
v_mul_f32 v250, v250, v249
v_accvgpr_write_b32 a69, v250
v_accvgpr_read_b32 v250, a70
v_mul_f32 v250, v250, v249
v_accvgpr_write_b32 a70, v250
v_accvgpr_read_b32 v250, a71
v_mul_f32 v250, v250, v249
v_accvgpr_write_b32 a71, v250
v_accvgpr_read_b32 v250, a72
v_mul_f32 v250, v250, v249
v_accvgpr_write_b32 a72, v250
v_accvgpr_read_b32 v250, a73
v_mul_f32 v250, v250, v249
v_accvgpr_write_b32 a73, v250
v_accvgpr_read_b32 v250, a74
v_mul_f32 v250, v250, v249
v_accvgpr_write_b32 a74, v250
v_accvgpr_read_b32 v250, a75
v_mul_f32 v250, v250, v249
v_accvgpr_write_b32 a75, v250
v_accvgpr_read_b32 v250, a76
v_mul_f32 v250, v250, v249
v_accvgpr_write_b32 a76, v250
v_accvgpr_read_b32 v250, a77
v_mul_f32 v250, v250, v249
v_accvgpr_write_b32 a77, v250
v_accvgpr_read_b32 v250, a78
v_mul_f32 v250, v250, v249
v_accvgpr_write_b32 a78, v250
v_accvgpr_read_b32 v250, a79
v_mul_f32 v250, v250, v249
v_accvgpr_write_b32 a79, v250
v_accvgpr_read_b32 v250, a80
v_mul_f32 v250, v250, v249
v_accvgpr_write_b32 a80, v250
v_accvgpr_read_b32 v250, a81
v_mul_f32 v250, v250, v249
v_accvgpr_write_b32 a81, v250
v_accvgpr_read_b32 v250, a82
v_mul_f32 v250, v250, v249
v_accvgpr_write_b32 a82, v250
v_accvgpr_read_b32 v250, a83
v_mul_f32 v250, v250, v249
v_accvgpr_write_b32 a83, v250
v_accvgpr_read_b32 v250, a84
v_mul_f32 v250, v250, v249
v_accvgpr_write_b32 a84, v250
v_accvgpr_read_b32 v250, a85
v_mul_f32 v250, v250, v249
v_accvgpr_write_b32 a85, v250
v_accvgpr_read_b32 v250, a86
v_mul_f32 v250, v250, v249
v_accvgpr_write_b32 a86, v250
v_accvgpr_read_b32 v250, a87
v_mul_f32 v250, v250, v249
v_accvgpr_write_b32 a87, v250
v_accvgpr_read_b32 v250, a88
v_mul_f32 v250, v250, v249
v_accvgpr_write_b32 a88, v250
v_accvgpr_read_b32 v250, a89
v_mul_f32 v250, v250, v249
v_accvgpr_write_b32 a89, v250
v_accvgpr_read_b32 v250, a90
v_mul_f32 v250, v250, v249
v_accvgpr_write_b32 a90, v250
v_accvgpr_read_b32 v250, a91
v_mul_f32 v250, v250, v249
v_accvgpr_write_b32 a91, v250
v_accvgpr_read_b32 v250, a92
v_mul_f32 v250, v250, v249
v_accvgpr_write_b32 a92, v250
v_accvgpr_read_b32 v250, a93
v_mul_f32 v250, v250, v249
v_accvgpr_write_b32 a93, v250
v_accvgpr_read_b32 v250, a94
v_mul_f32 v250, v250, v249
v_accvgpr_write_b32 a94, v250
v_accvgpr_read_b32 v250, a95
v_mul_f32 v250, v250, v249
v_accvgpr_write_b32 a95, v250
s_nop 3
s_setpc_b64 s[46:47]
L_FB:
s_nop 15
s_nop 15
v_mov_b32 v250, v249
s_nop 0
s_nop 0
v_permlane32_swap_b32 v249, v250
v_max_f32 v249, v249, v250
v_max_f32 v249, 0, v249
v_sub_f32 v88, v88, v249
v_sub_f32 v89, v89, v249
v_sub_f32 v90, v90, v249
v_sub_f32 v91, v91, v249
v_sub_f32 v92, v92, v249
v_sub_f32 v93, v93, v249
v_sub_f32 v94, v94, v249
v_sub_f32 v95, v95, v249
v_sub_f32 v96, v96, v249
v_sub_f32 v97, v97, v249
v_sub_f32 v98, v98, v249
v_sub_f32 v99, v99, v249
v_sub_f32 v100, v100, v249
v_sub_f32 v101, v101, v249
v_sub_f32 v102, v102, v249
v_sub_f32 v103, v103, v249
v_sub_f32 v108, v108, v249
v_sub_f32 v109, v109, v249
v_sub_f32 v110, v110, v249
v_sub_f32 v111, v111, v249
v_sub_f32 v112, v112, v249
v_sub_f32 v113, v113, v249
v_sub_f32 v114, v114, v249
v_sub_f32 v115, v115, v249
v_sub_f32 v116, v116, v249
v_sub_f32 v117, v117, v249
v_sub_f32 v118, v118, v249
v_sub_f32 v119, v119, v249
v_sub_f32 v120, v120, v249
v_sub_f32 v121, v121, v249
v_sub_f32 v122, v122, v249
v_sub_f32 v123, v123, v249
v_exp_f32 v249, -v249
s_nop 1
v_mul_f32 v246, v246, v249
v_mul_f32 v247, v247, v249
v_accvgpr_read_b32 v250, a0
v_mul_f32 v250, v250, v249
v_accvgpr_write_b32 a0, v250
v_accvgpr_read_b32 v250, a1
v_mul_f32 v250, v250, v249
v_accvgpr_write_b32 a1, v250
v_accvgpr_read_b32 v250, a2
v_mul_f32 v250, v250, v249
v_accvgpr_write_b32 a2, v250
v_accvgpr_read_b32 v250, a3
v_mul_f32 v250, v250, v249
v_accvgpr_write_b32 a3, v250
v_accvgpr_read_b32 v250, a4
v_mul_f32 v250, v250, v249
v_accvgpr_write_b32 a4, v250
v_accvgpr_read_b32 v250, a5
v_mul_f32 v250, v250, v249
v_accvgpr_write_b32 a5, v250
v_accvgpr_read_b32 v250, a6
v_mul_f32 v250, v250, v249
v_accvgpr_write_b32 a6, v250
v_accvgpr_read_b32 v250, a7
v_mul_f32 v250, v250, v249
v_accvgpr_write_b32 a7, v250
v_accvgpr_read_b32 v250, a8
v_mul_f32 v250, v250, v249
v_accvgpr_write_b32 a8, v250
v_accvgpr_read_b32 v250, a9
v_mul_f32 v250, v250, v249
v_accvgpr_write_b32 a9, v250
v_accvgpr_read_b32 v250, a10
v_mul_f32 v250, v250, v249
v_accvgpr_write_b32 a10, v250
v_accvgpr_read_b32 v250, a11
v_mul_f32 v250, v250, v249
v_accvgpr_write_b32 a11, v250
v_accvgpr_read_b32 v250, a12
v_mul_f32 v250, v250, v249
v_accvgpr_write_b32 a12, v250
v_accvgpr_read_b32 v250, a13
v_mul_f32 v250, v250, v249
v_accvgpr_write_b32 a13, v250
v_accvgpr_read_b32 v250, a14
v_mul_f32 v250, v250, v249
v_accvgpr_write_b32 a14, v250
v_accvgpr_read_b32 v250, a15
v_mul_f32 v250, v250, v249
v_accvgpr_write_b32 a15, v250
v_accvgpr_read_b32 v250, a16
v_mul_f32 v250, v250, v249
v_accvgpr_write_b32 a16, v250
v_accvgpr_read_b32 v250, a17
v_mul_f32 v250, v250, v249
v_accvgpr_write_b32 a17, v250
v_accvgpr_read_b32 v250, a18
v_mul_f32 v250, v250, v249
v_accvgpr_write_b32 a18, v250
v_accvgpr_read_b32 v250, a19
v_mul_f32 v250, v250, v249
v_accvgpr_write_b32 a19, v250
v_accvgpr_read_b32 v250, a20
v_mul_f32 v250, v250, v249
v_accvgpr_write_b32 a20, v250
v_accvgpr_read_b32 v250, a21
v_mul_f32 v250, v250, v249
v_accvgpr_write_b32 a21, v250
v_accvgpr_read_b32 v250, a22
v_mul_f32 v250, v250, v249
v_accvgpr_write_b32 a22, v250
v_accvgpr_read_b32 v250, a23
v_mul_f32 v250, v250, v249
v_accvgpr_write_b32 a23, v250
v_accvgpr_read_b32 v250, a24
v_mul_f32 v250, v250, v249
v_accvgpr_write_b32 a24, v250
v_accvgpr_read_b32 v250, a25
v_mul_f32 v250, v250, v249
v_accvgpr_write_b32 a25, v250
v_accvgpr_read_b32 v250, a26
v_mul_f32 v250, v250, v249
v_accvgpr_write_b32 a26, v250
v_accvgpr_read_b32 v250, a27
v_mul_f32 v250, v250, v249
v_accvgpr_write_b32 a27, v250
v_accvgpr_read_b32 v250, a28
v_mul_f32 v250, v250, v249
v_accvgpr_write_b32 a28, v250
v_accvgpr_read_b32 v250, a29
v_mul_f32 v250, v250, v249
v_accvgpr_write_b32 a29, v250
v_accvgpr_read_b32 v250, a30
v_mul_f32 v250, v250, v249
v_accvgpr_write_b32 a30, v250
v_accvgpr_read_b32 v250, a31
v_mul_f32 v250, v250, v249
v_accvgpr_write_b32 a31, v250
v_accvgpr_read_b32 v250, a32
v_mul_f32 v250, v250, v249
v_accvgpr_write_b32 a32, v250
v_accvgpr_read_b32 v250, a33
v_mul_f32 v250, v250, v249
v_accvgpr_write_b32 a33, v250
v_accvgpr_read_b32 v250, a34
v_mul_f32 v250, v250, v249
v_accvgpr_write_b32 a34, v250
v_accvgpr_read_b32 v250, a35
v_mul_f32 v250, v250, v249
v_accvgpr_write_b32 a35, v250
v_accvgpr_read_b32 v250, a36
v_mul_f32 v250, v250, v249
v_accvgpr_write_b32 a36, v250
v_accvgpr_read_b32 v250, a37
v_mul_f32 v250, v250, v249
v_accvgpr_write_b32 a37, v250
v_accvgpr_read_b32 v250, a38
v_mul_f32 v250, v250, v249
v_accvgpr_write_b32 a38, v250
v_accvgpr_read_b32 v250, a39
v_mul_f32 v250, v250, v249
v_accvgpr_write_b32 a39, v250
v_accvgpr_read_b32 v250, a40
v_mul_f32 v250, v250, v249
v_accvgpr_write_b32 a40, v250
v_accvgpr_read_b32 v250, a41
v_mul_f32 v250, v250, v249
v_accvgpr_write_b32 a41, v250
v_accvgpr_read_b32 v250, a42
v_mul_f32 v250, v250, v249
v_accvgpr_write_b32 a42, v250
v_accvgpr_read_b32 v250, a43
v_mul_f32 v250, v250, v249
v_accvgpr_write_b32 a43, v250
v_accvgpr_read_b32 v250, a44
v_mul_f32 v250, v250, v249
v_accvgpr_write_b32 a44, v250
v_accvgpr_read_b32 v250, a45
v_mul_f32 v250, v250, v249
v_accvgpr_write_b32 a45, v250
v_accvgpr_read_b32 v250, a46
v_mul_f32 v250, v250, v249
v_accvgpr_write_b32 a46, v250
v_accvgpr_read_b32 v250, a47
v_mul_f32 v250, v250, v249
v_accvgpr_write_b32 a47, v250
v_accvgpr_read_b32 v250, a48
v_mul_f32 v250, v250, v249
v_accvgpr_write_b32 a48, v250
v_accvgpr_read_b32 v250, a49
v_mul_f32 v250, v250, v249
v_accvgpr_write_b32 a49, v250
v_accvgpr_read_b32 v250, a50
v_mul_f32 v250, v250, v249
v_accvgpr_write_b32 a50, v250
v_accvgpr_read_b32 v250, a51
v_mul_f32 v250, v250, v249
v_accvgpr_write_b32 a51, v250
v_accvgpr_read_b32 v250, a52
v_mul_f32 v250, v250, v249
v_accvgpr_write_b32 a52, v250
v_accvgpr_read_b32 v250, a53
v_mul_f32 v250, v250, v249
v_accvgpr_write_b32 a53, v250
v_accvgpr_read_b32 v250, a54
v_mul_f32 v250, v250, v249
v_accvgpr_write_b32 a54, v250
v_accvgpr_read_b32 v250, a55
v_mul_f32 v250, v250, v249
v_accvgpr_write_b32 a55, v250
v_accvgpr_read_b32 v250, a56
v_mul_f32 v250, v250, v249
v_accvgpr_write_b32 a56, v250
v_accvgpr_read_b32 v250, a57
v_mul_f32 v250, v250, v249
v_accvgpr_write_b32 a57, v250
v_accvgpr_read_b32 v250, a58
v_mul_f32 v250, v250, v249
v_accvgpr_write_b32 a58, v250
v_accvgpr_read_b32 v250, a59
v_mul_f32 v250, v250, v249
v_accvgpr_write_b32 a59, v250
v_accvgpr_read_b32 v250, a60
v_mul_f32 v250, v250, v249
v_accvgpr_write_b32 a60, v250
v_accvgpr_read_b32 v250, a61
v_mul_f32 v250, v250, v249
v_accvgpr_write_b32 a61, v250
v_accvgpr_read_b32 v250, a62
v_mul_f32 v250, v250, v249
v_accvgpr_write_b32 a62, v250
v_accvgpr_read_b32 v250, a63
v_mul_f32 v250, v250, v249
v_accvgpr_write_b32 a63, v250
v_accvgpr_read_b32 v250, a64
v_mul_f32 v250, v250, v249
v_accvgpr_write_b32 a64, v250
v_accvgpr_read_b32 v250, a65
v_mul_f32 v250, v250, v249
v_accvgpr_write_b32 a65, v250
v_accvgpr_read_b32 v250, a66
v_mul_f32 v250, v250, v249
v_accvgpr_write_b32 a66, v250
v_accvgpr_read_b32 v250, a67
v_mul_f32 v250, v250, v249
v_accvgpr_write_b32 a67, v250
v_accvgpr_read_b32 v250, a68
v_mul_f32 v250, v250, v249
v_accvgpr_write_b32 a68, v250
v_accvgpr_read_b32 v250, a69
v_mul_f32 v250, v250, v249
v_accvgpr_write_b32 a69, v250
v_accvgpr_read_b32 v250, a70
v_mul_f32 v250, v250, v249
v_accvgpr_write_b32 a70, v250
v_accvgpr_read_b32 v250, a71
v_mul_f32 v250, v250, v249
v_accvgpr_write_b32 a71, v250
v_accvgpr_read_b32 v250, a72
v_mul_f32 v250, v250, v249
v_accvgpr_write_b32 a72, v250
v_accvgpr_read_b32 v250, a73
v_mul_f32 v250, v250, v249
v_accvgpr_write_b32 a73, v250
v_accvgpr_read_b32 v250, a74
v_mul_f32 v250, v250, v249
v_accvgpr_write_b32 a74, v250
v_accvgpr_read_b32 v250, a75
v_mul_f32 v250, v250, v249
v_accvgpr_write_b32 a75, v250
v_accvgpr_read_b32 v250, a76
v_mul_f32 v250, v250, v249
v_accvgpr_write_b32 a76, v250
v_accvgpr_read_b32 v250, a77
v_mul_f32 v250, v250, v249
v_accvgpr_write_b32 a77, v250
v_accvgpr_read_b32 v250, a78
v_mul_f32 v250, v250, v249
v_accvgpr_write_b32 a78, v250
v_accvgpr_read_b32 v250, a79
v_mul_f32 v250, v250, v249
v_accvgpr_write_b32 a79, v250
v_accvgpr_read_b32 v250, a80
v_mul_f32 v250, v250, v249
v_accvgpr_write_b32 a80, v250
v_accvgpr_read_b32 v250, a81
v_mul_f32 v250, v250, v249
v_accvgpr_write_b32 a81, v250
v_accvgpr_read_b32 v250, a82
v_mul_f32 v250, v250, v249
v_accvgpr_write_b32 a82, v250
v_accvgpr_read_b32 v250, a83
v_mul_f32 v250, v250, v249
v_accvgpr_write_b32 a83, v250
v_accvgpr_read_b32 v250, a84
v_mul_f32 v250, v250, v249
v_accvgpr_write_b32 a84, v250
v_accvgpr_read_b32 v250, a85
v_mul_f32 v250, v250, v249
v_accvgpr_write_b32 a85, v250
v_accvgpr_read_b32 v250, a86
v_mul_f32 v250, v250, v249
v_accvgpr_write_b32 a86, v250
v_accvgpr_read_b32 v250, a87
v_mul_f32 v250, v250, v249
v_accvgpr_write_b32 a87, v250
v_accvgpr_read_b32 v250, a88
v_mul_f32 v250, v250, v249
v_accvgpr_write_b32 a88, v250
v_accvgpr_read_b32 v250, a89
v_mul_f32 v250, v250, v249
v_accvgpr_write_b32 a89, v250
v_accvgpr_read_b32 v250, a90
v_mul_f32 v250, v250, v249
v_accvgpr_write_b32 a90, v250
v_accvgpr_read_b32 v250, a91
v_mul_f32 v250, v250, v249
v_accvgpr_write_b32 a91, v250
v_accvgpr_read_b32 v250, a92
v_mul_f32 v250, v250, v249
v_accvgpr_write_b32 a92, v250
v_accvgpr_read_b32 v250, a93
v_mul_f32 v250, v250, v249
v_accvgpr_write_b32 a93, v250
v_accvgpr_read_b32 v250, a94
v_mul_f32 v250, v250, v249
v_accvgpr_write_b32 a94, v250
v_accvgpr_read_b32 v250, a95
v_mul_f32 v250, v250, v249
v_accvgpr_write_b32 a95, v250
v_lshlrev_b32 v250, 16, v72
v_and_b32 v72, 0xffff0000, v72
v_mul_f32 v250, v250, v249
v_mul_f32 v72, v72, v249
v_cvt_pk_bf16_f32 v72, v250, v72
v_lshlrev_b32 v250, 16, v73
v_and_b32 v73, 0xffff0000, v73
v_mul_f32 v250, v250, v249
v_mul_f32 v73, v73, v249
v_cvt_pk_bf16_f32 v73, v250, v73
v_lshlrev_b32 v250, 16, v74
v_and_b32 v74, 0xffff0000, v74
v_mul_f32 v250, v250, v249
v_mul_f32 v74, v74, v249
v_cvt_pk_bf16_f32 v74, v250, v74
v_lshlrev_b32 v250, 16, v75
v_and_b32 v75, 0xffff0000, v75
v_mul_f32 v250, v250, v249
v_mul_f32 v75, v75, v249
v_cvt_pk_bf16_f32 v75, v250, v75
v_lshlrev_b32 v250, 16, v80
v_and_b32 v80, 0xffff0000, v80
v_mul_f32 v250, v250, v249
v_mul_f32 v80, v80, v249
v_cvt_pk_bf16_f32 v80, v250, v80
v_lshlrev_b32 v250, 16, v81
v_and_b32 v81, 0xffff0000, v81
v_mul_f32 v250, v250, v249
v_mul_f32 v81, v81, v249
v_cvt_pk_bf16_f32 v81, v250, v81
v_lshlrev_b32 v250, 16, v82
v_and_b32 v82, 0xffff0000, v82
v_mul_f32 v250, v250, v249
v_mul_f32 v82, v82, v249
v_cvt_pk_bf16_f32 v82, v250, v82
v_lshlrev_b32 v250, 16, v83
v_and_b32 v83, 0xffff0000, v83
v_mul_f32 v250, v250, v249
v_mul_f32 v83, v83, v249
v_cvt_pk_bf16_f32 v83, v250, v83
s_nop 3
s_setpc_b64 s[46:47]
L_FX:
s_nop 15
s_nop 15
v_mov_b32 v255, v252
s_nop 0
s_nop 0
v_permlane32_swap_b32 v252, v255
v_max_f32 v252, v252, v255
v_mov_b32 v255, v252
s_nop 0
s_nop 0
v_permlane16_swap_b32 v252, v255
v_max_f32 v252, v252, v255
v_max_f32 v252, 0, v252
v_sub_f32 v104, v104, v252
v_sub_f32 v105, v105, v252
v_sub_f32 v106, v106, v252
v_sub_f32 v107, v107, v252
v_sub_f32 v124, v124, v252
v_sub_f32 v125, v125, v252
v_sub_f32 v126, v126, v252
v_sub_f32 v127, v127, v252
v_exp_f32 v252, -v252
s_nop 1
v_mul_f32 v248, v248, v252
v_accvgpr_read_b32 v255, a96
v_mul_f32 v255, v255, v252
v_accvgpr_write_b32 a96, v255
v_accvgpr_read_b32 v255, a97
v_mul_f32 v255, v255, v252
v_accvgpr_write_b32 a97, v255
v_accvgpr_read_b32 v255, a98
v_mul_f32 v255, v255, v252
v_accvgpr_write_b32 a98, v255
v_accvgpr_read_b32 v255, a99
v_mul_f32 v255, v255, v252
v_accvgpr_write_b32 a99, v255
v_accvgpr_read_b32 v255, a100
v_mul_f32 v255, v255, v252
v_accvgpr_write_b32 a100, v255
v_accvgpr_read_b32 v255, a101
v_mul_f32 v255, v255, v252
v_accvgpr_write_b32 a101, v255
v_accvgpr_read_b32 v255, a102
v_mul_f32 v255, v255, v252
v_accvgpr_write_b32 a102, v255
v_accvgpr_read_b32 v255, a103
v_mul_f32 v255, v255, v252
v_accvgpr_write_b32 a103, v255
v_accvgpr_read_b32 v255, a104
v_mul_f32 v255, v255, v252
v_accvgpr_write_b32 a104, v255
v_accvgpr_read_b32 v255, a105
v_mul_f32 v255, v255, v252
v_accvgpr_write_b32 a105, v255
v_accvgpr_read_b32 v255, a106
v_mul_f32 v255, v255, v252
v_accvgpr_write_b32 a106, v255
v_accvgpr_read_b32 v255, a107
v_mul_f32 v255, v255, v252
v_accvgpr_write_b32 a107, v255
v_accvgpr_read_b32 v255, a108
v_mul_f32 v255, v255, v252
v_accvgpr_write_b32 a108, v255
v_accvgpr_read_b32 v255, a109
v_mul_f32 v255, v255, v252
v_accvgpr_write_b32 a109, v255
v_accvgpr_read_b32 v255, a110
v_mul_f32 v255, v255, v252
v_accvgpr_write_b32 a110, v255
v_accvgpr_read_b32 v255, a111
v_mul_f32 v255, v255, v252
v_accvgpr_write_b32 a111, v255
v_accvgpr_read_b32 v255, a112
v_mul_f32 v255, v255, v252
v_accvgpr_write_b32 a112, v255
v_accvgpr_read_b32 v255, a113
v_mul_f32 v255, v255, v252
v_accvgpr_write_b32 a113, v255
v_accvgpr_read_b32 v255, a114
v_mul_f32 v255, v255, v252
v_accvgpr_write_b32 a114, v255
v_accvgpr_read_b32 v255, a115
v_mul_f32 v255, v255, v252
v_accvgpr_write_b32 a115, v255
v_accvgpr_read_b32 v255, a116
v_mul_f32 v255, v255, v252
v_accvgpr_write_b32 a116, v255
v_accvgpr_read_b32 v255, a117
v_mul_f32 v255, v255, v252
v_accvgpr_write_b32 a117, v255
v_accvgpr_read_b32 v255, a118
v_mul_f32 v255, v255, v252
v_accvgpr_write_b32 a118, v255
v_accvgpr_read_b32 v255, a119
v_mul_f32 v255, v255, v252
v_accvgpr_write_b32 a119, v255
v_accvgpr_read_b32 v255, a120
v_mul_f32 v255, v255, v252
v_accvgpr_write_b32 a120, v255
v_accvgpr_read_b32 v255, a121
v_mul_f32 v255, v255, v252
v_accvgpr_write_b32 a121, v255
v_accvgpr_read_b32 v255, a122
v_mul_f32 v255, v255, v252
v_accvgpr_write_b32 a122, v255
v_accvgpr_read_b32 v255, a123
v_mul_f32 v255, v255, v252
v_accvgpr_write_b32 a123, v255
v_accvgpr_read_b32 v255, a124
v_mul_f32 v255, v255, v252
v_accvgpr_write_b32 a124, v255
v_accvgpr_read_b32 v255, a125
v_mul_f32 v255, v255, v252
v_accvgpr_write_b32 a125, v255
v_accvgpr_read_b32 v255, a126
v_mul_f32 v255, v255, v252
v_accvgpr_write_b32 a126, v255
v_accvgpr_read_b32 v255, a127
v_mul_f32 v255, v255, v252
v_accvgpr_write_b32 a127, v255
v_accvgpr_read_b32 v255, a128
v_mul_f32 v255, v255, v252
v_accvgpr_write_b32 a128, v255
v_accvgpr_read_b32 v255, a129
v_mul_f32 v255, v255, v252
v_accvgpr_write_b32 a129, v255
v_accvgpr_read_b32 v255, a130
v_mul_f32 v255, v255, v252
v_accvgpr_write_b32 a130, v255
v_accvgpr_read_b32 v255, a131
v_mul_f32 v255, v255, v252
v_accvgpr_write_b32 a131, v255
v_accvgpr_read_b32 v255, a132
v_mul_f32 v255, v255, v252
v_accvgpr_write_b32 a132, v255
v_accvgpr_read_b32 v255, a133
v_mul_f32 v255, v255, v252
v_accvgpr_write_b32 a133, v255
v_accvgpr_read_b32 v255, a134
v_mul_f32 v255, v255, v252
v_accvgpr_write_b32 a134, v255
v_accvgpr_read_b32 v255, a135
v_mul_f32 v255, v255, v252
v_accvgpr_write_b32 a135, v255
v_accvgpr_read_b32 v255, a136
v_mul_f32 v255, v255, v252
v_accvgpr_write_b32 a136, v255
v_accvgpr_read_b32 v255, a137
v_mul_f32 v255, v255, v252
v_accvgpr_write_b32 a137, v255
v_accvgpr_read_b32 v255, a138
v_mul_f32 v255, v255, v252
v_accvgpr_write_b32 a138, v255
v_accvgpr_read_b32 v255, a139
v_mul_f32 v255, v255, v252
v_accvgpr_write_b32 a139, v255
v_accvgpr_read_b32 v255, a140
v_mul_f32 v255, v255, v252
v_accvgpr_write_b32 a140, v255
v_accvgpr_read_b32 v255, a141
v_mul_f32 v255, v255, v252
v_accvgpr_write_b32 a141, v255
v_accvgpr_read_b32 v255, a142
v_mul_f32 v255, v255, v252
v_accvgpr_write_b32 a142, v255
v_accvgpr_read_b32 v255, a143
v_mul_f32 v255, v255, v252
v_accvgpr_write_b32 a143, v255
s_nop 3
s_setpc_b64 s[46:47]
L_sp0:
buffer_load_dword v253, off, s[28:31], 0 sc1
s_waitcnt vmcnt(0)
v_readfirstlane_b32 s40, v253
s_nop 0
s_bfe_u32 s40, s40, 0x100000
s_cmp_lt_u32 s40, s57
s_cbranch_scc1 L_sp0
s_branch L_pr0
L_sp1:
buffer_load_dword v253, off, s[28:31], 0 sc1
s_waitcnt vmcnt(0)
v_readfirstlane_b32 s40, v253
s_nop 0
s_bfe_u32 s40, s40, 0x100010
s_cmp_lt_u32 s40, s57
s_cbranch_scc1 L_sp1
s_branch L_pr1
L_last:
.globl reduce_kernel
.p2align 8
.type reduce_kernel,@function
reduce_kernel:
s_cmp_ge_u32 s2, 0x100
s_cbranch_scc1 L_end2
s_load_dwordx2 s[4:5], s[0:1], 96
s_load_dwordx2 s[8:9], s[0:1], 80
v_lshrrev_b32 v1, 6, v0
v_and_b32 v0, 63, v0
s_lshr_b32 s13, s2, 2
s_and_b32 s14, s2, 3
v_readfirstlane_b32 s12, v1
s_mul_i32 s15, s13, 46080
s_add_u32 s15, s15, 0x2000000
s_mul_i32 s16, s14, 10240
s_lshl_b32 s17, s12, 11
s_add_u32 s16, s16, s17
s_add_u32 s16, s16, s15
v_lshlrev_b32 v2, 4, v0
s_mov_b32 s6, 0x10000000
s_mov_b32 s7, 0x20000
s_mov_b32 s10, 2949120
s_mov_b32 s11, 0x20000
s_waitcnt lgkmcnt(0)
buffer_load_dwordx4 v[8:11], v2, s[4:7], s16 offen
buffer_load_dwordx4 v[12:15], v2, s[4:7], s16 offen offset:1024
s_add_u32 s16, s16, 2949120
buffer_load_dwordx4 v[16:19], v2, s[4:7], s16 offen
buffer_load_dwordx4 v[20:23], v2, s[4:7], s16 offen offset:1024
s_add_u32 s16, s16, 2949120
buffer_load_dwordx4 v[24:27], v2, s[4:7], s16 offen
buffer_load_dwordx4 v[28:31], v2, s[4:7], s16 offen offset:1024
s_add_u32 s16, s16, 2949120
buffer_load_dwordx4 v[32:35], v2, s[4:7], s16 offen
buffer_load_dwordx4 v[36:39], v2, s[4:7], s16 offen offset:1024
s_add_u32 s16, s16, 2949120
s_and_b32 s18, s14, 1
s_mul_i32 s18, s18, 5
s_add_u32 s18, s18, s12
s_lshl_b32 s19, s18, 9
s_add_u32 s19, s19, s15
s_add_u32 s19, s19, 40960
v_lshlrev_b32 v3, 3, v0
buffer_load_dwordx2 v[40:41], v3, s[4:7], s19 offen
s_add_u32 s19, s19, 2949120
buffer_load_dwordx2 v[42:43], v3, s[4:7], s19 offen
s_add_u32 s19, s19, 2949120
buffer_load_dwordx2 v[44:45], v3, s[4:7], s19 offen
s_add_u32 s19, s19, 2949120
buffer_load_dwordx2 v[46:47], v3, s[4:7], s19 offen
s_add_u32 s19, s19, 2949120
s_bfe_u32 s20, s13, 0x30002
s_mul_i32 s20, s20, 368640
s_lshr_b32 s21, s13, 5
s_mul_i32 s21, s21, 1280
s_add_u32 s20, s20, s21
s_and_b32 s21, s13, 3
s_mul_i32 s21, s21, 320
s_add_u32 s20, s20, s21
s_mul_i32 s21, s14, 81920
s_add_u32 s21, s21, s20
s_lshl_b32 s22, s12, 6
s_add_u32 s21, s21, s22
v_and_b32 v4, 31, v0
v_mul_u32_u24 v4, 0xa00, v4
v_lshrrev_b32 v5, 5, v0
v_lshl_add_u32 v4, v5, 4, v4
s_lshl_b32 s22, s18, 5
s_add_u32 s22, s22, s20
s_add_u32 s22, s22, 327680
v_and_b32 v5, 15, v0
v_mul_u32_u24 v5, 0xa00, v5
v_lshrrev_b32 v6, 4, v0
v_lshl_add_u32 v5, v6, 3, v5
s_waitcnt vmcnt(11)
v_lshlrev_b32 v6, 16, v8
v_and_b32 v7, 0xffff0000, v8
s_waitcnt vmcnt(9)
v_lshlrev_b32 v1, 16, v16
v_and_b32 v16, 0xffff0000, v16
v_add_f32 v6, v6, v1
v_add_f32 v7, v7, v16
s_waitcnt vmcnt(7)
v_lshlrev_b32 v1, 16, v24
v_and_b32 v24, 0xffff0000, v24
v_add_f32 v6, v6, v1
v_add_f32 v7, v7, v24
s_waitcnt vmcnt(5)
v_lshlrev_b32 v1, 16, v32
v_and_b32 v32, 0xffff0000, v32
v_add_f32 v6, v6, v1
v_add_f32 v7, v7, v32
v_cvt_pk_bf16_f32 v8, v6, v7
v_lshlrev_b32 v6, 16, v9
v_and_b32 v7, 0xffff0000, v9
v_lshlrev_b32 v1, 16, v17
v_and_b32 v17, 0xffff0000, v17
v_add_f32 v6, v6, v1
v_add_f32 v7, v7, v17
v_lshlrev_b32 v1, 16, v25
v_and_b32 v25, 0xffff0000, v25
v_add_f32 v6, v6, v1
v_add_f32 v7, v7, v25
v_lshlrev_b32 v1, 16, v33
v_and_b32 v33, 0xffff0000, v33
v_add_f32 v6, v6, v1
v_add_f32 v7, v7, v33
v_cvt_pk_bf16_f32 v9, v6, v7
v_lshlrev_b32 v6, 16, v10
v_and_b32 v7, 0xffff0000, v10
v_lshlrev_b32 v1, 16, v18
v_and_b32 v18, 0xffff0000, v18
v_add_f32 v6, v6, v1
v_add_f32 v7, v7, v18
v_lshlrev_b32 v1, 16, v26
v_and_b32 v26, 0xffff0000, v26
v_add_f32 v6, v6, v1
v_add_f32 v7, v7, v26
v_lshlrev_b32 v1, 16, v34
v_and_b32 v34, 0xffff0000, v34
v_add_f32 v6, v6, v1
v_add_f32 v7, v7, v34
v_cvt_pk_bf16_f32 v10, v6, v7
v_lshlrev_b32 v6, 16, v11
v_and_b32 v7, 0xffff0000, v11
v_lshlrev_b32 v1, 16, v19
v_and_b32 v19, 0xffff0000, v19
v_add_f32 v6, v6, v1
v_add_f32 v7, v7, v19
v_lshlrev_b32 v1, 16, v27
v_and_b32 v27, 0xffff0000, v27
v_add_f32 v6, v6, v1
v_add_f32 v7, v7, v27
v_lshlrev_b32 v1, 16, v35
v_and_b32 v35, 0xffff0000, v35
v_add_f32 v6, v6, v1
v_add_f32 v7, v7, v35
v_cvt_pk_bf16_f32 v11, v6, v7
buffer_store_dwordx4 v[8:11], v4, s[8:11], s21 offen offset:0
v_lshlrev_b32 v6, 16, v12
v_and_b32 v7, 0xffff0000, v12
v_lshlrev_b32 v1, 16, v20
v_and_b32 v20, 0xffff0000, v20
v_add_f32 v6, v6, v1
v_add_f32 v7, v7, v20
v_lshlrev_b32 v1, 16, v28
v_and_b32 v28, 0xffff0000, v28
v_add_f32 v6, v6, v1
v_add_f32 v7, v7, v28
s_waitcnt vmcnt(5)
v_lshlrev_b32 v1, 16, v36
v_and_b32 v36, 0xffff0000, v36
v_add_f32 v6, v6, v1
v_add_f32 v7, v7, v36
v_cvt_pk_bf16_f32 v12, v6, v7
v_lshlrev_b32 v6, 16, v13
v_and_b32 v7, 0xffff0000, v13
v_lshlrev_b32 v1, 16, v21
v_and_b32 v21, 0xffff0000, v21
v_add_f32 v6, v6, v1
v_add_f32 v7, v7, v21
v_lshlrev_b32 v1, 16, v29
v_and_b32 v29, 0xffff0000, v29
v_add_f32 v6, v6, v1
v_add_f32 v7, v7, v29
v_lshlrev_b32 v1, 16, v37
v_and_b32 v37, 0xffff0000, v37
v_add_f32 v6, v6, v1
v_add_f32 v7, v7, v37
v_cvt_pk_bf16_f32 v13, v6, v7
v_lshlrev_b32 v6, 16, v14
v_and_b32 v7, 0xffff0000, v14
v_lshlrev_b32 v1, 16, v22
v_and_b32 v22, 0xffff0000, v22
v_add_f32 v6, v6, v1
v_add_f32 v7, v7, v22
v_lshlrev_b32 v1, 16, v30
v_and_b32 v30, 0xffff0000, v30
v_add_f32 v6, v6, v1
v_add_f32 v7, v7, v30
v_lshlrev_b32 v1, 16, v38
v_and_b32 v38, 0xffff0000, v38
v_add_f32 v6, v6, v1
v_add_f32 v7, v7, v38
v_cvt_pk_bf16_f32 v14, v6, v7
v_lshlrev_b32 v6, 16, v15
v_and_b32 v7, 0xffff0000, v15
v_lshlrev_b32 v1, 16, v23
v_and_b32 v23, 0xffff0000, v23
v_add_f32 v6, v6, v1
v_add_f32 v7, v7, v23
v_lshlrev_b32 v1, 16, v31
v_and_b32 v31, 0xffff0000, v31
v_add_f32 v6, v6, v1
v_add_f32 v7, v7, v31
v_lshlrev_b32 v1, 16, v39
v_and_b32 v39, 0xffff0000, v39
v_add_f32 v6, v6, v1
v_add_f32 v7, v7, v39
v_cvt_pk_bf16_f32 v15, v6, v7
buffer_store_dwordx4 v[12:15], v4, s[8:11], s21 offen offset:32
s_cmp_ge_u32 s14, 2
s_cbranch_scc1 L_end2
s_waitcnt vmcnt(5)
v_lshlrev_b32 v6, 16, v40
v_and_b32 v7, 0xffff0000, v40
s_waitcnt vmcnt(4)
v_lshlrev_b32 v1, 16, v42
v_and_b32 v42, 0xffff0000, v42
v_add_f32 v6, v6, v1
v_add_f32 v7, v7, v42
s_waitcnt vmcnt(3)
v_lshlrev_b32 v1, 16, v44
v_and_b32 v44, 0xffff0000, v44
v_add_f32 v6, v6, v1
v_add_f32 v7, v7, v44
s_waitcnt vmcnt(2)
v_lshlrev_b32 v1, 16, v46
v_and_b32 v46, 0xffff0000, v46
v_add_f32 v6, v6, v1
v_add_f32 v7, v7, v46
v_cvt_pk_bf16_f32 v40, v6, v7
v_lshlrev_b32 v6, 16, v41
v_and_b32 v7, 0xffff0000, v41
v_lshlrev_b32 v1, 16, v43
v_and_b32 v43, 0xffff0000, v43
v_add_f32 v6, v6, v1
v_add_f32 v7, v7, v43
v_lshlrev_b32 v1, 16, v45
v_and_b32 v45, 0xffff0000, v45
v_add_f32 v6, v6, v1
v_add_f32 v7, v7, v45
v_lshlrev_b32 v1, 16, v47
v_and_b32 v47, 0xffff0000, v47
v_add_f32 v6, v6, v1
v_add_f32 v7, v7, v47
v_cvt_pk_bf16_f32 v41, v6, v7
buffer_store_dwordx2 v[40:41], v5, s[8:11], s22 offen
L_end2:
s_endpgm
.section .rodata,"a"
.p2align 6
.amdhsa_kernel concat_heads__gqa_block_cached__gqa_block_cached__near_ridge_kernel
  .amdhsa_next_free_vgpr 512
  .amdhsa_next_free_sgpr 102
  .amdhsa_accum_offset 256
  .amdhsa_group_segment_fixed_size 0
  .amdhsa_kernarg_size 104
  .amdhsa_user_sgpr_count 2
  .amdhsa_user_sgpr_kernarg_segment_ptr 1
  .amdhsa_system_sgpr_workgroup_id_x 1
.end_amdhsa_kernel
.p2align 6
.amdhsa_kernel reduce_kernel
  .amdhsa_next_free_vgpr 48
  .amdhsa_next_free_sgpr 102
  .amdhsa_accum_offset 48
  .amdhsa_group_segment_fixed_size 0
  .amdhsa_kernarg_size 104
  .amdhsa_user_sgpr_count 2
  .amdhsa_user_sgpr_kernarg_segment_ptr 1
  .amdhsa_system_sgpr_workgroup_id_x 1
.end_amdhsa_kernel
```
